```python
import torch

def _softmax(x, axis=-1):
    return torch.softmax(x, dim=axis)
def _gelu(x):
    return torch.nn.functional.gelu(x, approximate="tanh")
def _silu(x):
    return torch.nn.functional.silu(x)
def _sigmoid(x):
    return torch.sigmoid(x)
def _layernorm(x, axis=-1, eps=1e-5):
    m = x.mean(dim=axis, keepdim=True)
    v = x.var(dim=axis, keepdim=True, unbiased=False)
    return (x - m) / torch.sqrt(v + eps)
def _scatter_add(tgt, idx, src, axis=0):
    return tgt.clone().index_add_(axis, idx, src)
def _segment_sum(src, seg, n):
    out = torch.zeros((n,) + src.shape[1:], dtype=src.dtype)
    return out.index_add_(0, seg, src)
def _pad(x, pw):
    flat = tuple(v for pair in reversed(pw) for v in pair)
    return torch.nn.functional.pad(x, flat)

kernel_name = 'standalone__gqa_softmax__near_ridge'

def setup_inputs():

    _w = (lambda a: (lambda t: t.to(torch.bfloat16) if t.is_floating_point() else t)(torch.as_tensor(a)))
    B, Hq, Hkv, Sq, Sk, D = 32, 32, 4, 192, 512, 128
    return {
        "q": _w((lambda *s: torch.randn(*s, dtype=torch.bfloat16) * 0.8)(B, Hq, Sq, D)),
        "k": _w((lambda *s: torch.randn(*s, dtype=torch.bfloat16) * 0.8)(B, Hkv, Sk, D)),
        "v": _w((lambda *s: torch.randn(*s, dtype=torch.bfloat16) * 0.05)(B, Hkv, Sk, D)),
    }

def reference(q, k, v):
    B, Hq, Sq, D = q.shape
    Hkv = k.shape[1]
    rep = Hq // Hkv
    k = (lambda x, n, axis: torch.repeat_interleave(x, n, dim=axis))(k, rep, axis=1)
    v = (lambda x, n, axis: torch.repeat_interleave(x, n, dim=axis))(v, rep, axis=1)
    scale = D ** -0.5
    scores = torch.einsum("bhqd,bhkd->bhqk", q, k) * scale
    p = _softmax(scores, axis=-1)
    return torch.einsum("bhqk,bhkd->bhqd", p, v)
```

```asm
; @launch grid=(256,1,1) block=(256,1,1) lds=163840
.amdgcn_target "amdgcn-amd-amdhsa--gfx950"
.text
.globl standalone__gqa_softmax__near_ridge_kernel
.p2align 12
.p2align 8
.type standalone__gqa_softmax__near_ridge_kernel,@function
standalone__gqa_softmax__near_ridge_kernel:
    s_load_dwordx8 s[36:43], s[0:1], 0
    s_cmp_ge_u32 s2, 256
    s_cbranch_scc1 Lend
    v_lshrrev_b32 v98, 6, v0
    v_and_b32 v96, 15, v0
    v_bfe_u32 v97, v0, 4, 2
    v_readfirstlane_b32 s33, v98
    s_and_b32 s3, s2, 7
    s_mul_i32 s3, s3, 96
    s_lshr_b32 s4, s2, 3
    s_getpc_b64 s[98:99]
Lpf:
    v_lshl_add_u32 v104, s4, 8, v0
    v_mul_u32_u24 v104, 12, v104
    v_min_u32 v104, Lfb-Lpf-8, v104
    v_mov_b32 v105, s99
    v_add_co_u32 v104, vcc, s98, v104
    s_add_u32 s3, s3, s4
    s_lshl_b32 s5, s3, 16
    v_addc_co_u32 v105, vcc, 0, v105, vcc
    global_load_dword v106, v[104:105], off
    s_mul_i32 s6, s3, 43691
    s_lshr_b32 s6, s6, 18
    s_lshl_b32 s6, s6, 17
    v_lshrrev_b32 v101, 4, v0
    v_lshlrev_b32 v99, 8, v96
    v_lshlrev_b32 v100, 8, v97
    s_lshl_b32 s26, s33, 10
    s_lshl_b32 s7, s33, 14
    v_xor_b32 v101, v101, v96
    v_lshl_add_u32 v16, v97, 4, v99
    v_lshl_add_u32 v17, v101, 4, v100
    v_add_u32 v16, s7, v16
    v_xor_b32 v102, v97, v96
    v_lshl_add_u32 v102, v102, 4, v100
    v_add_u32 v240, s7, v102
    v_xor_b32 v241, 64, v240
    v_xor_b32 v242, 0x80, v240
    v_xor_b32 v243, 0xc0, v240
    s_lshl_b32 s27, s33, 12
    s_mov_b32 s10, 0x10000
    s_mov_b32 s11, 0x20000
    s_mov_b32 s14, 0x20000
    s_mov_b32 s15, 0x20000
    s_waitcnt lgkmcnt(0)
    s_add_u32 s12, s38, s6
    s_addc_u32 s13, s39, 0
    s_add_u32 s8, s36, s5
    s_addc_u32 s9, s37, 0
    s_mov_b32 s30, 0
    s_add_u32 m0, s27, 32768
    s_nop 0
    buffer_load_dwordx4 v240, s[8:11], s30 offen nt lds
    buffer_load_dwordx4 v241, s[8:11], s30 offen offset:1024 nt lds
    buffer_load_dwordx4 v242, s[8:11], s30 offen offset:2048 nt lds
    buffer_load_dwordx4 v243, s[8:11], s30 offen offset:3072 nt lds
    s_add_u32 m0, s26, 0
    s_nop 0
    buffer_load_dwordx4 v17, s[12:15], m0 offen nt lds
    s_add_u32 m0, s26, 4096
    s_nop 0
    buffer_load_dwordx4 v17, s[12:15], m0 offen nt lds
    s_add_u32 m0, s26, 8192
    s_nop 0
    buffer_load_dwordx4 v17, s[12:15], m0 offen nt lds
    s_add_u32 m0, s26, 12288
    s_nop 0
    buffer_load_dwordx4 v17, s[12:15], m0 offen nt lds
    s_add_u32 s61, s27, 32768
    s_mov_b32 s24, 0x3e0293ee
    s_mov_b32 s34, s24
    s_mov_b32 s35, s24
    s_mov_b32 s25, 0xffff0000
    s_mov_b32 s28, 0x2b800000
    s_mov_b32 s32, 0x34000000
    v_lshlrev_b32 v101, 2, v97
    v_xor_b32 v101, v101, v96
    v_lshl_add_u32 v18, v101, 4, v100
    s_mov_b32 s18, 0x20000
    s_mov_b32 s19, 0x20000
    s_mov_b32 s22, 0x10000
    s_mov_b32 s23, 0x20000
    s_add_u32 s16, s40, s6
    s_addc_u32 s17, s41, 0
    s_add_u32 s20, s42, s5
    s_addc_u32 s21, s43, 0
    s_add_u32 s3, s3, s4
    s_add_u32 s3, s3, 32
    s_lshl_b32 s5, s3, 16
    s_mul_i32 s6, s3, 43691
    s_lshr_b32 s6, s6, 18
    s_lshl_b32 s6, s6, 17
    s_add_u32 s44, s36, s5
    s_addc_u32 s45, s37, 0
    s_mov_b32 s46, 0x20000
    s_mov_b32 s47, 0x20000
    s_add_u32 s48, s38, s6
    s_addc_u32 s49, s39, 0
    s_mov_b32 s50, 0x20000
    s_mov_b32 s51, 0x20000
    s_add_u32 s52, s40, s6
    s_addc_u32 s53, s41, 0
    s_mov_b32 s54, 0x20000
    s_mov_b32 s55, 0x20000
    s_add_u32 s56, s42, s5
    s_addc_u32 s57, s43, 0
    s_mov_b32 s58, 0x20000
    s_mov_b32 s59, 0x20000
    v_add_u32 v101, 0, v97
    v_xor_b32 v101, v101, v96
    v_lshl_add_u32 v4, v101, 4, v99
    v_add_u32 v8, 0x10000, v4
    v_add_u32 v244, s61, v4
    v_add_u32 v101, 4, v97
    v_xor_b32 v101, v101, v96
    v_lshl_add_u32 v5, v101, 4, v99
    v_add_u32 v9, 0x10000, v5
    v_add_u32 v245, s61, v5
    v_add_u32 v101, 8, v97
    v_xor_b32 v101, v101, v96
    v_lshl_add_u32 v6, v101, 4, v99
    v_add_u32 v10, 0x10000, v6
    v_add_u32 v246, s61, v6
    v_add_u32 v101, 12, v97
    v_xor_b32 v101, v101, v96
    v_lshl_add_u32 v7, v101, 4, v99
    v_add_u32 v11, 0x10000, v7
    v_add_u32 v247, s61, v7
    v_lshrrev_b32 v102, 2, v96
    v_lshl_add_u32 v101, v97, 2, v102
    v_lshlrev_b32 v101, 8, v101
    v_and_b32 v103, 3, v96
    v_lshl_add_u32 v101, v103, 4, v101
    v_add_u32 v101, 0x18000, v101
    v_xor_b32 v103, 0, v102
    v_lshl_add_u32 v12, v103, 6, v101
    v_xor_b32 v103, 1, v102
    v_lshl_add_u32 v13, v103, 6, v101
    v_xor_b32 v103, 2, v102
    v_lshl_add_u32 v14, v103, 6, v101
    v_xor_b32 v103, 3, v102
    v_lshl_add_u32 v15, v103, 6, v101
    v_and_b32 v101, 2, v96
    v_cmp_eq_u32 vcc, 0, v101
    v_mov_b32 v103, 0x3f803f80
    v_and_b32 v101, 1, v96
    v_cndmask_b32 v102, 0, v103, vcc
    v_cmp_eq_u32 vcc, 1, v101
    v_xor_b32 v103, v102, v103
    v_accvgpr_write_b32 a120, v102
    v_accvgpr_write_b32 a121, v102
    v_accvgpr_write_b32 a122, v102
    v_accvgpr_write_b32 a123, v102
    v_accvgpr_write_b32 a124, v103
    v_accvgpr_write_b32 a125, v103
    v_accvgpr_write_b32 a126, v103
    v_accvgpr_write_b32 a127, v103
    v_mov_b32 v102, 0x4444
    v_mov_b32 v103, 0xeeee
    v_cndmask_b32 v22, v102, v103, vcc
    v_mov_b32 v19, 0
    v_mov_b32 v24, 0
    v_mov_b32 v25, 0
    v_mov_b32 v26, 0
    v_mov_b32 v27, 0
    v_mov_b32 v28, 0
    v_mov_b32 v29, 0
    v_mov_b32 v30, 0
    v_mov_b32 v31, 0
    v_and_b32 v101, 7, v96
    v_lshlrev_b32 v101, 8, v101
    v_lshrrev_b32 v102, 3, v96
    v_lshl_add_u32 v101, v102, 6, v101
    v_lshl_add_u32 v101, v97, 4, v101
    v_add_u32 v23, s7, v101
    s_mov_b32 vcc_lo, 0x00ff00ff
    s_mov_b32 vcc_hi, 0x00ff00ff
    s_mov_b32 s30, 4096
    s_add_u32 m0, s27, 49152
    s_nop 0
    buffer_load_dwordx4 v240, s[8:11], s30 offen nt lds
    buffer_load_dwordx4 v241, s[8:11], s30 offen offset:1024 nt lds
    buffer_load_dwordx4 v242, s[8:11], s30 offen offset:2048 nt lds
    buffer_load_dwordx4 v243, s[8:11], s30 offen offset:3072 nt lds
    s_mov_b64 exec, 0
    s_cmp_eq_u32 s33, 0
    s_cbranch_scc1 Lpad0
    s_cmp_eq_u32 s33, 1
    s_cbranch_scc1 Lpad1
    s_cmp_eq_u32 s33, 2
    s_cbranch_scc1 Lpad2
    s_branch Lpad3
Lret0:
    s_mov_b64 exec, -1
    s_mov_b64 exec, 0
    s_cmp_eq_u32 s33, 0
    s_cbranch_scc1 Lpad8
    s_cmp_eq_u32 s33, 1
    s_cbranch_scc1 Lpad9
    s_cmp_eq_u32 s33, 2
    s_cbranch_scc1 Lpad10
    s_branch Lpad11
Lret1:
    s_mov_b64 exec, -1
    s_waitcnt vmcnt(8)
    ds_read_b128 v[64:67], v244 offset:0
    ds_read_b128 v[68:71], v245 offset:0
    ds_read_b128 v[72:75], v246 offset:0
    ds_read_b128 v[76:79], v247 offset:0
    s_add_u32 s29, s27, 0
    s_add_u32 m0, s27, 98304
    s_nop 0
    buffer_load_dwordx4 v18, s[16:19], s29 offen lds
    buffer_load_dwordx4 v18, s[16:19], s29 offen offset:1024 lds
    buffer_load_dwordx4 v18, s[16:19], s29 offen offset:2048 lds
    buffer_load_dwordx4 v18, s[16:19], s29 offen offset:3072 lds
    s_waitcnt lgkmcnt(3)
    v_lshlrev_b32 v224, 16, v64
    v_lshlrev_b32 v226, 16, v65
    v_lshlrev_b32 v228, 16, v66
    v_lshlrev_b32 v230, 16, v67
    v_and_b32 v225, s25, v64
    v_and_b32 v227, s25, v65
    v_and_b32 v229, s25, v66
    v_and_b32 v231, s25, v67
    v_pk_mul_f32 v[224:225], v[224:225], s[34:35]
    v_pk_mul_f32 v[226:227], v[226:227], s[34:35]
    v_pk_mul_f32 v[228:229], v[228:229], s[34:35]
    v_pk_mul_f32 v[230:231], v[230:231], s[34:35]
    v_cvt_pk_bf16_f32 v64, v224, v225
    v_cvt_pk_bf16_f32 v65, v226, v227
    v_cvt_pk_bf16_f32 v66, v228, v229
    v_cvt_pk_bf16_f32 v67, v230, v231
    s_waitcnt lgkmcnt(0)
    v_lshlrev_b32 v232, 16, v68
    v_lshlrev_b32 v234, 16, v69
    v_lshlrev_b32 v236, 16, v70
    v_lshlrev_b32 v238, 16, v71
    v_and_b32 v233, s25, v68
    v_and_b32 v235, s25, v69
    v_and_b32 v237, s25, v70
    v_and_b32 v239, s25, v71
    v_pk_mul_f32 v[232:233], v[232:233], s[34:35]
    v_pk_mul_f32 v[234:235], v[234:235], s[34:35]
    v_pk_mul_f32 v[236:237], v[236:237], s[34:35]
    v_pk_mul_f32 v[238:239], v[238:239], s[34:35]
    v_cvt_pk_bf16_f32 v68, v232, v233
    v_cvt_pk_bf16_f32 v69, v234, v235
    v_cvt_pk_bf16_f32 v70, v236, v237
    v_cvt_pk_bf16_f32 v71, v238, v239
    s_waitcnt vmcnt(8)
    s_barrier
    ds_read_b128 a[128:131], v4 offset:0
    ds_read_b128 a[132:135], v5 offset:0
    ds_read_b128 a[136:139], v6 offset:0
    ds_read_b128 a[140:143], v7 offset:0
    ds_read_b128 a[144:147], v7 offset:4096
    ds_read_b128 a[148:151], v6 offset:4096
    ds_read_b128 a[152:155], v5 offset:4096
    ds_read_b128 a[156:159], v4 offset:4096
    ds_read_b128 a[160:163], v4 offset:8192
    ds_read_b128 a[164:167], v5 offset:8192
    ds_read_b128 a[168:171], v6 offset:8192
    ds_read_b128 a[172:175], v7 offset:8192
    ds_read_b128 a[176:179], v7 offset:12288
    ds_read_b128 a[180:183], v6 offset:12288
    ds_read_b128 a[184:187], v5 offset:12288
    ds_read_b128 a[188:191], v4 offset:12288
    s_add_u32 m0, s26, 16384
    s_nop 0
    buffer_load_dwordx4 v17, s[12:15], m0 offen nt lds
    s_add_u32 m0, s26, 20480
    s_nop 0
    buffer_load_dwordx4 v17, s[12:15], m0 offen nt lds
    s_add_u32 m0, s26, 24576
    s_nop 0
    buffer_load_dwordx4 v17, s[12:15], m0 offen nt lds
    s_add_u32 m0, s26, 28672
    s_nop 0
    buffer_load_dwordx4 v17, s[12:15], m0 offen nt lds
    v_lshlrev_b32 v224, 16, v72
    v_lshlrev_b32 v226, 16, v73
    v_lshlrev_b32 v228, 16, v74
    v_lshlrev_b32 v230, 16, v75
    v_and_b32 v225, s25, v72
    v_and_b32 v227, s25, v73
    v_and_b32 v229, s25, v74
    v_and_b32 v231, s25, v75
    v_pk_mul_f32 v[224:225], v[224:225], s[34:35]
    v_pk_mul_f32 v[226:227], v[226:227], s[34:35]
    v_pk_mul_f32 v[228:229], v[228:229], s[34:35]
    v_pk_mul_f32 v[230:231], v[230:231], s[34:35]
    v_cvt_pk_bf16_f32 v72, v224, v225
    v_cvt_pk_bf16_f32 v73, v226, v227
    v_cvt_pk_bf16_f32 v74, v228, v229
    v_cvt_pk_bf16_f32 v75, v230, v231
    v_lshlrev_b32 v232, 16, v76
    v_lshlrev_b32 v234, 16, v77
    v_lshlrev_b32 v236, 16, v78
    v_lshlrev_b32 v238, 16, v79
    v_and_b32 v233, s25, v76
    v_and_b32 v235, s25, v77
    v_and_b32 v237, s25, v78
    v_and_b32 v239, s25, v79
    v_pk_mul_f32 v[232:233], v[232:233], s[34:35]
    v_pk_mul_f32 v[234:235], v[234:235], s[34:35]
    v_pk_mul_f32 v[236:237], v[236:237], s[34:35]
    v_pk_mul_f32 v[238:239], v[238:239], s[34:35]
    v_cvt_pk_bf16_f32 v76, v232, v233
    v_cvt_pk_bf16_f32 v77, v234, v235
    v_cvt_pk_bf16_f32 v78, v236, v237
    v_cvt_pk_bf16_f32 v79, v238, v239
    s_waitcnt lgkmcnt(0)
    v_mfma_f32_16x16x32_bf16 v[96:99], a[128:131], v[64:67], 0
    v_mfma_f32_16x16x32_bf16 v[96:99], a[132:135], v[68:71], v[96:99]
    v_mfma_f32_16x16x32_bf16 v[96:99], a[136:139], v[72:75], v[96:99]
    v_mfma_f32_16x16x32_bf16 v[96:99], a[140:143], v[76:79], v[96:99]
    v_mfma_f32_16x16x32_bf16 v[100:103], a[144:147], v[76:79], 0
    v_mfma_f32_16x16x32_bf16 v[100:103], a[148:151], v[72:75], v[100:103]
    v_mfma_f32_16x16x32_bf16 v[100:103], a[152:155], v[68:71], v[100:103]
    v_mfma_f32_16x16x32_bf16 v[100:103], a[156:159], v[64:67], v[100:103]
    v_mfma_f32_16x16x32_bf16 v[104:107], a[160:163], v[64:67], 0
    s_waitcnt vmcnt(8)
    ds_read_b128 v[80:83], v244 offset:16384
    ds_read_b128 v[84:87], v245 offset:16384
    v_mfma_f32_16x16x32_bf16 v[104:107], a[164:167], v[68:71], v[104:107]
    ds_read_b128 v[88:91], v246 offset:16384
    ds_read_b128 v[92:95], v247 offset:16384
    v_mfma_f32_16x16x32_bf16 v[104:107], a[168:171], v[72:75], v[104:107]
    v_exp_f32 v96, v96
    v_mfma_f32_16x16x32_bf16 v[104:107], a[172:175], v[76:79], v[104:107]
    v_mfma_f32_16x16x32_bf16 v[108:111], a[176:179], v[76:79], 0
    v_exp_f32 v97, v97
    v_mfma_f32_16x16x32_bf16 v[108:111], a[180:183], v[72:75], v[108:111]
    s_add_u32 s29, s27, 16384
    v_cvt_pk_bf16_f32 v96, v96, v97
    v_mfma_f32_16x16x32_bf16 v[108:111], a[184:187], v[68:71], v[108:111]
    s_add_u32 m0, s27, 114688
    v_exp_f32 v98, v98
    v_mfma_f32_16x16x32_bf16 v[108:111], a[188:191], v[64:67], v[108:111]
    s_waitcnt lgkmcnt(3)
    buffer_load_dwordx4 v18, s[16:19], s29 offen lds
    v_exp_f32 v99, v99
    s_nop 0
    v_cvt_pk_bf16_f32 v97, v98, v99
    v_lshlrev_b32 v0, 16, v80
    v_exp_f32 v100, v100
    buffer_load_dwordx4 v18, s[16:19], s29 offen offset:1024 lds
    v_exp_f32 v101, v101
    s_nop 0
    v_cvt_pk_bf16_f32 v98, v100, v101
    v_lshlrev_b32 v1, 16, v81
    v_exp_f32 v102, v102
    v_lshlrev_b32 v2, 16, v82
    v_lshlrev_b32 v3, 16, v83
    v_exp_f32 v103, v103
    s_nop 0
    v_cvt_pk_bf16_f32 v99, v102, v103
    v_and_b32 v80, s25, v80
    v_exp_f32 v104, v104
    buffer_load_dwordx4 v18, s[16:19], s29 offen offset:2048 lds
    v_exp_f32 v105, v105
    s_nop 0
    v_cvt_pk_bf16_f32 v100, v104, v105
    v_and_b32 v81, s25, v81
    v_exp_f32 v106, v106
    buffer_load_dwordx4 v18, s[16:19], s29 offen offset:3072 lds
    v_and_b32 v82, s25, v82
    v_and_b32 v83, s25, v83
    v_mul_f32 v0, s24, v0
    v_mul_f32 v1, s24, v1
    v_mul_f32 v2, s24, v2
    v_mul_f32 v3, s24, v3
    v_pk_mul_f32 v[80:81], v[80:81], s[34:35]
    v_pk_mul_f32 v[82:83], v[82:83], s[34:35]
    v_cvt_pk_bf16_f32 v80, v0, v80
    v_cvt_pk_bf16_f32 v81, v1, v81
    v_cvt_pk_bf16_f32 v82, v2, v82
    v_cvt_pk_bf16_f32 v83, v3, v83
    s_waitcnt lgkmcnt(0)
    v_lshlrev_b32 v0, 16, v84
    v_lshlrev_b32 v1, 16, v85
    v_lshlrev_b32 v2, 16, v86
    v_lshlrev_b32 v3, 16, v87
    v_and_b32 v84, s25, v84
    v_and_b32 v85, s25, v85
    v_and_b32 v86, s25, v86
    v_and_b32 v87, s25, v87
    v_pk_mul_f32 v[0:1], v[0:1], s[34:35]
    v_pk_mul_f32 v[2:3], v[2:3], s[34:35]
    v_pk_mul_f32 v[84:85], v[84:85], s[34:35]
    v_pk_mul_f32 v[86:87], v[86:87], s[34:35]
    v_cvt_pk_bf16_f32 v84, v0, v84
    v_cvt_pk_bf16_f32 v85, v1, v85
    v_cvt_pk_bf16_f32 v86, v2, v86
    v_cvt_pk_bf16_f32 v87, v3, v87
    v_lshlrev_b32 v0, 16, v88
    v_lshlrev_b32 v1, 16, v89
    v_lshlrev_b32 v2, 16, v90
    v_lshlrev_b32 v3, 16, v91
    v_and_b32 v88, s25, v88
    v_and_b32 v89, s25, v89
    v_and_b32 v90, s25, v90
    v_and_b32 v91, s25, v91
    v_pk_mul_f32 v[0:1], v[0:1], s[34:35]
    v_pk_mul_f32 v[2:3], v[2:3], s[34:35]
    v_pk_mul_f32 v[88:89], v[88:89], s[34:35]
    v_pk_mul_f32 v[90:91], v[90:91], s[34:35]
    v_cvt_pk_bf16_f32 v88, v0, v88
    v_cvt_pk_bf16_f32 v89, v1, v89
    v_cvt_pk_bf16_f32 v90, v2, v90
    v_cvt_pk_bf16_f32 v91, v3, v91
    v_lshlrev_b32 v0, 16, v92
    v_lshlrev_b32 v1, 16, v93
    v_lshlrev_b32 v2, 16, v94
    v_lshlrev_b32 v3, 16, v95
    v_and_b32 v92, s25, v92
    v_and_b32 v93, s25, v93
    v_and_b32 v94, s25, v94
    v_and_b32 v95, s25, v95
    v_pk_mul_f32 v[0:1], v[0:1], s[34:35]
    v_pk_mul_f32 v[2:3], v[2:3], s[34:35]
    v_pk_mul_f32 v[92:93], v[92:93], s[34:35]
    v_pk_mul_f32 v[94:95], v[94:95], s[34:35]
    v_cvt_pk_bf16_f32 v92, v0, v92
    v_cvt_pk_bf16_f32 v93, v1, v93
    v_cvt_pk_bf16_f32 v94, v2, v94
    v_cvt_pk_bf16_f32 v95, v3, v95
    v_mfma_f32_16x16x32_bf16 v[112:115], a[128:131], v[80:83], 0
    v_exp_f32 v107, v107
    v_mfma_f32_16x16x32_bf16 v[112:115], a[132:135], v[84:87], v[112:115]
    s_waitcnt vmcnt(8)
    v_cvt_pk_bf16_f32 v101, v106, v107
    v_mfma_f32_16x16x32_bf16 v[112:115], a[136:139], v[88:91], v[112:115]
    s_barrier
    v_exp_f32 v108, v108
    v_mfma_f32_16x16x32_bf16 v[112:115], a[140:143], v[92:95], v[112:115]
    ds_read_b64_tr_b16 a[192:193], v12 offset:0
    ds_read_b64_tr_b16 a[194:195], v12 offset:4096
    v_mfma_f32_16x16x32_bf16 v[116:119], a[144:147], v[92:95], 0
    v_exp_f32 v109, v109
    v_mfma_f32_16x16x32_bf16 v[116:119], a[148:151], v[88:91], v[116:119]
    ds_read_b64_tr_b16 a[196:197], v12 offset:8192
    v_cvt_pk_bf16_f32 v102, v108, v109
    v_mfma_f32_16x16x32_bf16 v[116:119], a[152:155], v[84:87], v[116:119]
    v_exp_f32 v110, v110
    v_mfma_f32_16x16x32_bf16 v[116:119], a[156:159], v[80:83], v[116:119]
    s_mov_b32 s30, 8192
    ds_read_b64_tr_b16 a[198:199], v12 offset:12288
    ds_read_b64_tr_b16 a[200:201], v12 offset:8200
    v_mfma_f32_16x16x32_bf16 v[120:123], a[160:163], v[80:83], 0
    s_add_u32 m0, s27, 65536
    v_exp_f32 v111, v111
    v_mfma_f32_16x16x32_bf16 v[120:123], a[164:167], v[84:87], v[120:123]
    ds_read_b64_tr_b16 a[202:203], v12 offset:12296
    buffer_load_dwordx4 v240, s[8:11], s30 offen nt lds
    v_cvt_pk_bf16_f32 v103, v110, v111
    v_mfma_f32_16x16x32_bf16 v[120:123], a[168:171], v[88:91], v[120:123]
    v_exp_f32 v112, v112
    v_mfma_f32_16x16x32_bf16 v[120:123], a[172:175], v[92:95], v[120:123]
    ds_read_b64_tr_b16 a[204:205], v12 offset:8
    ds_read_b64_tr_b16 a[206:207], v12 offset:4104
    v_mfma_f32_16x16x32_bf16 v[124:127], a[176:179], v[92:95], 0
    v_exp_f32 v113, v113
    v_mfma_f32_16x16x32_bf16 v[124:127], a[180:183], v[88:91], v[124:127]
    ds_read_b64_tr_b16 a[208:209], v13 offset:0
    ds_read_b64_tr_b16 a[210:211], v13 offset:4096
    v_cvt_pk_bf16_f32 v112, v112, v113
    v_mfma_f32_16x16x32_bf16 v[124:127], a[184:187], v[84:87], v[124:127]
    ds_read_b64_tr_b16 a[212:213], v13 offset:8192
    ds_read_b64_tr_b16 a[214:215], v13 offset:12288
    v_exp_f32 v114, v114
    v_mfma_f32_16x16x32_bf16 v[124:127], a[188:191], v[80:83], v[124:127]
    ds_read_b64_tr_b16 a[216:217], v13 offset:8200
    ds_read_b64_tr_b16 a[218:219], v13 offset:12296
    v_smfmac_f32_16x16x64_bf16 v[24:27], a[120:123], v[96:103], v22
    s_waitcnt lgkmcnt(9)
    ds_read_b64_tr_b16 a[220:221], v13 offset:8
    ds_read_b64_tr_b16 a[222:223], v13 offset:4104
    v_exp_f32 v115, v115
    v_mfma_f32_16x16x32_bf16 v[128:131], a[192:195], v[96:99], 0
    ds_read_b64_tr_b16 a[224:225], v14 offset:0
    ds_read_b64_tr_b16 a[226:227], v14 offset:4096
    v_cvt_pk_bf16_f32 v113, v114, v115
    v_mfma_f32_16x16x32_bf16 v[128:131], a[196:199], v[100:103], v[128:131]
    s_waitcnt lgkmcnt(10)
    ds_read_b64_tr_b16 a[228:229], v14 offset:8192
    ds_read_b64_tr_b16 a[230:231], v14 offset:12288
    v_exp_f32 v116, v116
    v_mfma_f32_16x16x32_bf16 v[132:135], a[200:203], v[100:103], 0
    ds_read_b64_tr_b16 a[232:233], v14 offset:8200
    ds_read_b64_tr_b16 a[234:235], v14 offset:12296
    v_mfma_f32_16x16x32_bf16 v[132:135], a[204:207], v[96:99], v[132:135]
    s_waitcnt lgkmcnt(11)
    ds_read_b64_tr_b16 a[236:237], v14 offset:8
    ds_read_b64_tr_b16 a[238:239], v14 offset:4104
    v_exp_f32 v117, v117
    v_mfma_f32_16x16x32_bf16 v[136:139], a[208:211], v[96:99], 0
    s_waitcnt vmcnt(5) lgkmcnt(10)
    ds_read_b64_tr_b16 a[240:241], v15 offset:0
    ds_read_b64_tr_b16 a[242:243], v15 offset:4096
    v_cvt_pk_bf16_f32 v114, v116, v117
    v_mfma_f32_16x16x32_bf16 v[136:139], a[212:215], v[100:103], v[136:139]
    s_barrier
    ds_read_b64_tr_b16 a[244:245], v15 offset:8192
    ds_read_b64_tr_b16 a[246:247], v15 offset:12288
    v_exp_f32 v118, v118
    v_mfma_f32_16x16x32_bf16 v[140:143], a[216:219], v[100:103], 0
    s_waitcnt lgkmcnt(10)
    ds_read_b64_tr_b16 a[248:249], v15 offset:8200
    ds_read_b64_tr_b16 a[250:251], v15 offset:12296
    v_mfma_f32_16x16x32_bf16 v[140:143], a[220:223], v[96:99], v[140:143]
    ds_read_b64_tr_b16 a[252:253], v15 offset:8
    ds_read_b64_tr_b16 a[254:255], v15 offset:4104
    v_exp_f32 v119, v119
    v_mfma_f32_16x16x32_bf16 v[144:147], a[224:227], v[96:99], 0
    s_waitcnt lgkmcnt(10)
    ds_read_b128 a[128:131], v4 offset:16384
    buffer_load_dwordx4 v241, s[8:11], s30 offen offset:1024 nt lds
    v_cvt_pk_bf16_f32 v115, v118, v119
    v_mfma_f32_16x16x32_bf16 v[144:147], a[228:231], v[100:103], v[144:147]
    ds_read_b128 a[132:135], v5 offset:16384
    v_exp_f32 v120, v120
    v_mfma_f32_16x16x32_bf16 v[148:151], a[232:235], v[100:103], 0
    s_waitcnt lgkmcnt(8)
    ds_read_b128 a[136:139], v6 offset:16384
    ds_read_b128 a[140:143], v7 offset:16384
    v_mfma_f32_16x16x32_bf16 v[148:151], a[236:239], v[96:99], v[148:151]
    v_exp_f32 v121, v121
    v_mfma_f32_16x16x32_bf16 v[152:155], a[240:243], v[96:99], 0
    s_waitcnt lgkmcnt(8)
    ds_read_b128 a[144:147], v7 offset:20480
    v_cvt_pk_bf16_f32 v116, v120, v121
    v_mfma_f32_16x16x32_bf16 v[152:155], a[244:247], v[100:103], v[152:155]
    s_branch Lpad0
.p2align 12
Lpad0:
    s_cbranch_execz Lpad4
    s_waitcnt lgkmcnt(7)
    ds_read_b128 a[148:151], v6 offset:20480
    v_exp_f32 v122, v122
    v_mfma_f32_16x16x32_bf16 v[156:159], a[248:251], v[100:103], 0
    s_waitcnt lgkmcnt(6)
    ds_read_b128 a[152:155], v5 offset:20480
    ds_read_b128 a[156:159], v4 offset:20480
    v_mfma_f32_16x16x32_bf16 v[156:159], a[252:255], v[96:99], v[156:159]
    s_waitcnt lgkmcnt(7)
    ds_read_b128 a[160:163], v4 offset:24576
    ds_read_b128 a[164:167], v5 offset:24576
    v_mfma_f32_16x16x32_bf16 v[96:99], a[128:131], v[64:67], 0
    s_waitcnt lgkmcnt(8)
    v_exp_f32 v123, v123
    v_mfma_f32_16x16x32_bf16 v[96:99], a[132:135], v[68:71], v[96:99]
    s_waitcnt lgkmcnt(7)
    ds_read_b128 a[168:171], v6 offset:24576
    v_cvt_pk_bf16_f32 v117, v122, v123
    v_mfma_f32_16x16x32_bf16 v[96:99], a[136:139], v[72:75], v[96:99]
    s_waitcnt lgkmcnt(7)
    v_exp_f32 v124, v124
    v_mfma_f32_16x16x32_bf16 v[96:99], a[140:143], v[76:79], v[96:99]
    s_waitcnt lgkmcnt(6)
    ds_read_b128 a[172:175], v7 offset:24576
    ds_read_b128 a[176:179], v7 offset:28672
    v_mfma_f32_16x16x32_bf16 v[100:103], a[144:147], v[76:79], 0
    s_waitcnt lgkmcnt(7)
    v_exp_f32 v125, v125
    v_mfma_f32_16x16x32_bf16 v[100:103], a[148:151], v[72:75], v[100:103]
    s_waitcnt lgkmcnt(6)
    ds_read_b128 a[180:183], v6 offset:28672
    v_cvt_pk_bf16_f32 v118, v124, v125
    v_mfma_f32_16x16x32_bf16 v[100:103], a[152:155], v[68:71], v[100:103]
    s_waitcnt lgkmcnt(5)
    ds_read_b128 a[184:187], v5 offset:28672
    v_exp_f32 v126, v126
    v_mfma_f32_16x16x32_bf16 v[100:103], a[156:159], v[64:67], v[100:103]
    ds_read_b128 a[188:191], v4 offset:28672
    buffer_load_dwordx4 v242, s[8:11], s30 offen offset:2048 nt lds
    v_mfma_f32_16x16x32_bf16 v[104:107], a[160:163], v[64:67], 0
    s_waitcnt lgkmcnt(5)
    v_exp_f32 v127, v127
    v_mfma_f32_16x16x32_bf16 v[104:107], a[164:167], v[68:71], v[104:107]
    v_cvt_pk_bf16_f32 v119, v126, v127
    v_mfma_f32_16x16x32_bf16 v[104:107], a[168:171], v[72:75], v[104:107]
    s_waitcnt lgkmcnt(4)
    v_exp_f32 v96, v96
    v_mfma_f32_16x16x32_bf16 v[104:107], a[172:175], v[76:79], v[104:107]
    s_waitcnt lgkmcnt(3)
    v_mfma_f32_16x16x32_bf16 v[108:111], a[176:179], v[76:79], 0
    s_waitcnt lgkmcnt(2)
    v_exp_f32 v97, v97
    v_mfma_f32_16x16x32_bf16 v[108:111], a[180:183], v[72:75], v[108:111]
    s_waitcnt lgkmcnt(1)
    v_cvt_pk_bf16_f32 v96, v96, v97
    v_mfma_f32_16x16x32_bf16 v[108:111], a[184:187], v[68:71], v[108:111]
    s_waitcnt lgkmcnt(0)
    v_exp_f32 v98, v98
    v_mfma_f32_16x16x32_bf16 v[108:111], a[188:191], v[64:67], v[108:111]
    s_waitcnt vmcnt(3)
    v_smfmac_f32_16x16x64_bf16 v[24:27], a[124:127], v[112:119], v22
    s_barrier
    v_exp_f32 v99, v99
    v_mfma_f32_16x16x32_bf16 v[160:163], a[192:195], v[112:115], 0
    ds_read_b64_tr_b16 a[116:117], v12 offset:16384
    v_cvt_pk_bf16_f32 v97, v98, v99
    v_mfma_f32_16x16x32_bf16 v[160:163], a[196:199], v[116:119], v[160:163]
    v_exp_f32 v100, v100
    v_mfma_f32_16x16x32_bf16 v[164:167], a[200:203], v[116:119], 0
    ds_read_b64_tr_b16 a[118:119], v12 offset:20480
    ds_read_b64_tr_b16 a[112:113], v12 offset:24576
    v_mfma_f32_16x16x32_bf16 v[164:167], a[204:207], v[112:115], v[164:167]
    v_exp_f32 v101, v101
    v_mfma_f32_16x16x32_bf16 v[168:171], a[208:211], v[112:115], 0
    ds_read_b64_tr_b16 a[114:115], v12 offset:28672
    v_cvt_pk_bf16_f32 v98, v100, v101
    v_mfma_f32_16x16x32_bf16 v[168:171], a[212:215], v[116:119], v[168:171]
    v_exp_f32 v102, v102
    v_mfma_f32_16x16x32_bf16 v[172:175], a[216:219], v[116:119], 0
    ds_read_b64_tr_b16 a[108:109], v12 offset:24584
    ds_read_b64_tr_b16 a[110:111], v12 offset:28680
    v_mfma_f32_16x16x32_bf16 v[172:175], a[220:223], v[112:115], v[172:175]
    buffer_load_dwordx4 v243, s[8:11], s30 offen offset:3072 nt lds
    v_exp_f32 v103, v103
    v_mfma_f32_16x16x32_bf16 v[176:179], a[224:227], v[112:115], 0
    ds_read_b64_tr_b16 a[104:105], v12 offset:16392
    v_cvt_pk_bf16_f32 v99, v102, v103
    v_mfma_f32_16x16x32_bf16 v[176:179], a[228:231], v[116:119], v[176:179]
    v_exp_f32 v104, v104
    v_mfma_f32_16x16x32_bf16 v[180:183], a[232:235], v[116:119], 0
    ds_read_b64_tr_b16 a[106:107], v12 offset:20488
    ds_read_b64_tr_b16 a[100:101], v13 offset:16384
    v_mfma_f32_16x16x32_bf16 v[180:183], a[236:239], v[112:115], v[180:183]
    v_exp_f32 v105, v105
    v_mfma_f32_16x16x32_bf16 v[184:187], a[240:243], v[112:115], 0
    s_add_u32 m0, s26, 32768
    ds_read_b64_tr_b16 a[102:103], v13 offset:20480
    v_cvt_pk_bf16_f32 v100, v104, v105
    v_mfma_f32_16x16x32_bf16 v[184:187], a[244:247], v[116:119], v[184:187]
    buffer_load_dwordx4 v17, s[12:15], m0 offen nt lds
    v_exp_f32 v106, v106
    v_mfma_f32_16x16x32_bf16 v[188:191], a[248:251], v[116:119], 0
    ds_read_b64_tr_b16 a[96:97], v13 offset:24576
    ds_read_b64_tr_b16 a[98:99], v13 offset:28672
    v_mfma_f32_16x16x32_bf16 v[188:191], a[252:255], v[112:115], v[188:191]
    ds_read_b64_tr_b16 a[92:93], v13 offset:24584
    ds_read_b64_tr_b16 a[94:95], v13 offset:28680
    v_mfma_f32_16x16x32_bf16 v[112:115], a[128:131], v[80:83], 0
    v_exp_f32 v107, v107
    v_mfma_f32_16x16x32_bf16 v[112:115], a[132:135], v[84:87], v[112:115]
    ds_read_b64_tr_b16 a[192:193], v13 offset:16392
    v_cvt_pk_bf16_f32 v101, v106, v107
    v_mfma_f32_16x16x32_bf16 v[112:115], a[136:139], v[88:91], v[112:115]
    s_add_u32 m0, s26, 36864
    v_exp_f32 v108, v108
    v_mfma_f32_16x16x32_bf16 v[112:115], a[140:143], v[92:95], v[112:115]
    ds_read_b64_tr_b16 a[194:195], v13 offset:20488
    ds_read_b64_tr_b16 a[196:197], v14 offset:16384
    buffer_load_dwordx4 v17, s[12:15], m0 offen nt lds
    v_mfma_f32_16x16x32_bf16 v[116:119], a[144:147], v[92:95], 0
    v_exp_f32 v109, v109
    v_mfma_f32_16x16x32_bf16 v[116:119], a[148:151], v[88:91], v[116:119]
    ds_read_b64_tr_b16 a[198:199], v14 offset:20480
    v_cvt_pk_bf16_f32 v102, v108, v109
    v_mfma_f32_16x16x32_bf16 v[116:119], a[152:155], v[84:87], v[116:119]
    v_exp_f32 v110, v110
    v_mfma_f32_16x16x32_bf16 v[116:119], a[156:159], v[80:83], v[116:119]
    ds_read_b64_tr_b16 a[200:201], v14 offset:24576
    ds_read_b64_tr_b16 a[202:203], v14 offset:28672
    v_mfma_f32_16x16x32_bf16 v[120:123], a[160:163], v[80:83], 0
    s_add_u32 m0, s26, 40960
    v_exp_f32 v111, v111
    v_mfma_f32_16x16x32_bf16 v[120:123], a[164:167], v[84:87], v[120:123]
    ds_read_b64_tr_b16 a[204:205], v14 offset:24584
    buffer_load_dwordx4 v17, s[12:15], m0 offen nt lds
    v_cvt_pk_bf16_f32 v103, v110, v111
    v_mfma_f32_16x16x32_bf16 v[120:123], a[168:171], v[88:91], v[120:123]
    v_exp_f32 v112, v112
    v_mfma_f32_16x16x32_bf16 v[120:123], a[172:175], v[92:95], v[120:123]
    ds_read_b64_tr_b16 a[206:207], v14 offset:28680
    ds_read_b64_tr_b16 a[208:209], v14 offset:16392
    v_mfma_f32_16x16x32_bf16 v[124:127], a[176:179], v[92:95], 0
    v_exp_f32 v113, v113
    v_mfma_f32_16x16x32_bf16 v[124:127], a[180:183], v[88:91], v[124:127]
    ds_read_b64_tr_b16 a[210:211], v14 offset:20488
    v_cvt_pk_bf16_f32 v112, v112, v113
    v_mfma_f32_16x16x32_bf16 v[124:127], a[184:187], v[84:87], v[124:127]
    s_add_u32 m0, s26, 45056
    v_exp_f32 v114, v114
    v_mfma_f32_16x16x32_bf16 v[124:127], a[188:191], v[80:83], v[124:127]
    ds_read_b64_tr_b16 a[212:213], v15 offset:16384
    ds_read_b64_tr_b16 a[214:215], v15 offset:20480
    buffer_load_dwordx4 v17, s[12:15], m0 offen nt lds
    v_smfmac_f32_16x16x64_bf16 v[24:27], a[120:123], v[96:103], v22
    s_waitcnt lgkmcnt(6)
    v_exp_f32 v115, v115
    v_mfma_f32_16x16x32_bf16 v[128:131], a[116:119], v[96:99], v[128:131]
    ds_read_b64_tr_b16 a[216:217], v15 offset:24576
    v_cvt_pk_bf16_f32 v113, v114, v115
    v_mfma_f32_16x16x32_bf16 v[128:131], a[112:115], v[100:103], v[128:131]
    v_exp_f32 v116, v116
    v_mfma_f32_16x16x32_bf16 v[132:135], a[108:111], v[100:103], v[132:135]
    s_add_u32 s29, s27, 32768
    ds_read_b64_tr_b16 a[218:219], v15 offset:28672
    ds_read_b64_tr_b16 a[220:221], v15 offset:24584
    v_mfma_f32_16x16x32_bf16 v[132:135], a[104:107], v[96:99], v[132:135]
    s_add_u32 m0, s27, 131072
    v_exp_f32 v117, v117
    v_mfma_f32_16x16x32_bf16 v[136:139], a[100:103], v[96:99], v[136:139]
    ds_read_b64_tr_b16 a[222:223], v15 offset:28680
    buffer_load_dwordx4 v18, s[16:19], s29 offen lds
    v_cvt_pk_bf16_f32 v114, v116, v117
    v_mfma_f32_16x16x32_bf16 v[136:139], a[96:99], v[100:103], v[136:139]
    s_waitcnt vmcnt(5)
    ds_read_b128 v[32:35], v244 offset:32768
    v_exp_f32 v118, v118
    v_mfma_f32_16x16x32_bf16 v[140:143], a[92:95], v[100:103], v[140:143]
    ds_read_b64_tr_b16 a[224:225], v15 offset:16392
    ds_read_b64_tr_b16 a[226:227], v15 offset:20488
    ds_read_b128 v[36:39], v245 offset:32768
    v_mfma_f32_16x16x32_bf16 v[140:143], a[192:195], v[96:99], v[140:143]
    ds_read_b128 v[40:43], v246 offset:32768
    v_exp_f32 v119, v119
    v_mfma_f32_16x16x32_bf16 v[144:147], a[196:199], v[96:99], v[144:147]
    buffer_load_dwordx4 v18, s[16:19], s29 offen offset:1024 lds
    ds_read_b128 v[44:47], v247 offset:32768
    v_cvt_pk_bf16_f32 v115, v118, v119
    v_mfma_f32_16x16x32_bf16 v[144:147], a[200:203], v[100:103], v[144:147]
    s_waitcnt lgkmcnt(7)
    v_exp_f32 v120, v120
    v_mfma_f32_16x16x32_bf16 v[148:151], a[204:207], v[100:103], v[148:151]
    v_mfma_f32_16x16x32_bf16 v[148:151], a[208:211], v[96:99], v[148:151]
    v_exp_f32 v121, v121
    v_mfma_f32_16x16x32_bf16 v[152:155], a[212:215], v[96:99], v[152:155]
    s_waitcnt lgkmcnt(5)
    v_cvt_pk_bf16_f32 v116, v120, v121
    v_lshlrev_b32 v0, 16, v32
    v_mfma_f32_16x16x32_bf16 v[152:155], a[216:219], v[100:103], v[152:155]
    v_exp_f32 v122, v122
    v_mfma_f32_16x16x32_bf16 v[156:159], a[220:223], v[100:103], v[156:159]
    s_waitcnt lgkmcnt(3)
    buffer_load_dwordx4 v18, s[16:19], s29 offen offset:2048 lds
    v_mfma_f32_16x16x32_bf16 v[156:159], a[224:227], v[96:99], v[156:159]
    v_lshlrev_b32 v1, 16, v33
    v_lshlrev_b32 v2, 16, v34
    v_lshlrev_b32 v3, 16, v35
    v_and_b32 v32, s25, v32
    v_and_b32 v33, s25, v33
    v_and_b32 v34, s25, v34
    v_and_b32 v35, s25, v35
    v_pk_mul_f32 v[0:1], v[0:1], s[34:35]
    v_pk_mul_f32 v[2:3], v[2:3], s[34:35]
    v_pk_mul_f32 v[32:33], v[32:33], s[34:35]
    v_pk_mul_f32 v[34:35], v[34:35], s[34:35]
    v_cvt_pk_bf16_f32 v0, v0, v32
    v_cvt_pk_bf16_f32 v1, v1, v33
    v_cvt_pk_bf16_f32 v2, v2, v34
    v_cvt_pk_bf16_f32 v3, v3, v35
    v_accvgpr_write_b32 a0, v0
    v_accvgpr_write_b32 a1, v1
    v_accvgpr_write_b32 a2, v2
    v_accvgpr_write_b32 a3, v3
    s_waitcnt lgkmcnt(0)
    v_lshlrev_b32 v0, 16, v36
    v_lshlrev_b32 v1, 16, v37
    v_lshlrev_b32 v2, 16, v38
    v_lshlrev_b32 v3, 16, v39
    v_and_b32 v36, s25, v36
    v_and_b32 v37, s25, v37
    v_and_b32 v38, s25, v38
    v_and_b32 v39, s25, v39
    v_pk_mul_f32 v[0:1], v[0:1], s[34:35]
    v_pk_mul_f32 v[2:3], v[2:3], s[34:35]
    v_pk_mul_f32 v[36:37], v[36:37], s[34:35]
    v_pk_mul_f32 v[38:39], v[38:39], s[34:35]
    v_cvt_pk_bf16_f32 v0, v0, v36
    v_cvt_pk_bf16_f32 v1, v1, v37
    v_cvt_pk_bf16_f32 v2, v2, v38
    v_cvt_pk_bf16_f32 v3, v3, v39
    v_accvgpr_write_b32 a4, v0
    v_accvgpr_write_b32 a5, v1
    v_accvgpr_write_b32 a6, v2
    v_accvgpr_write_b32 a7, v3
    v_lshlrev_b32 v0, 16, v40
    v_lshlrev_b32 v1, 16, v41
    v_lshlrev_b32 v2, 16, v42
    v_lshlrev_b32 v3, 16, v43
    v_and_b32 v40, s25, v40
    v_and_b32 v41, s25, v41
    v_and_b32 v42, s25, v42
    v_and_b32 v43, s25, v43
    v_pk_mul_f32 v[0:1], v[0:1], s[34:35]
    v_pk_mul_f32 v[2:3], v[2:3], s[34:35]
    v_pk_mul_f32 v[40:41], v[40:41], s[34:35]
    v_pk_mul_f32 v[42:43], v[42:43], s[34:35]
    v_cvt_pk_bf16_f32 v0, v0, v40
    v_cvt_pk_bf16_f32 v1, v1, v41
    v_cvt_pk_bf16_f32 v2, v2, v42
    v_cvt_pk_bf16_f32 v3, v3, v43
    v_accvgpr_write_b32 a8, v0
    v_accvgpr_write_b32 a9, v1
    v_accvgpr_write_b32 a10, v2
    v_accvgpr_write_b32 a11, v3
    v_lshlrev_b32 v0, 16, v44
    v_lshlrev_b32 v1, 16, v45
    v_lshlrev_b32 v2, 16, v46
    v_lshlrev_b32 v3, 16, v47
    v_and_b32 v44, s25, v44
    v_and_b32 v45, s25, v45
    v_and_b32 v46, s25, v46
    v_and_b32 v47, s25, v47
    v_pk_mul_f32 v[0:1], v[0:1], s[34:35]
    v_pk_mul_f32 v[2:3], v[2:3], s[34:35]
    v_pk_mul_f32 v[44:45], v[44:45], s[34:35]
    v_pk_mul_f32 v[46:47], v[46:47], s[34:35]
    v_cvt_pk_bf16_f32 v0, v0, v44
    v_cvt_pk_bf16_f32 v1, v1, v45
    v_cvt_pk_bf16_f32 v2, v2, v46
    v_cvt_pk_bf16_f32 v3, v3, v47
    v_accvgpr_write_b32 a12, v0
    v_accvgpr_write_b32 a13, v1
    v_accvgpr_write_b32 a14, v2
    v_accvgpr_write_b32 a15, v3
    v_mfma_f32_16x16x32_bf16 v[96:99], a[128:131], a[0:3], 0
    v_exp_f32 v123, v123
    v_mfma_f32_16x16x32_bf16 v[96:99], a[132:135], a[4:7], v[96:99]
    v_cvt_pk_bf16_f32 v117, v122, v123
    v_mfma_f32_16x16x32_bf16 v[96:99], a[136:139], a[8:11], v[96:99]
    v_exp_f32 v124, v124
    v_mfma_f32_16x16x32_bf16 v[96:99], a[140:143], a[12:15], v[96:99]
    buffer_load_dwordx4 v18, s[16:19], s29 offen offset:3072 lds
    v_mfma_f32_16x16x32_bf16 v[100:103], a[144:147], a[12:15], 0
    v_exp_f32 v125, v125
    v_mfma_f32_16x16x32_bf16 v[100:103], a[148:151], a[8:11], v[100:103]
    v_cvt_pk_bf16_f32 v118, v124, v125
    v_mfma_f32_16x16x32_bf16 v[100:103], a[152:155], a[4:7], v[100:103]
    v_exp_f32 v126, v126
    v_mfma_f32_16x16x32_bf16 v[100:103], a[156:159], a[0:3], v[100:103]
    v_mfma_f32_16x16x32_bf16 v[104:107], a[160:163], a[0:3], 0
    v_exp_f32 v127, v127
    v_mfma_f32_16x16x32_bf16 v[104:107], a[164:167], a[4:7], v[104:107]
    s_mov_b32 s30, 12288
    v_cvt_pk_bf16_f32 v119, v126, v127
    v_mfma_f32_16x16x32_bf16 v[104:107], a[168:171], a[8:11], v[104:107]
    s_add_u32 m0, s27, 81920
    v_exp_f32 v96, v96
    v_mfma_f32_16x16x32_bf16 v[104:107], a[172:175], a[12:15], v[104:107]
    buffer_load_dwordx4 v240, s[8:11], s30 offen nt lds
    v_mfma_f32_16x16x32_bf16 v[108:111], a[176:179], a[12:15], 0
    v_exp_f32 v97, v97
    v_mfma_f32_16x16x32_bf16 v[108:111], a[180:183], a[8:11], v[108:111]
    s_waitcnt vmcnt(5)
    v_cvt_pk_bf16_f32 v96, v96, v97
    v_mfma_f32_16x16x32_bf16 v[108:111], a[184:187], a[4:7], v[108:111]
    s_barrier
    v_exp_f32 v98, v98
    v_mfma_f32_16x16x32_bf16 v[108:111], a[188:191], a[0:3], v[108:111]
    ds_read_b128 a[128:131], v4 offset:32768
    v_smfmac_f32_16x16x64_bf16 v[24:27], a[124:127], v[112:119], v22
    v_exp_f32 v99, v99
    v_mfma_f32_16x16x32_bf16 v[160:163], a[116:119], v[112:115], v[160:163]
    ds_read_b128 a[132:135], v5 offset:32768
    v_cvt_pk_bf16_f32 v97, v98, v99
    v_mfma_f32_16x16x32_bf16 v[160:163], a[112:115], v[116:119], v[160:163]
    v_exp_f32 v100, v100
    v_mfma_f32_16x16x32_bf16 v[164:167], a[108:111], v[116:119], v[164:167]
    ds_read_b128 a[136:139], v6 offset:32768
    v_mfma_f32_16x16x32_bf16 v[164:167], a[104:107], v[112:115], v[164:167]
    v_exp_f32 v101, v101
    v_mfma_f32_16x16x32_bf16 v[168:171], a[100:103], v[112:115], v[168:171]
    ds_read_b128 a[140:143], v7 offset:32768
    v_cvt_pk_bf16_f32 v98, v100, v101
    v_mfma_f32_16x16x32_bf16 v[168:171], a[96:99], v[116:119], v[168:171]
    v_exp_f32 v102, v102
    v_mfma_f32_16x16x32_bf16 v[172:175], a[92:95], v[116:119], v[172:175]
    ds_read_b128 a[144:147], v7 offset:36864
    buffer_load_dwordx4 v241, s[8:11], s30 offen offset:1024 nt lds
    v_mfma_f32_16x16x32_bf16 v[172:175], a[192:195], v[112:115], v[172:175]
    v_exp_f32 v103, v103
    v_mfma_f32_16x16x32_bf16 v[176:179], a[196:199], v[112:115], v[176:179]
    ds_read_b128 a[148:151], v6 offset:36864
    v_cvt_pk_bf16_f32 v99, v102, v103
    v_mfma_f32_16x16x32_bf16 v[176:179], a[200:203], v[116:119], v[176:179]
    v_exp_f32 v104, v104
    v_mfma_f32_16x16x32_bf16 v[180:183], a[204:207], v[116:119], v[180:183]
    ds_read_b128 a[152:155], v5 offset:36864
    v_mfma_f32_16x16x32_bf16 v[180:183], a[208:211], v[112:115], v[180:183]
    v_exp_f32 v105, v105
    v_mfma_f32_16x16x32_bf16 v[184:187], a[212:215], v[112:115], v[184:187]
    ds_read_b128 a[156:159], v4 offset:36864
    v_cvt_pk_bf16_f32 v100, v104, v105
    v_mfma_f32_16x16x32_bf16 v[184:187], a[216:219], v[116:119], v[184:187]
    v_exp_f32 v106, v106
    v_mfma_f32_16x16x32_bf16 v[188:191], a[220:223], v[116:119], v[188:191]
    ds_read_b128 a[160:163], v4 offset:40960
    v_mfma_f32_16x16x32_bf16 v[188:191], a[224:227], v[112:115], v[188:191]
    s_waitcnt lgkmcnt(5)
    ds_read_b128 a[164:167], v5 offset:40960
    v_mfma_f32_16x16x32_bf16 v[112:115], a[128:131], v[64:67], 0
    v_exp_f32 v107, v107
    v_mfma_f32_16x16x32_bf16 v[112:115], a[132:135], v[68:71], v[112:115]
    ds_read_b128 a[168:171], v6 offset:40960
    v_cvt_pk_bf16_f32 v101, v106, v107
    v_mfma_f32_16x16x32_bf16 v[112:115], a[136:139], v[72:75], v[112:115]
    v_exp_f32 v108, v108
    v_mfma_f32_16x16x32_bf16 v[112:115], a[140:143], v[76:79], v[112:115]
    s_waitcnt lgkmcnt(5)
    ds_read_b128 a[172:175], v7 offset:40960
    buffer_load_dwordx4 v242, s[8:11], s30 offen offset:2048 nt lds
    v_mfma_f32_16x16x32_bf16 v[116:119], a[144:147], v[76:79], 0
    ds_read_b128 a[176:179], v7 offset:45056
    v_exp_f32 v109, v109
    v_mfma_f32_16x16x32_bf16 v[116:119], a[148:151], v[72:75], v[116:119]
    s_waitcnt lgkmcnt(5)
    ds_read_b128 a[180:183], v6 offset:45056
    v_cvt_pk_bf16_f32 v102, v108, v109
    v_mfma_f32_16x16x32_bf16 v[116:119], a[152:155], v[68:71], v[116:119]
    ds_read_b128 a[184:187], v5 offset:45056
    v_exp_f32 v110, v110
    v_mfma_f32_16x16x32_bf16 v[116:119], a[156:159], v[64:67], v[116:119]
    s_waitcnt lgkmcnt(6)
    ds_read_b128 a[188:191], v4 offset:45056
    v_mfma_f32_16x16x32_bf16 v[120:123], a[160:163], v[64:67], 0
    s_waitcnt lgkmcnt(6)
    v_exp_f32 v111, v111
    v_mfma_f32_16x16x32_bf16 v[120:123], a[164:167], v[68:71], v[120:123]
    s_waitcnt lgkmcnt(5)
    v_cvt_pk_bf16_f32 v103, v110, v111
    v_mfma_f32_16x16x32_bf16 v[120:123], a[168:171], v[72:75], v[120:123]
    s_waitcnt lgkmcnt(4)
    v_exp_f32 v112, v112
    v_mfma_f32_16x16x32_bf16 v[120:123], a[172:175], v[76:79], v[120:123]
    s_waitcnt lgkmcnt(3)
    v_mfma_f32_16x16x32_bf16 v[124:127], a[176:179], v[76:79], 0
    s_waitcnt lgkmcnt(2)
    v_exp_f32 v113, v113
    v_mfma_f32_16x16x32_bf16 v[124:127], a[180:183], v[72:75], v[124:127]
    s_waitcnt lgkmcnt(1)
    v_cvt_pk_bf16_f32 v112, v112, v113
    v_mfma_f32_16x16x32_bf16 v[124:127], a[184:187], v[68:71], v[124:127]
    s_waitcnt lgkmcnt(0)
    v_exp_f32 v114, v114
    v_mfma_f32_16x16x32_bf16 v[124:127], a[188:191], v[64:67], v[124:127]
    s_waitcnt vmcnt(3)
    buffer_load_dwordx4 v243, s[8:11], s30 offen offset:3072 nt lds
    v_smfmac_f32_16x16x64_bf16 v[28:31], a[120:123], v[96:103], v22
    s_barrier
    v_exp_f32 v115, v115
    v_mfma_f32_16x16x32_bf16 v[192:195], a[116:119], v[96:99], 0
    ds_read_b64_tr_b16 a[228:229], v12 offset:32768
    v_cvt_pk_bf16_f32 v113, v114, v115
    v_mfma_f32_16x16x32_bf16 v[192:195], a[112:115], v[100:103], v[192:195]
    v_exp_f32 v116, v116
    v_mfma_f32_16x16x32_bf16 v[196:199], a[108:111], v[100:103], 0
    ds_read_b64_tr_b16 a[230:231], v12 offset:36864
    ds_read_b64_tr_b16 a[232:233], v12 offset:40960
    v_mfma_f32_16x16x32_bf16 v[196:199], a[104:107], v[96:99], v[196:199]
    v_exp_f32 v117, v117
    v_mfma_f32_16x16x32_bf16 v[200:203], a[100:103], v[96:99], 0
    ds_read_b64_tr_b16 a[234:235], v12 offset:45056
    v_cvt_pk_bf16_f32 v114, v116, v117
    v_mfma_f32_16x16x32_bf16 v[200:203], a[96:99], v[100:103], v[200:203]
    s_add_u32 m0, s26, 49152
    v_exp_f32 v118, v118
    v_mfma_f32_16x16x32_bf16 v[204:207], a[92:95], v[100:103], 0
    ds_read_b64_tr_b16 a[236:237], v12 offset:40968
    ds_read_b64_tr_b16 a[238:239], v12 offset:45064
    buffer_load_dwordx4 v17, s[12:15], m0 offen nt lds
    v_mfma_f32_16x16x32_bf16 v[204:207], a[192:195], v[96:99], v[204:207]
    v_exp_f32 v119, v119
    v_mfma_f32_16x16x32_bf16 v[208:211], a[196:199], v[96:99], 0
    ds_read_b64_tr_b16 a[240:241], v12 offset:32776
    v_cvt_pk_bf16_f32 v115, v118, v119
    v_mfma_f32_16x16x32_bf16 v[208:211], a[200:203], v[100:103], v[208:211]
    v_exp_f32 v120, v120
    v_mfma_f32_16x16x32_bf16 v[212:215], a[204:207], v[100:103], 0
    ds_read_b64_tr_b16 a[242:243], v12 offset:36872
    ds_read_b64_tr_b16 a[244:245], v13 offset:32768
    v_mfma_f32_16x16x32_bf16 v[212:215], a[208:211], v[96:99], v[212:215]
    s_add_u32 m0, s26, 53248
    v_exp_f32 v121, v121
    v_mfma_f32_16x16x32_bf16 v[216:219], a[212:215], v[96:99], 0
    ds_read_b64_tr_b16 a[246:247], v13 offset:36864
    buffer_load_dwordx4 v17, s[12:15], m0 offen nt lds
    v_cvt_pk_bf16_f32 v116, v120, v121
    v_mfma_f32_16x16x32_bf16 v[216:219], a[216:219], v[100:103], v[216:219]
    v_exp_f32 v122, v122
    v_mfma_f32_16x16x32_bf16 v[220:223], a[220:223], v[100:103], 0
    ds_read_b64_tr_b16 a[248:249], v13 offset:40960
    ds_read_b64_tr_b16 a[250:251], v13 offset:45056
    v_mfma_f32_16x16x32_bf16 v[220:223], a[224:227], v[96:99], v[220:223]
    ds_read_b64_tr_b16 a[252:253], v13 offset:40968
    ds_read_b64_tr_b16 a[254:255], v13 offset:45064
    v_mfma_f32_16x16x32_bf16 v[96:99], a[128:131], v[80:83], 0
    v_exp_f32 v123, v123
    v_mfma_f32_16x16x32_bf16 v[96:99], a[132:135], v[84:87], v[96:99]
    s_add_u32 m0, s26, 57344
    ds_read_b64_tr_b16 a[116:117], v13 offset:32776
    v_cvt_pk_bf16_f32 v117, v122, v123
    v_mfma_f32_16x16x32_bf16 v[96:99], a[136:139], v[88:91], v[96:99]
    buffer_load_dwordx4 v17, s[12:15], m0 offen nt lds
    v_exp_f32 v124, v124
    v_mfma_f32_16x16x32_bf16 v[96:99], a[140:143], v[92:95], v[96:99]
    ds_read_b64_tr_b16 a[118:119], v13 offset:36872
    ds_read_b64_tr_b16 a[112:113], v14 offset:32768
    v_mfma_f32_16x16x32_bf16 v[100:103], a[144:147], v[92:95], 0
    v_exp_f32 v125, v125
    v_mfma_f32_16x16x32_bf16 v[100:103], a[148:151], v[88:91], v[100:103]
    ds_read_b64_tr_b16 a[114:115], v14 offset:36864
    v_cvt_pk_bf16_f32 v118, v124, v125
    v_mfma_f32_16x16x32_bf16 v[100:103], a[152:155], v[84:87], v[100:103]
    v_exp_f32 v126, v126
    v_mfma_f32_16x16x32_bf16 v[100:103], a[156:159], v[80:83], v[100:103]
    s_add_u32 m0, s26, 61440
    ds_read_b64_tr_b16 a[108:109], v14 offset:40960
    ds_read_b64_tr_b16 a[110:111], v14 offset:45056
    v_mfma_f32_16x16x32_bf16 v[104:107], a[160:163], v[80:83], 0
    buffer_load_dwordx4 v17, s[12:15], m0 offen nt lds
    v_exp_f32 v127, v127
    v_mfma_f32_16x16x32_bf16 v[104:107], a[164:167], v[84:87], v[104:107]
    ds_read_b64_tr_b16 a[104:105], v14 offset:40968
    v_cvt_pk_bf16_f32 v119, v126, v127
    v_mfma_f32_16x16x32_bf16 v[104:107], a[168:171], v[88:91], v[104:107]
    v_exp_f32 v96, v96
    v_mfma_f32_16x16x32_bf16 v[104:107], a[172:175], v[92:95], v[104:107]
    ds_read_b64_tr_b16 a[106:107], v14 offset:45064
    ds_read_b64_tr_b16 a[100:101], v14 offset:32776
    v_mfma_f32_16x16x32_bf16 v[108:111], a[176:179], v[92:95], 0
    s_add_u32 s29, s27, 49152
    v_exp_f32 v97, v97
    v_mfma_f32_16x16x32_bf16 v[108:111], a[180:183], v[88:91], v[108:111]
    s_add_u32 m0, s27, 147456
    ds_read_b64_tr_b16 a[102:103], v14 offset:36872
    v_cvt_pk_bf16_f32 v96, v96, v97
    v_mfma_f32_16x16x32_bf16 v[108:111], a[184:187], v[84:87], v[108:111]
    buffer_load_dwordx4 v18, s[16:19], s29 offen lds
    v_exp_f32 v98, v98
    v_mfma_f32_16x16x32_bf16 v[108:111], a[188:191], v[80:83], v[108:111]
    ds_read_b64_tr_b16 a[96:97], v15 offset:32768
    ds_read_b64_tr_b16 a[98:99], v15 offset:36864
    v_smfmac_f32_16x16x64_bf16 v[24:27], a[120:123], v[112:119], v22
    s_waitcnt lgkmcnt(6)
    v_exp_f32 v99, v99
    v_mfma_f32_16x16x32_bf16 v[128:131], a[228:231], v[112:115], v[128:131]
    ds_read_b64_tr_b16 a[92:93], v15 offset:40960
    v_cvt_pk_bf16_f32 v97, v98, v99
    v_mfma_f32_16x16x32_bf16 v[128:131], a[232:235], v[116:119], v[128:131]
    v_exp_f32 v100, v100
    v_mfma_f32_16x16x32_bf16 v[132:135], a[236:239], v[116:119], v[132:135]
    ds_read_b64_tr_b16 a[94:95], v15 offset:45056
    ds_read_b64_tr_b16 a[192:193], v15 offset:40968
    v_mfma_f32_16x16x32_bf16 v[132:135], a[240:243], v[112:115], v[132:135]
    buffer_load_dwordx4 v18, s[16:19], s29 offen offset:1024 lds
    v_exp_f32 v101, v101
    v_mfma_f32_16x16x32_bf16 v[136:139], a[244:247], v[112:115], v[136:139]
    ds_read_b64_tr_b16 a[194:195], v15 offset:45064
    v_cvt_pk_bf16_f32 v98, v100, v101
    v_mfma_f32_16x16x32_bf16 v[136:139], a[248:251], v[116:119], v[136:139]
    v_exp_f32 v102, v102
    v_mfma_f32_16x16x32_bf16 v[140:143], a[252:255], v[116:119], v[140:143]
    ds_read_b64_tr_b16 a[196:197], v15 offset:32776
    ds_read_b64_tr_b16 a[198:199], v15 offset:36872
    v_mfma_f32_16x16x32_bf16 v[140:143], a[116:119], v[112:115], v[140:143]
    v_exp_f32 v103, v103
    v_mfma_f32_16x16x32_bf16 v[144:147], a[112:115], v[112:115], v[144:147]
    s_mov_b32 s30, 0
    buffer_load_dwordx4 v[48:51], v16, s[44:47], s30 offen nt
    v_cvt_pk_bf16_f32 v99, v102, v103
    v_mfma_f32_16x16x32_bf16 v[144:147], a[108:111], v[116:119], v[144:147]
    s_waitcnt lgkmcnt(5)
    buffer_load_dwordx4 v18, s[16:19], s29 offen offset:2048 lds
    v_exp_f32 v104, v104
    v_mfma_f32_16x16x32_bf16 v[148:151], a[104:107], v[116:119], v[148:151]
    v_mfma_f32_16x16x32_bf16 v[148:151], a[100:103], v[112:115], v[148:151]
    v_exp_f32 v105, v105
    v_mfma_f32_16x16x32_bf16 v[152:155], a[96:99], v[112:115], v[152:155]
    s_waitcnt lgkmcnt(3)
    buffer_load_dwordx4 v18, s[16:19], s29 offen offset:3072 lds
    v_cvt_pk_bf16_f32 v100, v104, v105
    v_mfma_f32_16x16x32_bf16 v[152:155], a[92:95], v[116:119], v[152:155]
    s_waitcnt lgkmcnt(2)
    v_exp_f32 v106, v106
    v_mfma_f32_16x16x32_bf16 v[156:159], a[192:195], v[116:119], v[156:159]
    s_waitcnt lgkmcnt(0)
    v_mfma_f32_16x16x32_bf16 v[156:159], a[196:199], v[112:115], v[156:159]
    s_barrier
    v_mfma_f32_16x16x32_bf16 v[112:115], a[128:131], a[0:3], 0
    v_exp_f32 v107, v107
    v_mfma_f32_16x16x32_bf16 v[112:115], a[132:135], a[4:7], v[112:115]
    v_cvt_pk_bf16_f32 v101, v106, v107
    v_mfma_f32_16x16x32_bf16 v[112:115], a[136:139], a[8:11], v[112:115]
    v_exp_f32 v108, v108
    v_mfma_f32_16x16x32_bf16 v[112:115], a[140:143], a[12:15], v[112:115]
    v_mfma_f32_16x16x32_bf16 v[116:119], a[144:147], a[12:15], 0
    v_exp_f32 v109, v109
    v_mfma_f32_16x16x32_bf16 v[116:119], a[148:151], a[8:11], v[116:119]
    s_add_u32 s29, s27, 65536
    v_cvt_pk_bf16_f32 v102, v108, v109
    v_mfma_f32_16x16x32_bf16 v[116:119], a[152:155], a[4:7], v[116:119]
    s_add_u32 m0, s27, 131072
    v_exp_f32 v110, v110
    v_mfma_f32_16x16x32_bf16 v[116:119], a[156:159], a[0:3], v[116:119]
    buffer_load_dwordx4 v18, s[16:19], s29 offen lds
    v_mfma_f32_16x16x32_bf16 v[120:123], a[160:163], a[0:3], 0
    v_exp_f32 v111, v111
    v_mfma_f32_16x16x32_bf16 v[120:123], a[164:167], a[4:7], v[120:123]
    s_mov_b32 s30, 0
    buffer_load_dwordx4 v[52:55], v16, s[44:47], s30 offen offset:64 nt
    v_cvt_pk_bf16_f32 v103, v110, v111
    v_mfma_f32_16x16x32_bf16 v[120:123], a[168:171], a[8:11], v[120:123]
    s_waitcnt vmcnt(11)
    ds_read_b128 v[32:35], v244 offset:49152
    v_exp_f32 v112, v112
    v_mfma_f32_16x16x32_bf16 v[120:123], a[172:175], a[12:15], v[120:123]
    ds_read_b128 v[36:39], v245 offset:49152
    ds_read_b128 v[40:43], v246 offset:49152
    v_mfma_f32_16x16x32_bf16 v[124:127], a[176:179], a[12:15], 0
    v_exp_f32 v113, v113
    v_mfma_f32_16x16x32_bf16 v[124:127], a[180:183], a[8:11], v[124:127]
    buffer_load_dwordx4 v18, s[16:19], s29 offen offset:1024 lds
    ds_read_b128 v[44:47], v247 offset:49152
    v_cvt_pk_bf16_f32 v112, v112, v113
    v_mfma_f32_16x16x32_bf16 v[124:127], a[184:187], a[4:7], v[124:127]
    v_exp_f32 v114, v114
    v_mfma_f32_16x16x32_bf16 v[124:127], a[188:191], a[0:3], v[124:127]
    v_smfmac_f32_16x16x64_bf16 v[24:27], a[124:127], v[96:103], v22
    v_exp_f32 v115, v115
    v_mfma_f32_16x16x32_bf16 v[160:163], a[228:231], v[96:99], v[160:163]
    s_waitcnt lgkmcnt(3)
    v_cvt_pk_bf16_f32 v113, v114, v115
    v_lshlrev_b32 v0, 16, v32
    v_mfma_f32_16x16x32_bf16 v[160:163], a[232:235], v[100:103], v[160:163]
    v_exp_f32 v116, v116
    v_mfma_f32_16x16x32_bf16 v[164:167], a[236:239], v[100:103], v[164:167]
    buffer_load_dwordx4 v18, s[16:19], s29 offen offset:2048 lds
    v_mfma_f32_16x16x32_bf16 v[164:167], a[240:243], v[96:99], v[164:167]
    v_exp_f32 v117, v117
    v_mfma_f32_16x16x32_bf16 v[168:171], a[244:247], v[96:99], v[168:171]
    v_cvt_pk_bf16_f32 v114, v116, v117
    v_lshlrev_b32 v1, 16, v33
    v_mfma_f32_16x16x32_bf16 v[168:171], a[248:251], v[100:103], v[168:171]
Lpad1:
    s_cbranch_execz Lpad5
    v_exp_f32 v118, v118
    v_mfma_f32_16x16x32_bf16 v[172:175], a[252:255], v[100:103], v[172:175]
    buffer_load_dwordx4 v18, s[16:19], s29 offen offset:3072 lds
    v_mfma_f32_16x16x32_bf16 v[172:175], a[116:119], v[96:99], v[172:175]
    v_exp_f32 v119, v119
    v_mfma_f32_16x16x32_bf16 v[176:179], a[112:115], v[96:99], v[176:179]
    v_cvt_pk_bf16_f32 v115, v118, v119
    v_lshlrev_b32 v2, 16, v34
    v_mfma_f32_16x16x32_bf16 v[176:179], a[108:111], v[100:103], v[176:179]
    v_exp_f32 v120, v120
    v_mfma_f32_16x16x32_bf16 v[180:183], a[104:107], v[100:103], v[180:183]
    v_lshlrev_b32 v3, 16, v35
    v_and_b32 v32, s25, v32
    v_mfma_f32_16x16x32_bf16 v[180:183], a[100:103], v[96:99], v[180:183]
    v_exp_f32 v121, v121
    v_mfma_f32_16x16x32_bf16 v[184:187], a[96:99], v[96:99], v[184:187]
    v_cvt_pk_bf16_f32 v116, v120, v121
    v_and_b32 v33, s25, v33
    v_mfma_f32_16x16x32_bf16 v[184:187], a[92:95], v[100:103], v[184:187]
    v_exp_f32 v122, v122
    v_mfma_f32_16x16x32_bf16 v[188:191], a[192:195], v[100:103], v[188:191]
    v_and_b32 v34, s25, v34
    v_and_b32 v35, s25, v35
    v_mfma_f32_16x16x32_bf16 v[188:191], a[196:199], v[96:99], v[188:191]
    v_mul_f32 v0, s24, v0
    v_mul_f32 v1, s24, v1
    v_mul_f32 v2, s24, v2
    v_mul_f32 v3, s24, v3
    v_mul_f32 v32, s24, v32
    v_mul_f32 v33, s24, v33
    v_pk_mul_f32 v[34:35], v[34:35], s[34:35]
    v_cvt_pk_bf16_f32 v0, v0, v32
    v_cvt_pk_bf16_f32 v1, v1, v33
    v_cvt_pk_bf16_f32 v2, v2, v34
    v_cvt_pk_bf16_f32 v3, v3, v35
    v_accvgpr_write_b32 a16, v0
    v_accvgpr_write_b32 a17, v1
    v_accvgpr_write_b32 a18, v2
    v_accvgpr_write_b32 a19, v3
    s_waitcnt lgkmcnt(0)
    v_lshlrev_b32 v0, 16, v36
    v_lshlrev_b32 v1, 16, v37
    v_lshlrev_b32 v2, 16, v38
    v_lshlrev_b32 v3, 16, v39
    v_and_b32 v36, s25, v36
    v_and_b32 v37, s25, v37
    v_and_b32 v38, s25, v38
    v_and_b32 v39, s25, v39
    v_pk_mul_f32 v[0:1], v[0:1], s[34:35]
    v_pk_mul_f32 v[2:3], v[2:3], s[34:35]
    v_pk_mul_f32 v[36:37], v[36:37], s[34:35]
    v_pk_mul_f32 v[38:39], v[38:39], s[34:35]
    v_cvt_pk_bf16_f32 v0, v0, v36
    v_cvt_pk_bf16_f32 v1, v1, v37
    v_cvt_pk_bf16_f32 v2, v2, v38
    v_cvt_pk_bf16_f32 v3, v3, v39
    v_accvgpr_write_b32 a20, v0
    v_accvgpr_write_b32 a21, v1
    v_accvgpr_write_b32 a22, v2
    v_accvgpr_write_b32 a23, v3
    v_lshlrev_b32 v0, 16, v40
    v_lshlrev_b32 v1, 16, v41
    v_lshlrev_b32 v2, 16, v42
    v_lshlrev_b32 v3, 16, v43
    v_and_b32 v40, s25, v40
    v_and_b32 v41, s25, v41
    v_and_b32 v42, s25, v42
    v_and_b32 v43, s25, v43
    v_pk_mul_f32 v[0:1], v[0:1], s[34:35]
    v_pk_mul_f32 v[2:3], v[2:3], s[34:35]
    v_pk_mul_f32 v[40:41], v[40:41], s[34:35]
    v_pk_mul_f32 v[42:43], v[42:43], s[34:35]
    v_cvt_pk_bf16_f32 v0, v0, v40
    v_cvt_pk_bf16_f32 v1, v1, v41
    v_cvt_pk_bf16_f32 v2, v2, v42
    v_cvt_pk_bf16_f32 v3, v3, v43
    v_accvgpr_write_b32 a24, v0
    v_accvgpr_write_b32 a25, v1
    v_accvgpr_write_b32 a26, v2
    v_accvgpr_write_b32 a27, v3
    v_lshlrev_b32 v0, 16, v44
    v_lshlrev_b32 v1, 16, v45
    v_lshlrev_b32 v2, 16, v46
    v_lshlrev_b32 v3, 16, v47
    v_and_b32 v44, s25, v44
    v_and_b32 v45, s25, v45
    v_and_b32 v46, s25, v46
    v_and_b32 v47, s25, v47
    v_pk_mul_f32 v[0:1], v[0:1], s[34:35]
    v_pk_mul_f32 v[2:3], v[2:3], s[34:35]
    v_pk_mul_f32 v[44:45], v[44:45], s[34:35]
    v_pk_mul_f32 v[46:47], v[46:47], s[34:35]
    v_cvt_pk_bf16_f32 v0, v0, v44
    v_cvt_pk_bf16_f32 v1, v1, v45
    v_cvt_pk_bf16_f32 v2, v2, v46
    v_cvt_pk_bf16_f32 v3, v3, v47
    v_accvgpr_write_b32 a28, v0
    v_accvgpr_write_b32 a29, v1
    v_accvgpr_write_b32 a30, v2
    v_accvgpr_write_b32 a31, v3
    v_mfma_f32_16x16x32_bf16 v[96:99], a[128:131], a[16:19], 0
    v_exp_f32 v123, v123
    v_mfma_f32_16x16x32_bf16 v[96:99], a[132:135], a[20:23], v[96:99]
    ds_read_b128 a[128:131], v4 offset:0
    v_cvt_pk_bf16_f32 v117, v122, v123
    v_mfma_f32_16x16x32_bf16 v[96:99], a[136:139], a[24:27], v[96:99]
    v_exp_f32 v124, v124
    v_mfma_f32_16x16x32_bf16 v[96:99], a[140:143], a[28:31], v[96:99]
    ds_read_b128 a[132:135], v5 offset:0
    v_mfma_f32_16x16x32_bf16 v[100:103], a[144:147], a[28:31], 0
    v_exp_f32 v125, v125
    v_mfma_f32_16x16x32_bf16 v[100:103], a[148:151], a[24:27], v[100:103]
    ds_read_b128 a[136:139], v6 offset:0
    v_cvt_pk_bf16_f32 v118, v124, v125
    v_mfma_f32_16x16x32_bf16 v[100:103], a[152:155], a[20:23], v[100:103]
    v_exp_f32 v126, v126
    v_mfma_f32_16x16x32_bf16 v[100:103], a[156:159], a[16:19], v[100:103]
    ds_read_b128 a[140:143], v7 offset:0
    v_mfma_f32_16x16x32_bf16 v[104:107], a[160:163], a[16:19], 0
    v_exp_f32 v127, v127
    v_mfma_f32_16x16x32_bf16 v[104:107], a[164:167], a[20:23], v[104:107]
    ds_read_b128 a[144:147], v7 offset:4096
    v_cvt_pk_bf16_f32 v119, v126, v127
    v_mfma_f32_16x16x32_bf16 v[104:107], a[168:171], a[24:27], v[104:107]
    v_exp_f32 v96, v96
    v_mfma_f32_16x16x32_bf16 v[104:107], a[172:175], a[28:31], v[104:107]
    ds_read_b128 a[148:151], v6 offset:4096
    v_mfma_f32_16x16x32_bf16 v[108:111], a[176:179], a[28:31], 0
    v_exp_f32 v97, v97
    v_mfma_f32_16x16x32_bf16 v[108:111], a[180:183], a[24:27], v[108:111]
    ds_read_b128 a[152:155], v5 offset:4096
    v_cvt_pk_bf16_f32 v96, v96, v97
    v_mfma_f32_16x16x32_bf16 v[108:111], a[184:187], a[20:23], v[108:111]
    v_exp_f32 v98, v98
    v_mfma_f32_16x16x32_bf16 v[108:111], a[188:191], a[16:19], v[108:111]
    ds_read_b128 a[156:159], v4 offset:4096
    v_smfmac_f32_16x16x64_bf16 v[28:31], a[120:123], v[112:119], v22
    v_exp_f32 v99, v99
    v_mfma_f32_16x16x32_bf16 v[192:195], a[228:231], v[112:115], v[192:195]
    ds_read_b128 a[160:163], v4 offset:8192
    v_cvt_pk_bf16_f32 v97, v98, v99
    v_mfma_f32_16x16x32_bf16 v[192:195], a[232:235], v[116:119], v[192:195]
    v_exp_f32 v100, v100
    v_mfma_f32_16x16x32_bf16 v[196:199], a[236:239], v[116:119], v[196:199]
    ds_read_b128 a[164:167], v5 offset:8192
    v_mfma_f32_16x16x32_bf16 v[196:199], a[240:243], v[112:115], v[196:199]
    v_exp_f32 v101, v101
    v_mfma_f32_16x16x32_bf16 v[200:203], a[244:247], v[112:115], v[200:203]
    ds_read_b128 a[168:171], v6 offset:8192
    v_cvt_pk_bf16_f32 v98, v100, v101
    v_mfma_f32_16x16x32_bf16 v[200:203], a[248:251], v[116:119], v[200:203]
    v_exp_f32 v102, v102
    v_mfma_f32_16x16x32_bf16 v[204:207], a[252:255], v[116:119], v[204:207]
    ds_read_b128 a[172:175], v7 offset:8192
    v_mfma_f32_16x16x32_bf16 v[204:207], a[116:119], v[112:115], v[204:207]
    v_exp_f32 v103, v103
    v_mfma_f32_16x16x32_bf16 v[208:211], a[112:115], v[112:115], v[208:211]
    ds_read_b128 a[176:179], v7 offset:12288
    v_cvt_pk_bf16_f32 v99, v102, v103
    v_mfma_f32_16x16x32_bf16 v[208:211], a[108:111], v[116:119], v[208:211]
    v_exp_f32 v104, v104
    v_mfma_f32_16x16x32_bf16 v[212:215], a[104:107], v[116:119], v[212:215]
    ds_read_b128 a[180:183], v6 offset:12288
    v_mfma_f32_16x16x32_bf16 v[212:215], a[100:103], v[112:115], v[212:215]
    v_exp_f32 v105, v105
    v_mfma_f32_16x16x32_bf16 v[216:219], a[96:99], v[112:115], v[216:219]
    ds_read_b128 a[184:187], v5 offset:12288
    v_cvt_pk_bf16_f32 v100, v104, v105
    v_mfma_f32_16x16x32_bf16 v[216:219], a[92:95], v[116:119], v[216:219]
    v_exp_f32 v106, v106
    v_mfma_f32_16x16x32_bf16 v[220:223], a[192:195], v[116:119], v[220:223]
    s_mov_b32 s30, 0
    ds_read_b128 a[188:191], v4 offset:12288
    buffer_load_dwordx4 v[56:59], v16, s[44:47], s30 offen offset:128 nt
    v_mfma_f32_16x16x32_bf16 v[220:223], a[196:199], v[112:115], v[220:223]
    s_waitcnt vmcnt(11) lgkmcnt(5)
    ds_read_b64_tr_b16 a[200:201], v12 offset:0
    ds_read_b64_tr_b16 a[202:203], v12 offset:4096
    v_mfma_f32_16x16x32_bf16 v[112:115], a[128:131], a[0:3], 0
    s_barrier
    v_exp_f32 v107, v107
    v_mfma_f32_16x16x32_bf16 v[112:115], a[132:135], a[4:7], v[112:115]
    ds_read_b64_tr_b16 a[204:205], v12 offset:8192
    v_cvt_pk_bf16_f32 v101, v106, v107
    v_mfma_f32_16x16x32_bf16 v[112:115], a[136:139], a[8:11], v[112:115]
    v_exp_f32 v108, v108
    v_mfma_f32_16x16x32_bf16 v[112:115], a[140:143], a[12:15], v[112:115]
    ds_read_b64_tr_b16 a[206:207], v12 offset:12288
    ds_read_b64_tr_b16 a[208:209], v12 offset:8200
    v_mfma_f32_16x16x32_bf16 v[116:119], a[144:147], a[12:15], 0
    v_exp_f32 v109, v109
    v_mfma_f32_16x16x32_bf16 v[116:119], a[148:151], a[8:11], v[116:119]
    ds_read_b64_tr_b16 a[210:211], v12 offset:12296
    v_cvt_pk_bf16_f32 v102, v108, v109
    v_mfma_f32_16x16x32_bf16 v[116:119], a[152:155], a[4:7], v[116:119]
    v_exp_f32 v110, v110
    v_mfma_f32_16x16x32_bf16 v[116:119], a[156:159], a[0:3], v[116:119]
    ds_read_b64_tr_b16 a[212:213], v12 offset:8
    v_mfma_f32_16x16x32_bf16 v[120:123], a[160:163], a[0:3], 0
    v_exp_f32 v111, v111
    v_mfma_f32_16x16x32_bf16 v[120:123], a[164:167], a[4:7], v[120:123]
    ds_read_b64_tr_b16 a[214:215], v12 offset:4104
    v_cvt_pk_bf16_f32 v103, v110, v111
    v_mfma_f32_16x16x32_bf16 v[120:123], a[168:171], a[8:11], v[120:123]
    s_waitcnt lgkmcnt(6)
    v_exp_f32 v112, v112
    v_mfma_f32_16x16x32_bf16 v[120:123], a[172:175], a[12:15], v[120:123]
    ds_read_b64_tr_b16 a[216:217], v13 offset:0
    v_mfma_f32_16x16x32_bf16 v[124:127], a[176:179], a[12:15], 0
    v_exp_f32 v113, v113
    v_mfma_f32_16x16x32_bf16 v[124:127], a[180:183], a[8:11], v[124:127]
    ds_read_b64_tr_b16 a[218:219], v13 offset:4096
    v_cvt_pk_bf16_f32 v112, v112, v113
    v_mfma_f32_16x16x32_bf16 v[124:127], a[184:187], a[4:7], v[124:127]
    v_exp_f32 v114, v114
    v_mfma_f32_16x16x32_bf16 v[124:127], a[188:191], a[0:3], v[124:127]
    s_mov_b32 s30, 0
    ds_read_b64_tr_b16 a[220:221], v13 offset:8192
    buffer_load_dwordx4 v[60:63], v16, s[44:47], s30 offen offset:192 nt
    v_smfmac_f32_16x16x64_bf16 v[28:31], a[124:127], v[96:103], v22
    v_exp_f32 v115, v115
    v_mfma_f32_16x16x32_bf16 v[224:227], a[228:231], v[96:99], 0
    ds_read_b64_tr_b16 a[222:223], v13 offset:12288
    v_cvt_pk_bf16_f32 v113, v114, v115
    v_mfma_f32_16x16x32_bf16 v[224:227], a[232:235], v[100:103], v[224:227]
    v_exp_f32 v116, v116
    v_mfma_f32_16x16x32_bf16 v[228:231], a[236:239], v[100:103], 0
    ds_read_b64_tr_b16 a[224:225], v13 offset:8200
    v_mfma_f32_16x16x32_bf16 v[228:231], a[240:243], v[96:99], v[228:231]
    v_exp_f32 v117, v117
    v_mfma_f32_16x16x32_bf16 v[232:235], a[244:247], v[96:99], 0
    ds_read_b64_tr_b16 a[226:227], v13 offset:12296
    v_cvt_pk_bf16_f32 v114, v116, v117
    v_mfma_f32_16x16x32_bf16 v[232:235], a[248:251], v[100:103], v[232:235]
    v_exp_f32 v118, v118
    v_mfma_f32_16x16x32_bf16 v[236:239], a[252:255], v[100:103], 0
    ds_read_b64_tr_b16 a[228:229], v13 offset:8
    v_mfma_f32_16x16x32_bf16 v[236:239], a[116:119], v[96:99], v[236:239]
    v_exp_f32 v119, v119
    v_mfma_f32_16x16x32_bf16 v[240:243], a[112:115], v[96:99], 0
    ds_read_b64_tr_b16 a[230:231], v13 offset:4104
    v_cvt_pk_bf16_f32 v115, v118, v119
    v_mfma_f32_16x16x32_bf16 v[240:243], a[108:111], v[100:103], v[240:243]
    v_exp_f32 v120, v120
    v_mfma_f32_16x16x32_bf16 v[244:247], a[104:107], v[100:103], 0
    ds_read_b64_tr_b16 a[232:233], v14 offset:0
    v_mfma_f32_16x16x32_bf16 v[244:247], a[100:103], v[96:99], v[244:247]
    v_exp_f32 v121, v121
    v_mfma_f32_16x16x32_bf16 v[248:251], a[96:99], v[96:99], 0
    ds_read_b64_tr_b16 a[234:235], v14 offset:4096
    v_cvt_pk_bf16_f32 v116, v120, v121
    v_mfma_f32_16x16x32_bf16 v[248:251], a[92:95], v[100:103], v[248:251]
    s_add_u32 m0, s26, 65536
    v_exp_f32 v122, v122
    v_mfma_f32_16x16x32_bf16 v[252:255], a[192:195], v[100:103], 0
    ds_read_b64_tr_b16 a[236:237], v14 offset:8192
    buffer_load_dwordx4 v17, s[12:15], m0 offen nt lds
    v_mfma_f32_16x16x32_bf16 v[252:255], a[196:199], v[96:99], v[252:255]
    ds_read_b64_tr_b16 a[238:239], v14 offset:12288
    v_mfma_f32_16x16x32_bf16 v[96:99], a[128:131], a[16:19], 0
    v_exp_f32 v123, v123
    v_mfma_f32_16x16x32_bf16 v[96:99], a[132:135], a[20:23], v[96:99]
    ds_read_b64_tr_b16 a[240:241], v14 offset:8200
    v_cvt_pk_bf16_f32 v117, v122, v123
    v_mfma_f32_16x16x32_bf16 v[96:99], a[136:139], a[24:27], v[96:99]
    v_exp_f32 v124, v124
    v_mfma_f32_16x16x32_bf16 v[96:99], a[140:143], a[28:31], v[96:99]
    s_add_u32 m0, s26, 69632
    ds_read_b64_tr_b16 a[242:243], v14 offset:12296
    ds_read_b128 a[128:131], v4 offset:16384
    v_mfma_f32_16x16x32_bf16 v[100:103], a[144:147], a[28:31], 0
    buffer_load_dwordx4 v17, s[12:15], m0 offen nt lds
    v_exp_f32 v125, v125
    v_mfma_f32_16x16x32_bf16 v[100:103], a[148:151], a[24:27], v[100:103]
    ds_read_b64_tr_b16 a[244:245], v14 offset:8
    v_cvt_pk_bf16_f32 v118, v124, v125
    v_mfma_f32_16x16x32_bf16 v[100:103], a[152:155], a[20:23], v[100:103]
    v_exp_f32 v126, v126
    v_mfma_f32_16x16x32_bf16 v[100:103], a[156:159], a[16:19], v[100:103]
    s_add_u32 m0, s26, 73728
    ds_read_b64_tr_b16 a[246:247], v14 offset:4104
    ds_read_b128 a[132:135], v5 offset:16384
    v_mfma_f32_16x16x32_bf16 v[104:107], a[160:163], a[16:19], 0
    buffer_load_dwordx4 v17, s[12:15], m0 offen nt lds
    v_exp_f32 v127, v127
    v_mfma_f32_16x16x32_bf16 v[104:107], a[164:167], a[20:23], v[104:107]
    ds_read_b64_tr_b16 a[248:249], v15 offset:0
    v_cvt_pk_bf16_f32 v119, v126, v127
    v_mfma_f32_16x16x32_bf16 v[104:107], a[168:171], a[24:27], v[104:107]
    v_exp_f32 v96, v96
    v_mfma_f32_16x16x32_bf16 v[104:107], a[172:175], a[28:31], v[104:107]
    s_add_u32 m0, s26, 77824
    ds_read_b64_tr_b16 a[250:251], v15 offset:4096
    ds_read_b128 a[136:139], v6 offset:16384
    v_mfma_f32_16x16x32_bf16 v[108:111], a[176:179], a[28:31], 0
    buffer_load_dwordx4 v17, s[12:15], m0 offen nt lds
    v_exp_f32 v97, v97
    v_mfma_f32_16x16x32_bf16 v[108:111], a[180:183], a[24:27], v[108:111]
    ds_read_b64_tr_b16 a[252:253], v15 offset:8192
    v_cvt_pk_bf16_f32 v96, v96, v97
    v_mfma_f32_16x16x32_bf16 v[108:111], a[184:187], a[20:23], v[108:111]
    v_exp_f32 v98, v98
    v_mfma_f32_16x16x32_bf16 v[108:111], a[188:191], a[16:19], v[108:111]
    ds_read_b64_tr_b16 a[254:255], v15 offset:12288
    ds_read_b128 a[140:143], v7 offset:16384
    v_smfmac_f32_16x16x64_bf16 v[28:31], a[120:123], v[112:119], v22
    v_exp_f32 v99, v99
    v_mfma_f32_16x16x32_bf16 v[192:195], a[200:203], v[112:115], v[192:195]
    s_waitcnt lgkmcnt(6)
    ds_read_b64_tr_b16 a[116:117], v15 offset:8200
    v_cvt_pk_bf16_f32 v97, v98, v99
    v_mfma_f32_16x16x32_bf16 v[192:195], a[204:207], v[116:119], v[192:195]
    v_exp_f32 v100, v100
    v_mfma_f32_16x16x32_bf16 v[196:199], a[208:211], v[116:119], v[196:199]
    ds_read_b64_tr_b16 a[118:119], v15 offset:12296
    ds_read_b128 a[144:147], v7 offset:20480
    v_mfma_f32_16x16x32_bf16 v[196:199], a[212:215], v[112:115], v[196:199]
    v_exp_f32 v101, v101
    v_mfma_f32_16x16x32_bf16 v[200:203], a[216:219], v[112:115], v[200:203]
    ds_read_b64_tr_b16 a[112:113], v15 offset:8
    v_cvt_pk_bf16_f32 v98, v100, v101
    v_mfma_f32_16x16x32_bf16 v[200:203], a[220:223], v[116:119], v[200:203]
    v_exp_f32 v102, v102
    v_mfma_f32_16x16x32_bf16 v[204:207], a[224:227], v[116:119], v[204:207]
    ds_read_b64_tr_b16 a[114:115], v15 offset:4104
    ds_read_b128 a[148:151], v6 offset:20480
    v_mfma_f32_16x16x32_bf16 v[204:207], a[228:231], v[112:115], v[204:207]
    v_exp_f32 v103, v103
    v_mfma_f32_16x16x32_bf16 v[208:211], a[232:235], v[112:115], v[208:211]
    ds_read_b128 a[152:155], v5 offset:20480
    v_cvt_pk_bf16_f32 v99, v102, v103
    v_mfma_f32_16x16x32_bf16 v[208:211], a[236:239], v[116:119], v[208:211]
    v_exp_f32 v104, v104
    v_mfma_f32_16x16x32_bf16 v[212:215], a[240:243], v[116:119], v[212:215]
    ds_read_b128 a[156:159], v4 offset:20480
    ds_read_b128 a[160:163], v4 offset:24576
    v_mfma_f32_16x16x32_bf16 v[212:215], a[244:247], v[112:115], v[212:215]
    s_waitcnt lgkmcnt(8)
    v_exp_f32 v105, v105
    v_mfma_f32_16x16x32_bf16 v[216:219], a[248:251], v[112:115], v[216:219]
    ds_read_b128 a[164:167], v5 offset:24576
    v_cvt_pk_bf16_f32 v100, v104, v105
    v_mfma_f32_16x16x32_bf16 v[216:219], a[252:255], v[116:119], v[216:219]
    s_waitcnt lgkmcnt(6)
    v_exp_f32 v106, v106
    v_mfma_f32_16x16x32_bf16 v[220:223], a[116:119], v[116:119], v[220:223]
    s_waitcnt lgkmcnt(5)
    ds_read_b128 a[168:171], v6 offset:24576
    ds_read_b128 a[172:175], v7 offset:24576
    v_mfma_f32_16x16x32_bf16 v[220:223], a[112:115], v[112:115], v[220:223]
    s_add_u32 m0, s26, 81920
    ds_read_b128 a[176:179], v7 offset:28672
    ds_read_b128 a[180:183], v6 offset:28672
    v_mfma_f32_16x16x32_bf16 v[112:115], a[128:131], a[16:19], 0
    buffer_load_dwordx4 v17, s[12:15], m0 offen nt lds
    v_exp_f32 v107, v107
    v_mfma_f32_16x16x32_bf16 v[112:115], a[132:135], a[20:23], v[112:115]
    ds_read_b128 a[184:187], v5 offset:28672
    v_cvt_pk_bf16_f32 v101, v106, v107
    v_mfma_f32_16x16x32_bf16 v[112:115], a[136:139], a[24:27], v[112:115]
    v_exp_f32 v108, v108
    v_mfma_f32_16x16x32_bf16 v[112:115], a[140:143], a[28:31], v[112:115]
    s_add_u32 m0, s26, 86016
    ds_read_b128 a[188:191], v4 offset:28672
    ds_read_b128 a[128:131], v4 offset:49152
    v_mfma_f32_16x16x32_bf16 v[116:119], a[144:147], a[28:31], 0
    s_waitcnt lgkmcnt(7)
    buffer_load_dwordx4 v17, s[12:15], m0 offen nt lds
    v_exp_f32 v109, v109
    v_mfma_f32_16x16x32_bf16 v[116:119], a[148:151], a[24:27], v[116:119]
    ds_read_b128 a[132:135], v5 offset:49152
    v_cvt_pk_bf16_f32 v102, v108, v109
    v_mfma_f32_16x16x32_bf16 v[116:119], a[152:155], a[20:23], v[116:119]
    s_mov_b32 s30, 4096
    v_exp_f32 v110, v110
    v_mfma_f32_16x16x32_bf16 v[116:119], a[156:159], a[16:19], v[116:119]
    s_add_u32 m0, s26, 90112
    ds_read_b128 a[136:139], v6 offset:49152
    ds_read_b128 a[140:143], v7 offset:49152
    buffer_load_dwordx4 v[32:35], v16, s[44:47], s30 offen nt
    v_mfma_f32_16x16x32_bf16 v[120:123], a[160:163], a[16:19], 0
    buffer_load_dwordx4 v17, s[12:15], m0 offen nt lds
    v_exp_f32 v111, v111
    v_mfma_f32_16x16x32_bf16 v[120:123], a[164:167], a[20:23], v[120:123]
    s_waitcnt lgkmcnt(5)
    ds_read_b128 a[144:147], v7 offset:53248
    v_cvt_pk_bf16_f32 v103, v110, v111
    v_mfma_f32_16x16x32_bf16 v[120:123], a[168:171], a[24:27], v[120:123]
    v_exp_f32 v112, v112
    v_mfma_f32_16x16x32_bf16 v[120:123], a[172:175], a[28:31], v[120:123]
    s_add_u32 m0, s26, 94208
    ds_read_b128 a[148:151], v6 offset:53248
    ds_read_b128 a[152:155], v5 offset:53248
    v_mfma_f32_16x16x32_bf16 v[124:127], a[176:179], a[28:31], 0
    buffer_load_dwordx4 v17, s[12:15], m0 offen nt lds
    v_exp_f32 v113, v113
    v_mfma_f32_16x16x32_bf16 v[124:127], a[180:183], a[24:27], v[124:127]
    ds_read_b128 a[156:159], v4 offset:53248
    v_cvt_pk_bf16_f32 v112, v112, v113
    v_mfma_f32_16x16x32_bf16 v[124:127], a[184:187], a[20:23], v[124:127]
    s_waitcnt lgkmcnt(6)
    v_exp_f32 v114, v114
    v_mfma_f32_16x16x32_bf16 v[124:127], a[188:191], a[16:19], v[124:127]
    ds_read_b128 a[160:163], v4 offset:57344
    ds_read_b128 a[164:167], v5 offset:57344
    v_smfmac_f32_16x16x64_bf16 v[28:31], a[124:127], v[96:103], v22
    v_exp_f32 v115, v115
    v_mfma_f32_16x16x32_bf16 v[224:227], a[200:203], v[96:99], v[224:227]
    ds_read_b128 a[168:171], v6 offset:57344
    v_cvt_pk_bf16_f32 v113, v114, v115
    v_mfma_f32_16x16x32_bf16 v[224:227], a[204:207], v[100:103], v[224:227]
    v_exp_f32 v116, v116
    v_mfma_f32_16x16x32_bf16 v[228:231], a[208:211], v[100:103], v[228:231]
    ds_read_b128 a[172:175], v7 offset:57344
    ds_read_b128 a[176:179], v7 offset:61440
    v_mfma_f32_16x16x32_bf16 v[228:231], a[212:215], v[96:99], v[228:231]
    v_exp_f32 v117, v117
    v_mfma_f32_16x16x32_bf16 v[232:235], a[216:219], v[96:99], v[232:235]
    ds_read_b128 a[180:183], v6 offset:61440
    v_cvt_pk_bf16_f32 v114, v116, v117
    v_mfma_f32_16x16x32_bf16 v[232:235], a[220:223], v[100:103], v[232:235]
    v_exp_f32 v118, v118
    v_mfma_f32_16x16x32_bf16 v[236:239], a[224:227], v[100:103], v[236:239]
    ds_read_b128 a[184:187], v5 offset:61440
    ds_read_b128 a[188:191], v4 offset:61440
    v_mfma_f32_16x16x32_bf16 v[236:239], a[228:231], v[96:99], v[236:239]
    s_mov_b32 s30, 4096
    buffer_load_dwordx4 v[36:39], v16, s[44:47], s30 offen offset:64 nt
    v_exp_f32 v119, v119
    v_mfma_f32_16x16x32_bf16 v[240:243], a[232:235], v[96:99], v[240:243]
    ds_read_b64_tr_b16 a[108:109], v12 offset:16384
    v_cvt_pk_bf16_f32 v115, v118, v119
    v_mfma_f32_16x16x32_bf16 v[240:243], a[236:239], v[100:103], v[240:243]
    v_exp_f32 v120, v120
    v_mfma_f32_16x16x32_bf16 v[244:247], a[240:243], v[100:103], v[244:247]
    ds_read_b64_tr_b16 a[110:111], v12 offset:20480
    ds_read_b64_tr_b16 a[104:105], v12 offset:24576
    v_mfma_f32_16x16x32_bf16 v[244:247], a[244:247], v[96:99], v[244:247]
    v_exp_f32 v121, v121
    v_mfma_f32_16x16x32_bf16 v[248:251], a[248:251], v[96:99], v[248:251]
    ds_read_b64_tr_b16 a[106:107], v12 offset:28672
    v_cvt_pk_bf16_f32 v116, v120, v121
    v_mfma_f32_16x16x32_bf16 v[248:251], a[252:255], v[100:103], v[248:251]
    v_exp_f32 v122, v122
    v_mfma_f32_16x16x32_bf16 v[252:255], a[116:119], v[100:103], v[252:255]
    ds_read_b64_tr_b16 a[100:101], v12 offset:24584
    ds_read_b64_tr_b16 a[102:103], v12 offset:28680
    v_mfma_f32_16x16x32_bf16 v[252:255], a[112:115], v[96:99], v[252:255]
    s_waitcnt vmcnt(17)
    ds_read_b64_tr_b16 a[96:97], v12 offset:16392
    ds_read_b64_tr_b16 a[98:99], v12 offset:20488
    v_mfma_f32_16x16x32_bf16 v[96:99], a[128:131], v[64:67], 0
    s_barrier
    v_exp_f32 v123, v123
    v_mfma_f32_16x16x32_bf16 v[96:99], a[132:135], v[68:71], v[96:99]
    s_waitcnt lgkmcnt(7)
    ds_read_b64_tr_b16 a[92:93], v13 offset:16384
    v_cvt_pk_bf16_f32 v117, v122, v123
    v_mfma_f32_16x16x32_bf16 v[96:99], a[136:139], v[72:75], v[96:99]
    v_exp_f32 v124, v124
    v_mfma_f32_16x16x32_bf16 v[96:99], a[140:143], v[76:79], v[96:99]
    ds_read_b64_tr_b16 a[94:95], v13 offset:20480
    ds_read_b64_tr_b16 a[192:193], v13 offset:24576
    v_mfma_f32_16x16x32_bf16 v[100:103], a[144:147], v[76:79], 0
    v_exp_f32 v125, v125
    v_mfma_f32_16x16x32_bf16 v[100:103], a[148:151], v[72:75], v[100:103]
    ds_read_b64_tr_b16 a[194:195], v13 offset:28672
    v_cvt_pk_bf16_f32 v118, v124, v125
    v_mfma_f32_16x16x32_bf16 v[100:103], a[152:155], v[68:71], v[100:103]
    v_exp_f32 v126, v126
    v_mfma_f32_16x16x32_bf16 v[100:103], a[156:159], v[64:67], v[100:103]
    ds_read_b64_tr_b16 a[196:197], v13 offset:24584
    ds_read_b64_tr_b16 a[198:199], v13 offset:28680
    v_mfma_f32_16x16x32_bf16 v[104:107], a[160:163], v[64:67], 0
    v_exp_f32 v127, v127
    v_mfma_f32_16x16x32_bf16 v[104:107], a[164:167], v[68:71], v[104:107]
    ds_read_b64_tr_b16 a[200:201], v13 offset:16392
    v_cvt_pk_bf16_f32 v119, v126, v127
    v_mfma_f32_16x16x32_bf16 v[104:107], a[168:171], v[72:75], v[104:107]
    v_exp_f32 v96, v96
    v_mfma_f32_16x16x32_bf16 v[104:107], a[172:175], v[76:79], v[104:107]
    ds_read_b64_tr_b16 a[202:203], v13 offset:20488
    ds_read_b64_tr_b16 a[204:205], v14 offset:16384
    v_mfma_f32_16x16x32_bf16 v[108:111], a[176:179], v[76:79], 0
    v_exp_f32 v97, v97
    v_mfma_f32_16x16x32_bf16 v[108:111], a[180:183], v[72:75], v[108:111]
    ds_read_b64_tr_b16 a[206:207], v14 offset:20480
    v_cvt_pk_bf16_f32 v96, v96, v97
    v_mfma_f32_16x16x32_bf16 v[108:111], a[184:187], v[68:71], v[108:111]
    v_exp_f32 v98, v98
    v_mfma_f32_16x16x32_bf16 v[108:111], a[188:191], v[64:67], v[108:111]
    ds_read_b64_tr_b16 a[208:209], v14 offset:24576
    ds_read_b64_tr_b16 a[210:211], v14 offset:28672
    v_smfmac_f32_16x16x64_bf16 v[28:31], a[124:127], v[112:119], v22
    s_waitcnt lgkmcnt(8)
    v_exp_f32 v99, v99
    v_mfma_f32_16x16x32_bf16 v[224:227], a[108:111], v[112:115], v[224:227]
    ds_read_b64_tr_b16 a[212:213], v14 offset:24584
    v_cvt_pk_bf16_f32 v97, v98, v99
    v_mfma_f32_16x16x32_bf16 v[224:227], a[104:107], v[116:119], v[224:227]
    v_exp_f32 v100, v100
    v_mfma_f32_16x16x32_bf16 v[228:231], a[100:103], v[116:119], v[228:231]
    ds_read_b64_tr_b16 a[214:215], v14 offset:28680
    ds_read_b64_tr_b16 a[216:217], v14 offset:16392
    v_mfma_f32_16x16x32_bf16 v[228:231], a[96:99], v[112:115], v[228:231]
    ds_read_b64_tr_b16 a[218:219], v14 offset:20488
    v_exp_f32 v101, v101
    v_mfma_f32_16x16x32_bf16 v[232:235], a[92:95], v[112:115], v[232:235]
    ds_read_b64_tr_b16 a[220:221], v15 offset:16384
    ds_read_b64_tr_b16 a[222:223], v15 offset:20480
    v_cvt_pk_bf16_f32 v98, v100, v101
    v_mfma_f32_16x16x32_bf16 v[232:235], a[192:195], v[116:119], v[232:235]
    s_waitcnt lgkmcnt(8)
    ds_read_b64_tr_b16 a[224:225], v15 offset:24576
    ds_read_b64_tr_b16 a[226:227], v15 offset:28672
    v_exp_f32 v102, v102
    v_mfma_f32_16x16x32_bf16 v[236:239], a[196:199], v[116:119], v[236:239]
    ds_read_b64_tr_b16 a[228:229], v15 offset:24584
    ds_read_b64_tr_b16 a[230:231], v15 offset:28680
    v_mfma_f32_16x16x32_bf16 v[236:239], a[200:203], v[112:115], v[236:239]
    ds_read_b64_tr_b16 a[232:233], v15 offset:16392
    ds_read_b64_tr_b16 a[234:235], v15 offset:20488
    v_exp_f32 v103, v103
    v_mfma_f32_16x16x32_bf16 v[240:243], a[204:207], v[112:115], v[240:243]
    s_waitcnt lgkmcnt(11)
    ds_read_b64_tr_b16 a[236:237], v12 offset:49152
    v_cvt_pk_bf16_f32 v99, v102, v103
    v_mfma_f32_16x16x32_bf16 v[240:243], a[208:211], v[116:119], v[240:243]
    s_waitcnt lgkmcnt(10)
    v_exp_f32 v104, v104
    v_mfma_f32_16x16x32_bf16 v[244:247], a[212:215], v[116:119], v[244:247]
    s_waitcnt lgkmcnt(9)
    ds_read_b64_tr_b16 a[238:239], v12 offset:53248
    ds_read_b64_tr_b16 a[240:241], v12 offset:57344
    v_mfma_f32_16x16x32_bf16 v[244:247], a[216:219], v[112:115], v[244:247]
    s_waitcnt lgkmcnt(9)
    v_exp_f32 v105, v105
    v_mfma_f32_16x16x32_bf16 v[248:251], a[220:223], v[112:115], v[248:251]
    s_waitcnt lgkmcnt(7)
    ds_read_b64_tr_b16 a[242:243], v12 offset:61440
    v_cvt_pk_bf16_f32 v100, v104, v105
    v_mfma_f32_16x16x32_bf16 v[248:251], a[224:227], v[116:119], v[248:251]
    s_waitcnt lgkmcnt(6)
    v_exp_f32 v106, v106
    v_mfma_f32_16x16x32_bf16 v[252:255], a[228:231], v[116:119], v[252:255]
    s_waitcnt lgkmcnt(4)
    ds_read_b64_tr_b16 a[244:245], v12 offset:57352
    ds_read_b64_tr_b16 a[246:247], v12 offset:61448
    v_mfma_f32_16x16x32_bf16 v[252:255], a[232:235], v[112:115], v[252:255]
    s_add_u32 m0, s26, 32768
    ds_read_b64_tr_b16 a[248:249], v12 offset:49160
    ds_read_b64_tr_b16 a[250:251], v12 offset:53256
    v_mfma_f32_16x16x32_bf16 v[112:115], a[128:131], v[80:83], 0
    buffer_load_dwordx4 v17, s[48:51], m0 offen nt lds
    v_exp_f32 v107, v107
    v_mfma_f32_16x16x32_bf16 v[112:115], a[132:135], v[84:87], v[112:115]
    ds_read_b64_tr_b16 a[252:253], v13 offset:49152
    v_cvt_pk_bf16_f32 v101, v106, v107
    v_mfma_f32_16x16x32_bf16 v[112:115], a[136:139], v[88:91], v[112:115]
    v_exp_f32 v108, v108
    v_mfma_f32_16x16x32_bf16 v[112:115], a[140:143], v[92:95], v[112:115]
    s_add_u32 m0, s26, 36864
    ds_read_b64_tr_b16 a[254:255], v13 offset:53248
    ds_read_b64_tr_b16 a[116:117], v13 offset:57344
    v_mfma_f32_16x16x32_bf16 v[116:119], a[144:147], v[92:95], 0
    buffer_load_dwordx4 v17, s[48:51], m0 offen nt lds
    v_exp_f32 v109, v109
    v_mfma_f32_16x16x32_bf16 v[116:119], a[148:151], v[88:91], v[116:119]
    ds_read_b64_tr_b16 a[118:119], v13 offset:61440
    v_cvt_pk_bf16_f32 v102, v108, v109
    v_mfma_f32_16x16x32_bf16 v[116:119], a[152:155], v[84:87], v[116:119]
    v_exp_f32 v110, v110
    v_mfma_f32_16x16x32_bf16 v[116:119], a[156:159], v[80:83], v[116:119]
    s_add_u32 m0, s26, 40960
    ds_read_b64_tr_b16 a[112:113], v13 offset:57352
    ds_read_b64_tr_b16 a[114:115], v13 offset:61448
    v_mfma_f32_16x16x32_bf16 v[120:123], a[160:163], v[80:83], 0
    buffer_load_dwordx4 v17, s[48:51], m0 offen nt lds
    v_exp_f32 v111, v111
    v_mfma_f32_16x16x32_bf16 v[120:123], a[164:167], v[84:87], v[120:123]
    ds_read_b64_tr_b16 a[108:109], v13 offset:49160
    v_cvt_pk_bf16_f32 v103, v110, v111
    v_mfma_f32_16x16x32_bf16 v[120:123], a[168:171], v[88:91], v[120:123]
    v_exp_f32 v112, v112
    v_mfma_f32_16x16x32_bf16 v[120:123], a[172:175], v[92:95], v[120:123]
    s_add_u32 m0, s26, 45056
    ds_read_b64_tr_b16 a[110:111], v13 offset:53256
    ds_read_b64_tr_b16 a[104:105], v14 offset:49152
    v_mfma_f32_16x16x32_bf16 v[124:127], a[176:179], v[92:95], 0
Lpad2:
    s_cbranch_execz Lpad6
    buffer_load_dwordx4 v17, s[48:51], m0 offen nt lds
    v_exp_f32 v113, v113
    v_mfma_f32_16x16x32_bf16 v[124:127], a[180:183], v[88:91], v[124:127]
    ds_read_b64_tr_b16 a[106:107], v14 offset:53248
    v_cvt_pk_bf16_f32 v112, v112, v113
    v_mfma_f32_16x16x32_bf16 v[124:127], a[184:187], v[84:87], v[124:127]
    v_exp_f32 v114, v114
    v_mfma_f32_16x16x32_bf16 v[124:127], a[188:191], v[80:83], v[124:127]
    ds_read_b64_tr_b16 a[100:101], v14 offset:57344
    ds_read_b64_tr_b16 a[102:103], v14 offset:61440
    v_smfmac_f32_16x16x64_bf16 v[24:27], a[120:123], v[96:103], v22
    s_waitcnt lgkmcnt(6)
    v_exp_f32 v115, v115
    v_mfma_f32_16x16x32_bf16 v[128:131], a[236:239], v[96:99], v[128:131]
    ds_read_b64_tr_b16 a[96:97], v14 offset:57352
    v_cvt_pk_bf16_f32 v113, v114, v115
    v_mfma_f32_16x16x32_bf16 v[128:131], a[240:243], v[100:103], v[128:131]
    v_exp_f32 v116, v116
    v_mfma_f32_16x16x32_bf16 v[132:135], a[244:247], v[100:103], v[132:135]
    ds_read_b64_tr_b16 a[98:99], v14 offset:61448
    ds_read_b64_tr_b16 a[92:93], v14 offset:49160
    v_mfma_f32_16x16x32_bf16 v[132:135], a[248:251], v[96:99], v[132:135]
    ds_read_b64_tr_b16 a[94:95], v14 offset:53256
    v_exp_f32 v117, v117
    v_mfma_f32_16x16x32_bf16 v[136:139], a[252:255], v[96:99], v[136:139]
    ds_read_b64_tr_b16 a[192:193], v15 offset:49152
    ds_read_b64_tr_b16 a[194:195], v15 offset:53248
    v_cvt_pk_bf16_f32 v114, v116, v117
    v_mfma_f32_16x16x32_bf16 v[136:139], a[116:119], v[100:103], v[136:139]
    ds_read_b64_tr_b16 a[196:197], v15 offset:57344
    ds_read_b64_tr_b16 a[198:199], v15 offset:61440
    v_exp_f32 v118, v118
    v_mfma_f32_16x16x32_bf16 v[140:143], a[112:115], v[100:103], v[140:143]
    s_waitcnt lgkmcnt(8)
    ds_read_b64_tr_b16 a[200:201], v15 offset:57352
    ds_read_b64_tr_b16 a[202:203], v15 offset:61448
    v_mfma_f32_16x16x32_bf16 v[140:143], a[108:111], v[96:99], v[140:143]
    ds_read_b64_tr_b16 a[204:205], v15 offset:49160
    ds_read_b64_tr_b16 a[206:207], v15 offset:53256
    v_exp_f32 v119, v119
    v_mfma_f32_16x16x32_bf16 v[144:147], a[104:107], v[96:99], v[144:147]
    v_cvt_pk_bf16_f32 v115, v118, v119
    v_lshlrev_b32 v0, 16, v48
    v_mfma_f32_16x16x32_bf16 v[144:147], a[100:103], v[100:103], v[144:147]
    s_waitcnt lgkmcnt(9)
    v_exp_f32 v120, v120
    v_mfma_f32_16x16x32_bf16 v[148:151], a[96:99], v[100:103], v[148:151]
    s_waitcnt lgkmcnt(8)
    v_lshlrev_b32 v1, 16, v49
    v_lshlrev_b32 v2, 16, v50
    v_mfma_f32_16x16x32_bf16 v[148:151], a[92:95], v[96:99], v[148:151]
    s_waitcnt lgkmcnt(6)
    v_exp_f32 v121, v121
    v_mfma_f32_16x16x32_bf16 v[152:155], a[192:195], v[96:99], v[152:155]
    s_waitcnt lgkmcnt(4)
    v_cvt_pk_bf16_f32 v116, v120, v121
    v_lshlrev_b32 v3, 16, v51
    v_mfma_f32_16x16x32_bf16 v[152:155], a[196:199], v[100:103], v[152:155]
    s_waitcnt lgkmcnt(2)
    v_exp_f32 v122, v122
    v_mfma_f32_16x16x32_bf16 v[156:159], a[200:203], v[100:103], v[156:159]
    s_waitcnt vmcnt(10) lgkmcnt(0)
    v_and_b32 v48, s25, v48
    v_mfma_f32_16x16x32_bf16 v[156:159], a[204:207], v[96:99], v[156:159]
    s_barrier
    v_mfma_f32_16x16x32_bf16 v[96:99], a[128:131], a[0:3], 0
    v_exp_f32 v123, v123
    v_and_b32 v49, s25, v49
    v_and_b32 v50, s25, v50
    v_and_b32 v51, s25, v51
    v_pk_mul_f32 v[0:1], v[0:1], s[34:35]
    v_pk_mul_f32 v[2:3], v[2:3], s[34:35]
    v_pk_mul_f32 v[48:49], v[48:49], s[34:35]
    v_pk_mul_f32 v[50:51], v[50:51], s[34:35]
    v_cvt_pk_bf16_f32 v48, v0, v48
    v_cvt_pk_bf16_f32 v49, v1, v49
    v_cvt_pk_bf16_f32 v50, v2, v50
    v_mfma_f32_16x16x32_bf16 v[96:99], a[132:135], a[4:7], v[96:99]
    s_add_u32 s29, s27, 81920
    v_cvt_pk_bf16_f32 v117, v122, v123
    v_cvt_pk_bf16_f32 v51, v3, v51
    v_mfma_f32_16x16x32_bf16 v[96:99], a[136:139], a[8:11], v[96:99]
    s_add_u32 m0, s27, 147456
    v_exp_f32 v124, v124
    v_mfma_f32_16x16x32_bf16 v[96:99], a[140:143], a[12:15], v[96:99]
    buffer_load_dwordx4 v18, s[16:19], s29 offen lds
    v_mfma_f32_16x16x32_bf16 v[100:103], a[144:147], a[12:15], 0
    v_exp_f32 v125, v125
    v_mfma_f32_16x16x32_bf16 v[100:103], a[148:151], a[8:11], v[100:103]
    v_cvt_pk_bf16_f32 v118, v124, v125
    v_accvgpr_write_b32 a32, v48
    v_mfma_f32_16x16x32_bf16 v[100:103], a[152:155], a[4:7], v[100:103]
    v_exp_f32 v126, v126
    v_mfma_f32_16x16x32_bf16 v[100:103], a[156:159], a[0:3], v[100:103]
    buffer_load_dwordx4 v18, s[16:19], s29 offen offset:1024 lds
    v_mfma_f32_16x16x32_bf16 v[104:107], a[160:163], a[0:3], 0
    v_exp_f32 v127, v127
    v_mfma_f32_16x16x32_bf16 v[104:107], a[164:167], a[4:7], v[104:107]
    v_cvt_pk_bf16_f32 v119, v126, v127
    v_accvgpr_write_b32 a33, v49
    v_mfma_f32_16x16x32_bf16 v[104:107], a[168:171], a[8:11], v[104:107]
    v_exp_f32 v96, v96
    v_mfma_f32_16x16x32_bf16 v[104:107], a[172:175], a[12:15], v[104:107]
    buffer_load_dwordx4 v18, s[16:19], s29 offen offset:2048 lds
    v_mfma_f32_16x16x32_bf16 v[108:111], a[176:179], a[12:15], 0
    v_exp_f32 v97, v97
    v_mfma_f32_16x16x32_bf16 v[108:111], a[180:183], a[8:11], v[108:111]
    v_cvt_pk_bf16_f32 v96, v96, v97
    v_accvgpr_write_b32 a34, v50
    v_mfma_f32_16x16x32_bf16 v[108:111], a[184:187], a[4:7], v[108:111]
    v_exp_f32 v98, v98
    v_mfma_f32_16x16x32_bf16 v[108:111], a[188:191], a[0:3], v[108:111]
    buffer_load_dwordx4 v18, s[16:19], s29 offen offset:3072 lds
    v_smfmac_f32_16x16x64_bf16 v[24:27], a[124:127], v[112:119], v22
    v_exp_f32 v99, v99
    v_mfma_f32_16x16x32_bf16 v[160:163], a[236:239], v[112:115], v[160:163]
    v_cvt_pk_bf16_f32 v97, v98, v99
    v_accvgpr_write_b32 a35, v51
    v_mfma_f32_16x16x32_bf16 v[160:163], a[240:243], v[116:119], v[160:163]
    v_exp_f32 v100, v100
    v_mfma_f32_16x16x32_bf16 v[164:167], a[244:247], v[116:119], v[164:167]
    s_mov_b32 s30, 4096
    buffer_load_dwordx4 v[40:43], v16, s[44:47], s30 offen offset:128 nt
    v_mfma_f32_16x16x32_bf16 v[164:167], a[248:251], v[112:115], v[164:167]
    v_exp_f32 v101, v101
    v_mfma_f32_16x16x32_bf16 v[168:171], a[252:255], v[112:115], v[168:171]
    v_cvt_pk_bf16_f32 v98, v100, v101
    v_lshlrev_b32 v0, 16, v52
    v_mfma_f32_16x16x32_bf16 v[168:171], a[116:119], v[116:119], v[168:171]
    s_add_u32 m0, s26, 98304
    v_exp_f32 v102, v102
    v_mfma_f32_16x16x32_bf16 v[172:175], a[112:115], v[116:119], v[172:175]
    buffer_load_dwordx4 v17, s[12:15], m0 offen nt lds
    v_mfma_f32_16x16x32_bf16 v[172:175], a[108:111], v[112:115], v[172:175]
    v_exp_f32 v103, v103
    v_mfma_f32_16x16x32_bf16 v[176:179], a[104:107], v[112:115], v[176:179]
    v_cvt_pk_bf16_f32 v99, v102, v103
    v_lshlrev_b32 v1, 16, v53
    v_mfma_f32_16x16x32_bf16 v[176:179], a[100:103], v[116:119], v[176:179]
    s_add_u32 m0, s26, 102400
    v_exp_f32 v104, v104
    v_mfma_f32_16x16x32_bf16 v[180:183], a[96:99], v[116:119], v[180:183]
    buffer_load_dwordx4 v17, s[12:15], m0 offen nt lds
    v_mfma_f32_16x16x32_bf16 v[180:183], a[92:95], v[112:115], v[180:183]
    v_exp_f32 v105, v105
    v_mfma_f32_16x16x32_bf16 v[184:187], a[192:195], v[112:115], v[184:187]
    v_cvt_pk_bf16_f32 v100, v104, v105
    v_lshlrev_b32 v2, 16, v54
    v_mfma_f32_16x16x32_bf16 v[184:187], a[196:199], v[116:119], v[184:187]
    s_mov_b32 s30, 4096
    v_exp_f32 v106, v106
    v_mfma_f32_16x16x32_bf16 v[188:191], a[200:203], v[116:119], v[188:191]
    s_add_u32 m0, s26, 106496
    buffer_load_dwordx4 v[44:47], v16, s[44:47], s30 offen offset:192 nt
    v_mfma_f32_16x16x32_bf16 v[188:191], a[204:207], v[112:115], v[188:191]
    buffer_load_dwordx4 v17, s[12:15], m0 offen nt lds
    v_mfma_f32_16x16x32_bf16 v[112:115], a[128:131], a[16:19], 0
    v_exp_f32 v107, v107
    v_mfma_f32_16x16x32_bf16 v[112:115], a[132:135], a[20:23], v[112:115]
    ds_read_b128 a[128:131], v8 offset:0
    v_cvt_pk_bf16_f32 v101, v106, v107
    v_mfma_f32_16x16x32_bf16 v[112:115], a[136:139], a[24:27], v[112:115]
    v_exp_f32 v108, v108
    v_mfma_f32_16x16x32_bf16 v[112:115], a[140:143], a[28:31], v[112:115]
    ds_read_b128 a[132:135], v9 offset:0
    v_lshlrev_b32 v3, 16, v55
    v_mfma_f32_16x16x32_bf16 v[116:119], a[144:147], a[28:31], 0
    v_exp_f32 v109, v109
    v_mfma_f32_16x16x32_bf16 v[116:119], a[148:151], a[24:27], v[116:119]
    ds_read_b128 a[136:139], v10 offset:0
    v_cvt_pk_bf16_f32 v102, v108, v109
    v_mfma_f32_16x16x32_bf16 v[116:119], a[152:155], a[20:23], v[116:119]
    v_exp_f32 v110, v110
    v_mfma_f32_16x16x32_bf16 v[116:119], a[156:159], a[16:19], v[116:119]
    ds_read_b128 a[140:143], v11 offset:0
    v_and_b32 v52, s25, v52
    v_and_b32 v53, s25, v53
    v_and_b32 v54, s25, v54
    v_and_b32 v55, s25, v55
    v_pk_mul_f32 v[0:1], v[0:1], s[34:35]
    v_pk_mul_f32 v[2:3], v[2:3], s[34:35]
    v_pk_mul_f32 v[52:53], v[52:53], s[34:35]
    v_pk_mul_f32 v[54:55], v[54:55], s[34:35]
    v_cvt_pk_bf16_f32 v52, v0, v52
    v_cvt_pk_bf16_f32 v53, v1, v53
    v_cvt_pk_bf16_f32 v54, v2, v54
    v_mfma_f32_16x16x32_bf16 v[120:123], a[160:163], a[16:19], 0
    v_exp_f32 v111, v111
    v_mfma_f32_16x16x32_bf16 v[120:123], a[164:167], a[20:23], v[120:123]
    ds_read_b128 a[144:147], v11 offset:4096
    v_cvt_pk_bf16_f32 v103, v110, v111
    v_mfma_f32_16x16x32_bf16 v[120:123], a[168:171], a[24:27], v[120:123]
    s_add_u32 m0, s26, 110592
    v_exp_f32 v112, v112
    v_mfma_f32_16x16x32_bf16 v[120:123], a[172:175], a[28:31], v[120:123]
    ds_read_b128 a[148:151], v10 offset:4096
    buffer_load_dwordx4 v17, s[12:15], m0 offen nt lds
    v_mfma_f32_16x16x32_bf16 v[124:127], a[176:179], a[28:31], 0
    v_exp_f32 v113, v113
    v_mfma_f32_16x16x32_bf16 v[124:127], a[180:183], a[24:27], v[124:127]
    ds_read_b128 a[152:155], v9 offset:4096
    v_cvt_pk_bf16_f32 v112, v112, v113
    v_mfma_f32_16x16x32_bf16 v[124:127], a[184:187], a[20:23], v[124:127]
    v_exp_f32 v114, v114
    v_mfma_f32_16x16x32_bf16 v[124:127], a[188:191], a[16:19], v[124:127]
    ds_read_b128 a[156:159], v8 offset:4096
    v_cvt_pk_bf16_f32 v55, v3, v55
    v_smfmac_f32_16x16x64_bf16 v[28:31], a[120:123], v[96:103], v22
    v_exp_f32 v115, v115
    v_mfma_f32_16x16x32_bf16 v[192:195], a[236:239], v[96:99], v[192:195]
    ds_read_b128 a[160:163], v8 offset:8192
    v_cvt_pk_bf16_f32 v113, v114, v115
    v_mfma_f32_16x16x32_bf16 v[192:195], a[240:243], v[100:103], v[192:195]
    v_exp_f32 v116, v116
    v_mfma_f32_16x16x32_bf16 v[196:199], a[244:247], v[100:103], v[196:199]
    ds_read_b128 a[164:167], v9 offset:8192
    v_accvgpr_write_b32 a36, v52
    v_mfma_f32_16x16x32_bf16 v[196:199], a[248:251], v[96:99], v[196:199]
    v_exp_f32 v117, v117
    v_mfma_f32_16x16x32_bf16 v[200:203], a[252:255], v[96:99], v[200:203]
    ds_read_b128 a[168:171], v10 offset:8192
    v_cvt_pk_bf16_f32 v114, v116, v117
    v_mfma_f32_16x16x32_bf16 v[200:203], a[116:119], v[100:103], v[200:203]
    v_exp_f32 v118, v118
    v_mfma_f32_16x16x32_bf16 v[204:207], a[112:115], v[100:103], v[204:207]
    ds_read_b128 a[172:175], v11 offset:8192
    v_accvgpr_write_b32 a37, v53
    v_mfma_f32_16x16x32_bf16 v[204:207], a[108:111], v[96:99], v[204:207]
    v_exp_f32 v119, v119
    v_mfma_f32_16x16x32_bf16 v[208:211], a[104:107], v[96:99], v[208:211]
    ds_read_b128 a[176:179], v11 offset:12288
    v_cvt_pk_bf16_f32 v115, v118, v119
    v_mfma_f32_16x16x32_bf16 v[208:211], a[100:103], v[100:103], v[208:211]
    v_exp_f32 v120, v120
    v_mfma_f32_16x16x32_bf16 v[212:215], a[96:99], v[100:103], v[212:215]
    ds_read_b128 a[180:183], v10 offset:12288
    v_accvgpr_write_b32 a38, v54
    v_mfma_f32_16x16x32_bf16 v[212:215], a[92:95], v[96:99], v[212:215]
    v_exp_f32 v121, v121
    v_mfma_f32_16x16x32_bf16 v[216:219], a[192:195], v[96:99], v[216:219]
    ds_read_b128 a[184:187], v9 offset:12288
    v_cvt_pk_bf16_f32 v116, v120, v121
    v_mfma_f32_16x16x32_bf16 v[216:219], a[196:199], v[100:103], v[216:219]
    v_exp_f32 v122, v122
    v_mfma_f32_16x16x32_bf16 v[220:223], a[200:203], v[100:103], v[220:223]
    ds_read_b128 a[188:191], v8 offset:12288
    v_accvgpr_write_b32 a39, v55
    v_mfma_f32_16x16x32_bf16 v[220:223], a[204:207], v[96:99], v[220:223]
    s_waitcnt lgkmcnt(5)
    ds_read_b64_tr_b16 a[208:209], v12 offset:32768
    ds_read_b64_tr_b16 a[210:211], v12 offset:36864
    v_mfma_f32_16x16x32_bf16 v[96:99], a[128:131], v[64:67], 0
    v_exp_f32 v123, v123
    v_mfma_f32_16x16x32_bf16 v[96:99], a[132:135], v[68:71], v[96:99]
    ds_read_b64_tr_b16 a[212:213], v12 offset:40960
    v_cvt_pk_bf16_f32 v117, v122, v123
    v_mfma_f32_16x16x32_bf16 v[96:99], a[136:139], v[72:75], v[96:99]
    v_exp_f32 v124, v124
    v_mfma_f32_16x16x32_bf16 v[96:99], a[140:143], v[76:79], v[96:99]
    ds_read_b64_tr_b16 a[214:215], v12 offset:45056
    ds_read_b64_tr_b16 a[216:217], v12 offset:40968
    v_mfma_f32_16x16x32_bf16 v[100:103], a[144:147], v[76:79], 0
    v_exp_f32 v125, v125
    v_mfma_f32_16x16x32_bf16 v[100:103], a[148:151], v[72:75], v[100:103]
    ds_read_b64_tr_b16 a[218:219], v12 offset:45064
    v_cvt_pk_bf16_f32 v118, v124, v125
    v_mfma_f32_16x16x32_bf16 v[100:103], a[152:155], v[68:71], v[100:103]
    v_exp_f32 v126, v126
    v_mfma_f32_16x16x32_bf16 v[100:103], a[156:159], v[64:67], v[100:103]
    ds_read_b64_tr_b16 a[220:221], v12 offset:32776
    v_lshlrev_b32 v0, 16, v56
    v_mfma_f32_16x16x32_bf16 v[104:107], a[160:163], v[64:67], 0
    v_exp_f32 v127, v127
    v_mfma_f32_16x16x32_bf16 v[104:107], a[164:167], v[68:71], v[104:107]
    ds_read_b64_tr_b16 a[222:223], v12 offset:36872
    v_cvt_pk_bf16_f32 v119, v126, v127
    v_mfma_f32_16x16x32_bf16 v[104:107], a[168:171], v[72:75], v[104:107]
    s_waitcnt lgkmcnt(6)
    v_exp_f32 v96, v96
    v_mfma_f32_16x16x32_bf16 v[104:107], a[172:175], v[76:79], v[104:107]
    ds_read_b64_tr_b16 a[224:225], v13 offset:32768
    v_lshlrev_b32 v1, 16, v57
    v_mfma_f32_16x16x32_bf16 v[108:111], a[176:179], v[76:79], 0
    v_exp_f32 v97, v97
    v_mfma_f32_16x16x32_bf16 v[108:111], a[180:183], v[72:75], v[108:111]
    ds_read_b64_tr_b16 a[226:227], v13 offset:36864
    v_cvt_pk_bf16_f32 v96, v96, v97
    v_mfma_f32_16x16x32_bf16 v[108:111], a[184:187], v[68:71], v[108:111]
    v_exp_f32 v98, v98
    v_mfma_f32_16x16x32_bf16 v[108:111], a[188:191], v[64:67], v[108:111]
    ds_read_b64_tr_b16 a[228:229], v13 offset:40960
    v_lshlrev_b32 v2, 16, v58
    v_smfmac_f32_16x16x64_bf16 v[28:31], a[124:127], v[112:119], v22
    v_exp_f32 v99, v99
    v_mfma_f32_16x16x32_bf16 v[224:227], a[236:239], v[112:115], v[224:227]
    ds_read_b64_tr_b16 a[230:231], v13 offset:45056
    v_cvt_pk_bf16_f32 v97, v98, v99
    v_mfma_f32_16x16x32_bf16 v[224:227], a[240:243], v[116:119], v[224:227]
    v_exp_f32 v100, v100
    v_mfma_f32_16x16x32_bf16 v[228:231], a[244:247], v[116:119], v[228:231]
    ds_read_b64_tr_b16 a[232:233], v13 offset:40968
    v_lshlrev_b32 v3, 16, v59
    v_mfma_f32_16x16x32_bf16 v[228:231], a[248:251], v[112:115], v[228:231]
    v_exp_f32 v101, v101
    v_mfma_f32_16x16x32_bf16 v[232:235], a[252:255], v[112:115], v[232:235]
    ds_read_b64_tr_b16 a[234:235], v13 offset:45064
    v_cvt_pk_bf16_f32 v98, v100, v101
    v_mfma_f32_16x16x32_bf16 v[232:235], a[116:119], v[116:119], v[232:235]
    v_exp_f32 v102, v102
    v_mfma_f32_16x16x32_bf16 v[236:239], a[112:115], v[116:119], v[236:239]
    ds_read_b64_tr_b16 a[236:237], v13 offset:32776
    v_and_b32 v56, s25, v56
    v_mfma_f32_16x16x32_bf16 v[236:239], a[108:111], v[112:115], v[236:239]
    v_exp_f32 v103, v103
    v_mfma_f32_16x16x32_bf16 v[240:243], a[104:107], v[112:115], v[240:243]
    ds_read_b64_tr_b16 a[238:239], v13 offset:36872
    v_cvt_pk_bf16_f32 v99, v102, v103
    v_mfma_f32_16x16x32_bf16 v[240:243], a[100:103], v[116:119], v[240:243]
    v_exp_f32 v104, v104
    v_mfma_f32_16x16x32_bf16 v[244:247], a[96:99], v[116:119], v[244:247]
    ds_read_b64_tr_b16 a[240:241], v14 offset:32768
    v_and_b32 v57, s25, v57
    v_mfma_f32_16x16x32_bf16 v[244:247], a[92:95], v[112:115], v[244:247]
    v_exp_f32 v105, v105
    v_mfma_f32_16x16x32_bf16 v[248:251], a[192:195], v[112:115], v[248:251]
    ds_read_b64_tr_b16 a[242:243], v14 offset:36864
    v_cvt_pk_bf16_f32 v100, v104, v105
    v_mfma_f32_16x16x32_bf16 v[248:251], a[196:199], v[116:119], v[248:251]
    s_add_u32 m0, s26, 114688
    v_exp_f32 v106, v106
    v_mfma_f32_16x16x32_bf16 v[252:255], a[200:203], v[116:119], v[252:255]
    ds_read_b64_tr_b16 a[244:245], v14 offset:40960
    buffer_load_dwordx4 v17, s[12:15], m0 offen nt lds
    v_mfma_f32_16x16x32_bf16 v[252:255], a[204:207], v[112:115], v[252:255]
    ds_read_b64_tr_b16 a[246:247], v14 offset:45056
    v_and_b32 v58, s25, v58
    v_mfma_f32_16x16x32_bf16 v[112:115], a[128:131], v[80:83], 0
    v_exp_f32 v107, v107
    v_mfma_f32_16x16x32_bf16 v[112:115], a[132:135], v[84:87], v[112:115]
    ds_read_b64_tr_b16 a[248:249], v14 offset:40968
    v_cvt_pk_bf16_f32 v101, v106, v107
    v_mfma_f32_16x16x32_bf16 v[112:115], a[136:139], v[88:91], v[112:115]
    s_add_u32 m0, s26, 118784
    v_exp_f32 v108, v108
    v_mfma_f32_16x16x32_bf16 v[112:115], a[140:143], v[92:95], v[112:115]
    ds_read_b64_tr_b16 a[250:251], v14 offset:45064
    buffer_load_dwordx4 v17, s[12:15], m0 offen nt lds
    v_mfma_f32_16x16x32_bf16 v[116:119], a[144:147], v[92:95], 0
    v_exp_f32 v109, v109
    v_mfma_f32_16x16x32_bf16 v[116:119], a[148:151], v[88:91], v[116:119]
    ds_read_b64_tr_b16 a[252:253], v14 offset:32776
    v_cvt_pk_bf16_f32 v102, v108, v109
    v_mfma_f32_16x16x32_bf16 v[116:119], a[152:155], v[84:87], v[116:119]
    s_add_u32 m0, s26, 122880
    v_exp_f32 v110, v110
    v_mfma_f32_16x16x32_bf16 v[116:119], a[156:159], v[80:83], v[116:119]
    ds_read_b64_tr_b16 a[254:255], v14 offset:36872
    buffer_load_dwordx4 v17, s[12:15], m0 offen nt lds
    v_mfma_f32_16x16x32_bf16 v[120:123], a[160:163], v[80:83], 0
    v_exp_f32 v111, v111
    v_mfma_f32_16x16x32_bf16 v[120:123], a[164:167], v[84:87], v[120:123]
    ds_read_b64_tr_b16 a[116:117], v15 offset:32768
    v_cvt_pk_bf16_f32 v103, v110, v111
    v_mfma_f32_16x16x32_bf16 v[120:123], a[168:171], v[88:91], v[120:123]
    s_add_u32 m0, s26, 126976
    v_exp_f32 v112, v112
    v_mfma_f32_16x16x32_bf16 v[120:123], a[172:175], v[92:95], v[120:123]
    ds_read_b64_tr_b16 a[118:119], v15 offset:36864
    buffer_load_dwordx4 v17, s[12:15], m0 offen nt lds
    v_mfma_f32_16x16x32_bf16 v[124:127], a[176:179], v[92:95], 0
    v_exp_f32 v113, v113
    v_mfma_f32_16x16x32_bf16 v[124:127], a[180:183], v[88:91], v[124:127]
    ds_read_b64_tr_b16 a[112:113], v15 offset:40960
    v_cvt_pk_bf16_f32 v112, v112, v113
    v_mfma_f32_16x16x32_bf16 v[124:127], a[184:187], v[84:87], v[124:127]
    v_exp_f32 v114, v114
    v_mfma_f32_16x16x32_bf16 v[124:127], a[188:191], v[80:83], v[124:127]
    ds_read_b64_tr_b16 a[114:115], v15 offset:45056
    v_and_b32 v59, s25, v59
    v_smfmac_f32_16x16x64_bf16 v[24:27], a[120:123], v[96:103], v22
    v_exp_f32 v115, v115
    v_mfma_f32_16x16x32_bf16 v[128:131], a[208:211], v[96:99], v[128:131]
    s_waitcnt lgkmcnt(4)
    ds_read_b64_tr_b16 a[108:109], v15 offset:40968
    v_cvt_pk_bf16_f32 v113, v114, v115
    v_mfma_f32_16x16x32_bf16 v[128:131], a[212:215], v[100:103], v[128:131]
    v_exp_f32 v116, v116
    v_mfma_f32_16x16x32_bf16 v[132:135], a[216:219], v[100:103], v[132:135]
    ds_read_b64_tr_b16 a[110:111], v15 offset:45064
    v_mul_f32 v0, s24, v0
    v_mfma_f32_16x16x32_bf16 v[132:135], a[220:223], v[96:99], v[132:135]
    v_exp_f32 v117, v117
    v_mfma_f32_16x16x32_bf16 v[136:139], a[224:227], v[96:99], v[136:139]
    ds_read_b64_tr_b16 a[104:105], v15 offset:32776
    v_cvt_pk_bf16_f32 v114, v116, v117
    v_mfma_f32_16x16x32_bf16 v[136:139], a[228:231], v[100:103], v[136:139]
    v_exp_f32 v118, v118
    v_mfma_f32_16x16x32_bf16 v[140:143], a[232:235], v[100:103], v[140:143]
    ds_read_b64_tr_b16 a[106:107], v15 offset:36872
    v_mul_f32 v1, s24, v1
    v_mfma_f32_16x16x32_bf16 v[140:143], a[236:239], v[96:99], v[140:143]
    v_exp_f32 v119, v119
    v_mfma_f32_16x16x32_bf16 v[144:147], a[240:243], v[96:99], v[144:147]
    v_cvt_pk_bf16_f32 v115, v118, v119
    v_mul_f32 v2, s24, v2
    v_mfma_f32_16x16x32_bf16 v[144:147], a[244:247], v[100:103], v[144:147]
    v_exp_f32 v120, v120
    v_mfma_f32_16x16x32_bf16 v[148:151], a[248:251], v[100:103], v[148:151]
    v_mul_f32 v3, s24, v3
    v_mul_f32 v56, s24, v56
    v_mfma_f32_16x16x32_bf16 v[148:151], a[252:255], v[96:99], v[148:151]
    s_waitcnt lgkmcnt(3)
    v_exp_f32 v121, v121
    v_mfma_f32_16x16x32_bf16 v[152:155], a[116:119], v[96:99], v[152:155]
    v_cvt_pk_bf16_f32 v116, v120, v121
    v_mul_f32 v57, s24, v57
    v_mfma_f32_16x16x32_bf16 v[152:155], a[112:115], v[100:103], v[152:155]
    s_waitcnt lgkmcnt(1)
    v_exp_f32 v122, v122
    v_mfma_f32_16x16x32_bf16 v[156:159], a[108:111], v[100:103], v[156:159]
    s_waitcnt lgkmcnt(0)
    v_mul_f32 v58, s24, v58
    v_mul_f32 v59, s24, v59
    v_mfma_f32_16x16x32_bf16 v[156:159], a[104:107], v[96:99], v[156:159]
    s_waitcnt vmcnt(10)
    v_cvt_pk_bf16_f32 v56, v0, v56
    v_cvt_pk_bf16_f32 v57, v1, v57
    v_mfma_f32_16x16x32_bf16 v[96:99], a[128:131], a[0:3], 0
    s_barrier
    v_exp_f32 v123, v123
    v_mfma_f32_16x16x32_bf16 v[96:99], a[132:135], a[4:7], v[96:99]
    s_add_u32 s29, s27, 98304
    v_cvt_pk_bf16_f32 v117, v122, v123
    v_cvt_pk_bf16_f32 v58, v2, v58
    v_mfma_f32_16x16x32_bf16 v[96:99], a[136:139], a[8:11], v[96:99]
    s_add_u32 m0, s27, 131072
    v_exp_f32 v124, v124
    v_mfma_f32_16x16x32_bf16 v[96:99], a[140:143], a[12:15], v[96:99]
    buffer_load_dwordx4 v18, s[16:19], s29 offen lds
    v_mfma_f32_16x16x32_bf16 v[100:103], a[144:147], a[12:15], 0
    v_exp_f32 v125, v125
    v_mfma_f32_16x16x32_bf16 v[100:103], a[148:151], a[8:11], v[100:103]
    v_cvt_pk_bf16_f32 v118, v124, v125
    v_cvt_pk_bf16_f32 v59, v3, v59
    v_mfma_f32_16x16x32_bf16 v[100:103], a[152:155], a[4:7], v[100:103]
    v_exp_f32 v126, v126
    v_mfma_f32_16x16x32_bf16 v[100:103], a[156:159], a[0:3], v[100:103]
    buffer_load_dwordx4 v18, s[16:19], s29 offen offset:1024 lds
    v_mfma_f32_16x16x32_bf16 v[104:107], a[160:163], a[0:3], 0
    v_exp_f32 v127, v127
    v_mfma_f32_16x16x32_bf16 v[104:107], a[164:167], a[4:7], v[104:107]
    v_cvt_pk_bf16_f32 v119, v126, v127
    v_accvgpr_write_b32 a40, v56
    v_mfma_f32_16x16x32_bf16 v[104:107], a[168:171], a[8:11], v[104:107]
    v_exp_f32 v96, v96
    v_mfma_f32_16x16x32_bf16 v[104:107], a[172:175], a[12:15], v[104:107]
    buffer_load_dwordx4 v18, s[16:19], s29 offen offset:2048 lds
    v_mfma_f32_16x16x32_bf16 v[108:111], a[176:179], a[12:15], 0
    v_exp_f32 v97, v97
    v_mfma_f32_16x16x32_bf16 v[108:111], a[180:183], a[8:11], v[108:111]
    v_cvt_pk_bf16_f32 v96, v96, v97
    v_accvgpr_write_b32 a41, v57
    v_mfma_f32_16x16x32_bf16 v[108:111], a[184:187], a[4:7], v[108:111]
    v_exp_f32 v98, v98
    v_mfma_f32_16x16x32_bf16 v[108:111], a[188:191], a[0:3], v[108:111]
    buffer_load_dwordx4 v18, s[16:19], s29 offen offset:3072 lds
    v_smfmac_f32_16x16x64_bf16 v[24:27], a[124:127], v[112:119], v22
    v_exp_f32 v99, v99
    v_mfma_f32_16x16x32_bf16 v[160:163], a[208:211], v[112:115], v[160:163]
    v_cvt_pk_bf16_f32 v97, v98, v99
    v_accvgpr_write_b32 a42, v58
    v_mfma_f32_16x16x32_bf16 v[160:163], a[212:215], v[116:119], v[160:163]
    v_exp_f32 v100, v100
    v_mfma_f32_16x16x32_bf16 v[164:167], a[216:219], v[116:119], v[164:167]
    v_accvgpr_write_b32 a43, v59
    v_lshlrev_b32 v0, 16, v60
    v_mfma_f32_16x16x32_bf16 v[164:167], a[220:223], v[112:115], v[164:167]
    v_exp_f32 v101, v101
    v_mfma_f32_16x16x32_bf16 v[168:171], a[224:227], v[112:115], v[168:171]
    v_cvt_pk_bf16_f32 v98, v100, v101
    v_lshlrev_b32 v1, 16, v61
    v_mfma_f32_16x16x32_bf16 v[168:171], a[228:231], v[116:119], v[168:171]
    v_exp_f32 v102, v102
    v_mfma_f32_16x16x32_bf16 v[172:175], a[232:235], v[116:119], v[172:175]
    s_mov_b32 s30, 8192
    buffer_load_dwordx4 v[48:51], v16, s[44:47], s30 offen nt
    v_mfma_f32_16x16x32_bf16 v[172:175], a[236:239], v[112:115], v[172:175]
    v_exp_f32 v103, v103
    v_mfma_f32_16x16x32_bf16 v[176:179], a[240:243], v[112:115], v[176:179]
    v_cvt_pk_bf16_f32 v99, v102, v103
    v_lshlrev_b32 v2, 16, v62
    v_mfma_f32_16x16x32_bf16 v[176:179], a[244:247], v[116:119], v[176:179]
    s_add_u32 m0, s26, 0
    v_exp_f32 v104, v104
    v_mfma_f32_16x16x32_bf16 v[180:183], a[248:251], v[116:119], v[180:183]
    buffer_load_dwordx4 v17, s[48:51], m0 offen nt lds
    v_mfma_f32_16x16x32_bf16 v[180:183], a[252:255], v[112:115], v[180:183]
    v_exp_f32 v105, v105
    v_mfma_f32_16x16x32_bf16 v[184:187], a[116:119], v[112:115], v[184:187]
    v_cvt_pk_bf16_f32 v100, v104, v105
    v_lshlrev_b32 v3, 16, v63
    v_mfma_f32_16x16x32_bf16 v[184:187], a[112:115], v[116:119], v[184:187]
    s_add_u32 m0, s26, 4096
    v_exp_f32 v106, v106
    v_mfma_f32_16x16x32_bf16 v[188:191], a[108:111], v[116:119], v[188:191]
    buffer_load_dwordx4 v17, s[48:51], m0 offen nt lds
    v_mfma_f32_16x16x32_bf16 v[188:191], a[104:107], v[112:115], v[188:191]
    v_and_b32 v60, s25, v60
    v_mfma_f32_16x16x32_bf16 v[112:115], a[128:131], a[16:19], 0
    v_exp_f32 v107, v107
    v_and_b32 v61, s25, v61
    v_and_b32 v62, s25, v62
    v_and_b32 v63, s25, v63
    v_pk_mul_f32 v[0:1], v[0:1], s[34:35]
    v_pk_mul_f32 v[2:3], v[2:3], s[34:35]
    v_pk_mul_f32 v[60:61], v[60:61], s[34:35]
    v_pk_mul_f32 v[62:63], v[62:63], s[34:35]
    v_cvt_pk_bf16_f32 v60, v0, v60
    v_cvt_pk_bf16_f32 v61, v1, v61
    v_cvt_pk_bf16_f32 v62, v2, v62
    v_mfma_f32_16x16x32_bf16 v[112:115], a[132:135], a[20:23], v[112:115]
    ds_read_b128 a[128:131], v8 offset:16384
    v_cvt_pk_bf16_f32 v101, v106, v107
    v_mfma_f32_16x16x32_bf16 v[112:115], a[136:139], a[24:27], v[112:115]
    v_exp_f32 v108, v108
    v_mfma_f32_16x16x32_bf16 v[112:115], a[140:143], a[28:31], v[112:115]
    ds_read_b128 a[132:135], v9 offset:16384
    v_cvt_pk_bf16_f32 v63, v3, v63
    v_mfma_f32_16x16x32_bf16 v[116:119], a[144:147], a[28:31], 0
    v_exp_f32 v109, v109
    v_mfma_f32_16x16x32_bf16 v[116:119], a[148:151], a[24:27], v[116:119]
    ds_read_b128 a[136:139], v10 offset:16384
    v_cvt_pk_bf16_f32 v102, v108, v109
    v_mfma_f32_16x16x32_bf16 v[116:119], a[152:155], a[20:23], v[116:119]
    s_mov_b32 s30, 8192
    v_exp_f32 v110, v110
    v_mfma_f32_16x16x32_bf16 v[116:119], a[156:159], a[16:19], v[116:119]
    s_add_u32 m0, s26, 8192
    ds_read_b128 a[140:143], v11 offset:16384
    buffer_load_dwordx4 v[52:55], v16, s[44:47], s30 offen offset:64 nt
    v_mfma_f32_16x16x32_bf16 v[120:123], a[160:163], a[16:19], 0
    buffer_load_dwordx4 v17, s[48:51], m0 offen nt lds
    v_exp_f32 v111, v111
    v_mfma_f32_16x16x32_bf16 v[120:123], a[164:167], a[20:23], v[120:123]
    ds_read_b128 a[144:147], v11 offset:20480
    v_cvt_pk_bf16_f32 v103, v110, v111
    v_mfma_f32_16x16x32_bf16 v[120:123], a[168:171], a[24:27], v[120:123]
    s_add_u32 m0, s26, 12288
    v_exp_f32 v112, v112
    v_mfma_f32_16x16x32_bf16 v[120:123], a[172:175], a[28:31], v[120:123]
    ds_read_b128 a[148:151], v10 offset:20480
    buffer_load_dwordx4 v17, s[48:51], m0 offen nt lds
    v_mfma_f32_16x16x32_bf16 v[124:127], a[176:179], a[28:31], 0
    v_exp_f32 v113, v113
    v_mfma_f32_16x16x32_bf16 v[124:127], a[180:183], a[24:27], v[124:127]
    ds_read_b128 a[152:155], v9 offset:20480
    v_cvt_pk_bf16_f32 v112, v112, v113
    v_mfma_f32_16x16x32_bf16 v[124:127], a[184:187], a[20:23], v[124:127]
    v_exp_f32 v114, v114
    v_mfma_f32_16x16x32_bf16 v[124:127], a[188:191], a[16:19], v[124:127]
    ds_read_b128 a[156:159], v8 offset:20480
    v_accvgpr_write_b32 a44, v60
    v_smfmac_f32_16x16x64_bf16 v[28:31], a[120:123], v[96:103], v22
    v_exp_f32 v115, v115
    v_mfma_f32_16x16x32_bf16 v[192:195], a[208:211], v[96:99], v[192:195]
    ds_read_b128 a[160:163], v8 offset:24576
    v_cvt_pk_bf16_f32 v113, v114, v115
    v_mfma_f32_16x16x32_bf16 v[192:195], a[212:215], v[100:103], v[192:195]
    v_exp_f32 v116, v116
    v_mfma_f32_16x16x32_bf16 v[196:199], a[216:219], v[100:103], v[196:199]
    ds_read_b128 a[164:167], v9 offset:24576
    v_accvgpr_write_b32 a45, v61
    v_mfma_f32_16x16x32_bf16 v[196:199], a[220:223], v[96:99], v[196:199]
    v_exp_f32 v117, v117
    v_mfma_f32_16x16x32_bf16 v[200:203], a[224:227], v[96:99], v[200:203]
    ds_read_b128 a[168:171], v10 offset:24576
    v_cvt_pk_bf16_f32 v114, v116, v117
    v_mfma_f32_16x16x32_bf16 v[200:203], a[228:231], v[100:103], v[200:203]
    v_exp_f32 v118, v118
    v_mfma_f32_16x16x32_bf16 v[204:207], a[232:235], v[100:103], v[204:207]
    ds_read_b128 a[172:175], v11 offset:24576
    v_accvgpr_write_b32 a46, v62
    v_mfma_f32_16x16x32_bf16 v[204:207], a[236:239], v[96:99], v[204:207]
    v_exp_f32 v119, v119
    v_mfma_f32_16x16x32_bf16 v[208:211], a[240:243], v[96:99], v[208:211]
    ds_read_b128 a[176:179], v11 offset:28672
    v_cvt_pk_bf16_f32 v115, v118, v119
    v_mfma_f32_16x16x32_bf16 v[208:211], a[244:247], v[100:103], v[208:211]
    v_exp_f32 v120, v120
    v_mfma_f32_16x16x32_bf16 v[212:215], a[248:251], v[100:103], v[212:215]
Lpad3:
    s_cbranch_execz Lpad7
    ds_read_b128 a[180:183], v10 offset:28672
    v_accvgpr_write_b32 a47, v63
    v_mfma_f32_16x16x32_bf16 v[212:215], a[252:255], v[96:99], v[212:215]
    v_exp_f32 v121, v121
    v_mfma_f32_16x16x32_bf16 v[216:219], a[116:119], v[96:99], v[216:219]
    ds_read_b128 a[184:187], v9 offset:28672
    v_cvt_pk_bf16_f32 v116, v120, v121
    v_mfma_f32_16x16x32_bf16 v[216:219], a[112:115], v[100:103], v[216:219]
    v_exp_f32 v122, v122
    v_mfma_f32_16x16x32_bf16 v[220:223], a[108:111], v[100:103], v[220:223]
    ds_read_b128 a[188:191], v8 offset:28672
    v_lshlrev_b32 v0, 16, v32
    v_mfma_f32_16x16x32_bf16 v[220:223], a[104:107], v[96:99], v[220:223]
    s_waitcnt lgkmcnt(5)
    ds_read_b64_tr_b16 a[100:101], v12 offset:49152
    ds_read_b64_tr_b16 a[102:103], v12 offset:53248
    v_mfma_f32_16x16x32_bf16 v[96:99], a[128:131], v[64:67], 0
    v_exp_f32 v123, v123
    v_mfma_f32_16x16x32_bf16 v[96:99], a[132:135], v[68:71], v[96:99]
    ds_read_b64_tr_b16 a[96:97], v12 offset:57344
    v_cvt_pk_bf16_f32 v117, v122, v123
    v_mfma_f32_16x16x32_bf16 v[96:99], a[136:139], v[72:75], v[96:99]
    v_exp_f32 v124, v124
    v_mfma_f32_16x16x32_bf16 v[96:99], a[140:143], v[76:79], v[96:99]
    ds_read_b64_tr_b16 a[98:99], v12 offset:61440
    ds_read_b64_tr_b16 a[92:93], v12 offset:57352
    v_mfma_f32_16x16x32_bf16 v[100:103], a[144:147], v[76:79], 0
    v_exp_f32 v125, v125
    v_mfma_f32_16x16x32_bf16 v[100:103], a[148:151], v[72:75], v[100:103]
    ds_read_b64_tr_b16 a[94:95], v12 offset:61448
    v_cvt_pk_bf16_f32 v118, v124, v125
    v_mfma_f32_16x16x32_bf16 v[100:103], a[152:155], v[68:71], v[100:103]
    v_exp_f32 v126, v126
    v_mfma_f32_16x16x32_bf16 v[100:103], a[156:159], v[64:67], v[100:103]
    ds_read_b64_tr_b16 a[192:193], v12 offset:49160
    v_lshlrev_b32 v1, 16, v33
    v_mfma_f32_16x16x32_bf16 v[104:107], a[160:163], v[64:67], 0
    v_exp_f32 v127, v127
    v_mfma_f32_16x16x32_bf16 v[104:107], a[164:167], v[68:71], v[104:107]
    ds_read_b64_tr_b16 a[194:195], v12 offset:53256
    v_cvt_pk_bf16_f32 v119, v126, v127
    v_mfma_f32_16x16x32_bf16 v[104:107], a[168:171], v[72:75], v[104:107]
    s_waitcnt lgkmcnt(6)
    v_exp_f32 v96, v96
    v_mfma_f32_16x16x32_bf16 v[104:107], a[172:175], v[76:79], v[104:107]
    ds_read_b64_tr_b16 a[196:197], v13 offset:49152
    v_lshlrev_b32 v2, 16, v34
    v_mfma_f32_16x16x32_bf16 v[108:111], a[176:179], v[76:79], 0
    v_exp_f32 v97, v97
    v_mfma_f32_16x16x32_bf16 v[108:111], a[180:183], v[72:75], v[108:111]
    ds_read_b64_tr_b16 a[198:199], v13 offset:53248
    v_cvt_pk_bf16_f32 v96, v96, v97
    v_mfma_f32_16x16x32_bf16 v[108:111], a[184:187], v[68:71], v[108:111]
    v_exp_f32 v98, v98
    v_mfma_f32_16x16x32_bf16 v[108:111], a[188:191], v[64:67], v[108:111]
    ds_read_b64_tr_b16 a[200:201], v13 offset:57344
    v_lshlrev_b32 v3, 16, v35
    v_smfmac_f32_16x16x64_bf16 v[28:31], a[124:127], v[112:119], v22
    v_exp_f32 v99, v99
    v_mfma_f32_16x16x32_bf16 v[224:227], a[208:211], v[112:115], v[224:227]
    ds_read_b64_tr_b16 a[202:203], v13 offset:61440
    v_cvt_pk_bf16_f32 v97, v98, v99
    v_mfma_f32_16x16x32_bf16 v[224:227], a[212:215], v[116:119], v[224:227]
    v_exp_f32 v100, v100
    v_mfma_f32_16x16x32_bf16 v[228:231], a[216:219], v[116:119], v[228:231]
    ds_read_b64_tr_b16 a[204:205], v13 offset:57352
    v_and_b32 v32, s25, v32
    v_and_b32 v33, s25, v33
    v_and_b32 v34, s25, v34
    v_and_b32 v35, s25, v35
    v_pk_mul_f32 v[0:1], v[0:1], s[34:35]
    v_pk_mul_f32 v[2:3], v[2:3], s[34:35]
    v_pk_mul_f32 v[32:33], v[32:33], s[34:35]
    v_pk_mul_f32 v[34:35], v[34:35], s[34:35]
    v_cvt_pk_bf16_f32 v32, v0, v32
    v_cvt_pk_bf16_f32 v33, v1, v33
    v_cvt_pk_bf16_f32 v34, v2, v34
    v_mfma_f32_16x16x32_bf16 v[228:231], a[220:223], v[112:115], v[228:231]
    v_exp_f32 v101, v101
    v_mfma_f32_16x16x32_bf16 v[232:235], a[224:227], v[112:115], v[232:235]
    ds_read_b64_tr_b16 a[206:207], v13 offset:61448
    v_cvt_pk_bf16_f32 v98, v100, v101
    v_mfma_f32_16x16x32_bf16 v[232:235], a[228:231], v[116:119], v[232:235]
    v_exp_f32 v102, v102
    v_mfma_f32_16x16x32_bf16 v[236:239], a[232:235], v[116:119], v[236:239]
    ds_read_b64_tr_b16 a[208:209], v13 offset:49160
    v_cvt_pk_bf16_f32 v35, v3, v35
    v_mfma_f32_16x16x32_bf16 v[236:239], a[236:239], v[112:115], v[236:239]
    v_exp_f32 v103, v103
    v_mfma_f32_16x16x32_bf16 v[240:243], a[240:243], v[112:115], v[240:243]
    ds_read_b64_tr_b16 a[210:211], v13 offset:53256
    v_cvt_pk_bf16_f32 v99, v102, v103
    v_mfma_f32_16x16x32_bf16 v[240:243], a[244:247], v[116:119], v[240:243]
    v_exp_f32 v104, v104
    v_mfma_f32_16x16x32_bf16 v[244:247], a[248:251], v[116:119], v[244:247]
    ds_read_b64_tr_b16 a[212:213], v14 offset:49152
    v_accvgpr_write_b32 a48, v32
    v_mfma_f32_16x16x32_bf16 v[244:247], a[252:255], v[112:115], v[244:247]
    v_exp_f32 v105, v105
    v_mfma_f32_16x16x32_bf16 v[248:251], a[116:119], v[112:115], v[248:251]
    ds_read_b64_tr_b16 a[214:215], v14 offset:53248
    v_cvt_pk_bf16_f32 v100, v104, v105
    v_mfma_f32_16x16x32_bf16 v[248:251], a[112:115], v[116:119], v[248:251]
    s_add_u32 m0, s26, 16384
    v_exp_f32 v106, v106
    v_mfma_f32_16x16x32_bf16 v[252:255], a[108:111], v[116:119], v[252:255]
    ds_read_b64_tr_b16 a[216:217], v14 offset:57344
    buffer_load_dwordx4 v17, s[48:51], m0 offen nt lds
    v_mfma_f32_16x16x32_bf16 v[252:255], a[104:107], v[112:115], v[252:255]
    ds_read_b64_tr_b16 a[218:219], v14 offset:61440
    v_accvgpr_write_b32 a49, v33
    v_mfma_f32_16x16x32_bf16 v[112:115], a[128:131], v[80:83], 0
    v_exp_f32 v107, v107
    v_mfma_f32_16x16x32_bf16 v[112:115], a[132:135], v[84:87], v[112:115]
    ds_read_b64_tr_b16 a[220:221], v14 offset:57352
    v_cvt_pk_bf16_f32 v101, v106, v107
    v_mfma_f32_16x16x32_bf16 v[112:115], a[136:139], v[88:91], v[112:115]
    s_add_u32 m0, s26, 20480
    v_exp_f32 v108, v108
    v_mfma_f32_16x16x32_bf16 v[112:115], a[140:143], v[92:95], v[112:115]
    ds_read_b64_tr_b16 a[222:223], v14 offset:61448
    buffer_load_dwordx4 v17, s[48:51], m0 offen nt lds
    v_mfma_f32_16x16x32_bf16 v[116:119], a[144:147], v[92:95], 0
    v_exp_f32 v109, v109
    v_mfma_f32_16x16x32_bf16 v[116:119], a[148:151], v[88:91], v[116:119]
    ds_read_b64_tr_b16 a[224:225], v14 offset:49160
    v_cvt_pk_bf16_f32 v102, v108, v109
    v_mfma_f32_16x16x32_bf16 v[116:119], a[152:155], v[84:87], v[116:119]
    s_add_u32 m0, s26, 24576
    v_exp_f32 v110, v110
    v_mfma_f32_16x16x32_bf16 v[116:119], a[156:159], v[80:83], v[116:119]
    ds_read_b64_tr_b16 a[226:227], v14 offset:53256
    buffer_load_dwordx4 v17, s[48:51], m0 offen nt lds
    v_mfma_f32_16x16x32_bf16 v[120:123], a[160:163], v[80:83], 0
    v_exp_f32 v111, v111
    v_mfma_f32_16x16x32_bf16 v[120:123], a[164:167], v[84:87], v[120:123]
    ds_read_b64_tr_b16 a[228:229], v15 offset:49152
    v_cvt_pk_bf16_f32 v103, v110, v111
    v_mfma_f32_16x16x32_bf16 v[120:123], a[168:171], v[88:91], v[120:123]
    s_add_u32 m0, s26, 28672
    v_exp_f32 v112, v112
    v_mfma_f32_16x16x32_bf16 v[120:123], a[172:175], v[92:95], v[120:123]
    ds_read_b64_tr_b16 a[230:231], v15 offset:53248
    buffer_load_dwordx4 v17, s[48:51], m0 offen nt lds
    v_mfma_f32_16x16x32_bf16 v[124:127], a[176:179], v[92:95], 0
    v_exp_f32 v113, v113
    v_mfma_f32_16x16x32_bf16 v[124:127], a[180:183], v[88:91], v[124:127]
    ds_read_b64_tr_b16 a[232:233], v15 offset:57344
    v_cvt_pk_bf16_f32 v112, v112, v113
    v_mfma_f32_16x16x32_bf16 v[124:127], a[184:187], v[84:87], v[124:127]
    v_exp_f32 v114, v114
    v_mfma_f32_16x16x32_bf16 v[124:127], a[188:191], v[80:83], v[124:127]
    ds_read_b64_tr_b16 a[234:235], v15 offset:61440
    v_accvgpr_write_b32 a50, v34
    v_smfmac_f32_16x16x64_bf16 v[24:27], a[120:123], v[96:103], v22
    v_exp_f32 v115, v115
    v_mfma_f32_16x16x32_bf16 v[128:131], a[100:103], v[96:99], v[128:131]
    s_waitcnt lgkmcnt(4)
    ds_read_b64_tr_b16 a[236:237], v15 offset:57352
    v_cvt_pk_bf16_f32 v113, v114, v115
    v_mfma_f32_16x16x32_bf16 v[128:131], a[96:99], v[100:103], v[128:131]
    v_exp_f32 v116, v116
    v_mfma_f32_16x16x32_bf16 v[132:135], a[92:95], v[100:103], v[132:135]
    ds_read_b64_tr_b16 a[238:239], v15 offset:61448
    v_accvgpr_write_b32 a51, v35
    v_mfma_f32_16x16x32_bf16 v[132:135], a[192:195], v[96:99], v[132:135]
    v_exp_f32 v117, v117
    v_mfma_f32_16x16x32_bf16 v[136:139], a[196:199], v[96:99], v[136:139]
    ds_read_b64_tr_b16 a[240:241], v15 offset:49160
    v_cvt_pk_bf16_f32 v114, v116, v117
    v_mfma_f32_16x16x32_bf16 v[136:139], a[200:203], v[100:103], v[136:139]
    v_exp_f32 v118, v118
    v_mfma_f32_16x16x32_bf16 v[140:143], a[204:207], v[100:103], v[140:143]
    ds_read_b64_tr_b16 a[242:243], v15 offset:53256
    v_lshlrev_b32 v0, 16, v36
    v_mfma_f32_16x16x32_bf16 v[140:143], a[208:211], v[96:99], v[140:143]
    v_exp_f32 v119, v119
    v_mfma_f32_16x16x32_bf16 v[144:147], a[212:215], v[96:99], v[144:147]
    v_cvt_pk_bf16_f32 v115, v118, v119
    v_lshlrev_b32 v1, 16, v37
    v_mfma_f32_16x16x32_bf16 v[144:147], a[216:219], v[100:103], v[144:147]
    v_exp_f32 v120, v120
    v_mfma_f32_16x16x32_bf16 v[148:151], a[220:223], v[100:103], v[148:151]
    v_lshlrev_b32 v2, 16, v38
    v_lshlrev_b32 v3, 16, v39
    v_mfma_f32_16x16x32_bf16 v[148:151], a[224:227], v[96:99], v[148:151]
    s_waitcnt lgkmcnt(3)
    v_exp_f32 v121, v121
    v_mfma_f32_16x16x32_bf16 v[152:155], a[228:231], v[96:99], v[152:155]
    v_cvt_pk_bf16_f32 v116, v120, v121
    v_and_b32 v36, s25, v36
    v_and_b32 v37, s25, v37
    v_and_b32 v38, s25, v38
    v_and_b32 v39, s25, v39
    v_pk_mul_f32 v[0:1], v[0:1], s[34:35]
    v_pk_mul_f32 v[2:3], v[2:3], s[34:35]
    v_pk_mul_f32 v[36:37], v[36:37], s[34:35]
    v_pk_mul_f32 v[38:39], v[38:39], s[34:35]
    v_cvt_pk_bf16_f32 v36, v0, v36
    v_cvt_pk_bf16_f32 v37, v1, v37
    v_cvt_pk_bf16_f32 v38, v2, v38
    v_mfma_f32_16x16x32_bf16 v[152:155], a[232:235], v[100:103], v[152:155]
    s_waitcnt lgkmcnt(0)
    v_exp_f32 v122, v122
    v_mfma_f32_16x16x32_bf16 v[156:159], a[236:239], v[100:103], v[156:159]
    v_cvt_pk_bf16_f32 v39, v3, v39
    v_accvgpr_write_b32 a52, v36
    v_mfma_f32_16x16x32_bf16 v[156:159], a[240:243], v[96:99], v[156:159]
    s_waitcnt vmcnt(10)
    v_accvgpr_write_b32 a53, v37
    v_accvgpr_write_b32 a54, v38
    v_mfma_f32_16x16x32_bf16 v[96:99], a[128:131], a[0:3], 0
    s_barrier
    v_exp_f32 v123, v123
    v_mfma_f32_16x16x32_bf16 v[96:99], a[132:135], a[4:7], v[96:99]
    s_add_u32 s29, s27, 114688
    v_cvt_pk_bf16_f32 v117, v122, v123
    v_accvgpr_write_b32 a55, v39
    v_mfma_f32_16x16x32_bf16 v[96:99], a[136:139], a[8:11], v[96:99]
    s_add_u32 m0, s27, 147456
    v_exp_f32 v124, v124
    v_mfma_f32_16x16x32_bf16 v[96:99], a[140:143], a[12:15], v[96:99]
    buffer_load_dwordx4 v18, s[16:19], s29 offen lds
    v_mfma_f32_16x16x32_bf16 v[100:103], a[144:147], a[12:15], 0
    v_exp_f32 v125, v125
    v_mfma_f32_16x16x32_bf16 v[100:103], a[148:151], a[8:11], v[100:103]
    v_cvt_pk_bf16_f32 v118, v124, v125
    v_lshlrev_b32 v0, 16, v40
    v_mfma_f32_16x16x32_bf16 v[100:103], a[152:155], a[4:7], v[100:103]
    v_exp_f32 v126, v126
    v_mfma_f32_16x16x32_bf16 v[100:103], a[156:159], a[0:3], v[100:103]
    buffer_load_dwordx4 v18, s[16:19], s29 offen offset:1024 lds
    v_mfma_f32_16x16x32_bf16 v[104:107], a[160:163], a[0:3], 0
    v_exp_f32 v127, v127
    v_mfma_f32_16x16x32_bf16 v[104:107], a[164:167], a[4:7], v[104:107]
    v_cvt_pk_bf16_f32 v119, v126, v127
    v_lshlrev_b32 v1, 16, v41
    v_mfma_f32_16x16x32_bf16 v[104:107], a[168:171], a[8:11], v[104:107]
    v_exp_f32 v96, v96
    v_mfma_f32_16x16x32_bf16 v[104:107], a[172:175], a[12:15], v[104:107]
    buffer_load_dwordx4 v18, s[16:19], s29 offen offset:2048 lds
    v_mfma_f32_16x16x32_bf16 v[108:111], a[176:179], a[12:15], 0
    v_exp_f32 v97, v97
    v_mfma_f32_16x16x32_bf16 v[108:111], a[180:183], a[8:11], v[108:111]
    v_cvt_pk_bf16_f32 v96, v96, v97
    v_lshlrev_b32 v2, 16, v42
    v_mfma_f32_16x16x32_bf16 v[108:111], a[184:187], a[4:7], v[108:111]
    v_exp_f32 v98, v98
    v_mfma_f32_16x16x32_bf16 v[108:111], a[188:191], a[0:3], v[108:111]
    buffer_load_dwordx4 v18, s[16:19], s29 offen offset:3072 lds
    v_smfmac_f32_16x16x64_bf16 v[24:27], a[124:127], v[112:119], v22
    v_exp_f32 v99, v99
    v_mfma_f32_16x16x32_bf16 v[160:163], a[100:103], v[112:115], v[160:163]
    v_cvt_pk_bf16_f32 v97, v98, v99
    v_lshlrev_b32 v3, 16, v43
    v_mfma_f32_16x16x32_bf16 v[160:163], a[96:99], v[116:119], v[160:163]
    v_exp_f32 v100, v100
    v_mfma_f32_16x16x32_bf16 v[164:167], a[92:95], v[116:119], v[164:167]
    s_mov_b32 s30, 8192
    buffer_load_dwordx4 v[56:59], v16, s[44:47], s30 offen offset:128 nt
    v_mfma_f32_16x16x32_bf16 v[164:167], a[192:195], v[112:115], v[164:167]
    v_exp_f32 v101, v101
    v_mfma_f32_16x16x32_bf16 v[168:171], a[196:199], v[112:115], v[168:171]
    v_cvt_pk_bf16_f32 v98, v100, v101
    v_and_b32 v40, s25, v40
    v_and_b32 v41, s25, v41
    v_and_b32 v42, s25, v42
    v_and_b32 v43, s25, v43
    v_pk_mul_f32 v[0:1], v[0:1], s[34:35]
    v_pk_mul_f32 v[2:3], v[2:3], s[34:35]
    v_pk_mul_f32 v[40:41], v[40:41], s[34:35]
    v_pk_mul_f32 v[42:43], v[42:43], s[34:35]
    v_cvt_pk_bf16_f32 v40, v0, v40
    v_cvt_pk_bf16_f32 v41, v1, v41
    v_cvt_pk_bf16_f32 v42, v2, v42
    v_mfma_f32_16x16x32_bf16 v[168:171], a[200:203], v[116:119], v[168:171]
    s_add_u32 m0, s26, 49152
    v_exp_f32 v102, v102
    v_mfma_f32_16x16x32_bf16 v[172:175], a[204:207], v[116:119], v[172:175]
    buffer_load_dwordx4 v17, s[48:51], m0 offen nt lds
    v_mfma_f32_16x16x32_bf16 v[172:175], a[208:211], v[112:115], v[172:175]
    v_exp_f32 v103, v103
    v_mfma_f32_16x16x32_bf16 v[176:179], a[212:215], v[112:115], v[176:179]
    v_cvt_pk_bf16_f32 v99, v102, v103
    v_cvt_pk_bf16_f32 v43, v3, v43
    v_mfma_f32_16x16x32_bf16 v[176:179], a[216:219], v[116:119], v[176:179]
    s_add_u32 m0, s26, 53248
    v_exp_f32 v104, v104
    v_mfma_f32_16x16x32_bf16 v[180:183], a[220:223], v[116:119], v[180:183]
    buffer_load_dwordx4 v17, s[48:51], m0 offen nt lds
    v_mfma_f32_16x16x32_bf16 v[180:183], a[224:227], v[112:115], v[180:183]
    v_exp_f32 v105, v105
    v_mfma_f32_16x16x32_bf16 v[184:187], a[228:231], v[112:115], v[184:187]
    v_cvt_pk_bf16_f32 v100, v104, v105
    v_accvgpr_write_b32 a56, v40
    v_mfma_f32_16x16x32_bf16 v[184:187], a[232:235], v[116:119], v[184:187]
    s_mov_b32 s30, 8192
    v_exp_f32 v106, v106
    v_mfma_f32_16x16x32_bf16 v[188:191], a[236:239], v[116:119], v[188:191]
    s_add_u32 m0, s26, 57344
    buffer_load_dwordx4 v[60:63], v16, s[44:47], s30 offen offset:192 nt
    v_mfma_f32_16x16x32_bf16 v[188:191], a[240:243], v[112:115], v[188:191]
    buffer_load_dwordx4 v17, s[48:51], m0 offen nt lds
    v_mfma_f32_16x16x32_bf16 v[112:115], a[128:131], a[16:19], 0
    v_exp_f32 v107, v107
    v_mfma_f32_16x16x32_bf16 v[112:115], a[132:135], a[20:23], v[112:115]
    ds_read_b128 a[128:131], v8 offset:32768
    v_cvt_pk_bf16_f32 v101, v106, v107
    v_mfma_f32_16x16x32_bf16 v[112:115], a[136:139], a[24:27], v[112:115]
    v_exp_f32 v108, v108
    v_mfma_f32_16x16x32_bf16 v[112:115], a[140:143], a[28:31], v[112:115]
    ds_read_b128 a[132:135], v9 offset:32768
    v_accvgpr_write_b32 a57, v41
    v_mfma_f32_16x16x32_bf16 v[116:119], a[144:147], a[28:31], 0
    v_exp_f32 v109, v109
    v_mfma_f32_16x16x32_bf16 v[116:119], a[148:151], a[24:27], v[116:119]
    ds_read_b128 a[136:139], v10 offset:32768
    v_cvt_pk_bf16_f32 v102, v108, v109
    v_mfma_f32_16x16x32_bf16 v[116:119], a[152:155], a[20:23], v[116:119]
    v_exp_f32 v110, v110
    v_mfma_f32_16x16x32_bf16 v[116:119], a[156:159], a[16:19], v[116:119]
    ds_read_b128 a[140:143], v11 offset:32768
    v_accvgpr_write_b32 a58, v42
    v_mfma_f32_16x16x32_bf16 v[120:123], a[160:163], a[16:19], 0
    v_exp_f32 v111, v111
    v_mfma_f32_16x16x32_bf16 v[120:123], a[164:167], a[20:23], v[120:123]
    ds_read_b128 a[144:147], v11 offset:36864
    v_cvt_pk_bf16_f32 v103, v110, v111
    v_mfma_f32_16x16x32_bf16 v[120:123], a[168:171], a[24:27], v[120:123]
    s_add_u32 m0, s26, 61440
    v_exp_f32 v112, v112
    v_mfma_f32_16x16x32_bf16 v[120:123], a[172:175], a[28:31], v[120:123]
    ds_read_b128 a[148:151], v10 offset:36864
    buffer_load_dwordx4 v17, s[48:51], m0 offen nt lds
    v_mfma_f32_16x16x32_bf16 v[124:127], a[176:179], a[28:31], 0
    v_exp_f32 v113, v113
    v_mfma_f32_16x16x32_bf16 v[124:127], a[180:183], a[24:27], v[124:127]
    ds_read_b128 a[152:155], v9 offset:36864
    v_cvt_pk_bf16_f32 v112, v112, v113
    v_mfma_f32_16x16x32_bf16 v[124:127], a[184:187], a[20:23], v[124:127]
    v_exp_f32 v114, v114
    v_mfma_f32_16x16x32_bf16 v[124:127], a[188:191], a[16:19], v[124:127]
    ds_read_b128 a[156:159], v8 offset:36864
    v_accvgpr_write_b32 a59, v43
    v_smfmac_f32_16x16x64_bf16 v[28:31], a[120:123], v[96:103], v22
    v_exp_f32 v115, v115
    v_mfma_f32_16x16x32_bf16 v[192:195], a[100:103], v[96:99], v[192:195]
    ds_read_b128 a[160:163], v8 offset:40960
    v_cvt_pk_bf16_f32 v113, v114, v115
    v_mfma_f32_16x16x32_bf16 v[192:195], a[96:99], v[100:103], v[192:195]
    v_exp_f32 v116, v116
    v_mfma_f32_16x16x32_bf16 v[196:199], a[92:95], v[100:103], v[196:199]
    ds_read_b128 a[164:167], v9 offset:40960
    v_lshlrev_b32 v0, 16, v44
    v_mfma_f32_16x16x32_bf16 v[196:199], a[192:195], v[96:99], v[196:199]
    v_exp_f32 v117, v117
    v_mfma_f32_16x16x32_bf16 v[200:203], a[196:199], v[96:99], v[200:203]
    ds_read_b128 a[168:171], v10 offset:40960
    v_cvt_pk_bf16_f32 v114, v116, v117
    v_mfma_f32_16x16x32_bf16 v[200:203], a[200:203], v[100:103], v[200:203]
    v_exp_f32 v118, v118
    v_mfma_f32_16x16x32_bf16 v[204:207], a[204:207], v[100:103], v[204:207]
    ds_read_b128 a[172:175], v11 offset:40960
    v_lshlrev_b32 v1, 16, v45
    v_mfma_f32_16x16x32_bf16 v[204:207], a[208:211], v[96:99], v[204:207]
    v_exp_f32 v119, v119
    v_mfma_f32_16x16x32_bf16 v[208:211], a[212:215], v[96:99], v[208:211]
    ds_read_b128 a[176:179], v11 offset:45056
    v_cvt_pk_bf16_f32 v115, v118, v119
    v_mfma_f32_16x16x32_bf16 v[208:211], a[216:219], v[100:103], v[208:211]
    v_exp_f32 v120, v120
    v_mfma_f32_16x16x32_bf16 v[212:215], a[220:223], v[100:103], v[212:215]
    ds_read_b128 a[180:183], v10 offset:45056
    v_lshlrev_b32 v2, 16, v46
    v_mfma_f32_16x16x32_bf16 v[212:215], a[224:227], v[96:99], v[212:215]
    v_exp_f32 v121, v121
    v_mfma_f32_16x16x32_bf16 v[216:219], a[228:231], v[96:99], v[216:219]
    ds_read_b128 a[184:187], v9 offset:45056
    v_cvt_pk_bf16_f32 v116, v120, v121
    v_mfma_f32_16x16x32_bf16 v[216:219], a[232:235], v[100:103], v[216:219]
    v_exp_f32 v122, v122
    v_mfma_f32_16x16x32_bf16 v[220:223], a[236:239], v[100:103], v[220:223]
    ds_read_b128 a[188:191], v8 offset:45056
    v_lshlrev_b32 v3, 16, v47
    v_mfma_f32_16x16x32_bf16 v[220:223], a[240:243], v[96:99], v[220:223]
    s_waitcnt lgkmcnt(5)
    ds_read_b64_tr_b16 a[244:245], v12 offset:32768
    ds_read_b64_tr_b16 a[246:247], v12 offset:36864
    v_mfma_f32_16x16x32_bf16 v[96:99], a[128:131], v[64:67], 0
    v_exp_f32 v123, v123
    v_mfma_f32_16x16x32_bf16 v[96:99], a[132:135], v[68:71], v[96:99]
    ds_read_b64_tr_b16 a[248:249], v12 offset:40960
    v_cvt_pk_bf16_f32 v117, v122, v123
    v_mfma_f32_16x16x32_bf16 v[96:99], a[136:139], v[72:75], v[96:99]
    v_exp_f32 v124, v124
    v_mfma_f32_16x16x32_bf16 v[96:99], a[140:143], v[76:79], v[96:99]
    ds_read_b64_tr_b16 a[250:251], v12 offset:45056
    ds_read_b64_tr_b16 a[252:253], v12 offset:40968
    v_mfma_f32_16x16x32_bf16 v[100:103], a[144:147], v[76:79], 0
    v_exp_f32 v125, v125
    v_mfma_f32_16x16x32_bf16 v[100:103], a[148:151], v[72:75], v[100:103]
    ds_read_b64_tr_b16 a[254:255], v12 offset:45064
    v_cvt_pk_bf16_f32 v118, v124, v125
    v_mfma_f32_16x16x32_bf16 v[100:103], a[152:155], v[68:71], v[100:103]
    v_exp_f32 v126, v126
    v_mfma_f32_16x16x32_bf16 v[100:103], a[156:159], v[64:67], v[100:103]
    ds_read_b64_tr_b16 a[116:117], v12 offset:32776
    v_and_b32 v44, s25, v44
    v_and_b32 v45, s25, v45
    v_and_b32 v46, s25, v46
    v_and_b32 v47, s25, v47
    v_pk_mul_f32 v[0:1], v[0:1], s[34:35]
    v_pk_mul_f32 v[2:3], v[2:3], s[34:35]
    v_pk_mul_f32 v[44:45], v[44:45], s[34:35]
    v_pk_mul_f32 v[46:47], v[46:47], s[34:35]
    v_cvt_pk_bf16_f32 v44, v0, v44
    v_cvt_pk_bf16_f32 v45, v1, v45
    v_cvt_pk_bf16_f32 v46, v2, v46
    v_mfma_f32_16x16x32_bf16 v[104:107], a[160:163], v[64:67], 0
    v_exp_f32 v127, v127
    v_mfma_f32_16x16x32_bf16 v[104:107], a[164:167], v[68:71], v[104:107]
    ds_read_b64_tr_b16 a[118:119], v12 offset:36872
    v_cvt_pk_bf16_f32 v119, v126, v127
    v_mfma_f32_16x16x32_bf16 v[104:107], a[168:171], v[72:75], v[104:107]
    s_waitcnt lgkmcnt(3)
    v_exp_f32 v96, v96
    v_mfma_f32_16x16x32_bf16 v[104:107], a[172:175], v[76:79], v[104:107]
    ds_read_b64_tr_b16 a[112:113], v13 offset:32768
    v_cvt_pk_bf16_f32 v47, v3, v47
    v_mfma_f32_16x16x32_bf16 v[108:111], a[176:179], v[76:79], 0
    v_exp_f32 v97, v97
    v_mfma_f32_16x16x32_bf16 v[108:111], a[180:183], v[72:75], v[108:111]
    ds_read_b64_tr_b16 a[114:115], v13 offset:36864
    v_cvt_pk_bf16_f32 v96, v96, v97
    v_mfma_f32_16x16x32_bf16 v[108:111], a[184:187], v[68:71], v[108:111]
    v_exp_f32 v98, v98
    v_mfma_f32_16x16x32_bf16 v[108:111], a[188:191], v[64:67], v[108:111]
    ds_read_b64_tr_b16 a[108:109], v13 offset:40960
    v_accvgpr_write_b32 a60, v44
    v_smfmac_f32_16x16x64_bf16 v[28:31], a[124:127], v[112:119], v22
    v_exp_f32 v99, v99
    v_mfma_f32_16x16x32_bf16 v[224:227], a[100:103], v[112:115], v[224:227]
    ds_read_b64_tr_b16 a[110:111], v13 offset:45056
    v_cvt_pk_bf16_f32 v97, v98, v99
    v_mfma_f32_16x16x32_bf16 v[224:227], a[96:99], v[116:119], v[224:227]
    v_exp_f32 v100, v100
    v_mfma_f32_16x16x32_bf16 v[228:231], a[92:95], v[116:119], v[228:231]
    ds_read_b64_tr_b16 a[104:105], v13 offset:40968
    v_accvgpr_write_b32 a61, v45
    v_mfma_f32_16x16x32_bf16 v[228:231], a[192:195], v[112:115], v[228:231]
    v_exp_f32 v101, v101
    v_mfma_f32_16x16x32_bf16 v[232:235], a[196:199], v[112:115], v[232:235]
    ds_read_b64_tr_b16 a[106:107], v13 offset:45064
    v_cvt_pk_bf16_f32 v98, v100, v101
    v_mfma_f32_16x16x32_bf16 v[232:235], a[200:203], v[116:119], v[232:235]
    v_exp_f32 v102, v102
    v_mfma_f32_16x16x32_bf16 v[236:239], a[204:207], v[116:119], v[236:239]
    ds_read_b64_tr_b16 a[100:101], v13 offset:32776
    v_accvgpr_write_b32 a62, v46
    v_mfma_f32_16x16x32_bf16 v[236:239], a[208:211], v[112:115], v[236:239]
    v_exp_f32 v103, v103
    v_mfma_f32_16x16x32_bf16 v[240:243], a[212:215], v[112:115], v[240:243]
    ds_read_b64_tr_b16 a[102:103], v13 offset:36872
    v_cvt_pk_bf16_f32 v99, v102, v103
    v_mfma_f32_16x16x32_bf16 v[240:243], a[216:219], v[116:119], v[240:243]
    v_exp_f32 v104, v104
    v_mfma_f32_16x16x32_bf16 v[244:247], a[220:223], v[116:119], v[244:247]
    ds_read_b64_tr_b16 a[96:97], v14 offset:32768
    v_accvgpr_write_b32 a63, v47
    v_mfma_f32_16x16x32_bf16 v[244:247], a[224:227], v[112:115], v[244:247]
    v_exp_f32 v105, v105
    v_mfma_f32_16x16x32_bf16 v[248:251], a[228:231], v[112:115], v[248:251]
    ds_read_b64_tr_b16 a[98:99], v14 offset:36864
    v_cvt_pk_bf16_f32 v100, v104, v105
    v_mfma_f32_16x16x32_bf16 v[248:251], a[232:235], v[116:119], v[248:251]
    s_add_u32 m0, s26, 65536
    v_exp_f32 v106, v106
    v_mfma_f32_16x16x32_bf16 v[252:255], a[236:239], v[116:119], v[252:255]
    ds_read_b64_tr_b16 a[92:93], v14 offset:40960
    buffer_load_dwordx4 v17, s[48:51], m0 offen nt lds
    v_mfma_f32_16x16x32_bf16 v[252:255], a[240:243], v[112:115], v[252:255]
    s_waitcnt vmcnt(20)
    ds_read_b64_tr_b16 a[94:95], v14 offset:45056
    v_lshlrev_b32 v0, 16, v48
    v_mfma_f32_16x16x32_bf16 v[112:115], a[128:131], v[80:83], 0
    v_exp_f32 v107, v107
    v_mfma_f32_16x16x32_bf16 v[112:115], a[132:135], v[84:87], v[112:115]
    ds_read_b64_tr_b16 a[192:193], v14 offset:40968
    v_cvt_pk_bf16_f32 v101, v106, v107
    v_mfma_f32_16x16x32_bf16 v[112:115], a[136:139], v[88:91], v[112:115]
    s_add_u32 m0, s26, 69632
    v_exp_f32 v108, v108
    v_mfma_f32_16x16x32_bf16 v[112:115], a[140:143], v[92:95], v[112:115]
    ds_read_b64_tr_b16 a[194:195], v14 offset:45064
    buffer_load_dwordx4 v17, s[48:51], m0 offen nt lds
    v_mfma_f32_16x16x32_bf16 v[116:119], a[144:147], v[92:95], 0
    v_exp_f32 v109, v109
    v_mfma_f32_16x16x32_bf16 v[116:119], a[148:151], v[88:91], v[116:119]
    ds_read_b64_tr_b16 a[196:197], v14 offset:32776
    v_cvt_pk_bf16_f32 v102, v108, v109
    v_mfma_f32_16x16x32_bf16 v[116:119], a[152:155], v[84:87], v[116:119]
    s_add_u32 m0, s26, 73728
    v_exp_f32 v110, v110
    v_mfma_f32_16x16x32_bf16 v[116:119], a[156:159], v[80:83], v[116:119]
    ds_read_b64_tr_b16 a[198:199], v14 offset:36872
    buffer_load_dwordx4 v17, s[48:51], m0 offen nt lds
    v_mfma_f32_16x16x32_bf16 v[120:123], a[160:163], v[80:83], 0
    v_exp_f32 v111, v111
    v_mfma_f32_16x16x32_bf16 v[120:123], a[164:167], v[84:87], v[120:123]
    ds_read_b64_tr_b16 a[200:201], v15 offset:32768
    v_cvt_pk_bf16_f32 v103, v110, v111
    v_mfma_f32_16x16x32_bf16 v[120:123], a[168:171], v[88:91], v[120:123]
    s_add_u32 m0, s26, 77824
    v_exp_f32 v112, v112
    v_mfma_f32_16x16x32_bf16 v[120:123], a[172:175], v[92:95], v[120:123]
    ds_read_b64_tr_b16 a[202:203], v15 offset:36864
    buffer_load_dwordx4 v17, s[48:51], m0 offen nt lds
    v_mfma_f32_16x16x32_bf16 v[124:127], a[176:179], v[92:95], 0
    v_exp_f32 v113, v113
    v_mfma_f32_16x16x32_bf16 v[124:127], a[180:183], v[88:91], v[124:127]
    ds_read_b64_tr_b16 a[204:205], v15 offset:40960
    v_cvt_pk_bf16_f32 v112, v112, v113
    v_mfma_f32_16x16x32_bf16 v[124:127], a[184:187], v[84:87], v[124:127]
    v_exp_f32 v114, v114
    v_mfma_f32_16x16x32_bf16 v[124:127], a[188:191], v[80:83], v[124:127]
    ds_read_b64_tr_b16 a[206:207], v15 offset:45056
    v_lshlrev_b32 v1, 16, v49
    v_smfmac_f32_16x16x64_bf16 v[24:27], a[120:123], v[96:103], v22
    v_exp_f32 v115, v115
    v_mfma_f32_16x16x32_bf16 v[128:131], a[244:247], v[96:99], v[128:131]
    ds_read_b64_tr_b16 a[208:209], v15 offset:40968
    v_cvt_pk_bf16_f32 v113, v114, v115
    v_mfma_f32_16x16x32_bf16 v[128:131], a[248:251], v[100:103], v[128:131]
    s_waitcnt lgkmcnt(4)
    v_exp_f32 v116, v116
    v_mfma_f32_16x16x32_bf16 v[132:135], a[252:255], v[100:103], v[132:135]
    ds_read_b64_tr_b16 a[210:211], v15 offset:45064
    v_lshlrev_b32 v2, 16, v50
    v_mfma_f32_16x16x32_bf16 v[132:135], a[116:119], v[96:99], v[132:135]
    v_exp_f32 v117, v117
    v_mfma_f32_16x16x32_bf16 v[136:139], a[112:115], v[96:99], v[136:139]
    ds_read_b64_tr_b16 a[212:213], v15 offset:32776
    v_cvt_pk_bf16_f32 v114, v116, v117
    v_mfma_f32_16x16x32_bf16 v[136:139], a[108:111], v[100:103], v[136:139]
    v_exp_f32 v118, v118
    v_mfma_f32_16x16x32_bf16 v[140:143], a[104:107], v[100:103], v[140:143]
    ds_read_b64_tr_b16 a[214:215], v15 offset:36872
    v_lshlrev_b32 v3, 16, v51
    v_mfma_f32_16x16x32_bf16 v[140:143], a[100:103], v[96:99], v[140:143]
    v_exp_f32 v119, v119
    v_mfma_f32_16x16x32_bf16 v[144:147], a[96:99], v[96:99], v[144:147]
    v_cvt_pk_bf16_f32 v115, v118, v119
    v_and_b32 v48, s25, v48
    v_and_b32 v49, s25, v49
    v_and_b32 v50, s25, v50
    v_and_b32 v51, s25, v51
    v_pk_mul_f32 v[0:1], v[0:1], s[34:35]
    v_pk_mul_f32 v[2:3], v[2:3], s[34:35]
    v_pk_mul_f32 v[48:49], v[48:49], s[34:35]
    v_pk_mul_f32 v[50:51], v[50:51], s[34:35]
    v_cvt_pk_bf16_f32 v48, v0, v48
    v_cvt_pk_bf16_f32 v49, v1, v49
    v_cvt_pk_bf16_f32 v50, v2, v50
    v_mfma_f32_16x16x32_bf16 v[144:147], a[92:95], v[100:103], v[144:147]
    v_exp_f32 v120, v120
    v_mfma_f32_16x16x32_bf16 v[148:151], a[192:195], v[100:103], v[148:151]
    v_cvt_pk_bf16_f32 v51, v3, v51
    v_accvgpr_write_b32 a64, v48
    v_mfma_f32_16x16x32_bf16 v[148:151], a[196:199], v[96:99], v[148:151]
    s_waitcnt lgkmcnt(1)
    v_exp_f32 v121, v121
    v_mfma_f32_16x16x32_bf16 v[152:155], a[200:203], v[96:99], v[152:155]
    v_cvt_pk_bf16_f32 v116, v120, v121
    v_accvgpr_write_b32 a65, v49
    v_mfma_f32_16x16x32_bf16 v[152:155], a[204:207], v[100:103], v[152:155]
    v_exp_f32 v122, v122
    v_mfma_f32_16x16x32_bf16 v[156:159], a[208:211], v[100:103], v[156:159]
    s_waitcnt lgkmcnt(0)
    v_accvgpr_write_b32 a66, v50
    v_accvgpr_write_b32 a67, v51
    v_mfma_f32_16x16x32_bf16 v[156:159], a[212:215], v[96:99], v[156:159]
    s_waitcnt vmcnt(20)
    v_lshlrev_b32 v0, 16, v52
    v_lshlrev_b32 v1, 16, v53
    v_mfma_f32_16x16x32_bf16 v[96:99], a[128:131], a[0:3], 0
    s_waitcnt vmcnt(10)
    s_barrier
    v_exp_f32 v123, v123
    v_mfma_f32_16x16x32_bf16 v[96:99], a[132:135], a[4:7], v[96:99]
Lpad4:
    s_cbranch_execz Lret0
    s_add_u32 s29, s27, 0
    v_cvt_pk_bf16_f32 v117, v122, v123
    v_lshlrev_b32 v2, 16, v54
    v_mfma_f32_16x16x32_bf16 v[96:99], a[136:139], a[8:11], v[96:99]
    s_add_u32 m0, s27, 131072
    v_exp_f32 v124, v124
    v_mfma_f32_16x16x32_bf16 v[96:99], a[140:143], a[12:15], v[96:99]
    buffer_load_dwordx4 v18, s[52:55], s29 offen lds
    v_mfma_f32_16x16x32_bf16 v[100:103], a[144:147], a[12:15], 0
    v_exp_f32 v125, v125
    v_mfma_f32_16x16x32_bf16 v[100:103], a[148:151], a[8:11], v[100:103]
    v_cvt_pk_bf16_f32 v118, v124, v125
    v_lshlrev_b32 v3, 16, v55
    v_mfma_f32_16x16x32_bf16 v[100:103], a[152:155], a[4:7], v[100:103]
    v_exp_f32 v126, v126
    v_mfma_f32_16x16x32_bf16 v[100:103], a[156:159], a[0:3], v[100:103]
    buffer_load_dwordx4 v18, s[52:55], s29 offen offset:1024 lds
    v_mfma_f32_16x16x32_bf16 v[104:107], a[160:163], a[0:3], 0
    v_exp_f32 v127, v127
    v_mfma_f32_16x16x32_bf16 v[104:107], a[164:167], a[4:7], v[104:107]
    v_cvt_pk_bf16_f32 v119, v126, v127
    v_and_b32 v52, s25, v52
    v_and_b32 v53, s25, v53
    v_and_b32 v54, s25, v54
    v_and_b32 v55, s25, v55
    v_pk_mul_f32 v[0:1], v[0:1], s[34:35]
    v_pk_mul_f32 v[2:3], v[2:3], s[34:35]
    v_pk_mul_f32 v[52:53], v[52:53], s[34:35]
    v_pk_mul_f32 v[54:55], v[54:55], s[34:35]
    v_cvt_pk_bf16_f32 v52, v0, v52
    v_cvt_pk_bf16_f32 v53, v1, v53
    v_cvt_pk_bf16_f32 v54, v2, v54
    v_mfma_f32_16x16x32_bf16 v[104:107], a[168:171], a[8:11], v[104:107]
    v_exp_f32 v96, v96
    v_mfma_f32_16x16x32_bf16 v[104:107], a[172:175], a[12:15], v[104:107]
    buffer_load_dwordx4 v18, s[52:55], s29 offen offset:2048 lds
    v_mfma_f32_16x16x32_bf16 v[108:111], a[176:179], a[12:15], 0
    v_exp_f32 v97, v97
    v_mfma_f32_16x16x32_bf16 v[108:111], a[180:183], a[8:11], v[108:111]
    v_cvt_pk_bf16_f32 v96, v96, v97
    v_cvt_pk_bf16_f32 v55, v3, v55
    v_mfma_f32_16x16x32_bf16 v[108:111], a[184:187], a[4:7], v[108:111]
    v_exp_f32 v98, v98
    v_mfma_f32_16x16x32_bf16 v[108:111], a[188:191], a[0:3], v[108:111]
    buffer_load_dwordx4 v18, s[52:55], s29 offen offset:3072 lds
    v_smfmac_f32_16x16x64_bf16 v[24:27], a[124:127], v[112:119], v22
    v_exp_f32 v99, v99
    v_mfma_f32_16x16x32_bf16 v[160:163], a[244:247], v[112:115], v[160:163]
    s_add_u32 s29, s27, 16384
    v_cvt_pk_bf16_f32 v97, v98, v99
    v_accvgpr_write_b32 a68, v52
    v_mfma_f32_16x16x32_bf16 v[160:163], a[248:251], v[116:119], v[160:163]
    s_add_u32 m0, s27, 98304
    v_exp_f32 v100, v100
    v_mfma_f32_16x16x32_bf16 v[164:167], a[252:255], v[116:119], v[164:167]
    buffer_load_dwordx4 v18, s[52:55], s29 offen lds
    v_mfma_f32_16x16x32_bf16 v[164:167], a[116:119], v[112:115], v[164:167]
    v_exp_f32 v101, v101
    v_mfma_f32_16x16x32_bf16 v[168:171], a[112:115], v[112:115], v[168:171]
    v_cvt_pk_bf16_f32 v98, v100, v101
    v_accvgpr_write_b32 a69, v53
    v_mfma_f32_16x16x32_bf16 v[168:171], a[108:111], v[116:119], v[168:171]
    v_exp_f32 v102, v102
    v_mfma_f32_16x16x32_bf16 v[172:175], a[104:107], v[116:119], v[172:175]
    s_mov_b32 s30, 12288
    buffer_load_dwordx4 v[32:35], v16, s[44:47], s30 offen nt
    v_mfma_f32_16x16x32_bf16 v[172:175], a[100:103], v[112:115], v[172:175]
    v_exp_f32 v103, v103
    v_mfma_f32_16x16x32_bf16 v[176:179], a[96:99], v[112:115], v[176:179]
    buffer_load_dwordx4 v18, s[52:55], s29 offen offset:1024 lds
    v_cvt_pk_bf16_f32 v99, v102, v103
    v_mfma_f32_16x16x32_bf16 v[176:179], a[92:95], v[116:119], v[176:179]
    v_exp_f32 v104, v104
    v_mfma_f32_16x16x32_bf16 v[180:183], a[192:195], v[116:119], v[180:183]
    buffer_load_dwordx4 v18, s[52:55], s29 offen offset:2048 lds
    v_mfma_f32_16x16x32_bf16 v[180:183], a[196:199], v[112:115], v[180:183]
    v_exp_f32 v105, v105
    v_mfma_f32_16x16x32_bf16 v[184:187], a[200:203], v[112:115], v[184:187]
    v_cvt_pk_bf16_f32 v100, v104, v105
    v_accvgpr_write_b32 a70, v54
    v_mfma_f32_16x16x32_bf16 v[184:187], a[204:207], v[116:119], v[184:187]
    v_exp_f32 v106, v106
    v_mfma_f32_16x16x32_bf16 v[188:191], a[208:211], v[116:119], v[188:191]
    buffer_load_dwordx4 v18, s[52:55], s29 offen offset:3072 lds
    v_mfma_f32_16x16x32_bf16 v[188:191], a[212:215], v[112:115], v[188:191]
    v_accvgpr_write_b32 a71, v55
    v_mfma_f32_16x16x32_bf16 v[112:115], a[128:131], a[16:19], 0
    v_exp_f32 v107, v107
    v_mfma_f32_16x16x32_bf16 v[112:115], a[132:135], a[20:23], v[112:115]
    ds_read_b128 a[128:131], v8 offset:49152
    v_cvt_pk_bf16_f32 v101, v106, v107
    v_mfma_f32_16x16x32_bf16 v[112:115], a[136:139], a[24:27], v[112:115]
    v_exp_f32 v108, v108
    v_mfma_f32_16x16x32_bf16 v[112:115], a[140:143], a[28:31], v[112:115]
    ds_read_b128 a[132:135], v9 offset:49152
    v_mfma_f32_16x16x32_bf16 v[116:119], a[144:147], a[28:31], 0
    v_exp_f32 v109, v109
    v_mfma_f32_16x16x32_bf16 v[116:119], a[148:151], a[24:27], v[116:119]
    ds_read_b128 a[136:139], v10 offset:49152
    v_cvt_pk_bf16_f32 v102, v108, v109
    v_mfma_f32_16x16x32_bf16 v[116:119], a[152:155], a[20:23], v[116:119]
    v_exp_f32 v110, v110
    v_mfma_f32_16x16x32_bf16 v[116:119], a[156:159], a[16:19], v[116:119]
    s_mov_b32 s30, 12288
    ds_read_b128 a[140:143], v11 offset:49152
    buffer_load_dwordx4 v[36:39], v16, s[44:47], s30 offen offset:64 nt
    v_mfma_f32_16x16x32_bf16 v[120:123], a[160:163], a[16:19], 0
    v_exp_f32 v111, v111
    v_mfma_f32_16x16x32_bf16 v[120:123], a[164:167], a[20:23], v[120:123]
    ds_read_b128 a[144:147], v11 offset:53248
    v_cvt_pk_bf16_f32 v103, v110, v111
    v_mfma_f32_16x16x32_bf16 v[120:123], a[168:171], a[24:27], v[120:123]
    v_exp_f32 v112, v112
    v_mfma_f32_16x16x32_bf16 v[120:123], a[172:175], a[28:31], v[120:123]
    ds_read_b128 a[148:151], v10 offset:53248
    v_mfma_f32_16x16x32_bf16 v[124:127], a[176:179], a[28:31], 0
    v_exp_f32 v113, v113
    v_mfma_f32_16x16x32_bf16 v[124:127], a[180:183], a[24:27], v[124:127]
    ds_read_b128 a[152:155], v9 offset:53248
    v_cvt_pk_bf16_f32 v112, v112, v113
    v_mfma_f32_16x16x32_bf16 v[124:127], a[184:187], a[20:23], v[124:127]
    v_exp_f32 v114, v114
    v_mfma_f32_16x16x32_bf16 v[124:127], a[188:191], a[16:19], v[124:127]
    s_waitcnt vmcnt(19)
    ds_read_b128 a[156:159], v8 offset:53248
    v_lshlrev_b32 v0, 16, v56
    v_smfmac_f32_16x16x64_bf16 v[28:31], a[120:123], v[96:103], v22
    v_exp_f32 v115, v115
    v_mfma_f32_16x16x32_bf16 v[192:195], a[244:247], v[96:99], v[192:195]
    ds_read_b128 a[160:163], v8 offset:57344
    v_cvt_pk_bf16_f32 v113, v114, v115
    v_mfma_f32_16x16x32_bf16 v[192:195], a[248:251], v[100:103], v[192:195]
    v_exp_f32 v116, v116
    v_mfma_f32_16x16x32_bf16 v[196:199], a[252:255], v[100:103], v[196:199]
    ds_read_b128 a[164:167], v9 offset:57344
    v_lshlrev_b32 v1, 16, v57
    v_mfma_f32_16x16x32_bf16 v[196:199], a[116:119], v[96:99], v[196:199]
    v_exp_f32 v117, v117
    v_mfma_f32_16x16x32_bf16 v[200:203], a[112:115], v[96:99], v[200:203]
    ds_read_b128 a[168:171], v10 offset:57344
    v_cvt_pk_bf16_f32 v114, v116, v117
    v_mfma_f32_16x16x32_bf16 v[200:203], a[108:111], v[100:103], v[200:203]
    v_exp_f32 v118, v118
    v_mfma_f32_16x16x32_bf16 v[204:207], a[104:107], v[100:103], v[204:207]
    ds_read_b128 a[172:175], v11 offset:57344
    v_lshlrev_b32 v2, 16, v58
    v_mfma_f32_16x16x32_bf16 v[204:207], a[100:103], v[96:99], v[204:207]
    v_exp_f32 v119, v119
    v_mfma_f32_16x16x32_bf16 v[208:211], a[96:99], v[96:99], v[208:211]
    ds_read_b128 a[176:179], v11 offset:61440
    v_cvt_pk_bf16_f32 v115, v118, v119
    v_mfma_f32_16x16x32_bf16 v[208:211], a[92:95], v[100:103], v[208:211]
    v_exp_f32 v120, v120
    v_mfma_f32_16x16x32_bf16 v[212:215], a[192:195], v[100:103], v[212:215]
    ds_read_b128 a[180:183], v10 offset:61440
    v_lshlrev_b32 v3, 16, v59
    v_mfma_f32_16x16x32_bf16 v[212:215], a[196:199], v[96:99], v[212:215]
    v_exp_f32 v121, v121
    v_mfma_f32_16x16x32_bf16 v[216:219], a[200:203], v[96:99], v[216:219]
    ds_read_b128 a[184:187], v9 offset:61440
    v_cvt_pk_bf16_f32 v116, v120, v121
    v_mfma_f32_16x16x32_bf16 v[216:219], a[204:207], v[100:103], v[216:219]
    v_exp_f32 v122, v122
    v_mfma_f32_16x16x32_bf16 v[220:223], a[208:211], v[100:103], v[220:223]
    ds_read_b128 a[188:191], v8 offset:61440
    v_and_b32 v56, s25, v56
    v_and_b32 v57, s25, v57
    v_and_b32 v58, s25, v58
    v_and_b32 v59, s25, v59
    v_pk_mul_f32 v[0:1], v[0:1], s[34:35]
    v_pk_mul_f32 v[2:3], v[2:3], s[34:35]
    v_pk_mul_f32 v[56:57], v[56:57], s[34:35]
    v_pk_mul_f32 v[58:59], v[58:59], s[34:35]
    v_cvt_pk_bf16_f32 v56, v0, v56
    v_cvt_pk_bf16_f32 v57, v1, v57
    v_cvt_pk_bf16_f32 v58, v2, v58
    v_mfma_f32_16x16x32_bf16 v[220:223], a[212:215], v[96:99], v[220:223]
    s_waitcnt lgkmcnt(3)
    ds_read_b64_tr_b16 a[216:217], v12 offset:49152
    ds_read_b64_tr_b16 a[218:219], v12 offset:53248
    v_mfma_f32_16x16x32_bf16 v[96:99], a[128:131], v[64:67], 0
    v_exp_f32 v123, v123
    v_mfma_f32_16x16x32_bf16 v[96:99], a[132:135], v[68:71], v[96:99]
    ds_read_b64_tr_b16 a[220:221], v12 offset:57344
    v_cvt_pk_bf16_f32 v117, v122, v123
    v_mfma_f32_16x16x32_bf16 v[96:99], a[136:139], v[72:75], v[96:99]
    v_exp_f32 v124, v124
    v_mfma_f32_16x16x32_bf16 v[96:99], a[140:143], v[76:79], v[96:99]
    ds_read_b64_tr_b16 a[222:223], v12 offset:61440
    ds_read_b64_tr_b16 a[224:225], v12 offset:57352
    v_mfma_f32_16x16x32_bf16 v[100:103], a[144:147], v[76:79], 0
    v_exp_f32 v125, v125
    v_mfma_f32_16x16x32_bf16 v[100:103], a[148:151], v[72:75], v[100:103]
    ds_read_b64_tr_b16 a[226:227], v12 offset:61448
    v_cvt_pk_bf16_f32 v118, v124, v125
    v_mfma_f32_16x16x32_bf16 v[100:103], a[152:155], v[68:71], v[100:103]
    v_exp_f32 v126, v126
    v_mfma_f32_16x16x32_bf16 v[100:103], a[156:159], v[64:67], v[100:103]
    ds_read_b64_tr_b16 a[228:229], v12 offset:49160
    v_cvt_pk_bf16_f32 v59, v3, v59
    v_mfma_f32_16x16x32_bf16 v[104:107], a[160:163], v[64:67], 0
    v_exp_f32 v127, v127
    v_mfma_f32_16x16x32_bf16 v[104:107], a[164:167], v[68:71], v[104:107]
    ds_read_b64_tr_b16 a[230:231], v12 offset:53256
    v_cvt_pk_bf16_f32 v119, v126, v127
    v_mfma_f32_16x16x32_bf16 v[104:107], a[168:171], v[72:75], v[104:107]
    v_exp_f32 v96, v96
    v_mfma_f32_16x16x32_bf16 v[104:107], a[172:175], v[76:79], v[104:107]
    ds_read_b64_tr_b16 a[232:233], v13 offset:49152
    v_accvgpr_write_b32 a72, v56
    v_mfma_f32_16x16x32_bf16 v[108:111], a[176:179], v[76:79], 0
    s_waitcnt lgkmcnt(6)
    v_exp_f32 v97, v97
    v_mfma_f32_16x16x32_bf16 v[108:111], a[180:183], v[72:75], v[108:111]
    ds_read_b64_tr_b16 a[234:235], v13 offset:53248
    v_cvt_pk_bf16_f32 v96, v96, v97
    v_mfma_f32_16x16x32_bf16 v[108:111], a[184:187], v[68:71], v[108:111]
    v_exp_f32 v98, v98
    v_mfma_f32_16x16x32_bf16 v[108:111], a[188:191], v[64:67], v[108:111]
    ds_read_b64_tr_b16 a[236:237], v13 offset:57344
    v_accvgpr_write_b32 a73, v57
    v_smfmac_f32_16x16x64_bf16 v[28:31], a[124:127], v[112:119], v22
    v_exp_f32 v99, v99
    v_mfma_f32_16x16x32_bf16 v[224:227], a[244:247], v[112:115], v[224:227]
    ds_read_b64_tr_b16 a[238:239], v13 offset:61440
    v_cvt_pk_bf16_f32 v97, v98, v99
    v_mfma_f32_16x16x32_bf16 v[224:227], a[248:251], v[116:119], v[224:227]
    v_exp_f32 v100, v100
    v_mfma_f32_16x16x32_bf16 v[228:231], a[252:255], v[116:119], v[228:231]
    ds_read_b64_tr_b16 a[240:241], v13 offset:57352
    v_accvgpr_write_b32 a74, v58
    v_mfma_f32_16x16x32_bf16 v[228:231], a[116:119], v[112:115], v[228:231]
    v_exp_f32 v101, v101
    v_mfma_f32_16x16x32_bf16 v[232:235], a[112:115], v[112:115], v[232:235]
    ds_read_b64_tr_b16 a[242:243], v13 offset:61448
    v_cvt_pk_bf16_f32 v98, v100, v101
    v_mfma_f32_16x16x32_bf16 v[232:235], a[108:111], v[116:119], v[232:235]
    v_exp_f32 v102, v102
    v_mfma_f32_16x16x32_bf16 v[236:239], a[104:107], v[116:119], v[236:239]
    ds_read_b64_tr_b16 a[244:245], v13 offset:49160
    v_accvgpr_write_b32 a75, v59
    v_mfma_f32_16x16x32_bf16 v[236:239], a[100:103], v[112:115], v[236:239]
    v_exp_f32 v103, v103
    v_mfma_f32_16x16x32_bf16 v[240:243], a[96:99], v[112:115], v[240:243]
    ds_read_b64_tr_b16 a[246:247], v13 offset:53256
    v_cvt_pk_bf16_f32 v99, v102, v103
    v_mfma_f32_16x16x32_bf16 v[240:243], a[92:95], v[116:119], v[240:243]
    v_exp_f32 v104, v104
    v_mfma_f32_16x16x32_bf16 v[244:247], a[192:195], v[116:119], v[244:247]
    s_waitcnt vmcnt(16)
    ds_read_b64_tr_b16 a[248:249], v14 offset:49152
    v_lshlrev_b32 v0, 16, v60
    v_mfma_f32_16x16x32_bf16 v[244:247], a[196:199], v[112:115], v[244:247]
    v_exp_f32 v105, v105
    v_mfma_f32_16x16x32_bf16 v[248:251], a[200:203], v[112:115], v[248:251]
    ds_read_b64_tr_b16 a[250:251], v14 offset:53248
    v_cvt_pk_bf16_f32 v100, v104, v105
    v_mfma_f32_16x16x32_bf16 v[248:251], a[204:207], v[116:119], v[248:251]
    s_add_u32 m0, s26, 81920
    v_exp_f32 v106, v106
    v_mfma_f32_16x16x32_bf16 v[252:255], a[208:211], v[116:119], v[252:255]
    ds_read_b64_tr_b16 a[252:253], v14 offset:57344
    buffer_load_dwordx4 v17, s[48:51], m0 offen nt lds
    v_mfma_f32_16x16x32_bf16 v[252:255], a[212:215], v[112:115], v[252:255]
    ds_read_b64_tr_b16 a[254:255], v14 offset:61440
    v_lshlrev_b32 v1, 16, v61
    v_mfma_f32_16x16x32_bf16 v[112:115], a[128:131], v[80:83], 0
    v_exp_f32 v107, v107
    v_mfma_f32_16x16x32_bf16 v[112:115], a[132:135], v[84:87], v[112:115]
    ds_read_b64_tr_b16 a[116:117], v14 offset:57352
    v_cvt_pk_bf16_f32 v101, v106, v107
    v_mfma_f32_16x16x32_bf16 v[112:115], a[136:139], v[88:91], v[112:115]
    s_add_u32 m0, s26, 86016
    v_exp_f32 v108, v108
    v_mfma_f32_16x16x32_bf16 v[112:115], a[140:143], v[92:95], v[112:115]
    ds_read_b64_tr_b16 a[118:119], v14 offset:61448
    buffer_load_dwordx4 v17, s[48:51], m0 offen nt lds
    v_mfma_f32_16x16x32_bf16 v[116:119], a[144:147], v[92:95], 0
    v_exp_f32 v109, v109
    v_mfma_f32_16x16x32_bf16 v[116:119], a[148:151], v[88:91], v[116:119]
    ds_read_b64_tr_b16 a[112:113], v14 offset:49160
    v_cvt_pk_bf16_f32 v102, v108, v109
    v_mfma_f32_16x16x32_bf16 v[116:119], a[152:155], v[84:87], v[116:119]
    s_add_u32 m0, s26, 90112
    v_exp_f32 v110, v110
    v_mfma_f32_16x16x32_bf16 v[116:119], a[156:159], v[80:83], v[116:119]
    ds_read_b64_tr_b16 a[114:115], v14 offset:53256
    buffer_load_dwordx4 v17, s[48:51], m0 offen nt lds
    v_mfma_f32_16x16x32_bf16 v[120:123], a[160:163], v[80:83], 0
    v_exp_f32 v111, v111
    v_mfma_f32_16x16x32_bf16 v[120:123], a[164:167], v[84:87], v[120:123]
    ds_read_b64_tr_b16 a[108:109], v15 offset:49152
    v_cvt_pk_bf16_f32 v103, v110, v111
    v_mfma_f32_16x16x32_bf16 v[120:123], a[168:171], v[88:91], v[120:123]
    s_add_u32 m0, s26, 94208
    v_exp_f32 v112, v112
    v_mfma_f32_16x16x32_bf16 v[120:123], a[172:175], v[92:95], v[120:123]
    ds_read_b64_tr_b16 a[110:111], v15 offset:53248
    buffer_load_dwordx4 v17, s[48:51], m0 offen nt lds
    v_mfma_f32_16x16x32_bf16 v[124:127], a[176:179], v[92:95], 0
    v_exp_f32 v113, v113
    v_mfma_f32_16x16x32_bf16 v[124:127], a[180:183], v[88:91], v[124:127]
    ds_read_b64_tr_b16 a[104:105], v15 offset:57344
    v_cvt_pk_bf16_f32 v112, v112, v113
    v_mfma_f32_16x16x32_bf16 v[124:127], a[184:187], v[84:87], v[124:127]
    v_exp_f32 v114, v114
    v_mfma_f32_16x16x32_bf16 v[124:127], a[188:191], v[80:83], v[124:127]
    ds_read_b64_tr_b16 a[106:107], v15 offset:61440
    v_lshlrev_b32 v2, 16, v62
    v_smfmac_f32_16x16x64_bf16 v[24:27], a[120:123], v[96:103], v22
    v_exp_f32 v115, v115
    v_mfma_f32_16x16x32_bf16 v[128:131], a[216:219], v[96:99], v[128:131]
    s_waitcnt lgkmcnt(4)
    ds_read_b64_tr_b16 a[100:101], v15 offset:57352
    v_cvt_pk_bf16_f32 v113, v114, v115
    v_mfma_f32_16x16x32_bf16 v[128:131], a[220:223], v[100:103], v[128:131]
    v_exp_f32 v116, v116
    v_mfma_f32_16x16x32_bf16 v[132:135], a[224:227], v[100:103], v[132:135]
    ds_read_b64_tr_b16 a[102:103], v15 offset:61448
    v_lshlrev_b32 v3, 16, v63
    v_mfma_f32_16x16x32_bf16 v[132:135], a[228:231], v[96:99], v[132:135]
    v_exp_f32 v117, v117
    v_mfma_f32_16x16x32_bf16 v[136:139], a[232:235], v[96:99], v[136:139]
    ds_read_b64_tr_b16 a[96:97], v15 offset:49160
    v_cvt_pk_bf16_f32 v114, v116, v117
    v_mfma_f32_16x16x32_bf16 v[136:139], a[236:239], v[100:103], v[136:139]
    v_exp_f32 v118, v118
    v_mfma_f32_16x16x32_bf16 v[140:143], a[240:243], v[100:103], v[140:143]
    ds_read_b64_tr_b16 a[98:99], v15 offset:53256
    v_add_f32 v24, v24, v25
    v_mfma_f32_16x16x32_bf16 v[140:143], a[244:247], v[96:99], v[140:143]
    v_exp_f32 v119, v119
    v_mfma_f32_16x16x32_bf16 v[144:147], a[248:251], v[96:99], v[144:147]
    v_cvt_pk_bf16_f32 v115, v118, v119
    v_and_b32 v60, s25, v60
    v_and_b32 v61, s25, v61
    v_and_b32 v62, s25, v62
    v_and_b32 v63, s25, v63
    v_pk_mul_f32 v[0:1], v[0:1], s[34:35]
    v_pk_mul_f32 v[2:3], v[2:3], s[34:35]
    v_pk_mul_f32 v[60:61], v[60:61], s[34:35]
    v_pk_mul_f32 v[62:63], v[62:63], s[34:35]
    v_cvt_pk_bf16_f32 v60, v0, v60
    v_cvt_pk_bf16_f32 v61, v1, v61
    v_cvt_pk_bf16_f32 v62, v2, v62
    v_mfma_f32_16x16x32_bf16 v[144:147], a[252:255], v[100:103], v[144:147]
    v_exp_f32 v120, v120
    v_mfma_f32_16x16x32_bf16 v[148:151], a[116:119], v[100:103], v[148:151]
    v_rcp_f32 v20, v24
    v_mfma_f32_16x16x32_bf16 v[148:151], a[112:115], v[96:99], v[148:151]
    s_waitcnt lgkmcnt(1)
    v_exp_f32 v121, v121
    v_mfma_f32_16x16x32_bf16 v[152:155], a[108:111], v[96:99], v[152:155]
    v_cvt_pk_bf16_f32 v116, v120, v121
    v_cvt_pk_bf16_f32 v63, v3, v63
    v_mfma_f32_16x16x32_bf16 v[152:155], a[104:107], v[100:103], v[152:155]
    v_exp_f32 v122, v122
    v_mfma_f32_16x16x32_bf16 v[156:159], a[100:103], v[100:103], v[156:159]
    s_waitcnt lgkmcnt(0)
    v_accvgpr_write_b32 a76, v60
    v_accvgpr_write_b32 a77, v61
    v_mfma_f32_16x16x32_bf16 v[156:159], a[96:99], v[96:99], v[156:159]
    s_waitcnt vmcnt(10)
    v_accvgpr_write_b32 a78, v62
    v_accvgpr_write_b32 a79, v63
    v_mfma_f32_16x16x32_bf16 v[96:99], a[128:131], a[0:3], 0
    s_barrier
    v_exp_f32 v123, v123
    v_mfma_f32_16x16x32_bf16 v[96:99], a[132:135], a[4:7], v[96:99]
    s_add_u32 s29, s27, 32768
    v_cvt_pk_bf16_f32 v117, v122, v123
    v_mfma_f32_16x16x32_bf16 v[96:99], a[136:139], a[8:11], v[96:99]
    s_add_u32 m0, s27, 147456
    v_exp_f32 v124, v124
    v_mfma_f32_16x16x32_bf16 v[96:99], a[140:143], a[12:15], v[96:99]
    buffer_load_dwordx4 v18, s[52:55], s29 offen lds
    v_mfma_f32_16x16x32_bf16 v[100:103], a[144:147], a[12:15], 0
    v_exp_f32 v125, v125
    v_subrev_u32 v24, s28, v24
    v_mov_b32 v21, v20
    v_max_u32 v19, v19, v24
    v_pk_mul_f32 v[128:129], v[128:129], v[20:21]
    v_pk_mul_f32 v[130:131], v[130:131], v[20:21]
    v_pk_mul_f32 v[132:133], v[132:133], v[20:21]
    v_pk_mul_f32 v[134:135], v[134:135], v[20:21]
    v_pk_mul_f32 v[136:137], v[136:137], v[20:21]
    v_pk_mul_f32 v[138:139], v[138:139], v[20:21]
    v_pk_mul_f32 v[140:141], v[140:141], v[20:21]
    v_pk_mul_f32 v[142:143], v[142:143], v[20:21]
    v_pk_mul_f32 v[144:145], v[144:145], v[20:21]
    v_pk_mul_f32 v[146:147], v[146:147], v[20:21]
    v_pk_mul_f32 v[148:149], v[148:149], v[20:21]
    v_pk_mul_f32 v[150:151], v[150:151], v[20:21]
    v_pk_mul_f32 v[152:153], v[152:153], v[20:21]
    v_pk_mul_f32 v[154:155], v[154:155], v[20:21]
    v_pk_mul_f32 v[156:157], v[156:157], v[20:21]
    v_pk_mul_f32 v[158:159], v[158:159], v[20:21]
    v_mov_b32 v24, 0
    v_mov_b32 v25, 0
    v_cvt_pk_bf16_f32 v40, v128, v129
    v_mfma_f32_16x16x32_bf16 v[100:103], a[148:151], a[8:11], v[100:103]
    v_cvt_pk_bf16_f32 v118, v124, v125
    v_cvt_pk_bf16_f32 v41, v130, v131
    v_mfma_f32_16x16x32_bf16 v[100:103], a[152:155], a[4:7], v[100:103]
    v_exp_f32 v126, v126
    v_mfma_f32_16x16x32_bf16 v[100:103], a[156:159], a[0:3], v[100:103]
    buffer_load_dwordx4 v18, s[52:55], s29 offen offset:1024 lds
    v_mfma_f32_16x16x32_bf16 v[104:107], a[160:163], a[0:3], 0
    v_exp_f32 v127, v127
    v_mfma_f32_16x16x32_bf16 v[104:107], a[164:167], a[4:7], v[104:107]
    v_cvt_pk_bf16_f32 v119, v126, v127
    v_cvt_pk_bf16_f32 v42, v132, v133
    v_mfma_f32_16x16x32_bf16 v[104:107], a[168:171], a[8:11], v[104:107]
    v_exp_f32 v96, v96
    v_mfma_f32_16x16x32_bf16 v[104:107], a[172:175], a[12:15], v[104:107]
    buffer_load_dwordx4 v18, s[52:55], s29 offen offset:2048 lds
    v_mfma_f32_16x16x32_bf16 v[108:111], a[176:179], a[12:15], 0
    v_exp_f32 v97, v97
    v_mfma_f32_16x16x32_bf16 v[108:111], a[180:183], a[8:11], v[108:111]
    v_cvt_pk_bf16_f32 v96, v96, v97
    v_cvt_pk_bf16_f32 v43, v134, v135
    v_mfma_f32_16x16x32_bf16 v[108:111], a[184:187], a[4:7], v[108:111]
    v_exp_f32 v98, v98
    v_mfma_f32_16x16x32_bf16 v[108:111], a[188:191], a[0:3], v[108:111]
    buffer_load_dwordx4 v18, s[52:55], s29 offen offset:3072 lds
    v_smfmac_f32_16x16x64_bf16 v[24:27], a[124:127], v[112:119], v22
    v_exp_f32 v99, v99
    v_mfma_f32_16x16x32_bf16 v[160:163], a[216:219], v[112:115], v[160:163]
    v_cvt_pk_bf16_f32 v97, v98, v99
    v_cvt_pk_bf16_f32 v44, v136, v137
    v_mfma_f32_16x16x32_bf16 v[160:163], a[220:223], v[116:119], v[160:163]
    v_exp_f32 v100, v100
    v_mfma_f32_16x16x32_bf16 v[164:167], a[224:227], v[116:119], v[164:167]
    s_mov_b32 s30, 12288
    buffer_load_dwordx4 v[48:51], v16, s[44:47], s30 offen offset:128 nt
    v_mfma_f32_16x16x32_bf16 v[164:167], a[228:231], v[112:115], v[164:167]
    v_exp_f32 v101, v101
    v_mfma_f32_16x16x32_bf16 v[168:171], a[232:235], v[112:115], v[168:171]
    v_cvt_pk_bf16_f32 v98, v100, v101
    v_add_f32 v26, v26, v27
    v_mfma_f32_16x16x32_bf16 v[168:171], a[236:239], v[116:119], v[168:171]
    v_exp_f32 v102, v102
    v_mfma_f32_16x16x32_bf16 v[172:175], a[240:243], v[116:119], v[172:175]
    v_rcp_f32 v20, v26
    v_mfma_f32_16x16x32_bf16 v[172:175], a[244:247], v[112:115], v[172:175]
    v_exp_f32 v103, v103
    v_mfma_f32_16x16x32_bf16 v[176:179], a[248:251], v[112:115], v[176:179]
    v_cvt_pk_bf16_f32 v99, v102, v103
    v_cvt_pk_bf16_f32 v45, v138, v139
    v_mfma_f32_16x16x32_bf16 v[176:179], a[252:255], v[116:119], v[176:179]
    v_exp_f32 v104, v104
    v_mfma_f32_16x16x32_bf16 v[180:183], a[116:119], v[116:119], v[180:183]
    v_cvt_pk_bf16_f32 v46, v140, v141
    v_cvt_pk_bf16_f32 v47, v142, v143
    v_mfma_f32_16x16x32_bf16 v[180:183], a[112:115], v[112:115], v[180:183]
    v_exp_f32 v105, v105
    v_mfma_f32_16x16x32_bf16 v[184:187], a[108:111], v[112:115], v[184:187]
    v_cvt_pk_bf16_f32 v100, v104, v105
    v_cndmask_b32_dpp v52, v44, v40, vcc row_ror:8 row_mask:0xf bank_mask:0xf
    v_mfma_f32_16x16x32_bf16 v[184:187], a[104:107], v[116:119], v[184:187]
    v_exp_f32 v106, v106
    v_mfma_f32_16x16x32_bf16 v[188:191], a[100:103], v[116:119], v[188:191]
    s_mov_b32 s30, 12288
    buffer_load_dwordx4 v[64:67], v16, s[44:47], s30 offen offset:192 nt
    v_mfma_f32_16x16x32_bf16 v[188:191], a[96:99], v[112:115], v[188:191]
    v_cndmask_b32_dpp v53, v45, v41, vcc row_ror:8 row_mask:0xf bank_mask:0xf
    v_cndmask_b32_dpp v54, v46, v42, vcc row_ror:8 row_mask:0xf bank_mask:0xf
    v_mfma_f32_16x16x32_bf16 v[112:115], a[128:131], a[16:19], 0
    v_exp_f32 v107, v107
    v_mfma_f32_16x16x32_bf16 v[112:115], a[132:135], a[20:23], v[112:115]
    ds_read_b128 a[128:131], v4 offset:0
    v_cvt_pk_bf16_f32 v101, v106, v107
    v_mfma_f32_16x16x32_bf16 v[112:115], a[136:139], a[24:27], v[112:115]
    v_exp_f32 v108, v108
    v_mfma_f32_16x16x32_bf16 v[112:115], a[140:143], a[28:31], v[112:115]
    ds_read_b128 a[132:135], v5 offset:0
    v_cndmask_b32_dpp v55, v47, v43, vcc row_ror:8 row_mask:0xf bank_mask:0xf
    v_mfma_f32_16x16x32_bf16 v[116:119], a[144:147], a[28:31], 0
    v_exp_f32 v109, v109
    v_subrev_u32 v26, s28, v26
    v_mov_b32 v21, v20
    v_max_u32 v19, v19, v26
    v_pk_mul_f32 v[160:161], v[160:161], v[20:21]
    v_pk_mul_f32 v[162:163], v[162:163], v[20:21]
    v_pk_mul_f32 v[164:165], v[164:165], v[20:21]
    v_pk_mul_f32 v[166:167], v[166:167], v[20:21]
    v_pk_mul_f32 v[168:169], v[168:169], v[20:21]
    v_pk_mul_f32 v[170:171], v[170:171], v[20:21]
    v_pk_mul_f32 v[172:173], v[172:173], v[20:21]
    v_pk_mul_f32 v[174:175], v[174:175], v[20:21]
    v_pk_mul_f32 v[176:177], v[176:177], v[20:21]
    v_pk_mul_f32 v[178:179], v[178:179], v[20:21]
    v_pk_mul_f32 v[180:181], v[180:181], v[20:21]
    v_pk_mul_f32 v[182:183], v[182:183], v[20:21]
    v_pk_mul_f32 v[184:185], v[184:185], v[20:21]
    v_pk_mul_f32 v[186:187], v[186:187], v[20:21]
    v_pk_mul_f32 v[188:189], v[188:189], v[20:21]
    v_pk_mul_f32 v[190:191], v[190:191], v[20:21]
    v_mov_b32 v26, 0
    v_mov_b32 v27, 0
    v_cvt_pk_bf16_f32 v68, v160, v161
    v_mfma_f32_16x16x32_bf16 v[116:119], a[148:151], a[24:27], v[116:119]
    ds_read_b128 a[136:139], v6 offset:0
    v_cvt_pk_bf16_f32 v102, v108, v109
    v_mfma_f32_16x16x32_bf16 v[116:119], a[152:155], a[20:23], v[116:119]
    v_exp_f32 v110, v110
    v_mfma_f32_16x16x32_bf16 v[116:119], a[156:159], a[16:19], v[116:119]
    ds_read_b128 a[140:143], v7 offset:0
    v_mov_b32_dpp v44, v40 row_ror:8 row_mask:0xf bank_mask:0x3
    v_mfma_f32_16x16x32_bf16 v[120:123], a[160:163], a[16:19], 0
    v_exp_f32 v111, v111
    v_mfma_f32_16x16x32_bf16 v[120:123], a[164:167], a[20:23], v[120:123]
    ds_read_b128 a[144:147], v7 offset:4096
    v_cvt_pk_bf16_f32 v103, v110, v111
    v_mfma_f32_16x16x32_bf16 v[120:123], a[168:171], a[24:27], v[120:123]
    v_exp_f32 v112, v112
    v_mfma_f32_16x16x32_bf16 v[120:123], a[172:175], a[28:31], v[120:123]
    ds_read_b128 a[148:151], v6 offset:4096
    v_mov_b32_dpp v45, v41 row_ror:8 row_mask:0xf bank_mask:0x3
    v_mfma_f32_16x16x32_bf16 v[124:127], a[176:179], a[28:31], 0
    v_exp_f32 v113, v113
    v_mfma_f32_16x16x32_bf16 v[124:127], a[180:183], a[24:27], v[124:127]
    ds_read_b128 a[152:155], v5 offset:4096
    v_cvt_pk_bf16_f32 v112, v112, v113
    v_mfma_f32_16x16x32_bf16 v[124:127], a[184:187], a[20:23], v[124:127]
    v_exp_f32 v114, v114
    v_mfma_f32_16x16x32_bf16 v[124:127], a[188:191], a[16:19], v[124:127]
    ds_read_b128 a[156:159], v4 offset:4096
    v_mov_b32_dpp v46, v42 row_ror:8 row_mask:0xf bank_mask:0x3
    v_smfmac_f32_16x16x64_bf16 v[28:31], a[120:123], v[96:103], v22
    v_exp_f32 v115, v115
    v_mfma_f32_16x16x32_bf16 v[192:195], a[216:219], v[96:99], v[192:195]
    ds_read_b128 a[160:163], v4 offset:8192
    v_cvt_pk_bf16_f32 v113, v114, v115
    v_mfma_f32_16x16x32_bf16 v[192:195], a[220:223], v[100:103], v[192:195]
    v_exp_f32 v116, v116
    v_mfma_f32_16x16x32_bf16 v[196:199], a[224:227], v[100:103], v[196:199]
    ds_read_b128 a[164:167], v5 offset:8192
    v_mov_b32_dpp v47, v43 row_ror:8 row_mask:0xf bank_mask:0x3
    v_mfma_f32_16x16x32_bf16 v[196:199], a[228:231], v[96:99], v[196:199]
    v_exp_f32 v117, v117
    v_mfma_f32_16x16x32_bf16 v[200:203], a[232:235], v[96:99], v[200:203]
    ds_read_b128 a[168:171], v6 offset:8192
    v_cvt_pk_bf16_f32 v114, v116, v117
    v_mfma_f32_16x16x32_bf16 v[200:203], a[236:239], v[100:103], v[200:203]
    v_exp_f32 v118, v118
    v_mfma_f32_16x16x32_bf16 v[204:207], a[240:243], v[100:103], v[204:207]
    ds_read_b128 a[172:175], v7 offset:8192
    v_add_f32 v28, v28, v29
    v_mfma_f32_16x16x32_bf16 v[204:207], a[244:247], v[96:99], v[204:207]
    v_exp_f32 v119, v119
    v_mfma_f32_16x16x32_bf16 v[208:211], a[248:251], v[96:99], v[208:211]
    ds_read_b128 a[176:179], v7 offset:12288
    v_cvt_pk_bf16_f32 v115, v118, v119
    v_mfma_f32_16x16x32_bf16 v[208:211], a[252:255], v[100:103], v[208:211]
    v_exp_f32 v120, v120
    v_mfma_f32_16x16x32_bf16 v[212:215], a[116:119], v[100:103], v[212:215]
    s_mov_b32 s31, 0
    ds_read_b128 a[180:183], v6 offset:12288
    buffer_store_dwordx4 v[52:55], v23, s[20:23], s31 offen offset:0 sc1
    v_mfma_f32_16x16x32_bf16 v[212:215], a[112:115], v[96:99], v[212:215]
    v_exp_f32 v121, v121
    v_mfma_f32_16x16x32_bf16 v[216:219], a[108:111], v[96:99], v[216:219]
    ds_read_b128 a[184:187], v5 offset:12288
    v_cvt_pk_bf16_f32 v116, v120, v121
    v_mfma_f32_16x16x32_bf16 v[216:219], a[104:107], v[100:103], v[216:219]
    v_exp_f32 v122, v122
    v_mfma_f32_16x16x32_bf16 v[220:223], a[100:103], v[100:103], v[220:223]
    ds_read_b128 a[188:191], v4 offset:12288
    v_cvt_pk_bf16_f32 v72, v144, v145
    v_mfma_f32_16x16x32_bf16 v[220:223], a[96:99], v[96:99], v[220:223]
    s_waitcnt lgkmcnt(4)
    ds_read_b64_tr_b16 a[92:93], v12 offset:32768
    ds_read_b64_tr_b16 a[94:95], v12 offset:36864
    v_rcp_f32 v20, v28
    v_mfma_f32_16x16x32_bf16 v[96:99], a[128:131], a[32:35], 0
    v_exp_f32 v123, v123
    v_mfma_f32_16x16x32_bf16 v[96:99], a[132:135], a[36:39], v[96:99]
    ds_read_b64_tr_b16 a[192:193], v12 offset:40960
    v_cvt_pk_bf16_f32 v117, v122, v123
    v_mfma_f32_16x16x32_bf16 v[96:99], a[136:139], a[40:43], v[96:99]
    v_exp_f32 v124, v124
    v_mfma_f32_16x16x32_bf16 v[96:99], a[140:143], a[44:47], v[96:99]
    ds_read_b64_tr_b16 a[194:195], v12 offset:45056
    ds_read_b64_tr_b16 a[196:197], v12 offset:40968
    v_mfma_f32_16x16x32_bf16 v[100:103], a[144:147], a[44:47], 0
Lpad5:
    s_cbranch_execz Lret0
    v_exp_f32 v125, v125
    v_subrev_u32 v28, s28, v28
    v_mov_b32 v21, v20
    v_max_u32 v19, v19, v28
    v_pk_mul_f32 v[192:193], v[192:193], v[20:21]
    v_pk_mul_f32 v[194:195], v[194:195], v[20:21]
    v_pk_mul_f32 v[196:197], v[196:197], v[20:21]
    v_pk_mul_f32 v[198:199], v[198:199], v[20:21]
    v_pk_mul_f32 v[200:201], v[200:201], v[20:21]
    v_pk_mul_f32 v[202:203], v[202:203], v[20:21]
    v_pk_mul_f32 v[204:205], v[204:205], v[20:21]
    v_pk_mul_f32 v[206:207], v[206:207], v[20:21]
    v_pk_mul_f32 v[208:209], v[208:209], v[20:21]
    v_pk_mul_f32 v[210:211], v[210:211], v[20:21]
    v_pk_mul_f32 v[212:213], v[212:213], v[20:21]
    v_pk_mul_f32 v[214:215], v[214:215], v[20:21]
    v_pk_mul_f32 v[216:217], v[216:217], v[20:21]
    v_pk_mul_f32 v[218:219], v[218:219], v[20:21]
    v_pk_mul_f32 v[220:221], v[220:221], v[20:21]
    v_pk_mul_f32 v[222:223], v[222:223], v[20:21]
    v_mov_b32 v28, 0
    v_mov_b32 v29, 0
    v_cvt_pk_bf16_f32 v76, v192, v193
    v_mfma_f32_16x16x32_bf16 v[100:103], a[148:151], a[40:43], v[100:103]
    ds_read_b64_tr_b16 a[198:199], v12 offset:45064
    v_cvt_pk_bf16_f32 v118, v124, v125
    v_mfma_f32_16x16x32_bf16 v[100:103], a[152:155], a[36:39], v[100:103]
    v_exp_f32 v126, v126
    v_mfma_f32_16x16x32_bf16 v[100:103], a[156:159], a[32:35], v[100:103]
    ds_read_b64_tr_b16 a[200:201], v12 offset:32776
    v_cvt_pk_bf16_f32 v73, v146, v147
    v_mfma_f32_16x16x32_bf16 v[104:107], a[160:163], a[32:35], 0
    v_exp_f32 v127, v127
    v_mfma_f32_16x16x32_bf16 v[104:107], a[164:167], a[36:39], v[104:107]
    ds_read_b64_tr_b16 a[202:203], v12 offset:36872
    v_cvt_pk_bf16_f32 v119, v126, v127
    v_mfma_f32_16x16x32_bf16 v[104:107], a[168:171], a[40:43], v[104:107]
    s_mov_b32 s31, 0
    v_exp_f32 v96, v96
    v_mfma_f32_16x16x32_bf16 v[104:107], a[172:175], a[44:47], v[104:107]
    s_waitcnt lgkmcnt(3)
    ds_read_b64_tr_b16 a[204:205], v13 offset:32768
    buffer_store_dwordx4 v[44:47], v23, s[20:23], s31 offen offset:2048 sc1
    v_mfma_f32_16x16x32_bf16 v[108:111], a[176:179], a[44:47], 0
    v_exp_f32 v97, v97
    v_mfma_f32_16x16x32_bf16 v[108:111], a[180:183], a[40:43], v[108:111]
    ds_read_b64_tr_b16 a[206:207], v13 offset:36864
    v_cvt_pk_bf16_f32 v96, v96, v97
    v_mfma_f32_16x16x32_bf16 v[108:111], a[184:187], a[36:39], v[108:111]
    v_exp_f32 v98, v98
    v_mfma_f32_16x16x32_bf16 v[108:111], a[188:191], a[32:35], v[108:111]
    ds_read_b64_tr_b16 a[208:209], v13 offset:40960
    v_cvt_pk_bf16_f32 v74, v148, v149
    v_smfmac_f32_16x16x64_bf16 v[28:31], a[124:127], v[112:119], v22
    v_exp_f32 v99, v99
    v_mfma_f32_16x16x32_bf16 v[224:227], a[216:219], v[112:115], v[224:227]
    ds_read_b64_tr_b16 a[210:211], v13 offset:45056
    v_cvt_pk_bf16_f32 v97, v98, v99
    v_mfma_f32_16x16x32_bf16 v[224:227], a[220:223], v[116:119], v[224:227]
    v_exp_f32 v100, v100
    v_mfma_f32_16x16x32_bf16 v[228:231], a[224:227], v[116:119], v[228:231]
    ds_read_b64_tr_b16 a[212:213], v13 offset:40968
    v_cvt_pk_bf16_f32 v75, v150, v151
    v_mfma_f32_16x16x32_bf16 v[228:231], a[228:231], v[112:115], v[228:231]
    v_exp_f32 v101, v101
    v_mfma_f32_16x16x32_bf16 v[232:235], a[232:235], v[112:115], v[232:235]
    ds_read_b64_tr_b16 a[214:215], v13 offset:45064
    v_cvt_pk_bf16_f32 v98, v100, v101
    v_mfma_f32_16x16x32_bf16 v[232:235], a[236:239], v[116:119], v[232:235]
    v_exp_f32 v102, v102
    v_mfma_f32_16x16x32_bf16 v[236:239], a[240:243], v[116:119], v[236:239]
    ds_read_b64_tr_b16 a[216:217], v13 offset:32776
    v_add_f32 v30, v30, v31
    v_mfma_f32_16x16x32_bf16 v[236:239], a[244:247], v[112:115], v[236:239]
    v_exp_f32 v103, v103
    v_mfma_f32_16x16x32_bf16 v[240:243], a[248:251], v[112:115], v[240:243]
    ds_read_b64_tr_b16 a[218:219], v13 offset:36872
    v_cvt_pk_bf16_f32 v99, v102, v103
    v_mfma_f32_16x16x32_bf16 v[240:243], a[252:255], v[116:119], v[240:243]
    v_exp_f32 v104, v104
    v_mfma_f32_16x16x32_bf16 v[244:247], a[116:119], v[116:119], v[244:247]
    ds_read_b64_tr_b16 a[220:221], v14 offset:32768
    v_cvt_pk_bf16_f32 v56, v152, v153
    v_mfma_f32_16x16x32_bf16 v[244:247], a[112:115], v[112:115], v[244:247]
    v_exp_f32 v105, v105
    v_mfma_f32_16x16x32_bf16 v[248:251], a[108:111], v[112:115], v[248:251]
    ds_read_b64_tr_b16 a[222:223], v14 offset:36864
    v_cvt_pk_bf16_f32 v100, v104, v105
    v_mfma_f32_16x16x32_bf16 v[248:251], a[104:107], v[116:119], v[248:251]
    v_exp_f32 v106, v106
    v_mfma_f32_16x16x32_bf16 v[252:255], a[100:103], v[116:119], v[252:255]
    ds_read_b64_tr_b16 a[224:225], v14 offset:40960
    v_cvt_pk_bf16_f32 v57, v154, v155
    v_mfma_f32_16x16x32_bf16 v[252:255], a[96:99], v[112:115], v[252:255]
    ds_read_b64_tr_b16 a[226:227], v14 offset:45056
    v_rcp_f32 v20, v30
    v_mfma_f32_16x16x32_bf16 v[112:115], a[128:131], a[48:51], 0
    v_exp_f32 v107, v107
    v_mfma_f32_16x16x32_bf16 v[112:115], a[132:135], a[52:55], v[112:115]
    ds_read_b64_tr_b16 a[228:229], v14 offset:40968
    v_cvt_pk_bf16_f32 v101, v106, v107
    v_mfma_f32_16x16x32_bf16 v[112:115], a[136:139], a[56:59], v[112:115]
    v_exp_f32 v108, v108
    v_mfma_f32_16x16x32_bf16 v[112:115], a[140:143], a[60:63], v[112:115]
    ds_read_b64_tr_b16 a[230:231], v14 offset:45064
    ds_read_b128 a[128:131], v4 offset:16384
    v_mfma_f32_16x16x32_bf16 v[116:119], a[144:147], a[60:63], 0
    v_exp_f32 v109, v109
    v_subrev_u32 v30, s28, v30
    v_mov_b32 v21, v20
    v_max_u32 v19, v19, v30
    v_pk_mul_f32 v[224:225], v[224:225], v[20:21]
    v_pk_mul_f32 v[226:227], v[226:227], v[20:21]
    v_pk_mul_f32 v[228:229], v[228:229], v[20:21]
    v_pk_mul_f32 v[230:231], v[230:231], v[20:21]
    v_pk_mul_f32 v[232:233], v[232:233], v[20:21]
    v_pk_mul_f32 v[234:235], v[234:235], v[20:21]
    v_pk_mul_f32 v[236:237], v[236:237], v[20:21]
    v_pk_mul_f32 v[238:239], v[238:239], v[20:21]
    v_pk_mul_f32 v[240:241], v[240:241], v[20:21]
    v_pk_mul_f32 v[242:243], v[242:243], v[20:21]
    v_pk_mul_f32 v[244:245], v[244:245], v[20:21]
    v_pk_mul_f32 v[246:247], v[246:247], v[20:21]
    v_pk_mul_f32 v[248:249], v[248:249], v[20:21]
    v_pk_mul_f32 v[250:251], v[250:251], v[20:21]
    v_pk_mul_f32 v[252:253], v[252:253], v[20:21]
    v_pk_mul_f32 v[254:255], v[254:255], v[20:21]
    v_mov_b32 v30, 0
    v_mov_b32 v31, 0
    v_cvt_pk_bf16_f32 v80, v224, v225
    v_mfma_f32_16x16x32_bf16 v[116:119], a[148:151], a[56:59], v[116:119]
    ds_read_b64_tr_b16 a[232:233], v14 offset:32776
    v_cvt_pk_bf16_f32 v102, v108, v109
    v_mfma_f32_16x16x32_bf16 v[116:119], a[152:155], a[52:55], v[116:119]
    v_exp_f32 v110, v110
    v_mfma_f32_16x16x32_bf16 v[116:119], a[156:159], a[48:51], v[116:119]
    ds_read_b64_tr_b16 a[234:235], v14 offset:36872
    ds_read_b128 a[132:135], v5 offset:16384
    v_mfma_f32_16x16x32_bf16 v[120:123], a[160:163], a[48:51], 0
    v_exp_f32 v111, v111
    v_mfma_f32_16x16x32_bf16 v[120:123], a[164:167], a[52:55], v[120:123]
    ds_read_b64_tr_b16 a[236:237], v15 offset:32768
    v_cvt_pk_bf16_f32 v103, v110, v111
    v_mfma_f32_16x16x32_bf16 v[120:123], a[168:171], a[56:59], v[120:123]
    v_exp_f32 v112, v112
    v_mfma_f32_16x16x32_bf16 v[120:123], a[172:175], a[60:63], v[120:123]
    ds_read_b64_tr_b16 a[238:239], v15 offset:36864
    ds_read_b128 a[136:139], v6 offset:16384
    v_mfma_f32_16x16x32_bf16 v[124:127], a[176:179], a[60:63], 0
    v_exp_f32 v113, v113
    v_mfma_f32_16x16x32_bf16 v[124:127], a[180:183], a[56:59], v[124:127]
    ds_read_b64_tr_b16 a[240:241], v15 offset:40960
    v_cvt_pk_bf16_f32 v112, v112, v113
    v_mfma_f32_16x16x32_bf16 v[124:127], a[184:187], a[52:55], v[124:127]
    v_exp_f32 v114, v114
    v_mfma_f32_16x16x32_bf16 v[124:127], a[188:191], a[48:51], v[124:127]
    ds_read_b64_tr_b16 a[242:243], v15 offset:45056
    ds_read_b128 a[140:143], v7 offset:16384
    v_smfmac_f32_16x16x64_bf16 v[24:27], a[120:123], v[96:103], v22
    v_exp_f32 v115, v115
    v_mfma_f32_16x16x32_bf16 v[128:131], a[92:95], v[96:99], 0
    ds_read_b64_tr_b16 a[244:245], v15 offset:40968
    v_cvt_pk_bf16_f32 v113, v114, v115
    v_mfma_f32_16x16x32_bf16 v[128:131], a[192:195], v[100:103], v[128:131]
    s_waitcnt lgkmcnt(7)
    v_exp_f32 v116, v116
    v_mfma_f32_16x16x32_bf16 v[132:135], a[196:199], v[100:103], 0
    ds_read_b64_tr_b16 a[246:247], v15 offset:45064
    ds_read_b128 a[144:147], v7 offset:20480
    v_mfma_f32_16x16x32_bf16 v[132:135], a[200:203], v[96:99], v[132:135]
    v_exp_f32 v117, v117
    v_mfma_f32_16x16x32_bf16 v[136:139], a[204:207], v[96:99], 0
    ds_read_b64_tr_b16 a[248:249], v15 offset:32776
    v_cvt_pk_bf16_f32 v114, v116, v117
    v_mfma_f32_16x16x32_bf16 v[136:139], a[208:211], v[100:103], v[136:139]
    v_exp_f32 v118, v118
    v_mfma_f32_16x16x32_bf16 v[140:143], a[212:215], v[100:103], 0
    ds_read_b64_tr_b16 a[250:251], v15 offset:36872
    ds_read_b128 a[148:151], v6 offset:20480
    v_mfma_f32_16x16x32_bf16 v[140:143], a[216:219], v[96:99], v[140:143]
    v_exp_f32 v119, v119
    v_mfma_f32_16x16x32_bf16 v[144:147], a[220:223], v[96:99], 0
    ds_read_b128 a[152:155], v5 offset:20480
    v_cvt_pk_bf16_f32 v115, v118, v119
    v_mfma_f32_16x16x32_bf16 v[144:147], a[224:227], v[100:103], v[144:147]
    v_exp_f32 v120, v120
    v_mfma_f32_16x16x32_bf16 v[148:151], a[228:231], v[100:103], 0
    ds_read_b128 a[156:159], v4 offset:20480
    ds_read_b128 a[160:163], v4 offset:24576
    v_cvt_pk_bf16_f32 v58, v156, v157
    v_cvt_pk_bf16_f32 v59, v158, v159
    v_mfma_f32_16x16x32_bf16 v[148:151], a[232:235], v[96:99], v[148:151]
    s_waitcnt lgkmcnt(6)
    v_exp_f32 v121, v121
    v_mfma_f32_16x16x32_bf16 v[152:155], a[236:239], v[96:99], 0
    ds_read_b128 a[164:167], v5 offset:24576
    v_cvt_pk_bf16_f32 v116, v120, v121
    v_mfma_f32_16x16x32_bf16 v[152:155], a[240:243], v[100:103], v[152:155]
    v_exp_f32 v122, v122
    v_mfma_f32_16x16x32_bf16 v[156:159], a[244:247], v[100:103], 0
    s_waitcnt lgkmcnt(5)
    ds_read_b128 a[168:171], v6 offset:24576
    ds_read_b128 a[172:175], v7 offset:24576
    v_mfma_f32_16x16x32_bf16 v[156:159], a[248:251], v[96:99], v[156:159]
    s_add_u32 m0, s26, 114688
    ds_read_b128 a[176:179], v7 offset:28672
    ds_read_b128 a[180:183], v6 offset:28672
    v_mfma_f32_16x16x32_bf16 v[96:99], a[128:131], a[32:35], 0
    s_waitcnt vmcnt(13)
    s_barrier
    buffer_load_dwordx4 v17, s[48:51], m0 offen nt lds
    v_exp_f32 v123, v123
    v_mfma_f32_16x16x32_bf16 v[96:99], a[132:135], a[36:39], v[96:99]
    ds_read_b128 a[184:187], v5 offset:28672
    v_cvt_pk_bf16_f32 v117, v122, v123
    v_mfma_f32_16x16x32_bf16 v[96:99], a[136:139], a[40:43], v[96:99]
    v_exp_f32 v124, v124
    v_mfma_f32_16x16x32_bf16 v[96:99], a[140:143], a[44:47], v[96:99]
    s_add_u32 m0, s26, 118784
    ds_read_b128 a[188:191], v4 offset:28672
    ds_read_b64_tr_b16 a[252:253], v12 offset:0
    v_mfma_f32_16x16x32_bf16 v[100:103], a[144:147], a[44:47], 0
    s_waitcnt lgkmcnt(7)
    buffer_load_dwordx4 v17, s[48:51], m0 offen nt lds
    v_exp_f32 v125, v125
    v_mfma_f32_16x16x32_bf16 v[100:103], a[148:151], a[40:43], v[100:103]
    ds_read_b64_tr_b16 a[254:255], v12 offset:4096
    v_cvt_pk_bf16_f32 v118, v124, v125
    v_mfma_f32_16x16x32_bf16 v[100:103], a[152:155], a[36:39], v[100:103]
    v_exp_f32 v126, v126
    v_mfma_f32_16x16x32_bf16 v[100:103], a[156:159], a[32:35], v[100:103]
    s_add_u32 m0, s26, 122880
    ds_read_b64_tr_b16 a[116:117], v12 offset:8192
    ds_read_b64_tr_b16 a[118:119], v12 offset:12288
    v_mfma_f32_16x16x32_bf16 v[104:107], a[160:163], a[32:35], 0
    buffer_load_dwordx4 v17, s[48:51], m0 offen nt lds
    v_exp_f32 v127, v127
    v_mfma_f32_16x16x32_bf16 v[104:107], a[164:167], a[36:39], v[104:107]
    s_waitcnt lgkmcnt(5)
    ds_read_b64_tr_b16 a[112:113], v12 offset:8200
    v_cvt_pk_bf16_f32 v119, v126, v127
    v_mfma_f32_16x16x32_bf16 v[104:107], a[168:171], a[40:43], v[104:107]
    v_exp_f32 v96, v96
    v_mfma_f32_16x16x32_bf16 v[104:107], a[172:175], a[44:47], v[104:107]
    s_add_u32 m0, s26, 126976
    ds_read_b64_tr_b16 a[114:115], v12 offset:12296
    ds_read_b64_tr_b16 a[108:109], v12 offset:8
    v_mfma_f32_16x16x32_bf16 v[108:111], a[176:179], a[44:47], 0
    buffer_load_dwordx4 v17, s[48:51], m0 offen nt lds
    v_exp_f32 v97, v97
    v_mfma_f32_16x16x32_bf16 v[108:111], a[180:183], a[40:43], v[108:111]
    s_add_u32 s29, s27, 49152
    ds_read_b64_tr_b16 a[110:111], v12 offset:4104
    v_cvt_pk_bf16_f32 v96, v96, v97
    v_mfma_f32_16x16x32_bf16 v[108:111], a[184:187], a[36:39], v[108:111]
    s_waitcnt lgkmcnt(6)
    v_exp_f32 v98, v98
    v_mfma_f32_16x16x32_bf16 v[108:111], a[188:191], a[32:35], v[108:111]
    s_add_u32 m0, s27, 131072
    ds_read_b64_tr_b16 a[104:105], v13 offset:0
    ds_read_b64_tr_b16 a[106:107], v13 offset:4096
    v_cvt_pk_bf16_f32 v69, v162, v163
    v_cvt_pk_bf16_f32 v70, v164, v165
    v_cvt_pk_bf16_f32 v71, v166, v167
    v_smfmac_f32_16x16x64_bf16 v[24:27], a[124:127], v[112:119], v22
    buffer_load_dwordx4 v18, s[52:55], s29 offen lds
    v_exp_f32 v99, v99
    v_mfma_f32_16x16x32_bf16 v[160:163], a[92:95], v[112:115], 0
    ds_read_b64_tr_b16 a[100:101], v13 offset:8192
    v_cvt_pk_bf16_f32 v97, v98, v99
    v_mfma_f32_16x16x32_bf16 v[160:163], a[192:195], v[116:119], v[160:163]
    v_exp_f32 v100, v100
    v_mfma_f32_16x16x32_bf16 v[164:167], a[196:199], v[116:119], 0
    ds_read_b64_tr_b16 a[102:103], v13 offset:12288
    ds_read_b64_tr_b16 a[96:97], v13 offset:8200
    v_cvt_pk_bf16_f32 v84, v168, v169
    v_cvt_pk_bf16_f32 v85, v170, v171
    v_cvt_pk_bf16_f32 v86, v172, v173
    v_cvt_pk_bf16_f32 v87, v174, v175
    v_mfma_f32_16x16x32_bf16 v[164:167], a[200:203], v[112:115], v[164:167]
    buffer_load_dwordx4 v18, s[52:55], s29 offen offset:1024 lds
    v_exp_f32 v101, v101
    v_mfma_f32_16x16x32_bf16 v[168:171], a[204:207], v[112:115], 0
    ds_read_b64_tr_b16 a[98:99], v13 offset:12296
    v_cvt_pk_bf16_f32 v98, v100, v101
    v_mfma_f32_16x16x32_bf16 v[168:171], a[208:211], v[116:119], v[168:171]
    v_exp_f32 v102, v102
    v_mfma_f32_16x16x32_bf16 v[172:175], a[212:215], v[116:119], 0
    ds_read_b64_tr_b16 a[92:93], v13 offset:8
    buffer_load_dwordx4 v18, s[52:55], s29 offen offset:2048 lds
    v_cvt_pk_bf16_f32 v88, v176, v177
    v_cvt_pk_bf16_f32 v89, v178, v179
    v_cvt_pk_bf16_f32 v90, v180, v181
    v_cvt_pk_bf16_f32 v91, v182, v183
    v_mfma_f32_16x16x32_bf16 v[172:175], a[216:219], v[112:115], v[172:175]
    v_exp_f32 v103, v103
    v_mfma_f32_16x16x32_bf16 v[176:179], a[220:223], v[112:115], 0
    ds_read_b64_tr_b16 a[94:95], v13 offset:4104
    v_cvt_pk_bf16_f32 v99, v102, v103
    v_mfma_f32_16x16x32_bf16 v[176:179], a[224:227], v[116:119], v[176:179]
    v_exp_f32 v104, v104
    v_mfma_f32_16x16x32_bf16 v[180:183], a[228:231], v[116:119], 0
    ds_read_b64_tr_b16 a[192:193], v14 offset:0
    buffer_load_dwordx4 v18, s[52:55], s29 offen offset:3072 lds
    v_cvt_pk_bf16_f32 v92, v184, v185
    v_cvt_pk_bf16_f32 v93, v186, v187
    v_cvt_pk_bf16_f32 v94, v188, v189
    v_cvt_pk_bf16_f32 v95, v190, v191
    v_mfma_f32_16x16x32_bf16 v[180:183], a[232:235], v[112:115], v[180:183]
    v_exp_f32 v105, v105
    v_mfma_f32_16x16x32_bf16 v[184:187], a[236:239], v[112:115], 0
    ds_read_b64_tr_b16 a[194:195], v14 offset:4096
    v_cvt_pk_bf16_f32 v100, v104, v105
    v_mfma_f32_16x16x32_bf16 v[184:187], a[240:243], v[116:119], v[184:187]
    v_exp_f32 v106, v106
    v_mfma_f32_16x16x32_bf16 v[188:191], a[244:247], v[116:119], 0
    ds_read_b64_tr_b16 a[196:197], v14 offset:8192
    v_cndmask_b32_dpp v60, v56, v72, vcc row_ror:8 row_mask:0xf bank_mask:0xf
    v_mfma_f32_16x16x32_bf16 v[188:191], a[248:251], v[112:115], v[188:191]
    ds_read_b64_tr_b16 a[198:199], v14 offset:12288
    v_cndmask_b32_dpp v61, v57, v73, vcc row_ror:8 row_mask:0xf bank_mask:0xf
    v_cndmask_b32_dpp v62, v58, v74, vcc row_ror:8 row_mask:0xf bank_mask:0xf
    v_cndmask_b32_dpp v63, v59, v75, vcc row_ror:8 row_mask:0xf bank_mask:0xf
    v_mov_b32_dpp v56, v72 row_ror:8 row_mask:0xf bank_mask:0x3
    v_mov_b32_dpp v57, v73 row_ror:8 row_mask:0xf bank_mask:0x3
    v_mov_b32_dpp v58, v74 row_ror:8 row_mask:0xf bank_mask:0x3
    v_mov_b32_dpp v59, v75 row_ror:8 row_mask:0xf bank_mask:0x3
    v_mfma_f32_16x16x32_bf16 v[112:115], a[128:131], a[48:51], 0
    v_exp_f32 v107, v107
    v_mfma_f32_16x16x32_bf16 v[112:115], a[132:135], a[52:55], v[112:115]
    ds_read_b64_tr_b16 a[200:201], v14 offset:8200
    v_cvt_pk_bf16_f32 v101, v106, v107
    v_mfma_f32_16x16x32_bf16 v[112:115], a[136:139], a[56:59], v[112:115]
    v_exp_f32 v108, v108
    v_mfma_f32_16x16x32_bf16 v[112:115], a[140:143], a[60:63], v[112:115]
    s_mov_b32 s31, 0
    ds_read_b64_tr_b16 a[202:203], v14 offset:12296
    buffer_store_dwordx4 v[60:63], v23, s[20:23], s31 offen offset:128 sc1
    v_mfma_f32_16x16x32_bf16 v[116:119], a[144:147], a[60:63], 0
    v_exp_f32 v109, v109
    v_mfma_f32_16x16x32_bf16 v[116:119], a[148:151], a[56:59], v[116:119]
    ds_read_b64_tr_b16 a[204:205], v14 offset:8
    v_cvt_pk_bf16_f32 v102, v108, v109
    v_mfma_f32_16x16x32_bf16 v[116:119], a[152:155], a[52:55], v[116:119]
    v_exp_f32 v110, v110
    v_mfma_f32_16x16x32_bf16 v[116:119], a[156:159], a[48:51], v[116:119]
    ds_read_b64_tr_b16 a[206:207], v14 offset:4104
    v_cvt_pk_bf16_f32 v77, v194, v195
    v_mfma_f32_16x16x32_bf16 v[120:123], a[160:163], a[48:51], 0
    v_exp_f32 v111, v111
    v_mfma_f32_16x16x32_bf16 v[120:123], a[164:167], a[52:55], v[120:123]
    ds_read_b64_tr_b16 a[208:209], v15 offset:0
    v_cvt_pk_bf16_f32 v103, v110, v111
    v_mfma_f32_16x16x32_bf16 v[120:123], a[168:171], a[56:59], v[120:123]
    v_exp_f32 v112, v112
    v_mfma_f32_16x16x32_bf16 v[120:123], a[172:175], a[60:63], v[120:123]
    ds_read_b64_tr_b16 a[210:211], v15 offset:4096
    v_cvt_pk_bf16_f32 v78, v196, v197
    v_mfma_f32_16x16x32_bf16 v[124:127], a[176:179], a[60:63], 0
    v_exp_f32 v113, v113
    v_mfma_f32_16x16x32_bf16 v[124:127], a[180:183], a[56:59], v[124:127]
    ds_read_b64_tr_b16 a[212:213], v15 offset:8192
    v_cvt_pk_bf16_f32 v112, v112, v113
    v_mfma_f32_16x16x32_bf16 v[124:127], a[184:187], a[52:55], v[124:127]
    v_exp_f32 v114, v114
    v_mfma_f32_16x16x32_bf16 v[124:127], a[188:191], a[48:51], v[124:127]
    s_mov_b32 s31, 0
    ds_read_b64_tr_b16 a[214:215], v15 offset:12288
    buffer_store_dwordx4 v[56:59], v23, s[20:23], s31 offen offset:2176 sc1
    v_smfmac_f32_16x16x64_bf16 v[24:27], a[120:123], v[96:103], v22
    v_exp_f32 v115, v115
    v_mfma_f32_16x16x32_bf16 v[128:131], a[252:255], v[96:99], v[128:131]
    s_waitcnt lgkmcnt(4)
    ds_read_b64_tr_b16 a[216:217], v15 offset:8200
    v_cvt_pk_bf16_f32 v113, v114, v115
    v_mfma_f32_16x16x32_bf16 v[128:131], a[116:119], v[100:103], v[128:131]
    v_exp_f32 v116, v116
    v_mfma_f32_16x16x32_bf16 v[132:135], a[112:115], v[100:103], v[132:135]
    ds_read_b64_tr_b16 a[218:219], v15 offset:12296
    v_cvt_pk_bf16_f32 v79, v198, v199
    v_mfma_f32_16x16x32_bf16 v[132:135], a[108:111], v[96:99], v[132:135]
    v_exp_f32 v117, v117
    v_mfma_f32_16x16x32_bf16 v[136:139], a[104:107], v[96:99], v[136:139]
    ds_read_b64_tr_b16 a[220:221], v15 offset:8
    v_cvt_pk_bf16_f32 v114, v116, v117
    v_mfma_f32_16x16x32_bf16 v[136:139], a[100:103], v[100:103], v[136:139]
    v_exp_f32 v118, v118
    v_mfma_f32_16x16x32_bf16 v[140:143], a[96:99], v[100:103], v[140:143]
    ds_read_b64_tr_b16 a[222:223], v15 offset:4104
    v_cvt_pk_bf16_f32 v40, v200, v201
    v_mfma_f32_16x16x32_bf16 v[140:143], a[92:95], v[96:99], v[140:143]
    v_exp_f32 v119, v119
    v_mfma_f32_16x16x32_bf16 v[144:147], a[192:195], v[96:99], v[144:147]
    v_cvt_pk_bf16_f32 v115, v118, v119
    v_cvt_pk_bf16_f32 v41, v202, v203
    v_mfma_f32_16x16x32_bf16 v[144:147], a[196:199], v[100:103], v[144:147]
    v_exp_f32 v120, v120
    v_mfma_f32_16x16x32_bf16 v[148:151], a[200:203], v[100:103], v[148:151]
    v_cvt_pk_bf16_f32 v42, v204, v205
    v_cvt_pk_bf16_f32 v43, v206, v207
    v_mfma_f32_16x16x32_bf16 v[148:151], a[204:207], v[96:99], v[148:151]
    s_waitcnt lgkmcnt(3)
    v_exp_f32 v121, v121
    v_mfma_f32_16x16x32_bf16 v[152:155], a[208:211], v[96:99], v[152:155]
    v_cvt_pk_bf16_f32 v116, v120, v121
    v_cvt_pk_bf16_f32 v52, v208, v209
    v_mfma_f32_16x16x32_bf16 v[152:155], a[212:215], v[100:103], v[152:155]
    s_waitcnt lgkmcnt(1)
    v_exp_f32 v122, v122
    v_mfma_f32_16x16x32_bf16 v[156:159], a[216:219], v[100:103], v[156:159]
    s_waitcnt lgkmcnt(0)
    v_cvt_pk_bf16_f32 v53, v210, v211
    v_cvt_pk_bf16_f32 v54, v212, v213
    v_mfma_f32_16x16x32_bf16 v[156:159], a[220:223], v[96:99], v[156:159]
    s_waitcnt vmcnt(14)
    v_cvt_pk_bf16_f32 v55, v214, v215
    v_cvt_pk_bf16_f32 v44, v216, v217
    v_mfma_f32_16x16x32_bf16 v[96:99], a[128:131], a[64:67], 0
    s_barrier
    v_exp_f32 v123, v123
    v_mfma_f32_16x16x32_bf16 v[96:99], a[132:135], a[68:71], v[96:99]
    ds_read_b128 a[128:131], v4 offset:32768
    v_cvt_pk_bf16_f32 v117, v122, v123
    v_mfma_f32_16x16x32_bf16 v[96:99], a[136:139], a[72:75], v[96:99]
    v_exp_f32 v124, v124
    v_mfma_f32_16x16x32_bf16 v[96:99], a[140:143], a[76:79], v[96:99]
    ds_read_b128 a[132:135], v5 offset:32768
    v_cvt_pk_bf16_f32 v45, v218, v219
    v_mfma_f32_16x16x32_bf16 v[100:103], a[144:147], a[76:79], 0
    v_exp_f32 v125, v125
    v_mfma_f32_16x16x32_bf16 v[100:103], a[148:151], a[72:75], v[100:103]
    ds_read_b128 a[136:139], v6 offset:32768
    v_cvt_pk_bf16_f32 v118, v124, v125
    v_mfma_f32_16x16x32_bf16 v[100:103], a[152:155], a[68:71], v[100:103]
    v_exp_f32 v126, v126
    v_mfma_f32_16x16x32_bf16 v[100:103], a[156:159], a[64:67], v[100:103]
    ds_read_b128 a[140:143], v7 offset:32768
    v_cvt_pk_bf16_f32 v46, v220, v221
    v_mfma_f32_16x16x32_bf16 v[104:107], a[160:163], a[64:67], 0
    v_exp_f32 v127, v127
    v_mfma_f32_16x16x32_bf16 v[104:107], a[164:167], a[68:71], v[104:107]
    ds_read_b128 a[144:147], v7 offset:36864
    v_cvt_pk_bf16_f32 v119, v126, v127
    v_mfma_f32_16x16x32_bf16 v[104:107], a[168:171], a[72:75], v[104:107]
    v_exp_f32 v96, v96
    v_mfma_f32_16x16x32_bf16 v[104:107], a[172:175], a[76:79], v[104:107]
    ds_read_b128 a[148:151], v6 offset:36864
    v_cvt_pk_bf16_f32 v47, v222, v223
    v_mfma_f32_16x16x32_bf16 v[108:111], a[176:179], a[76:79], 0
    v_exp_f32 v97, v97
    v_mfma_f32_16x16x32_bf16 v[108:111], a[180:183], a[72:75], v[108:111]
    ds_read_b128 a[152:155], v5 offset:36864
    v_cvt_pk_bf16_f32 v96, v96, v97
    v_mfma_f32_16x16x32_bf16 v[108:111], a[184:187], a[68:71], v[108:111]
    v_exp_f32 v98, v98
    v_mfma_f32_16x16x32_bf16 v[108:111], a[188:191], a[64:67], v[108:111]
    ds_read_b128 a[156:159], v4 offset:36864
    v_cndmask_b32_dpp v72, v84, v68, vcc row_ror:8 row_mask:0xf bank_mask:0xf
    v_smfmac_f32_16x16x64_bf16 v[24:27], a[124:127], v[112:119], v22
    v_exp_f32 v99, v99
    v_mfma_f32_16x16x32_bf16 v[160:163], a[252:255], v[112:115], v[160:163]
    ds_read_b128 a[160:163], v4 offset:40960
    v_cvt_pk_bf16_f32 v97, v98, v99
    v_mfma_f32_16x16x32_bf16 v[160:163], a[116:119], v[116:119], v[160:163]
    v_exp_f32 v100, v100
    v_mfma_f32_16x16x32_bf16 v[164:167], a[112:115], v[116:119], v[164:167]
    ds_read_b128 a[164:167], v5 offset:40960
    v_cndmask_b32_dpp v73, v85, v69, vcc row_ror:8 row_mask:0xf bank_mask:0xf
    v_mfma_f32_16x16x32_bf16 v[164:167], a[108:111], v[112:115], v[164:167]
    v_exp_f32 v101, v101
    v_mfma_f32_16x16x32_bf16 v[168:171], a[104:107], v[112:115], v[168:171]
    ds_read_b128 a[168:171], v6 offset:40960
    v_cvt_pk_bf16_f32 v98, v100, v101
    v_mfma_f32_16x16x32_bf16 v[168:171], a[100:103], v[116:119], v[168:171]
    v_exp_f32 v102, v102
    v_mfma_f32_16x16x32_bf16 v[172:175], a[96:99], v[116:119], v[172:175]
    s_mov_b32 s30, 65536
    ds_read_b128 a[172:175], v7 offset:40960
    buffer_load_dwordx4 v[60:63], v16, s[44:47], s30 offen nt
    v_mfma_f32_16x16x32_bf16 v[172:175], a[92:95], v[112:115], v[172:175]
    v_exp_f32 v103, v103
    v_mfma_f32_16x16x32_bf16 v[176:179], a[192:195], v[112:115], v[176:179]
    ds_read_b128 a[176:179], v7 offset:45056
    v_cvt_pk_bf16_f32 v99, v102, v103
    v_mfma_f32_16x16x32_bf16 v[176:179], a[196:199], v[116:119], v[176:179]
    v_exp_f32 v104, v104
    v_mfma_f32_16x16x32_bf16 v[180:183], a[200:203], v[116:119], v[180:183]
    ds_read_b128 a[180:183], v6 offset:45056
    v_cndmask_b32_dpp v74, v86, v70, vcc row_ror:8 row_mask:0xf bank_mask:0xf
    v_mfma_f32_16x16x32_bf16 v[180:183], a[204:207], v[112:115], v[180:183]
    v_exp_f32 v105, v105
    v_mfma_f32_16x16x32_bf16 v[184:187], a[208:211], v[112:115], v[184:187]
    ds_read_b128 a[184:187], v5 offset:45056
    v_cvt_pk_bf16_f32 v100, v104, v105
    v_mfma_f32_16x16x32_bf16 v[184:187], a[212:215], v[116:119], v[184:187]
    v_exp_f32 v106, v106
    v_mfma_f32_16x16x32_bf16 v[188:191], a[216:219], v[116:119], v[188:191]
    ds_read_b128 a[188:191], v4 offset:45056
    v_cndmask_b32_dpp v75, v87, v71, vcc row_ror:8 row_mask:0xf bank_mask:0xf
    v_mfma_f32_16x16x32_bf16 v[188:191], a[220:223], v[112:115], v[188:191]
    s_waitcnt lgkmcnt(5)
    ds_read_b64_tr_b16 a[224:225], v12 offset:49152
    ds_read_b64_tr_b16 a[226:227], v12 offset:53248
    v_mfma_f32_16x16x32_bf16 v[112:115], a[128:131], a[32:35], 0
    v_exp_f32 v107, v107
    v_mfma_f32_16x16x32_bf16 v[112:115], a[132:135], a[36:39], v[112:115]
    ds_read_b64_tr_b16 a[228:229], v12 offset:57344
    v_cvt_pk_bf16_f32 v101, v106, v107
    v_mfma_f32_16x16x32_bf16 v[112:115], a[136:139], a[40:43], v[112:115]
    v_exp_f32 v108, v108
    v_mfma_f32_16x16x32_bf16 v[112:115], a[140:143], a[44:47], v[112:115]
    ds_read_b64_tr_b16 a[230:231], v12 offset:61440
    ds_read_b64_tr_b16 a[232:233], v12 offset:57352
    v_mfma_f32_16x16x32_bf16 v[116:119], a[144:147], a[44:47], 0
    v_exp_f32 v109, v109
    v_mfma_f32_16x16x32_bf16 v[116:119], a[148:151], a[40:43], v[116:119]
    ds_read_b64_tr_b16 a[234:235], v12 offset:61448
    v_cvt_pk_bf16_f32 v102, v108, v109
    v_mfma_f32_16x16x32_bf16 v[116:119], a[152:155], a[36:39], v[116:119]
    v_exp_f32 v110, v110
    v_mfma_f32_16x16x32_bf16 v[116:119], a[156:159], a[32:35], v[116:119]
    s_mov_b32 s30, 65536
    ds_read_b64_tr_b16 a[236:237], v12 offset:49160
    buffer_load_dwordx4 v[56:59], v16, s[44:47], s30 offen offset:64 nt
    v_mfma_f32_16x16x32_bf16 v[120:123], a[160:163], a[32:35], 0
    v_exp_f32 v111, v111
    v_mfma_f32_16x16x32_bf16 v[120:123], a[164:167], a[36:39], v[120:123]
    ds_read_b64_tr_b16 a[238:239], v12 offset:53256
    v_cvt_pk_bf16_f32 v103, v110, v111
    v_mfma_f32_16x16x32_bf16 v[120:123], a[168:171], a[40:43], v[120:123]
    s_waitcnt lgkmcnt(5)
    v_exp_f32 v112, v112
    v_mfma_f32_16x16x32_bf16 v[120:123], a[172:175], a[44:47], v[120:123]
    ds_read_b64_tr_b16 a[240:241], v13 offset:49152
    v_mov_b32_dpp v84, v68 row_ror:8 row_mask:0xf bank_mask:0x3
    v_mfma_f32_16x16x32_bf16 v[124:127], a[176:179], a[44:47], 0
    v_exp_f32 v113, v113
    v_mfma_f32_16x16x32_bf16 v[124:127], a[180:183], a[40:43], v[124:127]
    ds_read_b64_tr_b16 a[242:243], v13 offset:53248
    v_cvt_pk_bf16_f32 v112, v112, v113
    v_mfma_f32_16x16x32_bf16 v[124:127], a[184:187], a[36:39], v[124:127]
    v_exp_f32 v114, v114
    v_mfma_f32_16x16x32_bf16 v[124:127], a[188:191], a[32:35], v[124:127]
    ds_read_b64_tr_b16 a[244:245], v13 offset:57344
    v_mov_b32_dpp v85, v69 row_ror:8 row_mask:0xf bank_mask:0x3
    v_smfmac_f32_16x16x64_bf16 v[28:31], a[120:123], v[96:103], v22
    v_exp_f32 v115, v115
    v_mfma_f32_16x16x32_bf16 v[192:195], a[252:255], v[96:99], 0
    ds_read_b64_tr_b16 a[246:247], v13 offset:61440
    v_cvt_pk_bf16_f32 v113, v114, v115
    v_mfma_f32_16x16x32_bf16 v[192:195], a[116:119], v[100:103], v[192:195]
    v_exp_f32 v116, v116
    v_mfma_f32_16x16x32_bf16 v[196:199], a[112:115], v[100:103], 0
    ds_read_b64_tr_b16 a[248:249], v13 offset:57352
    v_mov_b32_dpp v86, v70 row_ror:8 row_mask:0xf bank_mask:0x3
    v_mfma_f32_16x16x32_bf16 v[196:199], a[108:111], v[96:99], v[196:199]
    v_exp_f32 v117, v117
    v_mfma_f32_16x16x32_bf16 v[200:203], a[104:107], v[96:99], 0
    ds_read_b64_tr_b16 a[250:251], v13 offset:61448
    v_cvt_pk_bf16_f32 v114, v116, v117
    v_mfma_f32_16x16x32_bf16 v[200:203], a[100:103], v[100:103], v[200:203]
    v_exp_f32 v118, v118
    v_mfma_f32_16x16x32_bf16 v[204:207], a[96:99], v[100:103], 0
    ds_read_b64_tr_b16 a[252:253], v13 offset:49160
    v_mov_b32_dpp v87, v71 row_ror:8 row_mask:0xf bank_mask:0x3
    v_mfma_f32_16x16x32_bf16 v[204:207], a[92:95], v[96:99], v[204:207]
    v_exp_f32 v119, v119
    v_mfma_f32_16x16x32_bf16 v[208:211], a[192:195], v[96:99], 0
    ds_read_b64_tr_b16 a[254:255], v13 offset:53256
    v_cvt_pk_bf16_f32 v115, v118, v119
    v_mfma_f32_16x16x32_bf16 v[208:211], a[196:199], v[100:103], v[208:211]
    v_exp_f32 v120, v120
    v_mfma_f32_16x16x32_bf16 v[212:215], a[200:203], v[100:103], 0
Lpad6:
    s_cbranch_execz Lret0
    ds_read_b64_tr_b16 a[116:117], v14 offset:49152
    v_lshlrev_b32 v0, 16, v32
    v_mfma_f32_16x16x32_bf16 v[212:215], a[204:207], v[96:99], v[212:215]
    v_exp_f32 v121, v121
    v_mfma_f32_16x16x32_bf16 v[216:219], a[208:211], v[96:99], 0
    ds_read_b64_tr_b16 a[118:119], v14 offset:53248
    v_cvt_pk_bf16_f32 v116, v120, v121
    v_mfma_f32_16x16x32_bf16 v[216:219], a[212:215], v[100:103], v[216:219]
    v_exp_f32 v122, v122
    v_mfma_f32_16x16x32_bf16 v[220:223], a[216:219], v[100:103], 0
    s_mov_b32 s31, 4096
    ds_read_b64_tr_b16 a[112:113], v14 offset:57344
    buffer_store_dwordx4 v[72:75], v23, s[20:23], s31 offen offset:0 sc1
    v_mfma_f32_16x16x32_bf16 v[220:223], a[220:223], v[96:99], v[220:223]
    ds_read_b64_tr_b16 a[114:115], v14 offset:61440
    v_lshlrev_b32 v1, 16, v33
    v_mfma_f32_16x16x32_bf16 v[96:99], a[128:131], a[48:51], 0
    v_exp_f32 v123, v123
    v_mfma_f32_16x16x32_bf16 v[96:99], a[132:135], a[52:55], v[96:99]
    ds_read_b64_tr_b16 a[108:109], v14 offset:57352
    v_cvt_pk_bf16_f32 v117, v122, v123
    v_mfma_f32_16x16x32_bf16 v[96:99], a[136:139], a[56:59], v[96:99]
    v_exp_f32 v124, v124
    v_mfma_f32_16x16x32_bf16 v[96:99], a[140:143], a[60:63], v[96:99]
    ds_read_b64_tr_b16 a[110:111], v14 offset:61448
    v_lshlrev_b32 v2, 16, v34
    v_mfma_f32_16x16x32_bf16 v[100:103], a[144:147], a[60:63], 0
    v_exp_f32 v125, v125
    v_mfma_f32_16x16x32_bf16 v[100:103], a[148:151], a[56:59], v[100:103]
    ds_read_b64_tr_b16 a[104:105], v14 offset:49160
    v_cvt_pk_bf16_f32 v118, v124, v125
    v_mfma_f32_16x16x32_bf16 v[100:103], a[152:155], a[52:55], v[100:103]
    v_exp_f32 v126, v126
    v_mfma_f32_16x16x32_bf16 v[100:103], a[156:159], a[48:51], v[100:103]
    ds_read_b64_tr_b16 a[106:107], v14 offset:53256
    v_lshlrev_b32 v3, 16, v35
    v_mfma_f32_16x16x32_bf16 v[104:107], a[160:163], a[48:51], 0
    v_exp_f32 v127, v127
    v_mfma_f32_16x16x32_bf16 v[104:107], a[164:167], a[52:55], v[104:107]
    ds_read_b64_tr_b16 a[100:101], v15 offset:49152
    v_cvt_pk_bf16_f32 v119, v126, v127
    v_mfma_f32_16x16x32_bf16 v[104:107], a[168:171], a[56:59], v[104:107]
    s_mov_b32 s31, 4096
    buffer_store_dwordx4 v[84:87], v23, s[20:23], s31 offen offset:2048 sc1
    v_exp_f32 v96, v96
    v_mfma_f32_16x16x32_bf16 v[104:107], a[172:175], a[60:63], v[104:107]
    ds_read_b64_tr_b16 a[102:103], v15 offset:53248
    v_and_b32 v32, s25, v32
    v_and_b32 v33, s25, v33
    v_and_b32 v34, s25, v34
    v_and_b32 v35, s25, v35
    v_pk_mul_f32 v[0:1], v[0:1], s[34:35]
    v_pk_mul_f32 v[2:3], v[2:3], s[34:35]
    v_pk_mul_f32 v[32:33], v[32:33], s[34:35]
    v_pk_mul_f32 v[34:35], v[34:35], s[34:35]
    v_cvt_pk_bf16_f32 v32, v0, v32
    v_cvt_pk_bf16_f32 v33, v1, v33
    v_cvt_pk_bf16_f32 v34, v2, v34
    v_mfma_f32_16x16x32_bf16 v[108:111], a[176:179], a[60:63], 0
    v_exp_f32 v97, v97
    v_mfma_f32_16x16x32_bf16 v[108:111], a[180:183], a[56:59], v[108:111]
    ds_read_b64_tr_b16 a[96:97], v15 offset:57344
    v_cvt_pk_bf16_f32 v96, v96, v97
    v_mfma_f32_16x16x32_bf16 v[108:111], a[184:187], a[52:55], v[108:111]
    v_exp_f32 v98, v98
    v_mfma_f32_16x16x32_bf16 v[108:111], a[188:191], a[48:51], v[108:111]
    ds_read_b64_tr_b16 a[98:99], v15 offset:61440
    v_cvt_pk_bf16_f32 v35, v3, v35
    v_smfmac_f32_16x16x64_bf16 v[24:27], a[120:123], v[112:119], v22
    v_exp_f32 v99, v99
    v_mfma_f32_16x16x32_bf16 v[128:131], a[224:227], v[112:115], v[128:131]
    s_waitcnt lgkmcnt(2)
    ds_read_b64_tr_b16 a[92:93], v15 offset:57352
    v_cvt_pk_bf16_f32 v97, v98, v99
    v_mfma_f32_16x16x32_bf16 v[128:131], a[228:231], v[116:119], v[128:131]
    v_exp_f32 v100, v100
    v_mfma_f32_16x16x32_bf16 v[132:135], a[232:235], v[116:119], v[132:135]
    ds_read_b64_tr_b16 a[94:95], v15 offset:61448
    v_accvgpr_write_b32 a80, v32
    v_mfma_f32_16x16x32_bf16 v[132:135], a[236:239], v[112:115], v[132:135]
    v_exp_f32 v101, v101
    v_mfma_f32_16x16x32_bf16 v[136:139], a[240:243], v[112:115], v[136:139]
    ds_read_b64_tr_b16 a[192:193], v15 offset:49160
    v_cvt_pk_bf16_f32 v98, v100, v101
    v_mfma_f32_16x16x32_bf16 v[136:139], a[244:247], v[116:119], v[136:139]
    v_exp_f32 v102, v102
    v_mfma_f32_16x16x32_bf16 v[140:143], a[248:251], v[116:119], v[140:143]
    ds_read_b64_tr_b16 a[194:195], v15 offset:53256
    v_accvgpr_write_b32 a81, v33
    v_mfma_f32_16x16x32_bf16 v[140:143], a[252:255], v[112:115], v[140:143]
    v_exp_f32 v103, v103
    v_mfma_f32_16x16x32_bf16 v[144:147], a[116:119], v[112:115], v[144:147]
    v_cvt_pk_bf16_f32 v99, v102, v103
    v_accvgpr_write_b32 a82, v34
    v_mfma_f32_16x16x32_bf16 v[144:147], a[112:115], v[116:119], v[144:147]
    v_exp_f32 v104, v104
    v_mfma_f32_16x16x32_bf16 v[148:151], a[108:111], v[116:119], v[148:151]
    v_accvgpr_write_b32 a83, v35
    v_lshlrev_b32 v0, 16, v36
    v_mfma_f32_16x16x32_bf16 v[148:151], a[104:107], v[112:115], v[148:151]
    v_exp_f32 v105, v105
    v_mfma_f32_16x16x32_bf16 v[152:155], a[100:103], v[112:115], v[152:155]
    s_waitcnt lgkmcnt(2)
    v_cvt_pk_bf16_f32 v100, v104, v105
    v_lshlrev_b32 v1, 16, v37
    v_mfma_f32_16x16x32_bf16 v[152:155], a[96:99], v[116:119], v[152:155]
    v_exp_f32 v106, v106
    v_mfma_f32_16x16x32_bf16 v[156:159], a[92:95], v[116:119], v[156:159]
    s_waitcnt lgkmcnt(0)
    v_lshlrev_b32 v2, 16, v38
    v_lshlrev_b32 v3, 16, v39
    v_mfma_f32_16x16x32_bf16 v[156:159], a[192:195], v[112:115], v[156:159]
    v_and_b32 v36, s25, v36
    v_cndmask_b32_dpp v68, v92, v88, vcc row_ror:8 row_mask:0xf bank_mask:0xf
    v_and_b32 v37, s25, v37
    v_and_b32 v38, s25, v38
    v_and_b32 v39, s25, v39
    v_pk_mul_f32 v[0:1], v[0:1], s[34:35]
    v_pk_mul_f32 v[2:3], v[2:3], s[34:35]
    v_pk_mul_f32 v[36:37], v[36:37], s[34:35]
    v_pk_mul_f32 v[38:39], v[38:39], s[34:35]
    v_cvt_pk_bf16_f32 v36, v0, v36
    v_cvt_pk_bf16_f32 v37, v1, v37
    v_cvt_pk_bf16_f32 v38, v2, v38
    v_mfma_f32_16x16x32_bf16 v[112:115], a[128:131], a[64:67], 0
    s_waitcnt vmcnt(6)
    s_barrier
    v_exp_f32 v107, v107
    v_mfma_f32_16x16x32_bf16 v[112:115], a[132:135], a[68:71], v[112:115]
    s_add_u32 s29, s27, 65536
    v_cvt_pk_bf16_f32 v101, v106, v107
    v_cvt_pk_bf16_f32 v39, v3, v39
    v_mfma_f32_16x16x32_bf16 v[112:115], a[136:139], a[72:75], v[112:115]
    s_add_u32 m0, s27, 147456
    v_exp_f32 v108, v108
    v_mfma_f32_16x16x32_bf16 v[112:115], a[140:143], a[76:79], v[112:115]
    buffer_load_dwordx4 v18, s[52:55], s29 offen lds
    v_mfma_f32_16x16x32_bf16 v[116:119], a[144:147], a[76:79], 0
    v_exp_f32 v109, v109
    v_mfma_f32_16x16x32_bf16 v[116:119], a[148:151], a[72:75], v[116:119]
    v_cvt_pk_bf16_f32 v102, v108, v109
    v_accvgpr_write_b32 a84, v36
    v_mfma_f32_16x16x32_bf16 v[116:119], a[152:155], a[68:71], v[116:119]
    v_exp_f32 v110, v110
    v_mfma_f32_16x16x32_bf16 v[116:119], a[156:159], a[64:67], v[116:119]
    buffer_load_dwordx4 v18, s[52:55], s29 offen offset:1024 lds
    v_mfma_f32_16x16x32_bf16 v[120:123], a[160:163], a[64:67], 0
    v_exp_f32 v111, v111
    v_mfma_f32_16x16x32_bf16 v[120:123], a[164:167], a[68:71], v[120:123]
    v_cvt_pk_bf16_f32 v103, v110, v111
    v_accvgpr_write_b32 a85, v37
    v_mfma_f32_16x16x32_bf16 v[120:123], a[168:171], a[72:75], v[120:123]
    v_exp_f32 v112, v112
    v_mfma_f32_16x16x32_bf16 v[120:123], a[172:175], a[76:79], v[120:123]
    buffer_load_dwordx4 v18, s[52:55], s29 offen offset:2048 lds
    v_mfma_f32_16x16x32_bf16 v[124:127], a[176:179], a[76:79], 0
    v_exp_f32 v113, v113
    v_mfma_f32_16x16x32_bf16 v[124:127], a[180:183], a[72:75], v[124:127]
    v_cvt_pk_bf16_f32 v112, v112, v113
    v_accvgpr_write_b32 a86, v38
    v_mfma_f32_16x16x32_bf16 v[124:127], a[184:187], a[68:71], v[124:127]
    v_exp_f32 v114, v114
    v_mfma_f32_16x16x32_bf16 v[124:127], a[188:191], a[64:67], v[124:127]
    buffer_load_dwordx4 v18, s[52:55], s29 offen offset:3072 lds
    v_smfmac_f32_16x16x64_bf16 v[24:27], a[124:127], v[96:103], v22
    v_exp_f32 v115, v115
    v_mfma_f32_16x16x32_bf16 v[160:163], a[224:227], v[96:99], v[160:163]
    v_cvt_pk_bf16_f32 v113, v114, v115
    v_accvgpr_write_b32 a87, v39
    v_mfma_f32_16x16x32_bf16 v[160:163], a[228:231], v[100:103], v[160:163]
    v_exp_f32 v116, v116
    v_mfma_f32_16x16x32_bf16 v[164:167], a[232:235], v[100:103], v[164:167]
    s_mov_b32 s30, 65536
    buffer_load_dwordx4 v[72:75], v16, s[44:47], s30 offen offset:128 nt
    v_mfma_f32_16x16x32_bf16 v[164:167], a[236:239], v[96:99], v[164:167]
    v_exp_f32 v117, v117
    v_mfma_f32_16x16x32_bf16 v[168:171], a[240:243], v[96:99], v[168:171]
    v_cvt_pk_bf16_f32 v114, v116, v117
    v_lshlrev_b32 v0, 16, v48
    v_mfma_f32_16x16x32_bf16 v[168:171], a[244:247], v[100:103], v[168:171]
    v_exp_f32 v118, v118
    v_mfma_f32_16x16x32_bf16 v[172:175], a[248:251], v[100:103], v[172:175]
    v_lshlrev_b32 v1, 16, v49
    v_lshlrev_b32 v2, 16, v50
    v_mfma_f32_16x16x32_bf16 v[172:175], a[252:255], v[96:99], v[172:175]
    v_exp_f32 v119, v119
    v_mfma_f32_16x16x32_bf16 v[176:179], a[116:119], v[96:99], v[176:179]
    v_cvt_pk_bf16_f32 v115, v118, v119
    v_lshlrev_b32 v3, 16, v51
    v_mfma_f32_16x16x32_bf16 v[176:179], a[112:115], v[100:103], v[176:179]
    v_exp_f32 v120, v120
    v_mfma_f32_16x16x32_bf16 v[180:183], a[108:111], v[100:103], v[180:183]
    v_and_b32 v48, s25, v48
    v_cndmask_b32_dpp v69, v93, v89, vcc row_ror:8 row_mask:0xf bank_mask:0xf
    v_and_b32 v49, s25, v49
    v_and_b32 v50, s25, v50
    v_and_b32 v51, s25, v51
    v_pk_mul_f32 v[0:1], v[0:1], s[34:35]
    v_pk_mul_f32 v[2:3], v[2:3], s[34:35]
    v_pk_mul_f32 v[48:49], v[48:49], s[34:35]
    v_pk_mul_f32 v[50:51], v[50:51], s[34:35]
    v_cvt_pk_bf16_f32 v48, v0, v48
    v_cvt_pk_bf16_f32 v49, v1, v49
    v_cvt_pk_bf16_f32 v50, v2, v50
    v_mfma_f32_16x16x32_bf16 v[180:183], a[104:107], v[96:99], v[180:183]
    v_exp_f32 v121, v121
    v_mfma_f32_16x16x32_bf16 v[184:187], a[100:103], v[96:99], v[184:187]
    v_cvt_pk_bf16_f32 v116, v120, v121
    v_cvt_pk_bf16_f32 v51, v3, v51
    v_mfma_f32_16x16x32_bf16 v[184:187], a[96:99], v[100:103], v[184:187]
    v_exp_f32 v122, v122
    v_mfma_f32_16x16x32_bf16 v[188:191], a[92:95], v[100:103], v[188:191]
    s_mov_b32 s30, 65536
    buffer_load_dwordx4 v[84:87], v16, s[44:47], s30 offen offset:192 nt
    v_accvgpr_write_b32 a88, v48
    v_accvgpr_write_b32 a89, v49
    v_accvgpr_write_b32 a90, v50
    v_accvgpr_write_b32 a91, v51
    v_lshlrev_b32 v0, 16, v64
    v_lshlrev_b32 v1, 16, v65
    v_lshlrev_b32 v2, 16, v66
    v_lshlrev_b32 v3, 16, v67
    v_and_b32 v64, s25, v64
    v_and_b32 v65, s25, v65
    v_and_b32 v66, s25, v66
    v_and_b32 v67, s25, v67
    v_pk_mul_f32 v[0:1], v[0:1], s[34:35]
    v_pk_mul_f32 v[2:3], v[2:3], s[34:35]
    v_pk_mul_f32 v[64:65], v[64:65], s[34:35]
    v_pk_mul_f32 v[66:67], v[66:67], s[34:35]
    v_cvt_pk_bf16_f32 v64, v0, v64
    v_cvt_pk_bf16_f32 v65, v1, v65
    v_cvt_pk_bf16_f32 v66, v2, v66
    v_cvt_pk_bf16_f32 v67, v3, v67
    v_accvgpr_write_b32 a0, v64
    v_accvgpr_write_b32 a1, v65
    v_accvgpr_write_b32 a2, v66
    v_accvgpr_write_b32 a3, v67
    v_mfma_f32_16x16x32_bf16 v[188:191], a[192:195], v[96:99], v[188:191]
    v_cndmask_b32_dpp v70, v94, v90, vcc row_ror:8 row_mask:0xf bank_mask:0xf
    v_cndmask_b32_dpp v71, v95, v91, vcc row_ror:8 row_mask:0xf bank_mask:0xf
    v_mfma_f32_16x16x32_bf16 v[96:99], a[128:131], a[80:83], 0
    v_exp_f32 v123, v123
    v_mfma_f32_16x16x32_bf16 v[96:99], a[132:135], a[84:87], v[96:99]
    ds_read_b128 a[128:131], v4 offset:49152
    v_cvt_pk_bf16_f32 v117, v122, v123
    v_mfma_f32_16x16x32_bf16 v[96:99], a[136:139], a[88:91], v[96:99]
    v_exp_f32 v124, v124
    v_mfma_f32_16x16x32_bf16 v[96:99], a[140:143], a[0:3], v[96:99]
    ds_read_b128 a[132:135], v5 offset:49152
    v_mov_b32_dpp v92, v88 row_ror:8 row_mask:0xf bank_mask:0x3
    v_mfma_f32_16x16x32_bf16 v[100:103], a[144:147], a[0:3], 0
    v_exp_f32 v125, v125
    v_mfma_f32_16x16x32_bf16 v[100:103], a[148:151], a[88:91], v[100:103]
    ds_read_b128 a[136:139], v6 offset:49152
    v_cvt_pk_bf16_f32 v118, v124, v125
    v_mfma_f32_16x16x32_bf16 v[100:103], a[152:155], a[84:87], v[100:103]
    v_exp_f32 v126, v126
    v_mfma_f32_16x16x32_bf16 v[100:103], a[156:159], a[80:83], v[100:103]
    ds_read_b128 a[140:143], v7 offset:49152
    v_mov_b32_dpp v93, v89 row_ror:8 row_mask:0xf bank_mask:0x3
    v_mfma_f32_16x16x32_bf16 v[104:107], a[160:163], a[80:83], 0
    v_exp_f32 v127, v127
    v_mfma_f32_16x16x32_bf16 v[104:107], a[164:167], a[84:87], v[104:107]
    ds_read_b128 a[144:147], v7 offset:53248
    v_cvt_pk_bf16_f32 v119, v126, v127
    v_mfma_f32_16x16x32_bf16 v[104:107], a[168:171], a[88:91], v[104:107]
    v_exp_f32 v96, v96
    v_mfma_f32_16x16x32_bf16 v[104:107], a[172:175], a[0:3], v[104:107]
    ds_read_b128 a[148:151], v6 offset:53248
    v_mov_b32_dpp v94, v90 row_ror:8 row_mask:0xf bank_mask:0x3
    v_mfma_f32_16x16x32_bf16 v[108:111], a[176:179], a[0:3], 0
    v_exp_f32 v97, v97
    v_mfma_f32_16x16x32_bf16 v[108:111], a[180:183], a[88:91], v[108:111]
    ds_read_b128 a[152:155], v5 offset:53248
    v_cvt_pk_bf16_f32 v96, v96, v97
    v_mfma_f32_16x16x32_bf16 v[108:111], a[184:187], a[84:87], v[108:111]
    v_exp_f32 v98, v98
    v_mfma_f32_16x16x32_bf16 v[108:111], a[188:191], a[80:83], v[108:111]
    ds_read_b128 a[156:159], v4 offset:53248
    v_mov_b32_dpp v95, v91 row_ror:8 row_mask:0xf bank_mask:0x3
    v_smfmac_f32_16x16x64_bf16 v[28:31], a[120:123], v[112:119], v22
    v_exp_f32 v99, v99
    v_mfma_f32_16x16x32_bf16 v[192:195], a[224:227], v[112:115], v[192:195]
    ds_read_b128 a[160:163], v4 offset:57344
    v_cvt_pk_bf16_f32 v97, v98, v99
    v_mfma_f32_16x16x32_bf16 v[192:195], a[228:231], v[116:119], v[192:195]
    v_exp_f32 v100, v100
    v_mfma_f32_16x16x32_bf16 v[196:199], a[232:235], v[116:119], v[196:199]
    ds_read_b128 a[164:167], v5 offset:57344
    v_cvt_pk_bf16_f32 v81, v226, v227
    v_mfma_f32_16x16x32_bf16 v[196:199], a[236:239], v[112:115], v[196:199]
    v_exp_f32 v101, v101
    v_mfma_f32_16x16x32_bf16 v[200:203], a[240:243], v[112:115], v[200:203]
    ds_read_b128 a[168:171], v6 offset:57344
    v_cvt_pk_bf16_f32 v98, v100, v101
    v_mfma_f32_16x16x32_bf16 v[200:203], a[244:247], v[116:119], v[200:203]
    v_exp_f32 v102, v102
    v_mfma_f32_16x16x32_bf16 v[204:207], a[248:251], v[116:119], v[204:207]
    s_mov_b32 s31, 4096
    ds_read_b128 a[172:175], v7 offset:57344
    buffer_store_dwordx4 v[68:71], v23, s[20:23], s31 offen offset:128 sc1
    v_mfma_f32_16x16x32_bf16 v[204:207], a[252:255], v[112:115], v[204:207]
    v_exp_f32 v103, v103
    v_mfma_f32_16x16x32_bf16 v[208:211], a[116:119], v[112:115], v[208:211]
    ds_read_b128 a[176:179], v7 offset:61440
    v_cvt_pk_bf16_f32 v99, v102, v103
    v_mfma_f32_16x16x32_bf16 v[208:211], a[112:115], v[116:119], v[208:211]
    v_exp_f32 v104, v104
    v_mfma_f32_16x16x32_bf16 v[212:215], a[108:111], v[116:119], v[212:215]
    ds_read_b128 a[180:183], v6 offset:61440
    v_cvt_pk_bf16_f32 v82, v228, v229
    v_mfma_f32_16x16x32_bf16 v[212:215], a[104:107], v[112:115], v[212:215]
    v_exp_f32 v105, v105
    v_mfma_f32_16x16x32_bf16 v[216:219], a[100:103], v[112:115], v[216:219]
    ds_read_b128 a[184:187], v5 offset:61440
    v_cvt_pk_bf16_f32 v100, v104, v105
    v_mfma_f32_16x16x32_bf16 v[216:219], a[96:99], v[116:119], v[216:219]
    v_exp_f32 v106, v106
    v_mfma_f32_16x16x32_bf16 v[220:223], a[92:95], v[116:119], v[220:223]
    ds_read_b128 a[188:191], v4 offset:61440
    v_cvt_pk_bf16_f32 v83, v230, v231
    v_mfma_f32_16x16x32_bf16 v[220:223], a[192:195], v[112:115], v[220:223]
    s_waitcnt lgkmcnt(5)
    ds_read_b64_tr_b16 a[196:197], v12 offset:32768
    ds_read_b64_tr_b16 a[198:199], v12 offset:36864
    v_mfma_f32_16x16x32_bf16 v[112:115], a[128:131], a[32:35], 0
    v_exp_f32 v107, v107
    v_mfma_f32_16x16x32_bf16 v[112:115], a[132:135], a[36:39], v[112:115]
    ds_read_b64_tr_b16 a[200:201], v12 offset:40960
    v_cvt_pk_bf16_f32 v101, v106, v107
    v_mfma_f32_16x16x32_bf16 v[112:115], a[136:139], a[40:43], v[112:115]
    v_exp_f32 v108, v108
    v_mfma_f32_16x16x32_bf16 v[112:115], a[140:143], a[44:47], v[112:115]
    ds_read_b64_tr_b16 a[202:203], v12 offset:45056
    ds_read_b64_tr_b16 a[204:205], v12 offset:40968
    v_mfma_f32_16x16x32_bf16 v[116:119], a[144:147], a[44:47], 0
    v_exp_f32 v109, v109
    v_mfma_f32_16x16x32_bf16 v[116:119], a[148:151], a[40:43], v[116:119]
    ds_read_b64_tr_b16 a[206:207], v12 offset:45064
    v_cvt_pk_bf16_f32 v102, v108, v109
    v_mfma_f32_16x16x32_bf16 v[116:119], a[152:155], a[36:39], v[116:119]
    v_exp_f32 v110, v110
    v_mfma_f32_16x16x32_bf16 v[116:119], a[156:159], a[32:35], v[116:119]
    s_mov_b32 s31, 4096
    ds_read_b64_tr_b16 a[208:209], v12 offset:32776
    buffer_store_dwordx4 v[92:95], v23, s[20:23], s31 offen offset:2176 sc1
    v_mfma_f32_16x16x32_bf16 v[120:123], a[160:163], a[32:35], 0
    v_exp_f32 v111, v111
    v_mfma_f32_16x16x32_bf16 v[120:123], a[164:167], a[36:39], v[120:123]
    ds_read_b64_tr_b16 a[210:211], v12 offset:36872
    v_cvt_pk_bf16_f32 v103, v110, v111
    v_mfma_f32_16x16x32_bf16 v[120:123], a[168:171], a[40:43], v[120:123]
    s_waitcnt lgkmcnt(5)
    v_exp_f32 v112, v112
    v_mfma_f32_16x16x32_bf16 v[120:123], a[172:175], a[44:47], v[120:123]
    ds_read_b64_tr_b16 a[212:213], v13 offset:32768
    v_cvt_pk_bf16_f32 v32, v232, v233
    v_mfma_f32_16x16x32_bf16 v[124:127], a[176:179], a[44:47], 0
    v_exp_f32 v113, v113
    v_mfma_f32_16x16x32_bf16 v[124:127], a[180:183], a[40:43], v[124:127]
    ds_read_b64_tr_b16 a[214:215], v13 offset:36864
    v_cvt_pk_bf16_f32 v112, v112, v113
    v_mfma_f32_16x16x32_bf16 v[124:127], a[184:187], a[36:39], v[124:127]
    v_exp_f32 v114, v114
    v_mfma_f32_16x16x32_bf16 v[124:127], a[188:191], a[32:35], v[124:127]
    ds_read_b64_tr_b16 a[216:217], v13 offset:40960
    v_cvt_pk_bf16_f32 v33, v234, v235
    v_smfmac_f32_16x16x64_bf16 v[28:31], a[124:127], v[96:103], v22
    v_exp_f32 v115, v115
    v_mfma_f32_16x16x32_bf16 v[224:227], a[224:227], v[96:99], 0
    ds_read_b64_tr_b16 a[218:219], v13 offset:45056
    v_cvt_pk_bf16_f32 v113, v114, v115
    v_mfma_f32_16x16x32_bf16 v[224:227], a[228:231], v[100:103], v[224:227]
    v_exp_f32 v116, v116
    v_mfma_f32_16x16x32_bf16 v[228:231], a[232:235], v[100:103], 0
    ds_read_b64_tr_b16 a[220:221], v13 offset:40968
    v_cvt_pk_bf16_f32 v34, v236, v237
    v_cvt_pk_bf16_f32 v35, v238, v239
    v_mfma_f32_16x16x32_bf16 v[228:231], a[236:239], v[96:99], v[228:231]
    v_exp_f32 v117, v117
    v_mfma_f32_16x16x32_bf16 v[232:235], a[240:243], v[96:99], 0
    ds_read_b64_tr_b16 a[222:223], v13 offset:45064
    v_cvt_pk_bf16_f32 v114, v116, v117
    v_mfma_f32_16x16x32_bf16 v[232:235], a[244:247], v[100:103], v[232:235]
    v_exp_f32 v118, v118
    v_mfma_f32_16x16x32_bf16 v[236:239], a[248:251], v[100:103], 0
    ds_read_b64_tr_b16 a[224:225], v13 offset:32776
    v_cvt_pk_bf16_f32 v36, v240, v241
    v_cvt_pk_bf16_f32 v37, v242, v243
    v_cvt_pk_bf16_f32 v38, v244, v245
    v_cvt_pk_bf16_f32 v39, v246, v247
    v_mfma_f32_16x16x32_bf16 v[236:239], a[252:255], v[96:99], v[236:239]
    v_exp_f32 v119, v119
    v_mfma_f32_16x16x32_bf16 v[240:243], a[116:119], v[96:99], 0
    ds_read_b64_tr_b16 a[226:227], v13 offset:36872
    v_cvt_pk_bf16_f32 v115, v118, v119
    v_mfma_f32_16x16x32_bf16 v[240:243], a[112:115], v[100:103], v[240:243]
    v_exp_f32 v120, v120
    v_mfma_f32_16x16x32_bf16 v[244:247], a[108:111], v[100:103], 0
    ds_read_b64_tr_b16 a[228:229], v14 offset:32768
    v_cvt_pk_bf16_f32 v48, v248, v249
    v_cvt_pk_bf16_f32 v49, v250, v251
    v_cvt_pk_bf16_f32 v50, v252, v253
    v_cvt_pk_bf16_f32 v51, v254, v255
    v_mfma_f32_16x16x32_bf16 v[244:247], a[104:107], v[96:99], v[244:247]
    v_exp_f32 v121, v121
    v_mfma_f32_16x16x32_bf16 v[248:251], a[100:103], v[96:99], 0
    ds_read_b64_tr_b16 a[230:231], v14 offset:36864
    v_cvt_pk_bf16_f32 v116, v120, v121
    v_mfma_f32_16x16x32_bf16 v[248:251], a[96:99], v[100:103], v[248:251]
    s_add_u32 m0, s26, 98304
    v_exp_f32 v122, v122
    v_mfma_f32_16x16x32_bf16 v[252:255], a[92:95], v[100:103], 0
    ds_read_b64_tr_b16 a[232:233], v14 offset:40960
    buffer_load_dwordx4 v17, s[48:51], m0 offen nt lds
    v_mfma_f32_16x16x32_bf16 v[252:255], a[192:195], v[96:99], v[252:255]
    ds_read_b64_tr_b16 a[234:235], v14 offset:45056
    v_cndmask_b32_dpp v64, v40, v76, vcc row_ror:8 row_mask:0xf bank_mask:0xf
    v_mfma_f32_16x16x32_bf16 v[96:99], a[128:131], a[48:51], 0
    v_exp_f32 v123, v123
    v_mfma_f32_16x16x32_bf16 v[96:99], a[132:135], a[52:55], v[96:99]
    ds_read_b64_tr_b16 a[236:237], v14 offset:40968
    v_cvt_pk_bf16_f32 v117, v122, v123
    v_mfma_f32_16x16x32_bf16 v[96:99], a[136:139], a[56:59], v[96:99]
    s_add_u32 m0, s26, 102400
    v_exp_f32 v124, v124
    v_mfma_f32_16x16x32_bf16 v[96:99], a[140:143], a[60:63], v[96:99]
    ds_read_b64_tr_b16 a[238:239], v14 offset:45064
    buffer_load_dwordx4 v17, s[48:51], m0 offen nt lds
    v_mfma_f32_16x16x32_bf16 v[100:103], a[144:147], a[60:63], 0
    v_exp_f32 v125, v125
    v_mfma_f32_16x16x32_bf16 v[100:103], a[148:151], a[56:59], v[100:103]
    ds_read_b64_tr_b16 a[240:241], v14 offset:32776
    v_cvt_pk_bf16_f32 v118, v124, v125
    v_mfma_f32_16x16x32_bf16 v[100:103], a[152:155], a[52:55], v[100:103]
    s_add_u32 m0, s26, 106496
    v_exp_f32 v126, v126
    v_mfma_f32_16x16x32_bf16 v[100:103], a[156:159], a[48:51], v[100:103]
    ds_read_b64_tr_b16 a[242:243], v14 offset:36872
    buffer_load_dwordx4 v17, s[48:51], m0 offen nt lds
    v_mfma_f32_16x16x32_bf16 v[104:107], a[160:163], a[48:51], 0
    v_exp_f32 v127, v127
    v_mfma_f32_16x16x32_bf16 v[104:107], a[164:167], a[52:55], v[104:107]
    ds_read_b64_tr_b16 a[244:245], v15 offset:32768
    v_cvt_pk_bf16_f32 v119, v126, v127
    v_mfma_f32_16x16x32_bf16 v[104:107], a[168:171], a[56:59], v[104:107]
    s_add_u32 m0, s26, 110592
    v_exp_f32 v96, v96
    v_mfma_f32_16x16x32_bf16 v[104:107], a[172:175], a[60:63], v[104:107]
    ds_read_b64_tr_b16 a[246:247], v15 offset:36864
    buffer_load_dwordx4 v17, s[48:51], m0 offen nt lds
    v_mfma_f32_16x16x32_bf16 v[108:111], a[176:179], a[60:63], 0
    v_exp_f32 v97, v97
    v_mfma_f32_16x16x32_bf16 v[108:111], a[180:183], a[56:59], v[108:111]
    ds_read_b64_tr_b16 a[248:249], v15 offset:40960
    v_cvt_pk_bf16_f32 v96, v96, v97
    v_mfma_f32_16x16x32_bf16 v[108:111], a[184:187], a[52:55], v[108:111]
    v_exp_f32 v98, v98
    v_mfma_f32_16x16x32_bf16 v[108:111], a[188:191], a[48:51], v[108:111]
    ds_read_b64_tr_b16 a[250:251], v15 offset:45056
    v_cndmask_b32_dpp v65, v41, v77, vcc row_ror:8 row_mask:0xf bank_mask:0xf
    v_smfmac_f32_16x16x64_bf16 v[24:27], a[120:123], v[112:119], v22
    v_exp_f32 v99, v99
    v_mfma_f32_16x16x32_bf16 v[128:131], a[196:199], v[112:115], v[128:131]
    s_waitcnt lgkmcnt(4)
    ds_read_b64_tr_b16 a[252:253], v15 offset:40968
    v_cvt_pk_bf16_f32 v97, v98, v99
    v_mfma_f32_16x16x32_bf16 v[128:131], a[200:203], v[116:119], v[128:131]
    v_exp_f32 v100, v100
    v_mfma_f32_16x16x32_bf16 v[132:135], a[204:207], v[116:119], v[132:135]
    ds_read_b64_tr_b16 a[254:255], v15 offset:45064
    v_cndmask_b32_dpp v66, v42, v78, vcc row_ror:8 row_mask:0xf bank_mask:0xf
    v_mfma_f32_16x16x32_bf16 v[132:135], a[208:211], v[112:115], v[132:135]
    v_exp_f32 v101, v101
    v_mfma_f32_16x16x32_bf16 v[136:139], a[212:215], v[112:115], v[136:139]
    ds_read_b64_tr_b16 a[116:117], v15 offset:32776
    v_cvt_pk_bf16_f32 v98, v100, v101
    v_mfma_f32_16x16x32_bf16 v[136:139], a[216:219], v[116:119], v[136:139]
    v_exp_f32 v102, v102
    v_mfma_f32_16x16x32_bf16 v[140:143], a[220:223], v[116:119], v[140:143]
    ds_read_b64_tr_b16 a[118:119], v15 offset:36872
    v_cndmask_b32_dpp v67, v43, v79, vcc row_ror:8 row_mask:0xf bank_mask:0xf
    v_mfma_f32_16x16x32_bf16 v[140:143], a[224:227], v[112:115], v[140:143]
    v_exp_f32 v103, v103
    v_mfma_f32_16x16x32_bf16 v[144:147], a[228:231], v[112:115], v[144:147]
    v_cvt_pk_bf16_f32 v99, v102, v103
    v_mov_b32_dpp v40, v76 row_ror:8 row_mask:0xf bank_mask:0x3
    v_mfma_f32_16x16x32_bf16 v[144:147], a[232:235], v[116:119], v[144:147]
    v_exp_f32 v104, v104
    v_mfma_f32_16x16x32_bf16 v[148:151], a[236:239], v[116:119], v[148:151]
    v_mov_b32_dpp v41, v77 row_ror:8 row_mask:0xf bank_mask:0x3
    v_mov_b32_dpp v42, v78 row_ror:8 row_mask:0xf bank_mask:0x3
    v_mfma_f32_16x16x32_bf16 v[148:151], a[240:243], v[112:115], v[148:151]
    s_waitcnt lgkmcnt(3)
    v_exp_f32 v105, v105
    v_mfma_f32_16x16x32_bf16 v[152:155], a[244:247], v[112:115], v[152:155]
    v_cvt_pk_bf16_f32 v100, v104, v105
    v_mov_b32_dpp v43, v79 row_ror:8 row_mask:0xf bank_mask:0x3
    v_mfma_f32_16x16x32_bf16 v[152:155], a[248:251], v[116:119], v[152:155]
    s_waitcnt lgkmcnt(1)
    v_exp_f32 v106, v106
    v_mfma_f32_16x16x32_bf16 v[156:159], a[252:255], v[116:119], v[156:159]
    s_waitcnt lgkmcnt(0)
    s_waitcnt vmcnt(15)
    v_lshlrev_b32 v0, 16, v60
    v_lshlrev_b32 v1, 16, v61
    v_mfma_f32_16x16x32_bf16 v[156:159], a[116:119], v[112:115], v[156:159]
    s_waitcnt vmcnt(8)
    v_lshlrev_b32 v2, 16, v62
    v_lshlrev_b32 v3, 16, v63
    v_mfma_f32_16x16x32_bf16 v[112:115], a[128:131], a[64:67], 0
    s_barrier
    v_exp_f32 v107, v107
    v_mfma_f32_16x16x32_bf16 v[112:115], a[132:135], a[68:71], v[112:115]
    s_add_u32 s29, s27, 81920
    v_cvt_pk_bf16_f32 v101, v106, v107
    v_and_b32 v60, s25, v60
    v_mfma_f32_16x16x32_bf16 v[112:115], a[136:139], a[72:75], v[112:115]
    s_add_u32 m0, s27, 131072
    v_exp_f32 v108, v108
    v_mfma_f32_16x16x32_bf16 v[112:115], a[140:143], a[76:79], v[112:115]
    buffer_load_dwordx4 v18, s[52:55], s29 offen lds
    v_mfma_f32_16x16x32_bf16 v[116:119], a[144:147], a[76:79], 0
    v_exp_f32 v109, v109
    v_mfma_f32_16x16x32_bf16 v[116:119], a[148:151], a[72:75], v[116:119]
    v_cvt_pk_bf16_f32 v102, v108, v109
    v_and_b32 v61, s25, v61
    v_mfma_f32_16x16x32_bf16 v[116:119], a[152:155], a[68:71], v[116:119]
    v_exp_f32 v110, v110
    v_mfma_f32_16x16x32_bf16 v[116:119], a[156:159], a[64:67], v[116:119]
    buffer_load_dwordx4 v18, s[52:55], s29 offen offset:1024 lds
    v_mfma_f32_16x16x32_bf16 v[120:123], a[160:163], a[64:67], 0
    v_exp_f32 v111, v111
    v_mfma_f32_16x16x32_bf16 v[120:123], a[164:167], a[68:71], v[120:123]
    v_cvt_pk_bf16_f32 v103, v110, v111
    v_and_b32 v62, s25, v62
    v_mfma_f32_16x16x32_bf16 v[120:123], a[168:171], a[72:75], v[120:123]
    v_exp_f32 v112, v112
    v_mfma_f32_16x16x32_bf16 v[120:123], a[172:175], a[76:79], v[120:123]
    buffer_load_dwordx4 v18, s[52:55], s29 offen offset:2048 lds
    v_mfma_f32_16x16x32_bf16 v[124:127], a[176:179], a[76:79], 0
    v_exp_f32 v113, v113
    v_mfma_f32_16x16x32_bf16 v[124:127], a[180:183], a[72:75], v[124:127]
    v_cvt_pk_bf16_f32 v112, v112, v113
    v_and_b32 v63, s25, v63
    v_mfma_f32_16x16x32_bf16 v[124:127], a[184:187], a[68:71], v[124:127]
    v_exp_f32 v114, v114
    v_mfma_f32_16x16x32_bf16 v[124:127], a[188:191], a[64:67], v[124:127]
    buffer_load_dwordx4 v18, s[52:55], s29 offen offset:3072 lds
    v_smfmac_f32_16x16x64_bf16 v[24:27], a[124:127], v[96:103], v22
    v_exp_f32 v115, v115
    v_mfma_f32_16x16x32_bf16 v[160:163], a[196:199], v[96:99], v[160:163]
    v_cvt_pk_bf16_f32 v113, v114, v115
    v_mul_f32 v0, s24, v0
    v_mfma_f32_16x16x32_bf16 v[160:163], a[200:203], v[100:103], v[160:163]
    v_exp_f32 v116, v116
    v_mfma_f32_16x16x32_bf16 v[164:167], a[204:207], v[100:103], v[164:167]
    s_mov_b32 s30, 69632
    buffer_load_dwordx4 v[88:91], v16, s[44:47], s30 offen nt
    v_mfma_f32_16x16x32_bf16 v[164:167], a[208:211], v[96:99], v[164:167]
    v_exp_f32 v117, v117
    v_mfma_f32_16x16x32_bf16 v[168:171], a[212:215], v[96:99], v[168:171]
    v_cvt_pk_bf16_f32 v114, v116, v117
    v_mul_f32 v1, s24, v1
    v_mfma_f32_16x16x32_bf16 v[168:171], a[216:219], v[100:103], v[168:171]
    v_exp_f32 v118, v118
    v_mfma_f32_16x16x32_bf16 v[172:175], a[220:223], v[100:103], v[172:175]
    v_mul_f32 v2, s24, v2
    v_mul_f32 v3, s24, v3
    v_mfma_f32_16x16x32_bf16 v[172:175], a[224:227], v[96:99], v[172:175]
    v_exp_f32 v119, v119
    v_mfma_f32_16x16x32_bf16 v[176:179], a[228:231], v[96:99], v[176:179]
    v_cvt_pk_bf16_f32 v115, v118, v119
    v_mul_f32 v60, s24, v60
    v_mfma_f32_16x16x32_bf16 v[176:179], a[232:235], v[100:103], v[176:179]
    v_exp_f32 v120, v120
    v_mfma_f32_16x16x32_bf16 v[180:183], a[236:239], v[100:103], v[180:183]
    v_mul_f32 v61, s24, v61
    v_mul_f32 v62, s24, v62
    v_mfma_f32_16x16x32_bf16 v[180:183], a[240:243], v[96:99], v[180:183]
    v_exp_f32 v121, v121
    v_mfma_f32_16x16x32_bf16 v[184:187], a[244:247], v[96:99], v[184:187]
    v_cvt_pk_bf16_f32 v116, v120, v121
    v_mul_f32 v63, s24, v63
    v_mfma_f32_16x16x32_bf16 v[184:187], a[248:251], v[100:103], v[184:187]
    v_exp_f32 v122, v122
    v_mfma_f32_16x16x32_bf16 v[188:191], a[252:255], v[100:103], v[188:191]
    s_mov_b32 s31, 8192
    buffer_store_dwordx4 v[64:67], v23, s[20:23], s31 offen offset:0 sc1
    v_mfma_f32_16x16x32_bf16 v[188:191], a[116:119], v[96:99], v[188:191]
Lpad7:
    s_cbranch_execz Lret0
    v_cvt_pk_bf16_f32 v60, v0, v60
    v_cvt_pk_bf16_f32 v61, v1, v61
    v_mfma_f32_16x16x32_bf16 v[96:99], a[128:131], a[80:83], 0
    v_exp_f32 v123, v123
    v_mfma_f32_16x16x32_bf16 v[96:99], a[132:135], a[84:87], v[96:99]
    ds_read_b128 a[128:131], v8 offset:0
    v_cvt_pk_bf16_f32 v117, v122, v123
    v_mfma_f32_16x16x32_bf16 v[96:99], a[136:139], a[88:91], v[96:99]
    v_exp_f32 v124, v124
    v_mfma_f32_16x16x32_bf16 v[96:99], a[140:143], a[0:3], v[96:99]
    ds_read_b128 a[132:135], v9 offset:0
    v_cvt_pk_bf16_f32 v62, v2, v62
    v_mfma_f32_16x16x32_bf16 v[100:103], a[144:147], a[0:3], 0
    v_exp_f32 v125, v125
    v_mfma_f32_16x16x32_bf16 v[100:103], a[148:151], a[88:91], v[100:103]
    ds_read_b128 a[136:139], v10 offset:0
    v_cvt_pk_bf16_f32 v118, v124, v125
    v_mfma_f32_16x16x32_bf16 v[100:103], a[152:155], a[84:87], v[100:103]
    v_exp_f32 v126, v126
    v_mfma_f32_16x16x32_bf16 v[100:103], a[156:159], a[80:83], v[100:103]
    ds_read_b128 a[140:143], v11 offset:0
    v_cvt_pk_bf16_f32 v63, v3, v63
    v_mfma_f32_16x16x32_bf16 v[104:107], a[160:163], a[80:83], 0
    v_exp_f32 v127, v127
    v_mfma_f32_16x16x32_bf16 v[104:107], a[164:167], a[84:87], v[104:107]
    ds_read_b128 a[144:147], v11 offset:4096
    v_cvt_pk_bf16_f32 v119, v126, v127
    v_mfma_f32_16x16x32_bf16 v[104:107], a[168:171], a[88:91], v[104:107]
    s_mov_b32 s30, 69632
    buffer_load_dwordx4 v[68:71], v16, s[44:47], s30 offen offset:64 nt
    v_exp_f32 v96, v96
    v_mfma_f32_16x16x32_bf16 v[104:107], a[172:175], a[0:3], v[104:107]
    ds_read_b128 a[148:151], v10 offset:4096
    v_accvgpr_write_b32 a4, v60
    v_mfma_f32_16x16x32_bf16 v[108:111], a[176:179], a[0:3], 0
    v_exp_f32 v97, v97
    v_mfma_f32_16x16x32_bf16 v[108:111], a[180:183], a[88:91], v[108:111]
    ds_read_b128 a[152:155], v9 offset:4096
    v_cvt_pk_bf16_f32 v96, v96, v97
    v_mfma_f32_16x16x32_bf16 v[108:111], a[184:187], a[84:87], v[108:111]
    v_exp_f32 v98, v98
    v_mfma_f32_16x16x32_bf16 v[108:111], a[188:191], a[80:83], v[108:111]
    ds_read_b128 a[156:159], v8 offset:4096
    v_accvgpr_write_b32 a5, v61
    v_smfmac_f32_16x16x64_bf16 v[28:31], a[120:123], v[112:119], v22
    v_exp_f32 v99, v99
    v_mfma_f32_16x16x32_bf16 v[192:195], a[196:199], v[112:115], v[192:195]
    ds_read_b128 a[160:163], v8 offset:8192
    v_cvt_pk_bf16_f32 v97, v98, v99
    v_mfma_f32_16x16x32_bf16 v[192:195], a[200:203], v[116:119], v[192:195]
    v_exp_f32 v100, v100
    v_mfma_f32_16x16x32_bf16 v[196:199], a[204:207], v[116:119], v[196:199]
    ds_read_b128 a[164:167], v9 offset:8192
    v_accvgpr_write_b32 a6, v62
    v_mfma_f32_16x16x32_bf16 v[196:199], a[208:211], v[112:115], v[196:199]
    v_exp_f32 v101, v101
    v_mfma_f32_16x16x32_bf16 v[200:203], a[212:215], v[112:115], v[200:203]
    ds_read_b128 a[168:171], v10 offset:8192
    v_cvt_pk_bf16_f32 v98, v100, v101
    v_mfma_f32_16x16x32_bf16 v[200:203], a[216:219], v[116:119], v[200:203]
    s_mov_b32 s31, 8192
    buffer_store_dwordx4 v[40:43], v23, s[20:23], s31 offen offset:2048 sc1
    v_exp_f32 v102, v102
    v_mfma_f32_16x16x32_bf16 v[204:207], a[220:223], v[116:119], v[204:207]
    ds_read_b128 a[172:175], v11 offset:8192
    v_accvgpr_write_b32 a7, v63
    v_mfma_f32_16x16x32_bf16 v[204:207], a[224:227], v[112:115], v[204:207]
    v_exp_f32 v103, v103
    v_mfma_f32_16x16x32_bf16 v[208:211], a[228:231], v[112:115], v[208:211]
    ds_read_b128 a[176:179], v11 offset:12288
    v_cvt_pk_bf16_f32 v99, v102, v103
    v_mfma_f32_16x16x32_bf16 v[208:211], a[232:235], v[116:119], v[208:211]
    v_exp_f32 v104, v104
    v_mfma_f32_16x16x32_bf16 v[212:215], a[236:239], v[116:119], v[212:215]
    ds_read_b128 a[180:183], v10 offset:12288
    v_cndmask_b32_dpp v92, v44, v52, vcc row_ror:8 row_mask:0xf bank_mask:0xf
    v_mfma_f32_16x16x32_bf16 v[212:215], a[240:243], v[112:115], v[212:215]
    v_exp_f32 v105, v105
    v_mfma_f32_16x16x32_bf16 v[216:219], a[244:247], v[112:115], v[216:219]
    ds_read_b128 a[184:187], v9 offset:12288
    v_cvt_pk_bf16_f32 v100, v104, v105
    v_mfma_f32_16x16x32_bf16 v[216:219], a[248:251], v[116:119], v[216:219]
    v_exp_f32 v106, v106
    v_mfma_f32_16x16x32_bf16 v[220:223], a[252:255], v[116:119], v[220:223]
    ds_read_b128 a[188:191], v8 offset:12288
    v_cndmask_b32_dpp v93, v45, v53, vcc row_ror:8 row_mask:0xf bank_mask:0xf
    v_mfma_f32_16x16x32_bf16 v[220:223], a[116:119], v[112:115], v[220:223]
    s_waitcnt lgkmcnt(5)
    ds_read_b64_tr_b16 a[112:113], v12 offset:49152
    ds_read_b64_tr_b16 a[114:115], v12 offset:53248
    v_mfma_f32_16x16x32_bf16 v[112:115], a[128:131], a[32:35], 0
    v_exp_f32 v107, v107
    v_mfma_f32_16x16x32_bf16 v[112:115], a[132:135], a[36:39], v[112:115]
    ds_read_b64_tr_b16 a[108:109], v12 offset:57344
    v_cvt_pk_bf16_f32 v101, v106, v107
    v_mfma_f32_16x16x32_bf16 v[112:115], a[136:139], a[40:43], v[112:115]
    v_exp_f32 v108, v108
    v_mfma_f32_16x16x32_bf16 v[112:115], a[140:143], a[44:47], v[112:115]
    ds_read_b64_tr_b16 a[110:111], v12 offset:61440
    ds_read_b64_tr_b16 a[104:105], v12 offset:57352
    v_mfma_f32_16x16x32_bf16 v[116:119], a[144:147], a[44:47], 0
    v_exp_f32 v109, v109
    v_mfma_f32_16x16x32_bf16 v[116:119], a[148:151], a[40:43], v[116:119]
    ds_read_b64_tr_b16 a[106:107], v12 offset:61448
    v_cvt_pk_bf16_f32 v102, v108, v109
    v_mfma_f32_16x16x32_bf16 v[116:119], a[152:155], a[36:39], v[116:119]
    v_exp_f32 v110, v110
    v_mfma_f32_16x16x32_bf16 v[116:119], a[156:159], a[32:35], v[116:119]
    ds_read_b64_tr_b16 a[100:101], v12 offset:49160
    v_cndmask_b32_dpp v94, v46, v54, vcc row_ror:8 row_mask:0xf bank_mask:0xf
    v_mfma_f32_16x16x32_bf16 v[120:123], a[160:163], a[32:35], 0
    v_exp_f32 v111, v111
    v_mfma_f32_16x16x32_bf16 v[120:123], a[164:167], a[36:39], v[120:123]
    ds_read_b64_tr_b16 a[102:103], v12 offset:53256
    v_cvt_pk_bf16_f32 v103, v110, v111
    v_mfma_f32_16x16x32_bf16 v[120:123], a[168:171], a[40:43], v[120:123]
    s_waitcnt lgkmcnt(6)
    v_exp_f32 v112, v112
    v_mfma_f32_16x16x32_bf16 v[120:123], a[172:175], a[44:47], v[120:123]
    ds_read_b64_tr_b16 a[96:97], v13 offset:49152
    v_cndmask_b32_dpp v95, v47, v55, vcc row_ror:8 row_mask:0xf bank_mask:0xf
    v_mfma_f32_16x16x32_bf16 v[124:127], a[176:179], a[44:47], 0
    v_exp_f32 v113, v113
    v_mfma_f32_16x16x32_bf16 v[124:127], a[180:183], a[40:43], v[124:127]
    ds_read_b64_tr_b16 a[98:99], v13 offset:53248
    v_cvt_pk_bf16_f32 v112, v112, v113
    v_mfma_f32_16x16x32_bf16 v[124:127], a[184:187], a[36:39], v[124:127]
    v_exp_f32 v114, v114
    v_mfma_f32_16x16x32_bf16 v[124:127], a[188:191], a[32:35], v[124:127]
    ds_read_b64_tr_b16 a[92:93], v13 offset:57344
    v_mov_b32_dpp v44, v52 row_ror:8 row_mask:0xf bank_mask:0x3
    v_smfmac_f32_16x16x64_bf16 v[28:31], a[124:127], v[96:103], v22
    v_exp_f32 v115, v115
    v_mfma_f32_16x16x32_bf16 v[224:227], a[196:199], v[96:99], v[224:227]
    ds_read_b64_tr_b16 a[94:95], v13 offset:61440
    v_cvt_pk_bf16_f32 v113, v114, v115
    v_mfma_f32_16x16x32_bf16 v[224:227], a[200:203], v[100:103], v[224:227]
    v_exp_f32 v116, v116
    v_mfma_f32_16x16x32_bf16 v[228:231], a[204:207], v[100:103], v[228:231]
    ds_read_b64_tr_b16 a[192:193], v13 offset:57352
    v_mov_b32_dpp v45, v53 row_ror:8 row_mask:0xf bank_mask:0x3
    v_mfma_f32_16x16x32_bf16 v[228:231], a[208:211], v[96:99], v[228:231]
    v_exp_f32 v117, v117
    v_mfma_f32_16x16x32_bf16 v[232:235], a[212:215], v[96:99], v[232:235]
    ds_read_b64_tr_b16 a[194:195], v13 offset:61448
    v_cvt_pk_bf16_f32 v114, v116, v117
    v_mfma_f32_16x16x32_bf16 v[232:235], a[216:219], v[100:103], v[232:235]
    v_exp_f32 v118, v118
    v_mfma_f32_16x16x32_bf16 v[236:239], a[220:223], v[100:103], v[236:239]
    ds_read_b64_tr_b16 a[196:197], v13 offset:49160
    v_mov_b32_dpp v46, v54 row_ror:8 row_mask:0xf bank_mask:0x3
    v_mfma_f32_16x16x32_bf16 v[236:239], a[224:227], v[96:99], v[236:239]
    v_exp_f32 v119, v119
    v_mfma_f32_16x16x32_bf16 v[240:243], a[228:231], v[96:99], v[240:243]
    ds_read_b64_tr_b16 a[198:199], v13 offset:53256
    v_cvt_pk_bf16_f32 v115, v118, v119
    v_mfma_f32_16x16x32_bf16 v[240:243], a[232:235], v[100:103], v[240:243]
    v_exp_f32 v120, v120
    v_mfma_f32_16x16x32_bf16 v[244:247], a[236:239], v[100:103], v[244:247]
    ds_read_b64_tr_b16 a[200:201], v14 offset:49152
    v_mov_b32_dpp v47, v55 row_ror:8 row_mask:0xf bank_mask:0x3
    v_mfma_f32_16x16x32_bf16 v[244:247], a[240:243], v[96:99], v[244:247]
    v_exp_f32 v121, v121
    v_mfma_f32_16x16x32_bf16 v[248:251], a[244:247], v[96:99], v[248:251]
    ds_read_b64_tr_b16 a[202:203], v14 offset:53248
    v_cvt_pk_bf16_f32 v116, v120, v121
    v_mfma_f32_16x16x32_bf16 v[248:251], a[248:251], v[100:103], v[248:251]
    v_exp_f32 v122, v122
    v_mfma_f32_16x16x32_bf16 v[252:255], a[252:255], v[100:103], v[252:255]
    ds_read_b64_tr_b16 a[204:205], v14 offset:57344
    v_lshlrev_b32 v0, 16, v56
    v_mfma_f32_16x16x32_bf16 v[252:255], a[116:119], v[96:99], v[252:255]
    ds_read_b64_tr_b16 a[206:207], v14 offset:61440
    v_lshlrev_b32 v1, 16, v57
    v_mfma_f32_16x16x32_bf16 v[96:99], a[128:131], a[48:51], 0
    v_exp_f32 v123, v123
    v_mfma_f32_16x16x32_bf16 v[96:99], a[132:135], a[52:55], v[96:99]
    ds_read_b64_tr_b16 a[208:209], v14 offset:57352
    v_cvt_pk_bf16_f32 v117, v122, v123
    v_mfma_f32_16x16x32_bf16 v[96:99], a[136:139], a[56:59], v[96:99]
    v_exp_f32 v124, v124
    v_mfma_f32_16x16x32_bf16 v[96:99], a[140:143], a[60:63], v[96:99]
    ds_read_b64_tr_b16 a[210:211], v14 offset:61448
    v_lshlrev_b32 v2, 16, v58
    v_mfma_f32_16x16x32_bf16 v[100:103], a[144:147], a[60:63], 0
    v_exp_f32 v125, v125
    v_mfma_f32_16x16x32_bf16 v[100:103], a[148:151], a[56:59], v[100:103]
    ds_read_b64_tr_b16 a[212:213], v14 offset:49160
    v_cvt_pk_bf16_f32 v118, v124, v125
    v_mfma_f32_16x16x32_bf16 v[100:103], a[152:155], a[52:55], v[100:103]
    v_exp_f32 v126, v126
    v_mfma_f32_16x16x32_bf16 v[100:103], a[156:159], a[48:51], v[100:103]
    ds_read_b64_tr_b16 a[214:215], v14 offset:53256
    v_lshlrev_b32 v3, 16, v59
    v_mfma_f32_16x16x32_bf16 v[104:107], a[160:163], a[48:51], 0
    v_exp_f32 v127, v127
    v_mfma_f32_16x16x32_bf16 v[104:107], a[164:167], a[52:55], v[104:107]
    ds_read_b64_tr_b16 a[216:217], v15 offset:49152
    v_cvt_pk_bf16_f32 v119, v126, v127
    v_mfma_f32_16x16x32_bf16 v[104:107], a[168:171], a[56:59], v[104:107]
    v_exp_f32 v96, v96
    v_mfma_f32_16x16x32_bf16 v[104:107], a[172:175], a[60:63], v[104:107]
    ds_read_b64_tr_b16 a[218:219], v15 offset:53248
    v_and_b32 v56, s25, v56
    v_and_b32 v57, s25, v57
    v_and_b32 v58, s25, v58
    v_and_b32 v59, s25, v59
    v_pk_mul_f32 v[0:1], v[0:1], s[34:35]
    v_pk_mul_f32 v[2:3], v[2:3], s[34:35]
    v_pk_mul_f32 v[56:57], v[56:57], s[34:35]
    v_pk_mul_f32 v[58:59], v[58:59], s[34:35]
    v_cvt_pk_bf16_f32 v56, v0, v56
    v_cvt_pk_bf16_f32 v57, v1, v57
    v_cvt_pk_bf16_f32 v58, v2, v58
    v_mfma_f32_16x16x32_bf16 v[108:111], a[176:179], a[60:63], 0
    v_exp_f32 v97, v97
    v_mfma_f32_16x16x32_bf16 v[108:111], a[180:183], a[56:59], v[108:111]
    ds_read_b64_tr_b16 a[220:221], v15 offset:57344
    v_cvt_pk_bf16_f32 v96, v96, v97
    v_mfma_f32_16x16x32_bf16 v[108:111], a[184:187], a[52:55], v[108:111]
    v_exp_f32 v98, v98
    v_mfma_f32_16x16x32_bf16 v[108:111], a[188:191], a[48:51], v[108:111]
    ds_read_b64_tr_b16 a[222:223], v15 offset:61440
    v_cvt_pk_bf16_f32 v59, v3, v59
    v_smfmac_f32_16x16x64_bf16 v[24:27], a[120:123], v[112:119], v22
    v_exp_f32 v99, v99
    v_mfma_f32_16x16x32_bf16 v[128:131], a[112:115], v[112:115], v[128:131]
    s_waitcnt lgkmcnt(2)
    ds_read_b64_tr_b16 a[224:225], v15 offset:57352
    v_cvt_pk_bf16_f32 v97, v98, v99
    v_mfma_f32_16x16x32_bf16 v[128:131], a[108:111], v[116:119], v[128:131]
    v_exp_f32 v100, v100
    v_mfma_f32_16x16x32_bf16 v[132:135], a[104:107], v[116:119], v[132:135]
    ds_read_b64_tr_b16 a[226:227], v15 offset:61448
    v_accvgpr_write_b32 a8, v56
    v_mfma_f32_16x16x32_bf16 v[132:135], a[100:103], v[112:115], v[132:135]
    v_exp_f32 v101, v101
    v_mfma_f32_16x16x32_bf16 v[136:139], a[96:99], v[112:115], v[136:139]
    ds_read_b64_tr_b16 a[228:229], v15 offset:49160
    v_cvt_pk_bf16_f32 v98, v100, v101
    v_mfma_f32_16x16x32_bf16 v[136:139], a[92:95], v[116:119], v[136:139]
    v_exp_f32 v102, v102
    v_mfma_f32_16x16x32_bf16 v[140:143], a[192:195], v[116:119], v[140:143]
    ds_read_b64_tr_b16 a[230:231], v15 offset:53256
    v_accvgpr_write_b32 a9, v57
    v_mfma_f32_16x16x32_bf16 v[140:143], a[196:199], v[112:115], v[140:143]
    v_exp_f32 v103, v103
    v_mfma_f32_16x16x32_bf16 v[144:147], a[200:203], v[112:115], v[144:147]
    v_cvt_pk_bf16_f32 v99, v102, v103
    v_accvgpr_write_b32 a10, v58
    v_mfma_f32_16x16x32_bf16 v[144:147], a[204:207], v[116:119], v[144:147]
    v_exp_f32 v104, v104
    v_mfma_f32_16x16x32_bf16 v[148:151], a[208:211], v[116:119], v[148:151]
    s_waitcnt vmcnt(15)
    v_accvgpr_write_b32 a11, v59
    v_lshlrev_b32 v0, 16, v72
    v_mfma_f32_16x16x32_bf16 v[148:151], a[212:215], v[112:115], v[148:151]
    v_exp_f32 v105, v105
    v_mfma_f32_16x16x32_bf16 v[152:155], a[216:219], v[112:115], v[152:155]
    s_waitcnt lgkmcnt(2)
    v_cvt_pk_bf16_f32 v100, v104, v105
    v_lshlrev_b32 v1, 16, v73
    v_mfma_f32_16x16x32_bf16 v[152:155], a[220:223], v[116:119], v[152:155]
    v_exp_f32 v106, v106
    v_mfma_f32_16x16x32_bf16 v[156:159], a[224:227], v[116:119], v[156:159]
    s_waitcnt lgkmcnt(0)
    v_lshlrev_b32 v2, 16, v74
    v_lshlrev_b32 v3, 16, v75
    v_mfma_f32_16x16x32_bf16 v[156:159], a[228:231], v[112:115], v[156:159]
    s_waitcnt vmcnt(4)
    v_and_b32 v72, s25, v72
    v_and_b32 v73, s25, v73
    v_mfma_f32_16x16x32_bf16 v[112:115], a[128:131], a[64:67], 0
    s_barrier
    v_exp_f32 v107, v107
    v_mfma_f32_16x16x32_bf16 v[112:115], a[132:135], a[68:71], v[112:115]
    s_add_u32 s29, s27, 98304
    v_cvt_pk_bf16_f32 v101, v106, v107
    v_and_b32 v74, s25, v74
    v_mfma_f32_16x16x32_bf16 v[112:115], a[136:139], a[72:75], v[112:115]
    s_add_u32 m0, s27, 147456
    v_exp_f32 v108, v108
    v_mfma_f32_16x16x32_bf16 v[112:115], a[140:143], a[76:79], v[112:115]
    buffer_load_dwordx4 v18, s[52:55], s29 offen lds
    v_mfma_f32_16x16x32_bf16 v[116:119], a[144:147], a[76:79], 0
    v_exp_f32 v109, v109
    v_mfma_f32_16x16x32_bf16 v[116:119], a[148:151], a[72:75], v[116:119]
    v_cvt_pk_bf16_f32 v102, v108, v109
    v_and_b32 v75, s25, v75
    v_mfma_f32_16x16x32_bf16 v[116:119], a[152:155], a[68:71], v[116:119]
    v_exp_f32 v110, v110
    v_mfma_f32_16x16x32_bf16 v[116:119], a[156:159], a[64:67], v[116:119]
    buffer_load_dwordx4 v18, s[52:55], s29 offen offset:1024 lds
    v_mfma_f32_16x16x32_bf16 v[120:123], a[160:163], a[64:67], 0
    v_exp_f32 v111, v111
    v_mfma_f32_16x16x32_bf16 v[120:123], a[164:167], a[68:71], v[120:123]
    v_cvt_pk_bf16_f32 v103, v110, v111
    v_mul_f32 v0, s24, v0
    v_mfma_f32_16x16x32_bf16 v[120:123], a[168:171], a[72:75], v[120:123]
    v_exp_f32 v112, v112
    v_mfma_f32_16x16x32_bf16 v[120:123], a[172:175], a[76:79], v[120:123]
    buffer_load_dwordx4 v18, s[52:55], s29 offen offset:2048 lds
    v_mfma_f32_16x16x32_bf16 v[124:127], a[176:179], a[76:79], 0
    v_exp_f32 v113, v113
    v_mfma_f32_16x16x32_bf16 v[124:127], a[180:183], a[72:75], v[124:127]
    v_cvt_pk_bf16_f32 v112, v112, v113
    v_mul_f32 v1, s24, v1
    v_mfma_f32_16x16x32_bf16 v[124:127], a[184:187], a[68:71], v[124:127]
    v_exp_f32 v114, v114
    v_mfma_f32_16x16x32_bf16 v[124:127], a[188:191], a[64:67], v[124:127]
    buffer_load_dwordx4 v18, s[52:55], s29 offen offset:3072 lds
    v_smfmac_f32_16x16x64_bf16 v[24:27], a[124:127], v[96:103], v22
    v_exp_f32 v115, v115
    v_mfma_f32_16x16x32_bf16 v[160:163], a[112:115], v[96:99], v[160:163]
    v_cvt_pk_bf16_f32 v113, v114, v115
    v_mul_f32 v2, s24, v2
    v_mfma_f32_16x16x32_bf16 v[160:163], a[108:111], v[100:103], v[160:163]
    v_exp_f32 v116, v116
    v_mfma_f32_16x16x32_bf16 v[164:167], a[104:107], v[100:103], v[164:167]
    s_mov_b32 s30, 69632
    buffer_load_dwordx4 v[76:79], v16, s[44:47], s30 offen offset:128 nt
    v_mfma_f32_16x16x32_bf16 v[164:167], a[100:103], v[96:99], v[164:167]
    v_exp_f32 v117, v117
    v_mfma_f32_16x16x32_bf16 v[168:171], a[96:99], v[96:99], v[168:171]
    v_cvt_pk_bf16_f32 v114, v116, v117
    v_mul_f32 v3, s24, v3
    v_mfma_f32_16x16x32_bf16 v[168:171], a[92:95], v[100:103], v[168:171]
    v_exp_f32 v118, v118
    v_mfma_f32_16x16x32_bf16 v[172:175], a[192:195], v[100:103], v[172:175]
    v_mul_f32 v72, s24, v72
    v_mul_f32 v73, s24, v73
    v_mfma_f32_16x16x32_bf16 v[172:175], a[196:199], v[96:99], v[172:175]
    v_exp_f32 v119, v119
    v_mfma_f32_16x16x32_bf16 v[176:179], a[200:203], v[96:99], v[176:179]
    v_cvt_pk_bf16_f32 v115, v118, v119
    v_mul_f32 v74, s24, v74
    v_mfma_f32_16x16x32_bf16 v[176:179], a[204:207], v[100:103], v[176:179]
    v_exp_f32 v120, v120
    v_mfma_f32_16x16x32_bf16 v[180:183], a[208:211], v[100:103], v[180:183]
    v_mul_f32 v75, s24, v75
    v_cvt_pk_bf16_f32 v72, v0, v72
    v_mfma_f32_16x16x32_bf16 v[180:183], a[212:215], v[96:99], v[180:183]
    v_exp_f32 v121, v121
    v_mfma_f32_16x16x32_bf16 v[184:187], a[216:219], v[96:99], v[184:187]
    v_cvt_pk_bf16_f32 v116, v120, v121
    v_cvt_pk_bf16_f32 v73, v1, v73
    v_mfma_f32_16x16x32_bf16 v[184:187], a[220:223], v[100:103], v[184:187]
    v_exp_f32 v122, v122
    v_mfma_f32_16x16x32_bf16 v[188:191], a[224:227], v[100:103], v[188:191]
    s_mov_b32 s31, 8192
    buffer_store_dwordx4 v[92:95], v23, s[20:23], s31 offen offset:128 sc1
    v_mfma_f32_16x16x32_bf16 v[188:191], a[228:231], v[96:99], v[188:191]
    v_cvt_pk_bf16_f32 v74, v2, v74
    v_cvt_pk_bf16_f32 v75, v3, v75
    v_mfma_f32_16x16x32_bf16 v[96:99], a[128:131], a[80:83], 0
    v_exp_f32 v123, v123
    v_mfma_f32_16x16x32_bf16 v[96:99], a[132:135], a[84:87], v[96:99]
    ds_read_b128 a[128:131], v8 offset:16384
    v_cvt_pk_bf16_f32 v117, v122, v123
    v_mfma_f32_16x16x32_bf16 v[96:99], a[136:139], a[88:91], v[96:99]
    v_exp_f32 v124, v124
    v_mfma_f32_16x16x32_bf16 v[96:99], a[140:143], a[0:3], v[96:99]
    ds_read_b128 a[132:135], v9 offset:16384
    v_accvgpr_write_b32 a12, v72
    v_mfma_f32_16x16x32_bf16 v[100:103], a[144:147], a[0:3], 0
    v_exp_f32 v125, v125
    v_mfma_f32_16x16x32_bf16 v[100:103], a[148:151], a[88:91], v[100:103]
    ds_read_b128 a[136:139], v10 offset:16384
    v_cvt_pk_bf16_f32 v118, v124, v125
    v_mfma_f32_16x16x32_bf16 v[100:103], a[152:155], a[84:87], v[100:103]
    v_exp_f32 v126, v126
    v_mfma_f32_16x16x32_bf16 v[100:103], a[156:159], a[80:83], v[100:103]
    ds_read_b128 a[140:143], v11 offset:16384
    v_accvgpr_write_b32 a13, v73
    v_mfma_f32_16x16x32_bf16 v[104:107], a[160:163], a[80:83], 0
    v_exp_f32 v127, v127
    v_mfma_f32_16x16x32_bf16 v[104:107], a[164:167], a[84:87], v[104:107]
    ds_read_b128 a[144:147], v11 offset:20480
    v_cvt_pk_bf16_f32 v119, v126, v127
    v_mfma_f32_16x16x32_bf16 v[104:107], a[168:171], a[88:91], v[104:107]
    s_mov_b32 s30, 69632
    buffer_load_dwordx4 v[64:67], v16, s[44:47], s30 offen offset:192 nt
    v_exp_f32 v96, v96
    v_mfma_f32_16x16x32_bf16 v[104:107], a[172:175], a[0:3], v[104:107]
    ds_read_b128 a[148:151], v10 offset:20480
    v_accvgpr_write_b32 a14, v74
    v_mfma_f32_16x16x32_bf16 v[108:111], a[176:179], a[0:3], 0
    v_exp_f32 v97, v97
    v_mfma_f32_16x16x32_bf16 v[108:111], a[180:183], a[88:91], v[108:111]
    ds_read_b128 a[152:155], v9 offset:20480
    v_cvt_pk_bf16_f32 v96, v96, v97
    v_mfma_f32_16x16x32_bf16 v[108:111], a[184:187], a[84:87], v[108:111]
    v_exp_f32 v98, v98
    v_mfma_f32_16x16x32_bf16 v[108:111], a[188:191], a[80:83], v[108:111]
    ds_read_b128 a[156:159], v8 offset:20480
    v_accvgpr_write_b32 a15, v75
    v_smfmac_f32_16x16x64_bf16 v[28:31], a[120:123], v[112:119], v22
    v_exp_f32 v99, v99
    v_mfma_f32_16x16x32_bf16 v[192:195], a[112:115], v[112:115], v[192:195]
    ds_read_b128 a[160:163], v8 offset:24576
    v_cvt_pk_bf16_f32 v97, v98, v99
    v_mfma_f32_16x16x32_bf16 v[192:195], a[108:111], v[116:119], v[192:195]
    v_exp_f32 v100, v100
    v_mfma_f32_16x16x32_bf16 v[196:199], a[104:107], v[116:119], v[196:199]
    ds_read_b128 a[164:167], v9 offset:24576
    v_cndmask_b32_dpp v40, v32, v80, vcc row_ror:8 row_mask:0xf bank_mask:0xf
    v_mfma_f32_16x16x32_bf16 v[196:199], a[100:103], v[112:115], v[196:199]
    v_exp_f32 v101, v101
    v_mfma_f32_16x16x32_bf16 v[200:203], a[96:99], v[112:115], v[200:203]
    ds_read_b128 a[168:171], v10 offset:24576
    v_cvt_pk_bf16_f32 v98, v100, v101
    v_mfma_f32_16x16x32_bf16 v[200:203], a[92:95], v[116:119], v[200:203]
    s_mov_b32 s31, 8192
    buffer_store_dwordx4 v[44:47], v23, s[20:23], s31 offen offset:2176 sc1
    v_exp_f32 v102, v102
    v_mfma_f32_16x16x32_bf16 v[204:207], a[192:195], v[116:119], v[204:207]
    ds_read_b128 a[172:175], v11 offset:24576
    v_cndmask_b32_dpp v41, v33, v81, vcc row_ror:8 row_mask:0xf bank_mask:0xf
    v_mfma_f32_16x16x32_bf16 v[204:207], a[196:199], v[112:115], v[204:207]
    v_exp_f32 v103, v103
    v_mfma_f32_16x16x32_bf16 v[208:211], a[200:203], v[112:115], v[208:211]
    ds_read_b128 a[176:179], v11 offset:28672
    v_cvt_pk_bf16_f32 v99, v102, v103
    v_mfma_f32_16x16x32_bf16 v[208:211], a[204:207], v[116:119], v[208:211]
    v_exp_f32 v104, v104
    v_mfma_f32_16x16x32_bf16 v[212:215], a[208:211], v[116:119], v[212:215]
    ds_read_b128 a[180:183], v10 offset:28672
    v_cndmask_b32_dpp v42, v34, v82, vcc row_ror:8 row_mask:0xf bank_mask:0xf
    v_mfma_f32_16x16x32_bf16 v[212:215], a[212:215], v[112:115], v[212:215]
    v_exp_f32 v105, v105
    v_mfma_f32_16x16x32_bf16 v[216:219], a[216:219], v[112:115], v[216:219]
    ds_read_b128 a[184:187], v9 offset:28672
    v_cvt_pk_bf16_f32 v100, v104, v105
    v_mfma_f32_16x16x32_bf16 v[216:219], a[220:223], v[116:119], v[216:219]
    v_exp_f32 v106, v106
    v_mfma_f32_16x16x32_bf16 v[220:223], a[224:227], v[116:119], v[220:223]
    ds_read_b128 a[188:191], v8 offset:28672
    v_cndmask_b32_dpp v43, v35, v83, vcc row_ror:8 row_mask:0xf bank_mask:0xf
    v_mfma_f32_16x16x32_bf16 v[220:223], a[228:231], v[112:115], v[220:223]
    s_waitcnt lgkmcnt(5)
    ds_read_b64_tr_b16 a[232:233], v12 offset:32768
    ds_read_b64_tr_b16 a[234:235], v12 offset:36864
    v_mfma_f32_16x16x32_bf16 v[112:115], a[128:131], a[32:35], 0
    v_exp_f32 v107, v107
    v_mfma_f32_16x16x32_bf16 v[112:115], a[132:135], a[36:39], v[112:115]
    ds_read_b64_tr_b16 a[236:237], v12 offset:40960
    v_cvt_pk_bf16_f32 v101, v106, v107
    v_mfma_f32_16x16x32_bf16 v[112:115], a[136:139], a[40:43], v[112:115]
    v_exp_f32 v108, v108
    v_mfma_f32_16x16x32_bf16 v[112:115], a[140:143], a[44:47], v[112:115]
    ds_read_b64_tr_b16 a[238:239], v12 offset:45056
    ds_read_b64_tr_b16 a[240:241], v12 offset:40968
    v_mfma_f32_16x16x32_bf16 v[116:119], a[144:147], a[44:47], 0
    v_exp_f32 v109, v109
    v_mfma_f32_16x16x32_bf16 v[116:119], a[148:151], a[40:43], v[116:119]
    ds_read_b64_tr_b16 a[242:243], v12 offset:45064
    v_cvt_pk_bf16_f32 v102, v108, v109
    v_mfma_f32_16x16x32_bf16 v[116:119], a[152:155], a[36:39], v[116:119]
    v_exp_f32 v110, v110
    v_mfma_f32_16x16x32_bf16 v[116:119], a[156:159], a[32:35], v[116:119]
    ds_read_b64_tr_b16 a[244:245], v12 offset:32776
    v_mov_b32_dpp v32, v80 row_ror:8 row_mask:0xf bank_mask:0x3
    v_mfma_f32_16x16x32_bf16 v[120:123], a[160:163], a[32:35], 0
    v_exp_f32 v111, v111
    v_mfma_f32_16x16x32_bf16 v[120:123], a[164:167], a[36:39], v[120:123]
    ds_read_b64_tr_b16 a[246:247], v12 offset:36872
    v_cvt_pk_bf16_f32 v103, v110, v111
    v_mfma_f32_16x16x32_bf16 v[120:123], a[168:171], a[40:43], v[120:123]
    s_waitcnt lgkmcnt(6)
    v_exp_f32 v112, v112
    v_mfma_f32_16x16x32_bf16 v[120:123], a[172:175], a[44:47], v[120:123]
    ds_read_b64_tr_b16 a[248:249], v13 offset:32768
    v_mov_b32_dpp v33, v81 row_ror:8 row_mask:0xf bank_mask:0x3
    v_mfma_f32_16x16x32_bf16 v[124:127], a[176:179], a[44:47], 0
    v_exp_f32 v113, v113
    v_mfma_f32_16x16x32_bf16 v[124:127], a[180:183], a[40:43], v[124:127]
    ds_read_b64_tr_b16 a[250:251], v13 offset:36864
    v_cvt_pk_bf16_f32 v112, v112, v113
    v_mfma_f32_16x16x32_bf16 v[124:127], a[184:187], a[36:39], v[124:127]
    v_exp_f32 v114, v114
    v_mfma_f32_16x16x32_bf16 v[124:127], a[188:191], a[32:35], v[124:127]
    ds_read_b64_tr_b16 a[252:253], v13 offset:40960
    v_mov_b32_dpp v34, v82 row_ror:8 row_mask:0xf bank_mask:0x3
    v_smfmac_f32_16x16x64_bf16 v[28:31], a[124:127], v[96:103], v22
    v_exp_f32 v115, v115
    v_mfma_f32_16x16x32_bf16 v[224:227], a[112:115], v[96:99], v[224:227]
    ds_read_b64_tr_b16 a[254:255], v13 offset:45056
    v_cvt_pk_bf16_f32 v113, v114, v115
    v_mfma_f32_16x16x32_bf16 v[224:227], a[108:111], v[100:103], v[224:227]
    v_exp_f32 v116, v116
    v_mfma_f32_16x16x32_bf16 v[228:231], a[104:107], v[100:103], v[228:231]
    ds_read_b64_tr_b16 a[116:117], v13 offset:40968
    v_mov_b32_dpp v35, v83 row_ror:8 row_mask:0xf bank_mask:0x3
    v_mfma_f32_16x16x32_bf16 v[228:231], a[100:103], v[96:99], v[228:231]
    v_exp_f32 v117, v117
    v_mfma_f32_16x16x32_bf16 v[232:235], a[96:99], v[96:99], v[232:235]
    ds_read_b64_tr_b16 a[118:119], v13 offset:45064
    v_cvt_pk_bf16_f32 v114, v116, v117
    v_mfma_f32_16x16x32_bf16 v[232:235], a[92:95], v[100:103], v[232:235]
    v_exp_f32 v118, v118
    v_mfma_f32_16x16x32_bf16 v[236:239], a[192:195], v[100:103], v[236:239]
    ds_read_b64_tr_b16 a[112:113], v13 offset:32776
    v_lshlrev_b32 v0, 16, v84
    v_mfma_f32_16x16x32_bf16 v[236:239], a[196:199], v[96:99], v[236:239]
    v_exp_f32 v119, v119
    v_mfma_f32_16x16x32_bf16 v[240:243], a[200:203], v[96:99], v[240:243]
    ds_read_b64_tr_b16 a[114:115], v13 offset:36872
    v_cvt_pk_bf16_f32 v115, v118, v119
    v_mfma_f32_16x16x32_bf16 v[240:243], a[204:207], v[100:103], v[240:243]
    v_exp_f32 v120, v120
    v_mfma_f32_16x16x32_bf16 v[244:247], a[208:211], v[100:103], v[244:247]
    ds_read_b64_tr_b16 a[108:109], v14 offset:32768
    v_lshlrev_b32 v1, 16, v85
    v_mfma_f32_16x16x32_bf16 v[244:247], a[212:215], v[96:99], v[244:247]
    v_exp_f32 v121, v121
    v_mfma_f32_16x16x32_bf16 v[248:251], a[216:219], v[96:99], v[248:251]
    ds_read_b64_tr_b16 a[110:111], v14 offset:36864
    v_cvt_pk_bf16_f32 v116, v120, v121
    v_mfma_f32_16x16x32_bf16 v[248:251], a[220:223], v[100:103], v[248:251]
    v_exp_f32 v122, v122
    v_mfma_f32_16x16x32_bf16 v[252:255], a[224:227], v[100:103], v[252:255]
    ds_read_b64_tr_b16 a[104:105], v14 offset:40960
    v_lshlrev_b32 v2, 16, v86
    v_mfma_f32_16x16x32_bf16 v[252:255], a[228:231], v[96:99], v[252:255]
    ds_read_b64_tr_b16 a[106:107], v14 offset:45056
    v_lshlrev_b32 v3, 16, v87
    v_mfma_f32_16x16x32_bf16 v[96:99], a[128:131], a[48:51], 0
    v_exp_f32 v123, v123
    v_mfma_f32_16x16x32_bf16 v[96:99], a[132:135], a[52:55], v[96:99]
    ds_read_b64_tr_b16 a[100:101], v14 offset:40968
    v_cvt_pk_bf16_f32 v117, v122, v123
    v_mfma_f32_16x16x32_bf16 v[96:99], a[136:139], a[56:59], v[96:99]
    v_exp_f32 v124, v124
    v_mfma_f32_16x16x32_bf16 v[96:99], a[140:143], a[60:63], v[96:99]
    ds_read_b64_tr_b16 a[102:103], v14 offset:45064
    v_and_b32 v84, s25, v84
    v_mfma_f32_16x16x32_bf16 v[100:103], a[144:147], a[60:63], 0
    v_exp_f32 v125, v125
    v_mfma_f32_16x16x32_bf16 v[100:103], a[148:151], a[56:59], v[100:103]
    ds_read_b64_tr_b16 a[96:97], v14 offset:32776
    v_cvt_pk_bf16_f32 v118, v124, v125
    v_mfma_f32_16x16x32_bf16 v[100:103], a[152:155], a[52:55], v[100:103]
    v_exp_f32 v126, v126
    v_mfma_f32_16x16x32_bf16 v[100:103], a[156:159], a[48:51], v[100:103]
    ds_read_b64_tr_b16 a[98:99], v14 offset:36872
    v_and_b32 v85, s25, v85
    v_mfma_f32_16x16x32_bf16 v[104:107], a[160:163], a[48:51], 0
    v_exp_f32 v127, v127
    v_mfma_f32_16x16x32_bf16 v[104:107], a[164:167], a[52:55], v[104:107]
    ds_read_b64_tr_b16 a[92:93], v15 offset:32768
    v_cvt_pk_bf16_f32 v119, v126, v127
    v_mfma_f32_16x16x32_bf16 v[104:107], a[168:171], a[56:59], v[104:107]
    v_exp_f32 v96, v96
    v_mfma_f32_16x16x32_bf16 v[104:107], a[172:175], a[60:63], v[104:107]
    ds_read_b64_tr_b16 a[94:95], v15 offset:36864
    v_and_b32 v86, s25, v86
    v_mfma_f32_16x16x32_bf16 v[108:111], a[176:179], a[60:63], 0
    v_exp_f32 v97, v97
    v_mfma_f32_16x16x32_bf16 v[108:111], a[180:183], a[56:59], v[108:111]
    ds_read_b64_tr_b16 a[192:193], v15 offset:40960
    v_cvt_pk_bf16_f32 v96, v96, v97
    v_mfma_f32_16x16x32_bf16 v[108:111], a[184:187], a[52:55], v[108:111]
    v_exp_f32 v98, v98
    v_mfma_f32_16x16x32_bf16 v[108:111], a[188:191], a[48:51], v[108:111]
    ds_read_b64_tr_b16 a[194:195], v15 offset:45056
    v_and_b32 v87, s25, v87
    v_smfmac_f32_16x16x64_bf16 v[24:27], a[120:123], v[112:119], v22
    v_exp_f32 v99, v99
    v_mfma_f32_16x16x32_bf16 v[128:131], a[232:235], v[112:115], v[128:131]
    s_waitcnt lgkmcnt(4)
    ds_read_b64_tr_b16 a[196:197], v15 offset:40968
    v_cvt_pk_bf16_f32 v97, v98, v99
    v_mfma_f32_16x16x32_bf16 v[128:131], a[236:239], v[116:119], v[128:131]
    v_exp_f32 v100, v100
    v_mfma_f32_16x16x32_bf16 v[132:135], a[240:243], v[116:119], v[132:135]
    ds_read_b64_tr_b16 a[198:199], v15 offset:45064
    v_mul_f32 v0, s24, v0
    v_mfma_f32_16x16x32_bf16 v[132:135], a[244:247], v[112:115], v[132:135]
    v_exp_f32 v101, v101
    v_mfma_f32_16x16x32_bf16 v[136:139], a[248:251], v[112:115], v[136:139]
    ds_read_b64_tr_b16 a[200:201], v15 offset:32776
    v_cvt_pk_bf16_f32 v98, v100, v101
    v_mfma_f32_16x16x32_bf16 v[136:139], a[252:255], v[116:119], v[136:139]
    v_exp_f32 v102, v102
    v_mfma_f32_16x16x32_bf16 v[140:143], a[116:119], v[116:119], v[140:143]
    ds_read_b64_tr_b16 a[202:203], v15 offset:36872
    v_mul_f32 v1, s24, v1
    v_mfma_f32_16x16x32_bf16 v[140:143], a[112:115], v[112:115], v[140:143]
Lpad8:
    s_cbranch_execz Lpad12
    v_exp_f32 v103, v103
    v_mfma_f32_16x16x32_bf16 v[144:147], a[108:111], v[112:115], v[144:147]
    v_cvt_pk_bf16_f32 v99, v102, v103
    v_mul_f32 v2, s24, v2
    v_mfma_f32_16x16x32_bf16 v[144:147], a[104:107], v[116:119], v[144:147]
    v_exp_f32 v104, v104
    v_mfma_f32_16x16x32_bf16 v[148:151], a[100:103], v[116:119], v[148:151]
    v_mul_f32 v3, s24, v3
    v_mul_f32 v84, s24, v84
    v_mfma_f32_16x16x32_bf16 v[148:151], a[96:99], v[112:115], v[148:151]
    s_waitcnt lgkmcnt(3)
    v_exp_f32 v105, v105
    v_mfma_f32_16x16x32_bf16 v[152:155], a[92:95], v[112:115], v[152:155]
    v_cvt_pk_bf16_f32 v100, v104, v105
    v_mul_f32 v85, s24, v85
    v_mfma_f32_16x16x32_bf16 v[152:155], a[192:195], v[116:119], v[152:155]
    s_waitcnt lgkmcnt(1)
    v_exp_f32 v106, v106
    v_mfma_f32_16x16x32_bf16 v[156:159], a[196:199], v[116:119], v[156:159]
    s_waitcnt lgkmcnt(0)
    v_mul_f32 v86, s24, v86
    v_mul_f32 v87, s24, v87
    v_mfma_f32_16x16x32_bf16 v[156:159], a[200:203], v[112:115], v[156:159]
    s_waitcnt vmcnt(4)
    v_cvt_pk_bf16_f32 v84, v0, v84
    v_cvt_pk_bf16_f32 v85, v1, v85
    v_mfma_f32_16x16x32_bf16 v[112:115], a[128:131], a[64:67], 0
    s_barrier
    v_exp_f32 v107, v107
    v_mfma_f32_16x16x32_bf16 v[112:115], a[132:135], a[68:71], v[112:115]
    s_add_u32 s29, s27, 114688
    v_cvt_pk_bf16_f32 v101, v106, v107
    v_cvt_pk_bf16_f32 v86, v2, v86
    v_mfma_f32_16x16x32_bf16 v[112:115], a[136:139], a[72:75], v[112:115]
    s_add_u32 m0, s27, 131072
    v_exp_f32 v108, v108
    v_mfma_f32_16x16x32_bf16 v[112:115], a[140:143], a[76:79], v[112:115]
    buffer_load_dwordx4 v18, s[52:55], s29 offen lds
    v_mfma_f32_16x16x32_bf16 v[116:119], a[144:147], a[76:79], 0
    v_exp_f32 v109, v109
    v_mfma_f32_16x16x32_bf16 v[116:119], a[148:151], a[72:75], v[116:119]
    v_cvt_pk_bf16_f32 v102, v108, v109
    v_cvt_pk_bf16_f32 v87, v3, v87
    v_mfma_f32_16x16x32_bf16 v[116:119], a[152:155], a[68:71], v[116:119]
    v_exp_f32 v110, v110
    v_mfma_f32_16x16x32_bf16 v[116:119], a[156:159], a[64:67], v[116:119]
    buffer_load_dwordx4 v18, s[52:55], s29 offen offset:1024 lds
    v_mfma_f32_16x16x32_bf16 v[120:123], a[160:163], a[64:67], 0
    v_exp_f32 v111, v111
    v_mfma_f32_16x16x32_bf16 v[120:123], a[164:167], a[68:71], v[120:123]
    v_cvt_pk_bf16_f32 v103, v110, v111
    v_accvgpr_write_b32 a16, v84
    v_mfma_f32_16x16x32_bf16 v[120:123], a[168:171], a[72:75], v[120:123]
    v_exp_f32 v112, v112
    v_mfma_f32_16x16x32_bf16 v[120:123], a[172:175], a[76:79], v[120:123]
    buffer_load_dwordx4 v18, s[52:55], s29 offen offset:2048 lds
    v_mfma_f32_16x16x32_bf16 v[124:127], a[176:179], a[76:79], 0
    v_exp_f32 v113, v113
    v_mfma_f32_16x16x32_bf16 v[124:127], a[180:183], a[72:75], v[124:127]
    v_cvt_pk_bf16_f32 v112, v112, v113
    v_accvgpr_write_b32 a17, v85
    v_mfma_f32_16x16x32_bf16 v[124:127], a[184:187], a[68:71], v[124:127]
    v_exp_f32 v114, v114
    v_mfma_f32_16x16x32_bf16 v[124:127], a[188:191], a[64:67], v[124:127]
    buffer_load_dwordx4 v18, s[52:55], s29 offen offset:3072 lds
    v_smfmac_f32_16x16x64_bf16 v[24:27], a[124:127], v[96:103], v22
    v_exp_f32 v115, v115
    v_mfma_f32_16x16x32_bf16 v[160:163], a[232:235], v[96:99], v[160:163]
    v_cvt_pk_bf16_f32 v113, v114, v115
    v_accvgpr_write_b32 a18, v86
    v_mfma_f32_16x16x32_bf16 v[160:163], a[236:239], v[100:103], v[160:163]
    v_exp_f32 v116, v116
    v_mfma_f32_16x16x32_bf16 v[164:167], a[240:243], v[100:103], v[164:167]
    s_mov_b32 s30, 73728
    buffer_load_dwordx4 v[60:63], v16, s[44:47], s30 offen nt
    v_mfma_f32_16x16x32_bf16 v[164:167], a[244:247], v[96:99], v[164:167]
    v_exp_f32 v117, v117
    v_mfma_f32_16x16x32_bf16 v[168:171], a[248:251], v[96:99], v[168:171]
    v_cvt_pk_bf16_f32 v114, v116, v117
    v_accvgpr_write_b32 a19, v87
    v_mfma_f32_16x16x32_bf16 v[168:171], a[252:255], v[100:103], v[168:171]
    v_exp_f32 v118, v118
    v_mfma_f32_16x16x32_bf16 v[172:175], a[116:119], v[100:103], v[172:175]
    v_lshlrev_b32 v0, 16, v88
    v_lshlrev_b32 v1, 16, v89
    v_mfma_f32_16x16x32_bf16 v[172:175], a[112:115], v[96:99], v[172:175]
    v_exp_f32 v119, v119
    v_mfma_f32_16x16x32_bf16 v[176:179], a[108:111], v[96:99], v[176:179]
    v_cvt_pk_bf16_f32 v115, v118, v119
    v_lshlrev_b32 v2, 16, v90
    v_mfma_f32_16x16x32_bf16 v[176:179], a[104:107], v[100:103], v[176:179]
    v_exp_f32 v120, v120
    v_mfma_f32_16x16x32_bf16 v[180:183], a[100:103], v[100:103], v[180:183]
    v_lshlrev_b32 v3, 16, v91
    v_and_b32 v88, s25, v88
    v_mfma_f32_16x16x32_bf16 v[180:183], a[96:99], v[96:99], v[180:183]
    v_exp_f32 v121, v121
    v_mfma_f32_16x16x32_bf16 v[184:187], a[92:95], v[96:99], v[184:187]
    v_cvt_pk_bf16_f32 v116, v120, v121
    v_and_b32 v89, s25, v89
    v_mfma_f32_16x16x32_bf16 v[184:187], a[192:195], v[100:103], v[184:187]
    v_exp_f32 v122, v122
    v_mfma_f32_16x16x32_bf16 v[188:191], a[196:199], v[100:103], v[188:191]
    s_mov_b32 s31, 12288
    buffer_store_dwordx4 v[40:43], v23, s[20:23], s31 offen offset:0 sc1
    v_mfma_f32_16x16x32_bf16 v[188:191], a[200:203], v[96:99], v[188:191]
    v_and_b32 v90, s25, v90
    v_and_b32 v91, s25, v91
    v_mfma_f32_16x16x32_bf16 v[96:99], a[128:131], a[80:83], 0
    v_exp_f32 v123, v123
    v_mfma_f32_16x16x32_bf16 v[96:99], a[132:135], a[84:87], v[96:99]
    ds_read_b128 a[128:131], v8 offset:32768
    v_cvt_pk_bf16_f32 v117, v122, v123
    v_mfma_f32_16x16x32_bf16 v[96:99], a[136:139], a[88:91], v[96:99]
    v_exp_f32 v124, v124
    v_mfma_f32_16x16x32_bf16 v[96:99], a[140:143], a[0:3], v[96:99]
    ds_read_b128 a[132:135], v9 offset:32768
    v_mul_f32 v0, s24, v0
    v_mfma_f32_16x16x32_bf16 v[100:103], a[144:147], a[0:3], 0
    v_exp_f32 v125, v125
    v_mfma_f32_16x16x32_bf16 v[100:103], a[148:151], a[88:91], v[100:103]
    ds_read_b128 a[136:139], v10 offset:32768
    v_cvt_pk_bf16_f32 v118, v124, v125
    v_mfma_f32_16x16x32_bf16 v[100:103], a[152:155], a[84:87], v[100:103]
    v_exp_f32 v126, v126
    v_mfma_f32_16x16x32_bf16 v[100:103], a[156:159], a[80:83], v[100:103]
    ds_read_b128 a[140:143], v11 offset:32768
    v_mul_f32 v1, s24, v1
    v_mfma_f32_16x16x32_bf16 v[104:107], a[160:163], a[80:83], 0
    v_exp_f32 v127, v127
    v_mfma_f32_16x16x32_bf16 v[104:107], a[164:167], a[84:87], v[104:107]
    ds_read_b128 a[144:147], v11 offset:36864
    v_cvt_pk_bf16_f32 v119, v126, v127
    v_mfma_f32_16x16x32_bf16 v[104:107], a[168:171], a[88:91], v[104:107]
    s_mov_b32 s30, 73728
    buffer_load_dwordx4 v[52:55], v16, s[44:47], s30 offen offset:64 nt
    v_exp_f32 v96, v96
    v_mfma_f32_16x16x32_bf16 v[104:107], a[172:175], a[0:3], v[104:107]
    ds_read_b128 a[148:151], v10 offset:36864
    v_mul_f32 v2, s24, v2
    v_mfma_f32_16x16x32_bf16 v[108:111], a[176:179], a[0:3], 0
    v_exp_f32 v97, v97
    v_mfma_f32_16x16x32_bf16 v[108:111], a[180:183], a[88:91], v[108:111]
    ds_read_b128 a[152:155], v9 offset:36864
    v_cvt_pk_bf16_f32 v96, v96, v97
    v_mfma_f32_16x16x32_bf16 v[108:111], a[184:187], a[84:87], v[108:111]
    v_exp_f32 v98, v98
    v_mfma_f32_16x16x32_bf16 v[108:111], a[188:191], a[80:83], v[108:111]
    ds_read_b128 a[156:159], v8 offset:36864
    v_mul_f32 v3, s24, v3
    v_smfmac_f32_16x16x64_bf16 v[28:31], a[120:123], v[112:119], v22
    v_exp_f32 v99, v99
    v_mfma_f32_16x16x32_bf16 v[192:195], a[232:235], v[112:115], v[192:195]
    ds_read_b128 a[160:163], v8 offset:40960
    v_cvt_pk_bf16_f32 v97, v98, v99
    v_mfma_f32_16x16x32_bf16 v[192:195], a[236:239], v[116:119], v[192:195]
    v_exp_f32 v100, v100
    v_mfma_f32_16x16x32_bf16 v[196:199], a[240:243], v[116:119], v[196:199]
    ds_read_b128 a[164:167], v9 offset:40960
    v_mul_f32 v88, s24, v88
    v_mfma_f32_16x16x32_bf16 v[196:199], a[244:247], v[112:115], v[196:199]
    v_exp_f32 v101, v101
    v_mfma_f32_16x16x32_bf16 v[200:203], a[248:251], v[112:115], v[200:203]
    ds_read_b128 a[168:171], v10 offset:40960
    v_cvt_pk_bf16_f32 v98, v100, v101
    v_mfma_f32_16x16x32_bf16 v[200:203], a[252:255], v[116:119], v[200:203]
    s_mov_b32 s31, 12288
    buffer_store_dwordx4 v[32:35], v23, s[20:23], s31 offen offset:2048 sc1
    v_exp_f32 v102, v102
    v_mfma_f32_16x16x32_bf16 v[204:207], a[116:119], v[116:119], v[204:207]
    ds_read_b128 a[172:175], v11 offset:40960
    v_mul_f32 v89, s24, v89
    v_mfma_f32_16x16x32_bf16 v[204:207], a[112:115], v[112:115], v[204:207]
    v_exp_f32 v103, v103
    v_mfma_f32_16x16x32_bf16 v[208:211], a[108:111], v[112:115], v[208:211]
    ds_read_b128 a[176:179], v11 offset:45056
    v_cvt_pk_bf16_f32 v99, v102, v103
    v_mfma_f32_16x16x32_bf16 v[208:211], a[104:107], v[116:119], v[208:211]
    v_exp_f32 v104, v104
    v_mfma_f32_16x16x32_bf16 v[212:215], a[100:103], v[116:119], v[212:215]
    ds_read_b128 a[180:183], v10 offset:45056
    v_mul_f32 v90, s24, v90
    v_mfma_f32_16x16x32_bf16 v[212:215], a[96:99], v[112:115], v[212:215]
    v_exp_f32 v105, v105
    v_mfma_f32_16x16x32_bf16 v[216:219], a[92:95], v[112:115], v[216:219]
    ds_read_b128 a[184:187], v9 offset:45056
    v_cvt_pk_bf16_f32 v100, v104, v105
    v_mfma_f32_16x16x32_bf16 v[216:219], a[192:195], v[116:119], v[216:219]
    v_exp_f32 v106, v106
    v_mfma_f32_16x16x32_bf16 v[220:223], a[196:199], v[116:119], v[220:223]
    ds_read_b128 a[188:191], v8 offset:45056
    v_mul_f32 v91, s24, v91
    v_mfma_f32_16x16x32_bf16 v[220:223], a[200:203], v[112:115], v[220:223]
    s_waitcnt lgkmcnt(5)
    ds_read_b64_tr_b16 a[204:205], v12 offset:49152
    ds_read_b64_tr_b16 a[206:207], v12 offset:53248
    v_mfma_f32_16x16x32_bf16 v[112:115], a[128:131], a[32:35], 0
    v_exp_f32 v107, v107
    v_mfma_f32_16x16x32_bf16 v[112:115], a[132:135], a[36:39], v[112:115]
    ds_read_b64_tr_b16 a[208:209], v12 offset:57344
    v_cvt_pk_bf16_f32 v101, v106, v107
    v_mfma_f32_16x16x32_bf16 v[112:115], a[136:139], a[40:43], v[112:115]
    v_exp_f32 v108, v108
    v_mfma_f32_16x16x32_bf16 v[112:115], a[140:143], a[44:47], v[112:115]
    ds_read_b64_tr_b16 a[210:211], v12 offset:61440
    ds_read_b64_tr_b16 a[212:213], v12 offset:57352
    v_mfma_f32_16x16x32_bf16 v[116:119], a[144:147], a[44:47], 0
    v_exp_f32 v109, v109
    v_mfma_f32_16x16x32_bf16 v[116:119], a[148:151], a[40:43], v[116:119]
    ds_read_b64_tr_b16 a[214:215], v12 offset:61448
    v_cvt_pk_bf16_f32 v102, v108, v109
    v_mfma_f32_16x16x32_bf16 v[116:119], a[152:155], a[36:39], v[116:119]
    v_exp_f32 v110, v110
    v_mfma_f32_16x16x32_bf16 v[116:119], a[156:159], a[32:35], v[116:119]
    ds_read_b64_tr_b16 a[216:217], v12 offset:49160
    v_cvt_pk_bf16_f32 v88, v0, v88
    v_mfma_f32_16x16x32_bf16 v[120:123], a[160:163], a[32:35], 0
    v_exp_f32 v111, v111
    v_mfma_f32_16x16x32_bf16 v[120:123], a[164:167], a[36:39], v[120:123]
    ds_read_b64_tr_b16 a[218:219], v12 offset:53256
    v_cvt_pk_bf16_f32 v103, v110, v111
    v_mfma_f32_16x16x32_bf16 v[120:123], a[168:171], a[40:43], v[120:123]
    s_waitcnt lgkmcnt(6)
    v_exp_f32 v112, v112
    v_mfma_f32_16x16x32_bf16 v[120:123], a[172:175], a[44:47], v[120:123]
    ds_read_b64_tr_b16 a[220:221], v13 offset:49152
    v_cvt_pk_bf16_f32 v89, v1, v89
    v_mfma_f32_16x16x32_bf16 v[124:127], a[176:179], a[44:47], 0
    v_exp_f32 v113, v113
    v_mfma_f32_16x16x32_bf16 v[124:127], a[180:183], a[40:43], v[124:127]
    ds_read_b64_tr_b16 a[222:223], v13 offset:53248
    v_cvt_pk_bf16_f32 v112, v112, v113
    v_mfma_f32_16x16x32_bf16 v[124:127], a[184:187], a[36:39], v[124:127]
    v_exp_f32 v114, v114
    v_mfma_f32_16x16x32_bf16 v[124:127], a[188:191], a[32:35], v[124:127]
    ds_read_b64_tr_b16 a[224:225], v13 offset:57344
    v_cvt_pk_bf16_f32 v90, v2, v90
    v_smfmac_f32_16x16x64_bf16 v[28:31], a[124:127], v[96:103], v22
    v_exp_f32 v115, v115
    v_mfma_f32_16x16x32_bf16 v[224:227], a[232:235], v[96:99], v[224:227]
    ds_read_b64_tr_b16 a[226:227], v13 offset:61440
    v_cvt_pk_bf16_f32 v113, v114, v115
    v_mfma_f32_16x16x32_bf16 v[224:227], a[236:239], v[100:103], v[224:227]
    v_exp_f32 v116, v116
    v_mfma_f32_16x16x32_bf16 v[228:231], a[240:243], v[100:103], v[228:231]
    ds_read_b64_tr_b16 a[228:229], v13 offset:57352
    v_cvt_pk_bf16_f32 v91, v3, v91
    v_mfma_f32_16x16x32_bf16 v[228:231], a[244:247], v[96:99], v[228:231]
    v_exp_f32 v117, v117
    v_mfma_f32_16x16x32_bf16 v[232:235], a[248:251], v[96:99], v[232:235]
    ds_read_b64_tr_b16 a[230:231], v13 offset:61448
    v_cvt_pk_bf16_f32 v114, v116, v117
    v_mfma_f32_16x16x32_bf16 v[232:235], a[252:255], v[100:103], v[232:235]
    v_exp_f32 v118, v118
    v_mfma_f32_16x16x32_bf16 v[236:239], a[116:119], v[100:103], v[236:239]
    ds_read_b64_tr_b16 a[232:233], v13 offset:49160
    v_accvgpr_write_b32 a20, v88
    v_mfma_f32_16x16x32_bf16 v[236:239], a[112:115], v[96:99], v[236:239]
    v_exp_f32 v119, v119
    v_mfma_f32_16x16x32_bf16 v[240:243], a[108:111], v[96:99], v[240:243]
    ds_read_b64_tr_b16 a[234:235], v13 offset:53256
    v_cvt_pk_bf16_f32 v115, v118, v119
    v_mfma_f32_16x16x32_bf16 v[240:243], a[104:107], v[100:103], v[240:243]
    v_exp_f32 v120, v120
    v_mfma_f32_16x16x32_bf16 v[244:247], a[100:103], v[100:103], v[244:247]
    ds_read_b64_tr_b16 a[236:237], v14 offset:49152
    v_accvgpr_write_b32 a21, v89
    v_mfma_f32_16x16x32_bf16 v[244:247], a[96:99], v[96:99], v[244:247]
    v_exp_f32 v121, v121
    v_mfma_f32_16x16x32_bf16 v[248:251], a[92:95], v[96:99], v[248:251]
    ds_read_b64_tr_b16 a[238:239], v14 offset:53248
    v_cvt_pk_bf16_f32 v116, v120, v121
    v_mfma_f32_16x16x32_bf16 v[248:251], a[192:195], v[100:103], v[248:251]
    v_exp_f32 v122, v122
    v_mfma_f32_16x16x32_bf16 v[252:255], a[196:199], v[100:103], v[252:255]
    ds_read_b64_tr_b16 a[240:241], v14 offset:57344
    v_accvgpr_write_b32 a22, v90
    v_mfma_f32_16x16x32_bf16 v[252:255], a[200:203], v[96:99], v[252:255]
    ds_read_b64_tr_b16 a[242:243], v14 offset:61440
    v_accvgpr_write_b32 a23, v91
    v_mfma_f32_16x16x32_bf16 v[96:99], a[128:131], a[48:51], 0
    v_exp_f32 v123, v123
    v_mfma_f32_16x16x32_bf16 v[96:99], a[132:135], a[52:55], v[96:99]
    ds_read_b64_tr_b16 a[244:245], v14 offset:57352
    v_cvt_pk_bf16_f32 v117, v122, v123
    v_mfma_f32_16x16x32_bf16 v[96:99], a[136:139], a[56:59], v[96:99]
    v_exp_f32 v124, v124
    v_mfma_f32_16x16x32_bf16 v[96:99], a[140:143], a[60:63], v[96:99]
    ds_read_b64_tr_b16 a[246:247], v14 offset:61448
    v_cndmask_b32_dpp v56, v48, v36, vcc row_ror:8 row_mask:0xf bank_mask:0xf
    v_mfma_f32_16x16x32_bf16 v[100:103], a[144:147], a[60:63], 0
    v_exp_f32 v125, v125
    v_mfma_f32_16x16x32_bf16 v[100:103], a[148:151], a[56:59], v[100:103]
    ds_read_b64_tr_b16 a[248:249], v14 offset:49160
    v_cvt_pk_bf16_f32 v118, v124, v125
    v_mfma_f32_16x16x32_bf16 v[100:103], a[152:155], a[52:55], v[100:103]
    v_exp_f32 v126, v126
    v_mfma_f32_16x16x32_bf16 v[100:103], a[156:159], a[48:51], v[100:103]
    ds_read_b64_tr_b16 a[250:251], v14 offset:53256
    v_cndmask_b32_dpp v57, v49, v37, vcc row_ror:8 row_mask:0xf bank_mask:0xf
    v_mfma_f32_16x16x32_bf16 v[104:107], a[160:163], a[48:51], 0
    v_exp_f32 v127, v127
    v_mfma_f32_16x16x32_bf16 v[104:107], a[164:167], a[52:55], v[104:107]
    ds_read_b64_tr_b16 a[252:253], v15 offset:49152
    v_cvt_pk_bf16_f32 v119, v126, v127
    v_mfma_f32_16x16x32_bf16 v[104:107], a[168:171], a[56:59], v[104:107]
    v_exp_f32 v96, v96
    v_mfma_f32_16x16x32_bf16 v[104:107], a[172:175], a[60:63], v[104:107]
    ds_read_b64_tr_b16 a[254:255], v15 offset:53248
    v_cndmask_b32_dpp v58, v50, v38, vcc row_ror:8 row_mask:0xf bank_mask:0xf
    v_mfma_f32_16x16x32_bf16 v[108:111], a[176:179], a[60:63], 0
    v_exp_f32 v97, v97
    v_mfma_f32_16x16x32_bf16 v[108:111], a[180:183], a[56:59], v[108:111]
    ds_read_b64_tr_b16 a[116:117], v15 offset:57344
    v_cvt_pk_bf16_f32 v96, v96, v97
    v_mfma_f32_16x16x32_bf16 v[108:111], a[184:187], a[52:55], v[108:111]
    v_exp_f32 v98, v98
    v_mfma_f32_16x16x32_bf16 v[108:111], a[188:191], a[48:51], v[108:111]
    ds_read_b64_tr_b16 a[118:119], v15 offset:61440
    v_cndmask_b32_dpp v59, v51, v39, vcc row_ror:8 row_mask:0xf bank_mask:0xf
    v_smfmac_f32_16x16x64_bf16 v[24:27], a[120:123], v[112:119], v22
    v_exp_f32 v99, v99
    v_mfma_f32_16x16x32_bf16 v[128:131], a[204:207], v[112:115], v[128:131]
    s_waitcnt lgkmcnt(4)
    ds_read_b64_tr_b16 a[112:113], v15 offset:57352
    v_cvt_pk_bf16_f32 v97, v98, v99
    v_mfma_f32_16x16x32_bf16 v[128:131], a[208:211], v[116:119], v[128:131]
    v_exp_f32 v100, v100
    v_mfma_f32_16x16x32_bf16 v[132:135], a[212:215], v[116:119], v[132:135]
    ds_read_b64_tr_b16 a[114:115], v15 offset:61448
    v_mov_b32_dpp v48, v36 row_ror:8 row_mask:0xf bank_mask:0x3
    v_mfma_f32_16x16x32_bf16 v[132:135], a[216:219], v[112:115], v[132:135]
    v_exp_f32 v101, v101
    v_mfma_f32_16x16x32_bf16 v[136:139], a[220:223], v[112:115], v[136:139]
    ds_read_b64_tr_b16 a[108:109], v15 offset:49160
    v_cvt_pk_bf16_f32 v98, v100, v101
    v_mfma_f32_16x16x32_bf16 v[136:139], a[224:227], v[116:119], v[136:139]
    v_exp_f32 v102, v102
    v_mfma_f32_16x16x32_bf16 v[140:143], a[228:231], v[116:119], v[140:143]
    ds_read_b64_tr_b16 a[110:111], v15 offset:53256
    v_mov_b32_dpp v49, v37 row_ror:8 row_mask:0xf bank_mask:0x3
    v_mfma_f32_16x16x32_bf16 v[140:143], a[232:235], v[112:115], v[140:143]
    v_exp_f32 v103, v103
    v_mfma_f32_16x16x32_bf16 v[144:147], a[236:239], v[112:115], v[144:147]
    v_cvt_pk_bf16_f32 v99, v102, v103
    v_mov_b32_dpp v50, v38 row_ror:8 row_mask:0xf bank_mask:0x3
    v_mfma_f32_16x16x32_bf16 v[144:147], a[240:243], v[116:119], v[144:147]
    v_exp_f32 v104, v104
    v_mfma_f32_16x16x32_bf16 v[148:151], a[244:247], v[116:119], v[148:151]
    v_mov_b32_dpp v51, v39 row_ror:8 row_mask:0xf bank_mask:0x3
    v_lshlrev_b32 v0, 16, v68
    v_mfma_f32_16x16x32_bf16 v[148:151], a[248:251], v[112:115], v[148:151]
    s_waitcnt lgkmcnt(3)
    v_exp_f32 v105, v105
    v_mfma_f32_16x16x32_bf16 v[152:155], a[252:255], v[112:115], v[152:155]
    v_cvt_pk_bf16_f32 v100, v104, v105
    v_lshlrev_b32 v1, 16, v69
    v_mfma_f32_16x16x32_bf16 v[152:155], a[116:119], v[116:119], v[152:155]
    s_waitcnt lgkmcnt(1)
    v_exp_f32 v106, v106
    v_mfma_f32_16x16x32_bf16 v[156:159], a[112:115], v[116:119], v[156:159]
    s_waitcnt lgkmcnt(0)
    v_lshlrev_b32 v2, 16, v70
    v_lshlrev_b32 v3, 16, v71
    v_mfma_f32_16x16x32_bf16 v[156:159], a[108:111], v[112:115], v[156:159]
    s_waitcnt vmcnt(4)
    v_and_b32 v68, s25, v68
    v_and_b32 v69, s25, v69
    v_mfma_f32_16x16x32_bf16 v[112:115], a[128:131], a[64:67], 0
    s_barrier
    v_exp_f32 v107, v107
    v_mfma_f32_16x16x32_bf16 v[112:115], a[132:135], a[68:71], v[112:115]
    s_add_u32 s29, s27, 0
    v_cvt_pk_bf16_f32 v101, v106, v107
    v_and_b32 v70, s25, v70
    v_mfma_f32_16x16x32_bf16 v[112:115], a[136:139], a[72:75], v[112:115]
    s_add_u32 m0, s27, 147456
    v_exp_f32 v108, v108
    v_mfma_f32_16x16x32_bf16 v[112:115], a[140:143], a[76:79], v[112:115]
    buffer_load_dwordx4 v18, s[52:55], s29 offen lds
    v_mfma_f32_16x16x32_bf16 v[116:119], a[144:147], a[76:79], 0
    v_exp_f32 v109, v109
    v_mfma_f32_16x16x32_bf16 v[116:119], a[148:151], a[72:75], v[116:119]
    v_cvt_pk_bf16_f32 v102, v108, v109
    v_and_b32 v71, s25, v71
    v_mfma_f32_16x16x32_bf16 v[116:119], a[152:155], a[68:71], v[116:119]
    v_exp_f32 v110, v110
    v_mfma_f32_16x16x32_bf16 v[116:119], a[156:159], a[64:67], v[116:119]
    buffer_load_dwordx4 v18, s[52:55], s29 offen offset:1024 lds
    v_mfma_f32_16x16x32_bf16 v[120:123], a[160:163], a[64:67], 0
    v_exp_f32 v111, v111
    v_mfma_f32_16x16x32_bf16 v[120:123], a[164:167], a[68:71], v[120:123]
    v_cvt_pk_bf16_f32 v103, v110, v111
    v_mul_f32 v0, s24, v0
    v_mfma_f32_16x16x32_bf16 v[120:123], a[168:171], a[72:75], v[120:123]
    v_exp_f32 v112, v112
    v_mfma_f32_16x16x32_bf16 v[120:123], a[172:175], a[76:79], v[120:123]
    buffer_load_dwordx4 v18, s[52:55], s29 offen offset:2048 lds
    v_mfma_f32_16x16x32_bf16 v[124:127], a[176:179], a[76:79], 0
    v_exp_f32 v113, v113
    v_mfma_f32_16x16x32_bf16 v[124:127], a[180:183], a[72:75], v[124:127]
    v_cvt_pk_bf16_f32 v112, v112, v113
    v_mul_f32 v1, s24, v1
    v_mfma_f32_16x16x32_bf16 v[124:127], a[184:187], a[68:71], v[124:127]
    v_exp_f32 v114, v114
    v_mfma_f32_16x16x32_bf16 v[124:127], a[188:191], a[64:67], v[124:127]
    buffer_load_dwordx4 v18, s[52:55], s29 offen offset:3072 lds
    v_smfmac_f32_16x16x64_bf16 v[24:27], a[124:127], v[96:103], v22
    v_exp_f32 v115, v115
    v_mfma_f32_16x16x32_bf16 v[160:163], a[204:207], v[96:99], v[160:163]
    v_cvt_pk_bf16_f32 v113, v114, v115
    v_mul_f32 v2, s24, v2
    v_mfma_f32_16x16x32_bf16 v[160:163], a[208:211], v[100:103], v[160:163]
    v_exp_f32 v116, v116
    v_mfma_f32_16x16x32_bf16 v[164:167], a[212:215], v[100:103], v[164:167]
    s_mov_b32 s30, 73728
    buffer_load_dwordx4 v[92:95], v16, s[44:47], s30 offen offset:128 nt
    v_mfma_f32_16x16x32_bf16 v[164:167], a[216:219], v[96:99], v[164:167]
    v_exp_f32 v117, v117
    v_mfma_f32_16x16x32_bf16 v[168:171], a[220:223], v[96:99], v[168:171]
    v_cvt_pk_bf16_f32 v114, v116, v117
    v_mul_f32 v3, s24, v3
    v_mfma_f32_16x16x32_bf16 v[168:171], a[224:227], v[100:103], v[168:171]
    v_exp_f32 v118, v118
    v_mfma_f32_16x16x32_bf16 v[172:175], a[228:231], v[100:103], v[172:175]
    v_mul_f32 v68, s24, v68
    v_mul_f32 v69, s24, v69
    v_mfma_f32_16x16x32_bf16 v[172:175], a[232:235], v[96:99], v[172:175]
    v_exp_f32 v119, v119
    v_mfma_f32_16x16x32_bf16 v[176:179], a[236:239], v[96:99], v[176:179]
    v_cvt_pk_bf16_f32 v115, v118, v119
    v_mul_f32 v70, s24, v70
    v_mfma_f32_16x16x32_bf16 v[176:179], a[240:243], v[100:103], v[176:179]
    v_exp_f32 v120, v120
    v_mfma_f32_16x16x32_bf16 v[180:183], a[244:247], v[100:103], v[180:183]
    v_mul_f32 v71, s24, v71
    v_cvt_pk_bf16_f32 v68, v0, v68
    v_mfma_f32_16x16x32_bf16 v[180:183], a[248:251], v[96:99], v[180:183]
    v_exp_f32 v121, v121
    v_mfma_f32_16x16x32_bf16 v[184:187], a[252:255], v[96:99], v[184:187]
    v_cvt_pk_bf16_f32 v116, v120, v121
    v_cvt_pk_bf16_f32 v69, v1, v69
    v_mfma_f32_16x16x32_bf16 v[184:187], a[116:119], v[100:103], v[184:187]
    v_exp_f32 v122, v122
    v_mfma_f32_16x16x32_bf16 v[188:191], a[112:115], v[100:103], v[188:191]
    s_mov_b32 s31, 12288
    buffer_store_dwordx4 v[56:59], v23, s[20:23], s31 offen offset:128 sc1
    v_mfma_f32_16x16x32_bf16 v[188:191], a[108:111], v[96:99], v[188:191]
    v_cvt_pk_bf16_f32 v70, v2, v70
    v_cvt_pk_bf16_f32 v71, v3, v71
    v_mfma_f32_16x16x32_bf16 v[96:99], a[128:131], a[80:83], 0
    v_exp_f32 v123, v123
    v_mfma_f32_16x16x32_bf16 v[96:99], a[132:135], a[84:87], v[96:99]
    ds_read_b128 a[128:131], v8 offset:49152
    v_cvt_pk_bf16_f32 v117, v122, v123
    v_mfma_f32_16x16x32_bf16 v[96:99], a[136:139], a[88:91], v[96:99]
    v_exp_f32 v124, v124
    v_mfma_f32_16x16x32_bf16 v[96:99], a[140:143], a[0:3], v[96:99]
    ds_read_b128 a[132:135], v9 offset:49152
    v_accvgpr_write_b32 a24, v68
    v_mfma_f32_16x16x32_bf16 v[100:103], a[144:147], a[0:3], 0
    v_exp_f32 v125, v125
    v_mfma_f32_16x16x32_bf16 v[100:103], a[148:151], a[88:91], v[100:103]
    ds_read_b128 a[136:139], v10 offset:49152
    v_cvt_pk_bf16_f32 v118, v124, v125
    v_mfma_f32_16x16x32_bf16 v[100:103], a[152:155], a[84:87], v[100:103]
    v_exp_f32 v126, v126
    v_mfma_f32_16x16x32_bf16 v[100:103], a[156:159], a[80:83], v[100:103]
    ds_read_b128 a[140:143], v11 offset:49152
    v_accvgpr_write_b32 a25, v69
    v_mfma_f32_16x16x32_bf16 v[104:107], a[160:163], a[80:83], 0
    v_exp_f32 v127, v127
    v_mfma_f32_16x16x32_bf16 v[104:107], a[164:167], a[84:87], v[104:107]
    ds_read_b128 a[144:147], v11 offset:53248
    v_cvt_pk_bf16_f32 v119, v126, v127
    v_mfma_f32_16x16x32_bf16 v[104:107], a[168:171], a[88:91], v[104:107]
    s_mov_b32 s30, 73728
    buffer_load_dwordx4 v[72:75], v16, s[44:47], s30 offen offset:192 nt
    v_exp_f32 v96, v96
    v_mfma_f32_16x16x32_bf16 v[104:107], a[172:175], a[0:3], v[104:107]
    ds_read_b128 a[148:151], v10 offset:53248
    v_accvgpr_write_b32 a26, v70
    v_mfma_f32_16x16x32_bf16 v[108:111], a[176:179], a[0:3], 0
    v_exp_f32 v97, v97
    v_mfma_f32_16x16x32_bf16 v[108:111], a[180:183], a[88:91], v[108:111]
    ds_read_b128 a[152:155], v9 offset:53248
    v_cvt_pk_bf16_f32 v96, v96, v97
    v_mfma_f32_16x16x32_bf16 v[108:111], a[184:187], a[84:87], v[108:111]
    v_exp_f32 v98, v98
    v_mfma_f32_16x16x32_bf16 v[108:111], a[188:191], a[80:83], v[108:111]
    ds_read_b128 a[156:159], v8 offset:53248
    v_accvgpr_write_b32 a27, v71
    v_smfmac_f32_16x16x64_bf16 v[28:31], a[120:123], v[112:119], v22
    v_exp_f32 v99, v99
    v_mfma_f32_16x16x32_bf16 v[192:195], a[204:207], v[112:115], v[192:195]
    ds_read_b128 a[160:163], v8 offset:57344
    v_cvt_pk_bf16_f32 v97, v98, v99
    v_mfma_f32_16x16x32_bf16 v[192:195], a[208:211], v[116:119], v[192:195]
    v_exp_f32 v100, v100
    v_mfma_f32_16x16x32_bf16 v[196:199], a[212:215], v[116:119], v[196:199]
    ds_read_b128 a[164:167], v9 offset:57344
    v_lshlrev_b32 v0, 16, v76
    v_mfma_f32_16x16x32_bf16 v[196:199], a[216:219], v[112:115], v[196:199]
    v_exp_f32 v101, v101
    v_mfma_f32_16x16x32_bf16 v[200:203], a[220:223], v[112:115], v[200:203]
    ds_read_b128 a[168:171], v10 offset:57344
    v_cvt_pk_bf16_f32 v98, v100, v101
    v_mfma_f32_16x16x32_bf16 v[200:203], a[224:227], v[116:119], v[200:203]
    s_mov_b32 s31, 12288
    buffer_store_dwordx4 v[48:51], v23, s[20:23], s31 offen offset:2176 sc1
    v_exp_f32 v102, v102
    v_mfma_f32_16x16x32_bf16 v[204:207], a[228:231], v[116:119], v[204:207]
    ds_read_b128 a[172:175], v11 offset:57344
    v_lshlrev_b32 v1, 16, v77
    v_mfma_f32_16x16x32_bf16 v[204:207], a[232:235], v[112:115], v[204:207]
    v_exp_f32 v103, v103
    v_mfma_f32_16x16x32_bf16 v[208:211], a[236:239], v[112:115], v[208:211]
    ds_read_b128 a[176:179], v11 offset:61440
    v_cvt_pk_bf16_f32 v99, v102, v103
    v_mfma_f32_16x16x32_bf16 v[208:211], a[240:243], v[116:119], v[208:211]
    v_exp_f32 v104, v104
    v_mfma_f32_16x16x32_bf16 v[212:215], a[244:247], v[116:119], v[212:215]
    ds_read_b128 a[180:183], v10 offset:61440
    v_lshlrev_b32 v2, 16, v78
    v_mfma_f32_16x16x32_bf16 v[212:215], a[248:251], v[112:115], v[212:215]
    v_exp_f32 v105, v105
    v_mfma_f32_16x16x32_bf16 v[216:219], a[252:255], v[112:115], v[216:219]
    ds_read_b128 a[184:187], v9 offset:61440
    v_cvt_pk_bf16_f32 v100, v104, v105
    v_mfma_f32_16x16x32_bf16 v[216:219], a[116:119], v[116:119], v[216:219]
    v_exp_f32 v106, v106
    v_mfma_f32_16x16x32_bf16 v[220:223], a[112:115], v[116:119], v[220:223]
    ds_read_b128 a[188:191], v8 offset:61440
    v_lshlrev_b32 v3, 16, v79
    v_mfma_f32_16x16x32_bf16 v[220:223], a[108:111], v[112:115], v[220:223]
    s_waitcnt lgkmcnt(5)
    ds_read_b64_tr_b16 a[104:105], v12 offset:32768
    ds_read_b64_tr_b16 a[106:107], v12 offset:36864
    v_mfma_f32_16x16x32_bf16 v[112:115], a[128:131], a[32:35], 0
    v_exp_f32 v107, v107
    v_mfma_f32_16x16x32_bf16 v[112:115], a[132:135], a[36:39], v[112:115]
    ds_read_b64_tr_b16 a[100:101], v12 offset:40960
    v_cvt_pk_bf16_f32 v101, v106, v107
    v_mfma_f32_16x16x32_bf16 v[112:115], a[136:139], a[40:43], v[112:115]
    v_exp_f32 v108, v108
    v_mfma_f32_16x16x32_bf16 v[112:115], a[140:143], a[44:47], v[112:115]
    ds_read_b64_tr_b16 a[102:103], v12 offset:45056
    ds_read_b64_tr_b16 a[96:97], v12 offset:40968
    v_mfma_f32_16x16x32_bf16 v[116:119], a[144:147], a[44:47], 0
    v_exp_f32 v109, v109
    v_mfma_f32_16x16x32_bf16 v[116:119], a[148:151], a[40:43], v[116:119]
    ds_read_b64_tr_b16 a[98:99], v12 offset:45064
    v_cvt_pk_bf16_f32 v102, v108, v109
    v_mfma_f32_16x16x32_bf16 v[116:119], a[152:155], a[36:39], v[116:119]
    v_exp_f32 v110, v110
    v_mfma_f32_16x16x32_bf16 v[116:119], a[156:159], a[32:35], v[116:119]
    ds_read_b64_tr_b16 a[92:93], v12 offset:32776
    v_and_b32 v76, s25, v76
    v_and_b32 v77, s25, v77
    v_and_b32 v78, s25, v78
    v_and_b32 v79, s25, v79
    v_pk_mul_f32 v[0:1], v[0:1], s[34:35]
    v_pk_mul_f32 v[2:3], v[2:3], s[34:35]
    v_pk_mul_f32 v[76:77], v[76:77], s[34:35]
    v_pk_mul_f32 v[78:79], v[78:79], s[34:35]
    v_cvt_pk_bf16_f32 v76, v0, v76
    v_cvt_pk_bf16_f32 v77, v1, v77
    v_cvt_pk_bf16_f32 v78, v2, v78
    v_mfma_f32_16x16x32_bf16 v[120:123], a[160:163], a[32:35], 0
    v_exp_f32 v111, v111
    v_mfma_f32_16x16x32_bf16 v[120:123], a[164:167], a[36:39], v[120:123]
    ds_read_b64_tr_b16 a[94:95], v12 offset:36872
    v_cvt_pk_bf16_f32 v103, v110, v111
    v_mfma_f32_16x16x32_bf16 v[120:123], a[168:171], a[40:43], v[120:123]
    s_waitcnt lgkmcnt(3)
    v_exp_f32 v112, v112
    v_mfma_f32_16x16x32_bf16 v[120:123], a[172:175], a[44:47], v[120:123]
    ds_read_b64_tr_b16 a[192:193], v13 offset:32768
    v_cvt_pk_bf16_f32 v79, v3, v79
    v_mfma_f32_16x16x32_bf16 v[124:127], a[176:179], a[44:47], 0
    v_exp_f32 v113, v113
    v_mfma_f32_16x16x32_bf16 v[124:127], a[180:183], a[40:43], v[124:127]
    ds_read_b64_tr_b16 a[194:195], v13 offset:36864
    v_cvt_pk_bf16_f32 v112, v112, v113
    v_mfma_f32_16x16x32_bf16 v[124:127], a[184:187], a[36:39], v[124:127]
    v_exp_f32 v114, v114
    v_mfma_f32_16x16x32_bf16 v[124:127], a[188:191], a[32:35], v[124:127]
    ds_read_b64_tr_b16 a[196:197], v13 offset:40960
    v_accvgpr_write_b32 a28, v76
    v_smfmac_f32_16x16x64_bf16 v[28:31], a[124:127], v[96:103], v22
    v_exp_f32 v115, v115
    v_mfma_f32_16x16x32_bf16 v[224:227], a[204:207], v[96:99], v[224:227]
    ds_read_b64_tr_b16 a[198:199], v13 offset:45056
    v_cvt_pk_bf16_f32 v113, v114, v115
    v_mfma_f32_16x16x32_bf16 v[224:227], a[208:211], v[100:103], v[224:227]
    v_exp_f32 v116, v116
    v_mfma_f32_16x16x32_bf16 v[228:231], a[212:215], v[100:103], v[228:231]
    ds_read_b64_tr_b16 a[200:201], v13 offset:40968
    v_accvgpr_write_b32 a29, v77
    v_mfma_f32_16x16x32_bf16 v[228:231], a[216:219], v[96:99], v[228:231]
Lpad9:
    s_cbranch_execz Lpad13
    v_exp_f32 v117, v117
    v_mfma_f32_16x16x32_bf16 v[232:235], a[220:223], v[96:99], v[232:235]
    ds_read_b64_tr_b16 a[202:203], v13 offset:45064
    v_cvt_pk_bf16_f32 v114, v116, v117
    v_mfma_f32_16x16x32_bf16 v[232:235], a[224:227], v[100:103], v[232:235]
    v_exp_f32 v118, v118
    v_mfma_f32_16x16x32_bf16 v[236:239], a[228:231], v[100:103], v[236:239]
    ds_read_b64_tr_b16 a[204:205], v13 offset:32776
    v_accvgpr_write_b32 a30, v78
    v_mfma_f32_16x16x32_bf16 v[236:239], a[232:235], v[96:99], v[236:239]
    v_exp_f32 v119, v119
    v_mfma_f32_16x16x32_bf16 v[240:243], a[236:239], v[96:99], v[240:243]
    ds_read_b64_tr_b16 a[206:207], v13 offset:36872
    v_cvt_pk_bf16_f32 v115, v118, v119
    v_mfma_f32_16x16x32_bf16 v[240:243], a[240:243], v[100:103], v[240:243]
    v_exp_f32 v120, v120
    v_mfma_f32_16x16x32_bf16 v[244:247], a[244:247], v[100:103], v[244:247]
    ds_read_b64_tr_b16 a[208:209], v14 offset:32768
    v_accvgpr_write_b32 a31, v79
    v_mfma_f32_16x16x32_bf16 v[244:247], a[248:251], v[96:99], v[244:247]
    v_exp_f32 v121, v121
    v_mfma_f32_16x16x32_bf16 v[248:251], a[252:255], v[96:99], v[248:251]
    ds_read_b64_tr_b16 a[210:211], v14 offset:36864
    v_cvt_pk_bf16_f32 v116, v120, v121
    v_mfma_f32_16x16x32_bf16 v[248:251], a[116:119], v[100:103], v[248:251]
    v_exp_f32 v122, v122
    v_mfma_f32_16x16x32_bf16 v[252:255], a[112:115], v[100:103], v[252:255]
    ds_read_b64_tr_b16 a[212:213], v14 offset:40960
    v_lshlrev_b32 v0, 16, v64
    v_mfma_f32_16x16x32_bf16 v[252:255], a[108:111], v[96:99], v[252:255]
    ds_read_b64_tr_b16 a[214:215], v14 offset:45056
    v_lshlrev_b32 v1, 16, v65
    v_mfma_f32_16x16x32_bf16 v[96:99], a[128:131], a[48:51], 0
    v_exp_f32 v123, v123
    v_mfma_f32_16x16x32_bf16 v[96:99], a[132:135], a[52:55], v[96:99]
    ds_read_b64_tr_b16 a[216:217], v14 offset:40968
    v_cvt_pk_bf16_f32 v117, v122, v123
    v_mfma_f32_16x16x32_bf16 v[96:99], a[136:139], a[56:59], v[96:99]
    v_exp_f32 v124, v124
    v_mfma_f32_16x16x32_bf16 v[96:99], a[140:143], a[60:63], v[96:99]
    ds_read_b64_tr_b16 a[218:219], v14 offset:45064
    v_lshlrev_b32 v2, 16, v66
    v_mfma_f32_16x16x32_bf16 v[100:103], a[144:147], a[60:63], 0
    v_exp_f32 v125, v125
    v_mfma_f32_16x16x32_bf16 v[100:103], a[148:151], a[56:59], v[100:103]
    ds_read_b64_tr_b16 a[220:221], v14 offset:32776
    v_cvt_pk_bf16_f32 v118, v124, v125
    v_mfma_f32_16x16x32_bf16 v[100:103], a[152:155], a[52:55], v[100:103]
    v_exp_f32 v126, v126
    v_mfma_f32_16x16x32_bf16 v[100:103], a[156:159], a[48:51], v[100:103]
    ds_read_b64_tr_b16 a[222:223], v14 offset:36872
    v_lshlrev_b32 v3, 16, v67
    v_mfma_f32_16x16x32_bf16 v[104:107], a[160:163], a[48:51], 0
    v_exp_f32 v127, v127
    v_mfma_f32_16x16x32_bf16 v[104:107], a[164:167], a[52:55], v[104:107]
    ds_read_b64_tr_b16 a[224:225], v15 offset:32768
    v_cvt_pk_bf16_f32 v119, v126, v127
    v_mfma_f32_16x16x32_bf16 v[104:107], a[168:171], a[56:59], v[104:107]
    v_exp_f32 v96, v96
    v_mfma_f32_16x16x32_bf16 v[104:107], a[172:175], a[60:63], v[104:107]
    ds_read_b64_tr_b16 a[226:227], v15 offset:36864
    v_and_b32 v64, s25, v64
    v_and_b32 v65, s25, v65
    v_and_b32 v66, s25, v66
    v_and_b32 v67, s25, v67
    v_pk_mul_f32 v[0:1], v[0:1], s[34:35]
    v_pk_mul_f32 v[2:3], v[2:3], s[34:35]
    v_pk_mul_f32 v[64:65], v[64:65], s[34:35]
    v_pk_mul_f32 v[66:67], v[66:67], s[34:35]
    v_cvt_pk_bf16_f32 v64, v0, v64
    v_cvt_pk_bf16_f32 v65, v1, v65
    v_cvt_pk_bf16_f32 v66, v2, v66
    v_mfma_f32_16x16x32_bf16 v[108:111], a[176:179], a[60:63], 0
    v_exp_f32 v97, v97
    v_mfma_f32_16x16x32_bf16 v[108:111], a[180:183], a[56:59], v[108:111]
    ds_read_b64_tr_b16 a[228:229], v15 offset:40960
    v_cvt_pk_bf16_f32 v96, v96, v97
    v_mfma_f32_16x16x32_bf16 v[108:111], a[184:187], a[52:55], v[108:111]
    v_exp_f32 v98, v98
    v_mfma_f32_16x16x32_bf16 v[108:111], a[188:191], a[48:51], v[108:111]
    ds_read_b64_tr_b16 a[230:231], v15 offset:45056
    v_cvt_pk_bf16_f32 v67, v3, v67
    v_smfmac_f32_16x16x64_bf16 v[24:27], a[120:123], v[112:119], v22
    v_exp_f32 v99, v99
    v_mfma_f32_16x16x32_bf16 v[128:131], a[104:107], v[112:115], v[128:131]
    ds_read_b64_tr_b16 a[232:233], v15 offset:40968
    v_cvt_pk_bf16_f32 v97, v98, v99
    v_mfma_f32_16x16x32_bf16 v[128:131], a[100:103], v[116:119], v[128:131]
    s_waitcnt lgkmcnt(3)
    v_exp_f32 v100, v100
    v_mfma_f32_16x16x32_bf16 v[132:135], a[96:99], v[116:119], v[132:135]
    ds_read_b64_tr_b16 a[234:235], v15 offset:45064
    v_accvgpr_write_b32 a32, v64
    v_mfma_f32_16x16x32_bf16 v[132:135], a[92:95], v[112:115], v[132:135]
    v_exp_f32 v101, v101
    v_mfma_f32_16x16x32_bf16 v[136:139], a[192:195], v[112:115], v[136:139]
    ds_read_b64_tr_b16 a[236:237], v15 offset:32776
    v_cvt_pk_bf16_f32 v98, v100, v101
    v_mfma_f32_16x16x32_bf16 v[136:139], a[196:199], v[116:119], v[136:139]
    v_exp_f32 v102, v102
    v_mfma_f32_16x16x32_bf16 v[140:143], a[200:203], v[116:119], v[140:143]
    ds_read_b64_tr_b16 a[238:239], v15 offset:36872
    v_add_f32 v24, v24, v25
    v_mfma_f32_16x16x32_bf16 v[140:143], a[204:207], v[112:115], v[140:143]
    v_exp_f32 v103, v103
    v_mfma_f32_16x16x32_bf16 v[144:147], a[208:211], v[112:115], v[144:147]
    v_cvt_pk_bf16_f32 v99, v102, v103
    v_accvgpr_write_b32 a33, v65
    v_mfma_f32_16x16x32_bf16 v[144:147], a[212:215], v[116:119], v[144:147]
    v_exp_f32 v104, v104
    v_mfma_f32_16x16x32_bf16 v[148:151], a[216:219], v[116:119], v[148:151]
    v_rcp_f32 v20, v24
    v_mfma_f32_16x16x32_bf16 v[148:151], a[220:223], v[112:115], v[148:151]
    v_exp_f32 v105, v105
    v_mfma_f32_16x16x32_bf16 v[152:155], a[224:227], v[112:115], v[152:155]
    s_waitcnt lgkmcnt(2)
    v_cvt_pk_bf16_f32 v100, v104, v105
    v_accvgpr_write_b32 a34, v66
    v_mfma_f32_16x16x32_bf16 v[152:155], a[228:231], v[116:119], v[152:155]
    v_exp_f32 v106, v106
    v_mfma_f32_16x16x32_bf16 v[156:159], a[232:235], v[116:119], v[156:159]
    s_waitcnt vmcnt(4) lgkmcnt(0)
    v_accvgpr_write_b32 a35, v67
    v_mfma_f32_16x16x32_bf16 v[156:159], a[236:239], v[112:115], v[156:159]
    s_barrier
    v_mfma_f32_16x16x32_bf16 v[112:115], a[128:131], a[64:67], 0
    v_exp_f32 v107, v107
    v_mfma_f32_16x16x32_bf16 v[112:115], a[132:135], a[68:71], v[112:115]
    s_add_u32 s29, s27, 16384
    v_cvt_pk_bf16_f32 v101, v106, v107
    v_mfma_f32_16x16x32_bf16 v[112:115], a[136:139], a[72:75], v[112:115]
    s_add_u32 m0, s27, 131072
    v_exp_f32 v108, v108
    v_mfma_f32_16x16x32_bf16 v[112:115], a[140:143], a[76:79], v[112:115]
    buffer_load_dwordx4 v18, s[52:55], s29 offen lds
    v_mfma_f32_16x16x32_bf16 v[116:119], a[144:147], a[76:79], 0
    v_exp_f32 v109, v109
    v_subrev_u32 v24, s28, v24
    v_mov_b32 v21, v20
    v_max_u32 v19, v19, v24
    v_pk_mul_f32 v[128:129], v[128:129], v[20:21]
    v_pk_mul_f32 v[130:131], v[130:131], v[20:21]
    v_pk_mul_f32 v[132:133], v[132:133], v[20:21]
    v_pk_mul_f32 v[134:135], v[134:135], v[20:21]
    v_pk_mul_f32 v[136:137], v[136:137], v[20:21]
    v_pk_mul_f32 v[138:139], v[138:139], v[20:21]
    v_pk_mul_f32 v[140:141], v[140:141], v[20:21]
    v_pk_mul_f32 v[142:143], v[142:143], v[20:21]
    v_pk_mul_f32 v[144:145], v[144:145], v[20:21]
    v_pk_mul_f32 v[146:147], v[146:147], v[20:21]
    v_pk_mul_f32 v[148:149], v[148:149], v[20:21]
    v_pk_mul_f32 v[150:151], v[150:151], v[20:21]
    v_pk_mul_f32 v[152:153], v[152:153], v[20:21]
    v_pk_mul_f32 v[154:155], v[154:155], v[20:21]
    v_pk_mul_f32 v[156:157], v[156:157], v[20:21]
    v_pk_mul_f32 v[158:159], v[158:159], v[20:21]
    v_mov_b32 v24, 0
    v_mov_b32 v25, 0
    v_cvt_pk_bf16_f32 v44, v128, v129
    v_mfma_f32_16x16x32_bf16 v[116:119], a[148:151], a[72:75], v[116:119]
    v_cvt_pk_bf16_f32 v102, v108, v109
    v_cvt_pk_bf16_f32 v45, v130, v131
    v_mfma_f32_16x16x32_bf16 v[116:119], a[152:155], a[68:71], v[116:119]
    v_exp_f32 v110, v110
    v_mfma_f32_16x16x32_bf16 v[116:119], a[156:159], a[64:67], v[116:119]
    buffer_load_dwordx4 v18, s[52:55], s29 offen offset:1024 lds
    v_mfma_f32_16x16x32_bf16 v[120:123], a[160:163], a[64:67], 0
    v_exp_f32 v111, v111
    v_mfma_f32_16x16x32_bf16 v[120:123], a[164:167], a[68:71], v[120:123]
    v_cvt_pk_bf16_f32 v103, v110, v111
    v_cvt_pk_bf16_f32 v46, v132, v133
    v_mfma_f32_16x16x32_bf16 v[120:123], a[168:171], a[72:75], v[120:123]
    v_exp_f32 v112, v112
    v_mfma_f32_16x16x32_bf16 v[120:123], a[172:175], a[76:79], v[120:123]
    buffer_load_dwordx4 v18, s[52:55], s29 offen offset:2048 lds
    v_mfma_f32_16x16x32_bf16 v[124:127], a[176:179], a[76:79], 0
    v_exp_f32 v113, v113
    v_mfma_f32_16x16x32_bf16 v[124:127], a[180:183], a[72:75], v[124:127]
    v_cvt_pk_bf16_f32 v112, v112, v113
    v_cvt_pk_bf16_f32 v47, v134, v135
    v_mfma_f32_16x16x32_bf16 v[124:127], a[184:187], a[68:71], v[124:127]
    v_exp_f32 v114, v114
    v_mfma_f32_16x16x32_bf16 v[124:127], a[188:191], a[64:67], v[124:127]
    buffer_load_dwordx4 v18, s[52:55], s29 offen offset:3072 lds
    v_smfmac_f32_16x16x64_bf16 v[24:27], a[124:127], v[96:103], v22
    v_exp_f32 v115, v115
    v_mfma_f32_16x16x32_bf16 v[160:163], a[104:107], v[96:99], v[160:163]
    v_cvt_pk_bf16_f32 v113, v114, v115
    v_cvt_pk_bf16_f32 v80, v136, v137
    v_mfma_f32_16x16x32_bf16 v[160:163], a[100:103], v[100:103], v[160:163]
    v_exp_f32 v116, v116
    v_mfma_f32_16x16x32_bf16 v[164:167], a[96:99], v[100:103], v[164:167]
    s_mov_b32 s30, 77824
    buffer_load_dwordx4 v[84:87], v16, s[44:47], s30 offen nt
    v_mfma_f32_16x16x32_bf16 v[164:167], a[92:95], v[96:99], v[164:167]
    v_exp_f32 v117, v117
    v_mfma_f32_16x16x32_bf16 v[168:171], a[192:195], v[96:99], v[168:171]
    v_cvt_pk_bf16_f32 v114, v116, v117
    v_add_f32 v26, v26, v27
    v_mfma_f32_16x16x32_bf16 v[168:171], a[196:199], v[100:103], v[168:171]
    v_exp_f32 v118, v118
    v_mfma_f32_16x16x32_bf16 v[172:175], a[200:203], v[100:103], v[172:175]
    v_rcp_f32 v20, v26
    v_mfma_f32_16x16x32_bf16 v[172:175], a[204:207], v[96:99], v[172:175]
    v_exp_f32 v119, v119
    v_mfma_f32_16x16x32_bf16 v[176:179], a[208:211], v[96:99], v[176:179]
    v_cvt_pk_bf16_f32 v115, v118, v119
    v_cvt_pk_bf16_f32 v81, v138, v139
    v_mfma_f32_16x16x32_bf16 v[176:179], a[212:215], v[100:103], v[176:179]
    v_exp_f32 v120, v120
    v_mfma_f32_16x16x32_bf16 v[180:183], a[216:219], v[100:103], v[180:183]
    v_cvt_pk_bf16_f32 v82, v140, v141
    v_cvt_pk_bf16_f32 v83, v142, v143
    v_mfma_f32_16x16x32_bf16 v[180:183], a[220:223], v[96:99], v[180:183]
    v_exp_f32 v121, v121
    v_mfma_f32_16x16x32_bf16 v[184:187], a[224:227], v[96:99], v[184:187]
    v_cvt_pk_bf16_f32 v116, v120, v121
    v_cndmask_b32_dpp v40, v80, v44, vcc row_ror:8 row_mask:0xf bank_mask:0xf
    v_mfma_f32_16x16x32_bf16 v[184:187], a[228:231], v[100:103], v[184:187]
    v_exp_f32 v122, v122
    v_mfma_f32_16x16x32_bf16 v[188:191], a[232:235], v[100:103], v[188:191]
    s_mov_b32 s30, 77824
    buffer_load_dwordx4 v[32:35], v16, s[44:47], s30 offen offset:64 nt
    v_mfma_f32_16x16x32_bf16 v[188:191], a[236:239], v[96:99], v[188:191]
    v_cndmask_b32_dpp v41, v81, v45, vcc row_ror:8 row_mask:0xf bank_mask:0xf
    v_cndmask_b32_dpp v42, v82, v46, vcc row_ror:8 row_mask:0xf bank_mask:0xf
    v_mfma_f32_16x16x32_bf16 v[96:99], a[128:131], a[80:83], 0
    v_exp_f32 v123, v123
    v_mfma_f32_16x16x32_bf16 v[96:99], a[132:135], a[84:87], v[96:99]
    ds_read_b128 a[128:131], v4 offset:0
    v_cvt_pk_bf16_f32 v117, v122, v123
    v_mfma_f32_16x16x32_bf16 v[96:99], a[136:139], a[88:91], v[96:99]
    v_exp_f32 v124, v124
    v_mfma_f32_16x16x32_bf16 v[96:99], a[140:143], a[0:3], v[96:99]
    ds_read_b128 a[132:135], v5 offset:0
    v_cndmask_b32_dpp v43, v83, v47, vcc row_ror:8 row_mask:0xf bank_mask:0xf
    v_mfma_f32_16x16x32_bf16 v[100:103], a[144:147], a[0:3], 0
    v_exp_f32 v125, v125
    v_subrev_u32 v26, s28, v26
    v_mov_b32 v21, v20
    v_max_u32 v19, v19, v26
    v_pk_mul_f32 v[160:161], v[160:161], v[20:21]
    v_pk_mul_f32 v[162:163], v[162:163], v[20:21]
    v_pk_mul_f32 v[164:165], v[164:165], v[20:21]
    v_pk_mul_f32 v[166:167], v[166:167], v[20:21]
    v_pk_mul_f32 v[168:169], v[168:169], v[20:21]
    v_pk_mul_f32 v[170:171], v[170:171], v[20:21]
    v_pk_mul_f32 v[172:173], v[172:173], v[20:21]
    v_pk_mul_f32 v[174:175], v[174:175], v[20:21]
    v_pk_mul_f32 v[176:177], v[176:177], v[20:21]
    v_pk_mul_f32 v[178:179], v[178:179], v[20:21]
    v_pk_mul_f32 v[180:181], v[180:181], v[20:21]
    v_pk_mul_f32 v[182:183], v[182:183], v[20:21]
    v_pk_mul_f32 v[184:185], v[184:185], v[20:21]
    v_pk_mul_f32 v[186:187], v[186:187], v[20:21]
    v_pk_mul_f32 v[188:189], v[188:189], v[20:21]
    v_pk_mul_f32 v[190:191], v[190:191], v[20:21]
    v_mov_b32 v26, 0
    v_mov_b32 v27, 0
    v_cvt_pk_bf16_f32 v88, v160, v161
    v_mfma_f32_16x16x32_bf16 v[100:103], a[148:151], a[88:91], v[100:103]
    ds_read_b128 a[136:139], v6 offset:0
    v_cvt_pk_bf16_f32 v118, v124, v125
    v_mfma_f32_16x16x32_bf16 v[100:103], a[152:155], a[84:87], v[100:103]
    v_exp_f32 v126, v126
    v_mfma_f32_16x16x32_bf16 v[100:103], a[156:159], a[80:83], v[100:103]
    ds_read_b128 a[140:143], v7 offset:0
    v_mov_b32_dpp v80, v44 row_ror:8 row_mask:0xf bank_mask:0x3
    v_mfma_f32_16x16x32_bf16 v[104:107], a[160:163], a[80:83], 0
    v_exp_f32 v127, v127
    v_mfma_f32_16x16x32_bf16 v[104:107], a[164:167], a[84:87], v[104:107]
    ds_read_b128 a[144:147], v7 offset:4096
    v_cvt_pk_bf16_f32 v119, v126, v127
    v_mfma_f32_16x16x32_bf16 v[104:107], a[168:171], a[88:91], v[104:107]
    v_exp_f32 v96, v96
    v_mfma_f32_16x16x32_bf16 v[104:107], a[172:175], a[0:3], v[104:107]
    ds_read_b128 a[148:151], v6 offset:4096
    v_mov_b32_dpp v81, v45 row_ror:8 row_mask:0xf bank_mask:0x3
    v_mfma_f32_16x16x32_bf16 v[108:111], a[176:179], a[0:3], 0
    v_exp_f32 v97, v97
    v_mfma_f32_16x16x32_bf16 v[108:111], a[180:183], a[88:91], v[108:111]
    ds_read_b128 a[152:155], v5 offset:4096
    v_cvt_pk_bf16_f32 v96, v96, v97
    v_mfma_f32_16x16x32_bf16 v[108:111], a[184:187], a[84:87], v[108:111]
    v_exp_f32 v98, v98
    v_mfma_f32_16x16x32_bf16 v[108:111], a[188:191], a[80:83], v[108:111]
    ds_read_b128 a[156:159], v4 offset:4096
    v_mov_b32_dpp v82, v46 row_ror:8 row_mask:0xf bank_mask:0x3
    v_smfmac_f32_16x16x64_bf16 v[28:31], a[120:123], v[112:119], v22
    v_exp_f32 v99, v99
    v_mfma_f32_16x16x32_bf16 v[192:195], a[104:107], v[112:115], v[192:195]
    ds_read_b128 a[160:163], v4 offset:8192
    v_cvt_pk_bf16_f32 v97, v98, v99
    v_mfma_f32_16x16x32_bf16 v[192:195], a[100:103], v[116:119], v[192:195]
    v_exp_f32 v100, v100
    v_mfma_f32_16x16x32_bf16 v[196:199], a[96:99], v[116:119], v[196:199]
    ds_read_b128 a[164:167], v5 offset:8192
    v_mov_b32_dpp v83, v47 row_ror:8 row_mask:0xf bank_mask:0x3
    v_mfma_f32_16x16x32_bf16 v[196:199], a[92:95], v[112:115], v[196:199]
    v_exp_f32 v101, v101
    v_mfma_f32_16x16x32_bf16 v[200:203], a[192:195], v[112:115], v[200:203]
    ds_read_b128 a[168:171], v6 offset:8192
    v_cvt_pk_bf16_f32 v98, v100, v101
    v_mfma_f32_16x16x32_bf16 v[200:203], a[196:199], v[116:119], v[200:203]
    v_exp_f32 v102, v102
    v_mfma_f32_16x16x32_bf16 v[204:207], a[200:203], v[116:119], v[204:207]
    ds_read_b128 a[172:175], v7 offset:8192
    v_cvt_pk_bf16_f32 v36, v144, v145
    v_mfma_f32_16x16x32_bf16 v[204:207], a[204:207], v[112:115], v[204:207]
    v_exp_f32 v103, v103
    v_mfma_f32_16x16x32_bf16 v[208:211], a[208:211], v[112:115], v[208:211]
    ds_read_b128 a[176:179], v7 offset:12288
    v_cvt_pk_bf16_f32 v99, v102, v103
    v_mfma_f32_16x16x32_bf16 v[208:211], a[212:215], v[116:119], v[208:211]
    v_exp_f32 v104, v104
    v_mfma_f32_16x16x32_bf16 v[212:215], a[216:219], v[116:119], v[212:215]
    s_mov_b32 s31, 0
    ds_read_b128 a[180:183], v6 offset:12288
    buffer_store_dwordx4 v[40:43], v23, s[56:59], s31 offen offset:0 sc1
    v_mfma_f32_16x16x32_bf16 v[212:215], a[220:223], v[112:115], v[212:215]
    v_exp_f32 v105, v105
    v_mfma_f32_16x16x32_bf16 v[216:219], a[224:227], v[112:115], v[216:219]
    ds_read_b128 a[184:187], v5 offset:12288
    v_cvt_pk_bf16_f32 v100, v104, v105
    v_mfma_f32_16x16x32_bf16 v[216:219], a[228:231], v[116:119], v[216:219]
    v_exp_f32 v106, v106
    v_mfma_f32_16x16x32_bf16 v[220:223], a[232:235], v[116:119], v[220:223]
    ds_read_b128 a[188:191], v4 offset:12288
    v_cvt_pk_bf16_f32 v37, v146, v147
    v_mfma_f32_16x16x32_bf16 v[220:223], a[236:239], v[112:115], v[220:223]
    s_waitcnt lgkmcnt(4)
    ds_read_b64_tr_b16 a[240:241], v12 offset:49152
    ds_read_b64_tr_b16 a[242:243], v12 offset:53248
    v_mfma_f32_16x16x32_bf16 v[112:115], a[128:131], a[4:7], 0
    v_exp_f32 v107, v107
    v_mfma_f32_16x16x32_bf16 v[112:115], a[132:135], a[8:11], v[112:115]
    ds_read_b64_tr_b16 a[244:245], v12 offset:57344
    v_cvt_pk_bf16_f32 v101, v106, v107
    v_mfma_f32_16x16x32_bf16 v[112:115], a[136:139], a[12:15], v[112:115]
    v_exp_f32 v108, v108
    v_mfma_f32_16x16x32_bf16 v[112:115], a[140:143], a[16:19], v[112:115]
    ds_read_b64_tr_b16 a[246:247], v12 offset:61440
    ds_read_b64_tr_b16 a[248:249], v12 offset:57352
    v_mfma_f32_16x16x32_bf16 v[116:119], a[144:147], a[16:19], 0
    v_exp_f32 v109, v109
    v_mfma_f32_16x16x32_bf16 v[116:119], a[148:151], a[12:15], v[116:119]
    ds_read_b64_tr_b16 a[250:251], v12 offset:61448
    v_cvt_pk_bf16_f32 v102, v108, v109
    v_mfma_f32_16x16x32_bf16 v[116:119], a[152:155], a[8:11], v[116:119]
    v_exp_f32 v110, v110
    v_mfma_f32_16x16x32_bf16 v[116:119], a[156:159], a[4:7], v[116:119]
    ds_read_b64_tr_b16 a[252:253], v12 offset:49160
    v_cvt_pk_bf16_f32 v38, v148, v149
    v_mfma_f32_16x16x32_bf16 v[120:123], a[160:163], a[4:7], 0
    v_exp_f32 v111, v111
    v_mfma_f32_16x16x32_bf16 v[120:123], a[164:167], a[8:11], v[120:123]
    ds_read_b64_tr_b16 a[254:255], v12 offset:53256
    v_cvt_pk_bf16_f32 v103, v110, v111
    v_mfma_f32_16x16x32_bf16 v[120:123], a[168:171], a[12:15], v[120:123]
    s_mov_b32 s31, 0
    v_exp_f32 v112, v112
    v_mfma_f32_16x16x32_bf16 v[120:123], a[172:175], a[16:19], v[120:123]
    s_waitcnt lgkmcnt(5)
    ds_read_b64_tr_b16 a[116:117], v13 offset:49152
    buffer_store_dwordx4 v[80:83], v23, s[56:59], s31 offen offset:2048 sc1
    v_mfma_f32_16x16x32_bf16 v[124:127], a[176:179], a[16:19], 0
    v_exp_f32 v113, v113
    v_mfma_f32_16x16x32_bf16 v[124:127], a[180:183], a[12:15], v[124:127]
    ds_read_b64_tr_b16 a[118:119], v13 offset:53248
    v_cvt_pk_bf16_f32 v112, v112, v113
    v_mfma_f32_16x16x32_bf16 v[124:127], a[184:187], a[8:11], v[124:127]
    v_exp_f32 v114, v114
    v_mfma_f32_16x16x32_bf16 v[124:127], a[188:191], a[4:7], v[124:127]
    ds_read_b64_tr_b16 a[112:113], v13 offset:57344
    v_cvt_pk_bf16_f32 v39, v150, v151
    v_smfmac_f32_16x16x64_bf16 v[28:31], a[124:127], v[96:103], v22
    v_exp_f32 v115, v115
    v_mfma_f32_16x16x32_bf16 v[224:227], a[104:107], v[96:99], v[224:227]
    ds_read_b64_tr_b16 a[114:115], v13 offset:61440
    v_cvt_pk_bf16_f32 v113, v114, v115
    v_mfma_f32_16x16x32_bf16 v[224:227], a[100:103], v[100:103], v[224:227]
    v_exp_f32 v116, v116
    v_mfma_f32_16x16x32_bf16 v[228:231], a[96:99], v[100:103], v[228:231]
    ds_read_b64_tr_b16 a[108:109], v13 offset:57352
    v_cvt_pk_bf16_f32 v56, v152, v153
    v_mfma_f32_16x16x32_bf16 v[228:231], a[92:95], v[96:99], v[228:231]
    v_exp_f32 v117, v117
    v_mfma_f32_16x16x32_bf16 v[232:235], a[192:195], v[96:99], v[232:235]
    ds_read_b64_tr_b16 a[110:111], v13 offset:61448
    v_cvt_pk_bf16_f32 v114, v116, v117
    v_mfma_f32_16x16x32_bf16 v[232:235], a[196:199], v[100:103], v[232:235]
    v_exp_f32 v118, v118
    v_mfma_f32_16x16x32_bf16 v[236:239], a[200:203], v[100:103], v[236:239]
    ds_read_b64_tr_b16 a[104:105], v13 offset:49160
    v_cvt_pk_bf16_f32 v57, v154, v155
    v_mfma_f32_16x16x32_bf16 v[236:239], a[204:207], v[96:99], v[236:239]
    v_exp_f32 v119, v119
    v_mfma_f32_16x16x32_bf16 v[240:243], a[208:211], v[96:99], v[240:243]
    ds_read_b64_tr_b16 a[106:107], v13 offset:53256
    v_cvt_pk_bf16_f32 v115, v118, v119
    v_mfma_f32_16x16x32_bf16 v[240:243], a[212:215], v[100:103], v[240:243]
    v_exp_f32 v120, v120
    v_mfma_f32_16x16x32_bf16 v[244:247], a[216:219], v[100:103], v[244:247]
    ds_read_b64_tr_b16 a[100:101], v14 offset:49152
    v_cvt_pk_bf16_f32 v58, v156, v157
    v_mfma_f32_16x16x32_bf16 v[244:247], a[220:223], v[96:99], v[244:247]
    v_exp_f32 v121, v121
    v_mfma_f32_16x16x32_bf16 v[248:251], a[224:227], v[96:99], v[248:251]
    ds_read_b64_tr_b16 a[102:103], v14 offset:53248
    v_cvt_pk_bf16_f32 v116, v120, v121
    v_mfma_f32_16x16x32_bf16 v[248:251], a[228:231], v[100:103], v[248:251]
    v_exp_f32 v122, v122
    v_mfma_f32_16x16x32_bf16 v[252:255], a[232:235], v[100:103], v[252:255]
    ds_read_b64_tr_b16 a[96:97], v14 offset:57344
    v_cvt_pk_bf16_f32 v59, v158, v159
    v_mfma_f32_16x16x32_bf16 v[252:255], a[236:239], v[96:99], v[252:255]
    ds_read_b64_tr_b16 a[98:99], v14 offset:61440
    v_cvt_pk_bf16_f32 v89, v162, v163
    v_mfma_f32_16x16x32_bf16 v[96:99], a[128:131], a[20:23], 0
    v_exp_f32 v123, v123
    v_mfma_f32_16x16x32_bf16 v[96:99], a[132:135], a[24:27], v[96:99]
    ds_read_b64_tr_b16 a[92:93], v14 offset:57352
    v_cvt_pk_bf16_f32 v117, v122, v123
    v_mfma_f32_16x16x32_bf16 v[96:99], a[136:139], a[28:31], v[96:99]
    v_exp_f32 v124, v124
    v_mfma_f32_16x16x32_bf16 v[96:99], a[140:143], a[32:35], v[96:99]
    ds_read_b64_tr_b16 a[94:95], v14 offset:61448
    v_cvt_pk_bf16_f32 v90, v164, v165
    v_mfma_f32_16x16x32_bf16 v[100:103], a[144:147], a[32:35], 0
    v_exp_f32 v125, v125
    v_mfma_f32_16x16x32_bf16 v[100:103], a[148:151], a[28:31], v[100:103]
    ds_read_b64_tr_b16 a[192:193], v14 offset:49160
    v_cvt_pk_bf16_f32 v118, v124, v125
    v_mfma_f32_16x16x32_bf16 v[100:103], a[152:155], a[24:27], v[100:103]
    v_exp_f32 v126, v126
    v_mfma_f32_16x16x32_bf16 v[100:103], a[156:159], a[20:23], v[100:103]
    ds_read_b64_tr_b16 a[194:195], v14 offset:53256
    v_cvt_pk_bf16_f32 v91, v166, v167
    v_mfma_f32_16x16x32_bf16 v[104:107], a[160:163], a[20:23], 0
    v_exp_f32 v127, v127
    v_mfma_f32_16x16x32_bf16 v[104:107], a[164:167], a[24:27], v[104:107]
    ds_read_b64_tr_b16 a[196:197], v15 offset:49152
    v_cvt_pk_bf16_f32 v119, v126, v127
    v_mfma_f32_16x16x32_bf16 v[104:107], a[168:171], a[28:31], v[104:107]
    v_exp_f32 v96, v96
    v_mfma_f32_16x16x32_bf16 v[104:107], a[172:175], a[32:35], v[104:107]
    ds_read_b64_tr_b16 a[198:199], v15 offset:53248
    v_cvt_pk_bf16_f32 v68, v168, v169
    v_mfma_f32_16x16x32_bf16 v[108:111], a[176:179], a[32:35], 0
    v_exp_f32 v97, v97
    v_mfma_f32_16x16x32_bf16 v[108:111], a[180:183], a[28:31], v[108:111]
    ds_read_b64_tr_b16 a[200:201], v15 offset:57344
    v_cvt_pk_bf16_f32 v96, v96, v97
    v_mfma_f32_16x16x32_bf16 v[108:111], a[184:187], a[24:27], v[108:111]
    v_exp_f32 v98, v98
    v_mfma_f32_16x16x32_bf16 v[108:111], a[188:191], a[20:23], v[108:111]
    ds_read_b64_tr_b16 a[202:203], v15 offset:61440
    v_cvt_pk_bf16_f32 v69, v170, v171
    v_smfmac_f32_16x16x64_bf16 v[24:27], a[120:123], v[112:119], v22
    v_exp_f32 v99, v99
    v_mfma_f32_16x16x32_bf16 v[128:131], a[240:243], v[112:115], 0
    s_waitcnt lgkmcnt(4)
    ds_read_b64_tr_b16 a[204:205], v15 offset:57352
    v_cvt_pk_bf16_f32 v97, v98, v99
    v_mfma_f32_16x16x32_bf16 v[128:131], a[244:247], v[116:119], v[128:131]
    v_exp_f32 v100, v100
    v_mfma_f32_16x16x32_bf16 v[132:135], a[248:251], v[116:119], 0
    ds_read_b64_tr_b16 a[206:207], v15 offset:61448
    v_cvt_pk_bf16_f32 v70, v172, v173
    v_mfma_f32_16x16x32_bf16 v[132:135], a[252:255], v[112:115], v[132:135]
    v_exp_f32 v101, v101
    v_mfma_f32_16x16x32_bf16 v[136:139], a[116:119], v[112:115], 0
    ds_read_b64_tr_b16 a[208:209], v15 offset:49160
    v_cvt_pk_bf16_f32 v98, v100, v101
    v_mfma_f32_16x16x32_bf16 v[136:139], a[112:115], v[116:119], v[136:139]
    v_exp_f32 v102, v102
    v_mfma_f32_16x16x32_bf16 v[140:143], a[108:111], v[116:119], 0
    ds_read_b64_tr_b16 a[210:211], v15 offset:53256
    v_cvt_pk_bf16_f32 v71, v174, v175
    v_mfma_f32_16x16x32_bf16 v[140:143], a[104:107], v[112:115], v[140:143]
    v_exp_f32 v103, v103
    v_mfma_f32_16x16x32_bf16 v[144:147], a[100:103], v[112:115], 0
    v_cvt_pk_bf16_f32 v99, v102, v103
    v_lshlrev_b32 v0, 16, v60
    v_mfma_f32_16x16x32_bf16 v[144:147], a[96:99], v[116:119], v[144:147]
    v_exp_f32 v104, v104
    v_mfma_f32_16x16x32_bf16 v[148:151], a[92:95], v[116:119], 0
    v_lshlrev_b32 v1, 16, v61
    v_lshlrev_b32 v2, 16, v62
    v_mfma_f32_16x16x32_bf16 v[148:151], a[192:195], v[112:115], v[148:151]
    s_waitcnt lgkmcnt(3)
    v_exp_f32 v105, v105
    v_mfma_f32_16x16x32_bf16 v[152:155], a[196:199], v[112:115], 0
    v_cvt_pk_bf16_f32 v100, v104, v105
    v_lshlrev_b32 v3, 16, v63
    v_mfma_f32_16x16x32_bf16 v[152:155], a[200:203], v[116:119], v[152:155]
    s_waitcnt lgkmcnt(1)
    v_exp_f32 v106, v106
    v_mfma_f32_16x16x32_bf16 v[156:159], a[204:207], v[116:119], 0
    v_and_b32 v60, s25, v60
    v_cvt_pk_bf16_f32 v48, v176, v177
    v_and_b32 v61, s25, v61
    v_and_b32 v62, s25, v62
    v_and_b32 v63, s25, v63
    v_pk_mul_f32 v[0:1], v[0:1], s[34:35]
    v_pk_mul_f32 v[2:3], v[2:3], s[34:35]
    v_pk_mul_f32 v[60:61], v[60:61], s[34:35]
    v_pk_mul_f32 v[62:63], v[62:63], s[34:35]
    v_cvt_pk_bf16_f32 v60, v0, v60
    v_cvt_pk_bf16_f32 v61, v1, v61
    v_cvt_pk_bf16_f32 v62, v2, v62
    s_waitcnt lgkmcnt(0)
    v_mfma_f32_16x16x32_bf16 v[156:159], a[208:211], v[112:115], v[156:159]
    s_waitcnt vmcnt(4)
    v_cvt_pk_bf16_f32 v63, v3, v63
    v_accvgpr_write_b32 a36, v60
    v_mfma_f32_16x16x32_bf16 v[112:115], a[128:131], a[64:67], 0
    s_barrier
    v_exp_f32 v107, v107
    v_mfma_f32_16x16x32_bf16 v[112:115], a[132:135], a[68:71], v[112:115]
    s_add_u32 s29, s27, 32768
    v_cvt_pk_bf16_f32 v101, v106, v107
    v_accvgpr_write_b32 a37, v61
    v_mfma_f32_16x16x32_bf16 v[112:115], a[136:139], a[72:75], v[112:115]
    s_add_u32 m0, s27, 147456
    v_exp_f32 v108, v108
    v_mfma_f32_16x16x32_bf16 v[112:115], a[140:143], a[76:79], v[112:115]
    buffer_load_dwordx4 v18, s[52:55], s29 offen lds
    v_mfma_f32_16x16x32_bf16 v[116:119], a[144:147], a[76:79], 0
    v_exp_f32 v109, v109
    v_mfma_f32_16x16x32_bf16 v[116:119], a[148:151], a[72:75], v[116:119]
    v_cvt_pk_bf16_f32 v102, v108, v109
    v_accvgpr_write_b32 a38, v62
    v_mfma_f32_16x16x32_bf16 v[116:119], a[152:155], a[68:71], v[116:119]
    v_exp_f32 v110, v110
    v_mfma_f32_16x16x32_bf16 v[116:119], a[156:159], a[64:67], v[116:119]
    buffer_load_dwordx4 v18, s[52:55], s29 offen offset:1024 lds
    v_mfma_f32_16x16x32_bf16 v[120:123], a[160:163], a[64:67], 0
    v_exp_f32 v111, v111
    v_mfma_f32_16x16x32_bf16 v[120:123], a[164:167], a[68:71], v[120:123]
    v_cvt_pk_bf16_f32 v103, v110, v111
    v_accvgpr_write_b32 a39, v63
    v_mfma_f32_16x16x32_bf16 v[120:123], a[168:171], a[72:75], v[120:123]
    v_exp_f32 v112, v112
    v_mfma_f32_16x16x32_bf16 v[120:123], a[172:175], a[76:79], v[120:123]
    buffer_load_dwordx4 v18, s[52:55], s29 offen offset:2048 lds
    v_mfma_f32_16x16x32_bf16 v[124:127], a[176:179], a[76:79], 0
    v_exp_f32 v113, v113
    v_mfma_f32_16x16x32_bf16 v[124:127], a[180:183], a[72:75], v[124:127]
    v_cvt_pk_bf16_f32 v112, v112, v113
    v_cvt_pk_bf16_f32 v49, v178, v179
    v_mfma_f32_16x16x32_bf16 v[124:127], a[184:187], a[68:71], v[124:127]
    v_exp_f32 v114, v114
    v_mfma_f32_16x16x32_bf16 v[124:127], a[188:191], a[64:67], v[124:127]
    buffer_load_dwordx4 v18, s[52:55], s29 offen offset:3072 lds
    v_smfmac_f32_16x16x64_bf16 v[24:27], a[124:127], v[96:103], v22
    v_exp_f32 v115, v115
    v_mfma_f32_16x16x32_bf16 v[160:163], a[240:243], v[96:99], 0
    v_cvt_pk_bf16_f32 v113, v114, v115
    v_cvt_pk_bf16_f32 v50, v180, v181
    v_mfma_f32_16x16x32_bf16 v[160:163], a[244:247], v[100:103], v[160:163]
    v_exp_f32 v116, v116
    v_mfma_f32_16x16x32_bf16 v[164:167], a[248:251], v[100:103], 0
    s_mov_b32 s30, 77824
    buffer_load_dwordx4 v[76:79], v16, s[44:47], s30 offen offset:128 nt
    v_mfma_f32_16x16x32_bf16 v[164:167], a[252:255], v[96:99], v[164:167]
    v_exp_f32 v117, v117
    v_mfma_f32_16x16x32_bf16 v[168:171], a[116:119], v[96:99], 0
    v_cvt_pk_bf16_f32 v114, v116, v117
    v_cvt_pk_bf16_f32 v51, v182, v183
    v_mfma_f32_16x16x32_bf16 v[168:171], a[112:115], v[100:103], v[168:171]
    v_exp_f32 v118, v118
    v_mfma_f32_16x16x32_bf16 v[172:175], a[108:111], v[100:103], 0
    v_cvt_pk_bf16_f32 v64, v184, v185
    v_cvt_pk_bf16_f32 v65, v186, v187
    v_mfma_f32_16x16x32_bf16 v[172:175], a[104:107], v[96:99], v[172:175]
    v_exp_f32 v119, v119
    v_mfma_f32_16x16x32_bf16 v[176:179], a[100:103], v[96:99], 0
    v_cvt_pk_bf16_f32 v115, v118, v119
    v_cvt_pk_bf16_f32 v66, v188, v189
    v_mfma_f32_16x16x32_bf16 v[176:179], a[96:99], v[100:103], v[176:179]
Lpad10:
    s_cbranch_execz Lpad14
    v_exp_f32 v120, v120
    v_mfma_f32_16x16x32_bf16 v[180:183], a[92:95], v[100:103], 0
    v_cvt_pk_bf16_f32 v67, v190, v191
    v_cndmask_b32_dpp v44, v56, v36, vcc row_ror:8 row_mask:0xf bank_mask:0xf
    v_mfma_f32_16x16x32_bf16 v[180:183], a[192:195], v[96:99], v[180:183]
    v_exp_f32 v121, v121
    v_mfma_f32_16x16x32_bf16 v[184:187], a[196:199], v[96:99], 0
    v_cvt_pk_bf16_f32 v116, v120, v121
    v_cndmask_b32_dpp v45, v57, v37, vcc row_ror:8 row_mask:0xf bank_mask:0xf
    v_mfma_f32_16x16x32_bf16 v[184:187], a[200:203], v[100:103], v[184:187]
    v_exp_f32 v122, v122
    v_mfma_f32_16x16x32_bf16 v[188:191], a[204:207], v[100:103], 0
    s_mov_b32 s30, 77824
    buffer_load_dwordx4 v[40:43], v16, s[44:47], s30 offen offset:192 nt
    v_mfma_f32_16x16x32_bf16 v[188:191], a[208:211], v[96:99], v[188:191]
    v_cndmask_b32_dpp v46, v58, v38, vcc row_ror:8 row_mask:0xf bank_mask:0xf
    v_cndmask_b32_dpp v47, v59, v39, vcc row_ror:8 row_mask:0xf bank_mask:0xf
    v_mfma_f32_16x16x32_bf16 v[96:99], a[128:131], a[80:83], 0
    v_exp_f32 v123, v123
    v_mfma_f32_16x16x32_bf16 v[96:99], a[132:135], a[84:87], v[96:99]
    ds_read_b128 a[128:131], v4 offset:16384
    v_cvt_pk_bf16_f32 v117, v122, v123
    v_mfma_f32_16x16x32_bf16 v[96:99], a[136:139], a[88:91], v[96:99]
    v_exp_f32 v124, v124
    v_mfma_f32_16x16x32_bf16 v[96:99], a[140:143], a[0:3], v[96:99]
    ds_read_b128 a[132:135], v5 offset:16384
    v_mov_b32_dpp v56, v36 row_ror:8 row_mask:0xf bank_mask:0x3
    v_mfma_f32_16x16x32_bf16 v[100:103], a[144:147], a[0:3], 0
    v_exp_f32 v125, v125
    v_mfma_f32_16x16x32_bf16 v[100:103], a[148:151], a[88:91], v[100:103]
    ds_read_b128 a[136:139], v6 offset:16384
    v_cvt_pk_bf16_f32 v118, v124, v125
    v_mfma_f32_16x16x32_bf16 v[100:103], a[152:155], a[84:87], v[100:103]
    v_exp_f32 v126, v126
    v_mfma_f32_16x16x32_bf16 v[100:103], a[156:159], a[80:83], v[100:103]
    ds_read_b128 a[140:143], v7 offset:16384
    v_mov_b32_dpp v57, v37 row_ror:8 row_mask:0xf bank_mask:0x3
    v_mfma_f32_16x16x32_bf16 v[104:107], a[160:163], a[80:83], 0
    v_exp_f32 v127, v127
    v_mfma_f32_16x16x32_bf16 v[104:107], a[164:167], a[84:87], v[104:107]
    ds_read_b128 a[144:147], v7 offset:20480
    v_cvt_pk_bf16_f32 v119, v126, v127
    v_mfma_f32_16x16x32_bf16 v[104:107], a[168:171], a[88:91], v[104:107]
    v_exp_f32 v96, v96
    v_mfma_f32_16x16x32_bf16 v[104:107], a[172:175], a[0:3], v[104:107]
    ds_read_b128 a[148:151], v6 offset:20480
    v_mov_b32_dpp v58, v38 row_ror:8 row_mask:0xf bank_mask:0x3
    v_mfma_f32_16x16x32_bf16 v[108:111], a[176:179], a[0:3], 0
    v_exp_f32 v97, v97
    v_mfma_f32_16x16x32_bf16 v[108:111], a[180:183], a[88:91], v[108:111]
    ds_read_b128 a[152:155], v5 offset:20480
    v_cvt_pk_bf16_f32 v96, v96, v97
    v_mfma_f32_16x16x32_bf16 v[108:111], a[184:187], a[84:87], v[108:111]
    v_exp_f32 v98, v98
    v_mfma_f32_16x16x32_bf16 v[108:111], a[188:191], a[80:83], v[108:111]
    ds_read_b128 a[156:159], v4 offset:20480
    v_mov_b32_dpp v59, v39 row_ror:8 row_mask:0xf bank_mask:0x3
    v_smfmac_f32_16x16x64_bf16 v[28:31], a[120:123], v[112:119], v22
    v_exp_f32 v99, v99
    v_mfma_f32_16x16x32_bf16 v[192:195], a[240:243], v[112:115], v[192:195]
    ds_read_b128 a[160:163], v4 offset:24576
    v_cvt_pk_bf16_f32 v97, v98, v99
    v_mfma_f32_16x16x32_bf16 v[192:195], a[244:247], v[116:119], v[192:195]
    v_exp_f32 v100, v100
    v_mfma_f32_16x16x32_bf16 v[196:199], a[248:251], v[116:119], v[196:199]
    ds_read_b128 a[164:167], v5 offset:24576
    v_lshlrev_b32 v0, 16, v52
    v_mfma_f32_16x16x32_bf16 v[196:199], a[252:255], v[112:115], v[196:199]
    v_exp_f32 v101, v101
    v_mfma_f32_16x16x32_bf16 v[200:203], a[116:119], v[112:115], v[200:203]
    ds_read_b128 a[168:171], v6 offset:24576
    v_cvt_pk_bf16_f32 v98, v100, v101
    v_mfma_f32_16x16x32_bf16 v[200:203], a[112:115], v[116:119], v[200:203]
    v_exp_f32 v102, v102
    v_mfma_f32_16x16x32_bf16 v[204:207], a[108:111], v[116:119], v[204:207]
    s_mov_b32 s31, 0
    ds_read_b128 a[172:175], v7 offset:24576
    buffer_store_dwordx4 v[44:47], v23, s[56:59], s31 offen offset:128 sc1
    v_mfma_f32_16x16x32_bf16 v[204:207], a[104:107], v[112:115], v[204:207]
    v_exp_f32 v103, v103
    v_mfma_f32_16x16x32_bf16 v[208:211], a[100:103], v[112:115], v[208:211]
    ds_read_b128 a[176:179], v7 offset:28672
    v_cvt_pk_bf16_f32 v99, v102, v103
    v_mfma_f32_16x16x32_bf16 v[208:211], a[96:99], v[116:119], v[208:211]
    v_exp_f32 v104, v104
    v_mfma_f32_16x16x32_bf16 v[212:215], a[92:95], v[116:119], v[212:215]
    ds_read_b128 a[180:183], v6 offset:28672
    v_add_f32 v28, v28, v29
    v_mfma_f32_16x16x32_bf16 v[212:215], a[192:195], v[112:115], v[212:215]
    v_exp_f32 v105, v105
    v_mfma_f32_16x16x32_bf16 v[216:219], a[196:199], v[112:115], v[216:219]
    ds_read_b128 a[184:187], v5 offset:28672
    v_cvt_pk_bf16_f32 v100, v104, v105
    v_mfma_f32_16x16x32_bf16 v[216:219], a[200:203], v[116:119], v[216:219]
    v_exp_f32 v106, v106
    v_mfma_f32_16x16x32_bf16 v[220:223], a[204:207], v[116:119], v[220:223]
    ds_read_b128 a[188:191], v4 offset:28672
    v_lshlrev_b32 v1, 16, v53
    v_mfma_f32_16x16x32_bf16 v[220:223], a[208:211], v[112:115], v[220:223]
    s_waitcnt lgkmcnt(5)
    ds_read_b64_tr_b16 a[212:213], v12 offset:32768
    ds_read_b64_tr_b16 a[214:215], v12 offset:36864
    v_rcp_f32 v20, v28
    v_mfma_f32_16x16x32_bf16 v[112:115], a[128:131], a[4:7], 0
    v_exp_f32 v107, v107
    v_mfma_f32_16x16x32_bf16 v[112:115], a[132:135], a[8:11], v[112:115]
    ds_read_b64_tr_b16 a[216:217], v12 offset:40960
    v_cvt_pk_bf16_f32 v101, v106, v107
    v_mfma_f32_16x16x32_bf16 v[112:115], a[136:139], a[12:15], v[112:115]
    v_exp_f32 v108, v108
    v_mfma_f32_16x16x32_bf16 v[112:115], a[140:143], a[16:19], v[112:115]
    ds_read_b64_tr_b16 a[218:219], v12 offset:45056
    ds_read_b64_tr_b16 a[220:221], v12 offset:40968
    v_mfma_f32_16x16x32_bf16 v[116:119], a[144:147], a[16:19], 0
    v_exp_f32 v109, v109
    v_subrev_u32 v28, s28, v28
    v_mov_b32 v21, v20
    v_max_u32 v19, v19, v28
    v_pk_mul_f32 v[192:193], v[192:193], v[20:21]
    v_pk_mul_f32 v[194:195], v[194:195], v[20:21]
    v_pk_mul_f32 v[196:197], v[196:197], v[20:21]
    v_pk_mul_f32 v[198:199], v[198:199], v[20:21]
    v_pk_mul_f32 v[200:201], v[200:201], v[20:21]
    v_pk_mul_f32 v[202:203], v[202:203], v[20:21]
    v_pk_mul_f32 v[204:205], v[204:205], v[20:21]
    v_pk_mul_f32 v[206:207], v[206:207], v[20:21]
    v_pk_mul_f32 v[208:209], v[208:209], v[20:21]
    v_pk_mul_f32 v[210:211], v[210:211], v[20:21]
    v_pk_mul_f32 v[212:213], v[212:213], v[20:21]
    v_pk_mul_f32 v[214:215], v[214:215], v[20:21]
    v_pk_mul_f32 v[216:217], v[216:217], v[20:21]
    v_pk_mul_f32 v[218:219], v[218:219], v[20:21]
    v_pk_mul_f32 v[220:221], v[220:221], v[20:21]
    v_pk_mul_f32 v[222:223], v[222:223], v[20:21]
    v_mov_b32 v28, 0
    v_mov_b32 v29, 0
    v_cvt_pk_bf16_f32 v80, v192, v193
    v_mfma_f32_16x16x32_bf16 v[116:119], a[148:151], a[12:15], v[116:119]
    ds_read_b64_tr_b16 a[222:223], v12 offset:45064
    v_cvt_pk_bf16_f32 v102, v108, v109
    v_mfma_f32_16x16x32_bf16 v[116:119], a[152:155], a[8:11], v[116:119]
    v_exp_f32 v110, v110
    v_mfma_f32_16x16x32_bf16 v[116:119], a[156:159], a[4:7], v[116:119]
    s_mov_b32 s31, 0
    ds_read_b64_tr_b16 a[224:225], v12 offset:32776
    buffer_store_dwordx4 v[56:59], v23, s[56:59], s31 offen offset:2176 sc1
    v_mfma_f32_16x16x32_bf16 v[120:123], a[160:163], a[4:7], 0
    v_exp_f32 v111, v111
    v_mfma_f32_16x16x32_bf16 v[120:123], a[164:167], a[8:11], v[120:123]
    ds_read_b64_tr_b16 a[226:227], v12 offset:36872
    v_cvt_pk_bf16_f32 v103, v110, v111
    v_mfma_f32_16x16x32_bf16 v[120:123], a[168:171], a[12:15], v[120:123]
    s_waitcnt lgkmcnt(3)
    v_exp_f32 v112, v112
    v_mfma_f32_16x16x32_bf16 v[120:123], a[172:175], a[16:19], v[120:123]
    ds_read_b64_tr_b16 a[228:229], v13 offset:32768
    v_lshlrev_b32 v2, 16, v54
    v_mfma_f32_16x16x32_bf16 v[124:127], a[176:179], a[16:19], 0
    v_exp_f32 v113, v113
    v_mfma_f32_16x16x32_bf16 v[124:127], a[180:183], a[12:15], v[124:127]
    ds_read_b64_tr_b16 a[230:231], v13 offset:36864
    v_cvt_pk_bf16_f32 v112, v112, v113
    v_mfma_f32_16x16x32_bf16 v[124:127], a[184:187], a[8:11], v[124:127]
    v_exp_f32 v114, v114
    v_mfma_f32_16x16x32_bf16 v[124:127], a[188:191], a[4:7], v[124:127]
    ds_read_b64_tr_b16 a[232:233], v13 offset:40960
    v_lshlrev_b32 v3, 16, v55
    v_smfmac_f32_16x16x64_bf16 v[28:31], a[124:127], v[96:103], v22
    v_exp_f32 v115, v115
    v_mfma_f32_16x16x32_bf16 v[224:227], a[240:243], v[96:99], v[224:227]
    ds_read_b64_tr_b16 a[234:235], v13 offset:45056
    v_cvt_pk_bf16_f32 v113, v114, v115
    v_mfma_f32_16x16x32_bf16 v[224:227], a[244:247], v[100:103], v[224:227]
    v_exp_f32 v116, v116
    v_mfma_f32_16x16x32_bf16 v[228:231], a[248:251], v[100:103], v[228:231]
    ds_read_b64_tr_b16 a[236:237], v13 offset:40968
    v_and_b32 v52, s25, v52
    v_and_b32 v53, s25, v53
    v_and_b32 v54, s25, v54
    v_and_b32 v55, s25, v55
    v_pk_mul_f32 v[0:1], v[0:1], s[34:35]
    v_pk_mul_f32 v[2:3], v[2:3], s[34:35]
    v_pk_mul_f32 v[52:53], v[52:53], s[34:35]
    v_pk_mul_f32 v[54:55], v[54:55], s[34:35]
    v_cvt_pk_bf16_f32 v52, v0, v52
    v_cvt_pk_bf16_f32 v53, v1, v53
    v_cvt_pk_bf16_f32 v54, v2, v54
    v_mfma_f32_16x16x32_bf16 v[228:231], a[252:255], v[96:99], v[228:231]
    v_exp_f32 v117, v117
    v_mfma_f32_16x16x32_bf16 v[232:235], a[116:119], v[96:99], v[232:235]
    ds_read_b64_tr_b16 a[238:239], v13 offset:45064
    v_cvt_pk_bf16_f32 v114, v116, v117
    v_mfma_f32_16x16x32_bf16 v[232:235], a[112:115], v[100:103], v[232:235]
    v_exp_f32 v118, v118
    v_mfma_f32_16x16x32_bf16 v[236:239], a[108:111], v[100:103], v[236:239]
    ds_read_b64_tr_b16 a[240:241], v13 offset:32776
    v_cvt_pk_bf16_f32 v55, v3, v55
    v_mfma_f32_16x16x32_bf16 v[236:239], a[104:107], v[96:99], v[236:239]
    v_exp_f32 v119, v119
    v_mfma_f32_16x16x32_bf16 v[240:243], a[100:103], v[96:99], v[240:243]
    ds_read_b64_tr_b16 a[242:243], v13 offset:36872
    v_cvt_pk_bf16_f32 v115, v118, v119
    v_mfma_f32_16x16x32_bf16 v[240:243], a[96:99], v[100:103], v[240:243]
    v_exp_f32 v120, v120
    v_mfma_f32_16x16x32_bf16 v[244:247], a[92:95], v[100:103], v[244:247]
    ds_read_b64_tr_b16 a[244:245], v14 offset:32768
    v_accvgpr_write_b32 a40, v52
    v_mfma_f32_16x16x32_bf16 v[244:247], a[192:195], v[96:99], v[244:247]
    v_exp_f32 v121, v121
    v_mfma_f32_16x16x32_bf16 v[248:251], a[196:199], v[96:99], v[248:251]
    ds_read_b64_tr_b16 a[246:247], v14 offset:36864
    v_cvt_pk_bf16_f32 v116, v120, v121
    v_mfma_f32_16x16x32_bf16 v[248:251], a[200:203], v[100:103], v[248:251]
    v_exp_f32 v122, v122
    v_mfma_f32_16x16x32_bf16 v[252:255], a[204:207], v[100:103], v[252:255]
    ds_read_b64_tr_b16 a[248:249], v14 offset:40960
    v_accvgpr_write_b32 a41, v53
    v_mfma_f32_16x16x32_bf16 v[252:255], a[208:211], v[96:99], v[252:255]
    ds_read_b64_tr_b16 a[250:251], v14 offset:45056
    v_accvgpr_write_b32 a42, v54
    v_mfma_f32_16x16x32_bf16 v[96:99], a[128:131], a[20:23], 0
    v_exp_f32 v123, v123
    v_mfma_f32_16x16x32_bf16 v[96:99], a[132:135], a[24:27], v[96:99]
    ds_read_b64_tr_b16 a[252:253], v14 offset:40968
    v_cvt_pk_bf16_f32 v117, v122, v123
    v_mfma_f32_16x16x32_bf16 v[96:99], a[136:139], a[28:31], v[96:99]
    v_exp_f32 v124, v124
    v_mfma_f32_16x16x32_bf16 v[96:99], a[140:143], a[32:35], v[96:99]
    ds_read_b64_tr_b16 a[254:255], v14 offset:45064
    v_accvgpr_write_b32 a43, v55
    v_mfma_f32_16x16x32_bf16 v[100:103], a[144:147], a[32:35], 0
    v_exp_f32 v125, v125
    v_mfma_f32_16x16x32_bf16 v[100:103], a[148:151], a[28:31], v[100:103]
    ds_read_b64_tr_b16 a[116:117], v14 offset:32776
    v_cvt_pk_bf16_f32 v118, v124, v125
    v_mfma_f32_16x16x32_bf16 v[100:103], a[152:155], a[24:27], v[100:103]
    v_exp_f32 v126, v126
    v_mfma_f32_16x16x32_bf16 v[100:103], a[156:159], a[20:23], v[100:103]
    ds_read_b64_tr_b16 a[118:119], v14 offset:36872
    v_lshlrev_b32 v0, 16, v92
    v_mfma_f32_16x16x32_bf16 v[104:107], a[160:163], a[20:23], 0
    v_exp_f32 v127, v127
    v_mfma_f32_16x16x32_bf16 v[104:107], a[164:167], a[24:27], v[104:107]
    ds_read_b64_tr_b16 a[112:113], v15 offset:32768
    v_cvt_pk_bf16_f32 v119, v126, v127
    v_mfma_f32_16x16x32_bf16 v[104:107], a[168:171], a[28:31], v[104:107]
    v_exp_f32 v96, v96
    v_mfma_f32_16x16x32_bf16 v[104:107], a[172:175], a[32:35], v[104:107]
    ds_read_b64_tr_b16 a[114:115], v15 offset:36864
    v_lshlrev_b32 v1, 16, v93
    v_mfma_f32_16x16x32_bf16 v[108:111], a[176:179], a[32:35], 0
    v_exp_f32 v97, v97
    v_mfma_f32_16x16x32_bf16 v[108:111], a[180:183], a[28:31], v[108:111]
    ds_read_b64_tr_b16 a[108:109], v15 offset:40960
    v_cvt_pk_bf16_f32 v96, v96, v97
    v_mfma_f32_16x16x32_bf16 v[108:111], a[184:187], a[24:27], v[108:111]
    v_exp_f32 v98, v98
    v_mfma_f32_16x16x32_bf16 v[108:111], a[188:191], a[20:23], v[108:111]
    ds_read_b64_tr_b16 a[110:111], v15 offset:45056
    v_lshlrev_b32 v2, 16, v94
    v_smfmac_f32_16x16x64_bf16 v[24:27], a[120:123], v[112:119], v22
    v_exp_f32 v99, v99
    v_mfma_f32_16x16x32_bf16 v[128:131], a[212:215], v[112:115], v[128:131]
    ds_read_b64_tr_b16 a[104:105], v15 offset:40968
    v_cvt_pk_bf16_f32 v97, v98, v99
    v_mfma_f32_16x16x32_bf16 v[128:131], a[216:219], v[116:119], v[128:131]
    s_waitcnt lgkmcnt(5)
    v_exp_f32 v100, v100
    v_mfma_f32_16x16x32_bf16 v[132:135], a[220:223], v[116:119], v[132:135]
    ds_read_b64_tr_b16 a[106:107], v15 offset:45064
    v_lshlrev_b32 v3, 16, v95
    v_mfma_f32_16x16x32_bf16 v[132:135], a[224:227], v[112:115], v[132:135]
    v_exp_f32 v101, v101
    v_mfma_f32_16x16x32_bf16 v[136:139], a[228:231], v[112:115], v[136:139]
    ds_read_b64_tr_b16 a[100:101], v15 offset:32776
    v_cvt_pk_bf16_f32 v98, v100, v101
    v_mfma_f32_16x16x32_bf16 v[136:139], a[232:235], v[116:119], v[136:139]
    v_exp_f32 v102, v102
    v_mfma_f32_16x16x32_bf16 v[140:143], a[236:239], v[116:119], v[140:143]
    ds_read_b64_tr_b16 a[102:103], v15 offset:36872
    v_and_b32 v92, s25, v92
    v_and_b32 v93, s25, v93
    v_and_b32 v94, s25, v94
    v_and_b32 v95, s25, v95
    v_pk_mul_f32 v[0:1], v[0:1], s[34:35]
    v_pk_mul_f32 v[2:3], v[2:3], s[34:35]
    v_pk_mul_f32 v[92:93], v[92:93], s[34:35]
    v_pk_mul_f32 v[94:95], v[94:95], s[34:35]
    v_cvt_pk_bf16_f32 v92, v0, v92
    v_cvt_pk_bf16_f32 v93, v1, v93
    v_cvt_pk_bf16_f32 v94, v2, v94
    v_mfma_f32_16x16x32_bf16 v[140:143], a[240:243], v[112:115], v[140:143]
    v_exp_f32 v103, v103
    v_mfma_f32_16x16x32_bf16 v[144:147], a[244:247], v[112:115], v[144:147]
    v_cvt_pk_bf16_f32 v99, v102, v103
    v_cvt_pk_bf16_f32 v95, v3, v95
    v_mfma_f32_16x16x32_bf16 v[144:147], a[248:251], v[116:119], v[144:147]
    v_exp_f32 v104, v104
    v_mfma_f32_16x16x32_bf16 v[148:151], a[252:255], v[116:119], v[148:151]
    v_accvgpr_write_b32 a44, v92
    v_accvgpr_write_b32 a45, v93
    v_mfma_f32_16x16x32_bf16 v[148:151], a[116:119], v[112:115], v[148:151]
    s_waitcnt lgkmcnt(1)
    v_exp_f32 v105, v105
    v_mfma_f32_16x16x32_bf16 v[152:155], a[112:115], v[112:115], v[152:155]
    v_cvt_pk_bf16_f32 v100, v104, v105
    v_accvgpr_write_b32 a46, v94
    v_mfma_f32_16x16x32_bf16 v[152:155], a[108:111], v[116:119], v[152:155]
    v_exp_f32 v106, v106
    v_mfma_f32_16x16x32_bf16 v[156:159], a[104:107], v[116:119], v[156:159]
    v_accvgpr_write_b32 a47, v95
    v_lshlrev_b32 v0, 16, v72
    v_lshlrev_b32 v1, 16, v73
    v_lshlrev_b32 v2, 16, v74
    v_lshlrev_b32 v3, 16, v75
    v_and_b32 v72, s25, v72
    v_and_b32 v73, s25, v73
    v_and_b32 v74, s25, v74
    v_and_b32 v75, s25, v75
    v_pk_mul_f32 v[0:1], v[0:1], s[34:35]
    v_pk_mul_f32 v[2:3], v[2:3], s[34:35]
    v_pk_mul_f32 v[72:73], v[72:73], s[34:35]
    v_pk_mul_f32 v[74:75], v[74:75], s[34:35]
    v_cvt_pk_bf16_f32 v72, v0, v72
    v_cvt_pk_bf16_f32 v73, v1, v73
    v_cvt_pk_bf16_f32 v74, v2, v74
    v_cvt_pk_bf16_f32 v75, v3, v75
    v_accvgpr_write_b32 a48, v72
    v_accvgpr_write_b32 a49, v73
    v_accvgpr_write_b32 a50, v74
    v_accvgpr_write_b32 a51, v75
    s_waitcnt lgkmcnt(0)
    v_mfma_f32_16x16x32_bf16 v[156:159], a[100:103], v[112:115], v[156:159]
    s_waitcnt vmcnt(4)
    v_cvt_pk_bf16_f32 v81, v194, v195
    v_cvt_pk_bf16_f32 v82, v196, v197
    v_mfma_f32_16x16x32_bf16 v[112:115], a[128:131], a[36:39], 0
    s_barrier
    v_exp_f32 v107, v107
    v_mfma_f32_16x16x32_bf16 v[112:115], a[132:135], a[40:43], v[112:115]
    s_add_u32 s29, s27, 49152
    v_cvt_pk_bf16_f32 v101, v106, v107
    v_cvt_pk_bf16_f32 v83, v198, v199
    v_mfma_f32_16x16x32_bf16 v[112:115], a[136:139], a[44:47], v[112:115]
    s_add_u32 m0, s27, 131072
    v_exp_f32 v108, v108
    v_mfma_f32_16x16x32_bf16 v[112:115], a[140:143], a[48:51], v[112:115]
    buffer_load_dwordx4 v18, s[52:55], s29 offen lds
    v_mfma_f32_16x16x32_bf16 v[116:119], a[144:147], a[48:51], 0
    v_exp_f32 v109, v109
    v_mfma_f32_16x16x32_bf16 v[116:119], a[148:151], a[44:47], v[116:119]
    v_cvt_pk_bf16_f32 v102, v108, v109
    v_cvt_pk_bf16_f32 v60, v200, v201
    v_mfma_f32_16x16x32_bf16 v[116:119], a[152:155], a[40:43], v[116:119]
    v_exp_f32 v110, v110
    v_mfma_f32_16x16x32_bf16 v[116:119], a[156:159], a[36:39], v[116:119]
    buffer_load_dwordx4 v18, s[52:55], s29 offen offset:1024 lds
    v_mfma_f32_16x16x32_bf16 v[120:123], a[160:163], a[36:39], 0
    v_exp_f32 v111, v111
    v_mfma_f32_16x16x32_bf16 v[120:123], a[164:167], a[40:43], v[120:123]
    v_cvt_pk_bf16_f32 v103, v110, v111
    v_cvt_pk_bf16_f32 v61, v202, v203
    v_mfma_f32_16x16x32_bf16 v[120:123], a[168:171], a[44:47], v[120:123]
    v_exp_f32 v112, v112
    v_mfma_f32_16x16x32_bf16 v[120:123], a[172:175], a[48:51], v[120:123]
    buffer_load_dwordx4 v18, s[52:55], s29 offen offset:2048 lds
    v_mfma_f32_16x16x32_bf16 v[124:127], a[176:179], a[48:51], 0
    v_exp_f32 v113, v113
    v_mfma_f32_16x16x32_bf16 v[124:127], a[180:183], a[44:47], v[124:127]
    v_cvt_pk_bf16_f32 v112, v112, v113
    v_cvt_pk_bf16_f32 v62, v204, v205
    v_mfma_f32_16x16x32_bf16 v[124:127], a[184:187], a[40:43], v[124:127]
    v_exp_f32 v114, v114
    v_mfma_f32_16x16x32_bf16 v[124:127], a[188:191], a[36:39], v[124:127]
    buffer_load_dwordx4 v18, s[52:55], s29 offen offset:3072 lds
    v_smfmac_f32_16x16x64_bf16 v[24:27], a[124:127], v[96:103], v22
    v_exp_f32 v115, v115
    v_mfma_f32_16x16x32_bf16 v[160:163], a[212:215], v[96:99], v[160:163]
    v_cvt_pk_bf16_f32 v113, v114, v115
    v_cvt_pk_bf16_f32 v63, v206, v207
    v_mfma_f32_16x16x32_bf16 v[160:163], a[216:219], v[100:103], v[160:163]
    v_exp_f32 v116, v116
    v_mfma_f32_16x16x32_bf16 v[164:167], a[220:223], v[100:103], v[164:167]
    v_cvt_pk_bf16_f32 v36, v208, v209
    v_cvt_pk_bf16_f32 v37, v210, v211
    v_mfma_f32_16x16x32_bf16 v[164:167], a[224:227], v[96:99], v[164:167]
    v_exp_f32 v117, v117
    v_mfma_f32_16x16x32_bf16 v[168:171], a[228:231], v[96:99], v[168:171]
    v_cvt_pk_bf16_f32 v114, v116, v117
    v_cvt_pk_bf16_f32 v38, v212, v213
    v_mfma_f32_16x16x32_bf16 v[168:171], a[232:235], v[100:103], v[168:171]
    v_exp_f32 v118, v118
    v_mfma_f32_16x16x32_bf16 v[172:175], a[236:239], v[100:103], v[172:175]
    v_cvt_pk_bf16_f32 v39, v214, v215
    v_cvt_pk_bf16_f32 v44, v216, v217
    v_mfma_f32_16x16x32_bf16 v[172:175], a[240:243], v[96:99], v[172:175]
    v_exp_f32 v119, v119
    v_mfma_f32_16x16x32_bf16 v[176:179], a[244:247], v[96:99], v[176:179]
    v_cvt_pk_bf16_f32 v115, v118, v119
    v_cvt_pk_bf16_f32 v45, v218, v219
    v_mfma_f32_16x16x32_bf16 v[176:179], a[248:251], v[100:103], v[176:179]
    v_exp_f32 v120, v120
    v_mfma_f32_16x16x32_bf16 v[180:183], a[252:255], v[100:103], v[180:183]
    v_cvt_pk_bf16_f32 v46, v220, v221
    v_cvt_pk_bf16_f32 v47, v222, v223
    v_mfma_f32_16x16x32_bf16 v[180:183], a[116:119], v[96:99], v[180:183]
    v_exp_f32 v121, v121
    v_mfma_f32_16x16x32_bf16 v[184:187], a[112:115], v[96:99], v[184:187]
    v_cvt_pk_bf16_f32 v116, v120, v121
    v_cndmask_b32_dpp v56, v68, v88, vcc row_ror:8 row_mask:0xf bank_mask:0xf
    v_mfma_f32_16x16x32_bf16 v[184:187], a[108:111], v[100:103], v[184:187]
    v_exp_f32 v122, v122
    v_mfma_f32_16x16x32_bf16 v[188:191], a[104:107], v[100:103], v[188:191]
    v_cndmask_b32_dpp v57, v69, v89, vcc row_ror:8 row_mask:0xf bank_mask:0xf
    v_cndmask_b32_dpp v58, v70, v90, vcc row_ror:8 row_mask:0xf bank_mask:0xf
    v_mfma_f32_16x16x32_bf16 v[188:191], a[100:103], v[96:99], v[188:191]
    v_cndmask_b32_dpp v59, v71, v91, vcc row_ror:8 row_mask:0xf bank_mask:0xf
    v_mov_b32_dpp v68, v88 row_ror:8 row_mask:0xf bank_mask:0x3
    v_mfma_f32_16x16x32_bf16 v[96:99], a[128:131], a[80:83], 0
    v_exp_f32 v123, v123
    v_mfma_f32_16x16x32_bf16 v[96:99], a[132:135], a[84:87], v[96:99]
    ds_read_b128 a[128:131], v4 offset:32768
    v_cvt_pk_bf16_f32 v117, v122, v123
    v_mfma_f32_16x16x32_bf16 v[96:99], a[136:139], a[88:91], v[96:99]
    v_exp_f32 v124, v124
    v_mfma_f32_16x16x32_bf16 v[96:99], a[140:143], a[0:3], v[96:99]
    ds_read_b128 a[132:135], v5 offset:32768
    v_mov_b32_dpp v69, v89 row_ror:8 row_mask:0xf bank_mask:0x3
    v_mfma_f32_16x16x32_bf16 v[100:103], a[144:147], a[0:3], 0
    v_exp_f32 v125, v125
    v_mfma_f32_16x16x32_bf16 v[100:103], a[148:151], a[88:91], v[100:103]
    ds_read_b128 a[136:139], v6 offset:32768
    v_cvt_pk_bf16_f32 v118, v124, v125
    v_mfma_f32_16x16x32_bf16 v[100:103], a[152:155], a[84:87], v[100:103]
    v_exp_f32 v126, v126
    v_mfma_f32_16x16x32_bf16 v[100:103], a[156:159], a[80:83], v[100:103]
    ds_read_b128 a[140:143], v7 offset:32768
    v_mov_b32_dpp v70, v90 row_ror:8 row_mask:0xf bank_mask:0x3
    v_mfma_f32_16x16x32_bf16 v[104:107], a[160:163], a[80:83], 0
    v_exp_f32 v127, v127
    v_mfma_f32_16x16x32_bf16 v[104:107], a[164:167], a[84:87], v[104:107]
    ds_read_b128 a[144:147], v7 offset:36864
    v_cvt_pk_bf16_f32 v119, v126, v127
    v_mfma_f32_16x16x32_bf16 v[104:107], a[168:171], a[88:91], v[104:107]
    v_exp_f32 v96, v96
    v_mfma_f32_16x16x32_bf16 v[104:107], a[172:175], a[0:3], v[104:107]
    ds_read_b128 a[148:151], v6 offset:36864
    v_mov_b32_dpp v71, v91 row_ror:8 row_mask:0xf bank_mask:0x3
    v_mfma_f32_16x16x32_bf16 v[108:111], a[176:179], a[0:3], 0
    v_exp_f32 v97, v97
    v_mfma_f32_16x16x32_bf16 v[108:111], a[180:183], a[88:91], v[108:111]
    ds_read_b128 a[152:155], v5 offset:36864
    v_cvt_pk_bf16_f32 v96, v96, v97
    v_mfma_f32_16x16x32_bf16 v[108:111], a[184:187], a[84:87], v[108:111]
    v_exp_f32 v98, v98
    v_mfma_f32_16x16x32_bf16 v[108:111], a[188:191], a[80:83], v[108:111]
    ds_read_b128 a[156:159], v4 offset:36864
    v_lshlrev_b32 v0, 16, v84
    v_smfmac_f32_16x16x64_bf16 v[28:31], a[120:123], v[112:119], v22
    v_exp_f32 v99, v99
    v_mfma_f32_16x16x32_bf16 v[192:195], a[212:215], v[112:115], 0
    ds_read_b128 a[160:163], v4 offset:40960
    v_cvt_pk_bf16_f32 v97, v98, v99
    v_mfma_f32_16x16x32_bf16 v[192:195], a[216:219], v[116:119], v[192:195]
    v_exp_f32 v100, v100
    v_mfma_f32_16x16x32_bf16 v[196:199], a[220:223], v[116:119], 0
    s_mov_b32 s31, 4096
    ds_read_b128 a[164:167], v5 offset:40960
    buffer_store_dwordx4 v[56:59], v23, s[56:59], s31 offen offset:0 sc1
    v_mfma_f32_16x16x32_bf16 v[196:199], a[224:227], v[112:115], v[196:199]
    v_exp_f32 v101, v101
    v_mfma_f32_16x16x32_bf16 v[200:203], a[228:231], v[112:115], 0
    ds_read_b128 a[168:171], v6 offset:40960
    v_cvt_pk_bf16_f32 v98, v100, v101
    v_mfma_f32_16x16x32_bf16 v[200:203], a[232:235], v[116:119], v[200:203]
    v_exp_f32 v102, v102
    v_mfma_f32_16x16x32_bf16 v[204:207], a[236:239], v[116:119], 0
    ds_read_b128 a[172:175], v7 offset:40960
    v_lshlrev_b32 v1, 16, v85
    v_mfma_f32_16x16x32_bf16 v[204:207], a[240:243], v[112:115], v[204:207]
    v_exp_f32 v103, v103
    v_mfma_f32_16x16x32_bf16 v[208:211], a[244:247], v[112:115], 0
    ds_read_b128 a[176:179], v7 offset:45056
    v_cvt_pk_bf16_f32 v99, v102, v103
    v_mfma_f32_16x16x32_bf16 v[208:211], a[248:251], v[116:119], v[208:211]
    v_exp_f32 v104, v104
    v_mfma_f32_16x16x32_bf16 v[212:215], a[252:255], v[116:119], 0
    ds_read_b128 a[180:183], v6 offset:45056
    v_lshlrev_b32 v2, 16, v86
    v_mfma_f32_16x16x32_bf16 v[212:215], a[116:119], v[112:115], v[212:215]
    v_exp_f32 v105, v105
    v_mfma_f32_16x16x32_bf16 v[216:219], a[112:115], v[112:115], 0
    ds_read_b128 a[184:187], v5 offset:45056
    v_cvt_pk_bf16_f32 v100, v104, v105
    v_mfma_f32_16x16x32_bf16 v[216:219], a[108:111], v[116:119], v[216:219]
    v_exp_f32 v106, v106
    v_mfma_f32_16x16x32_bf16 v[220:223], a[104:107], v[116:119], 0
    ds_read_b128 a[188:191], v4 offset:45056
    v_lshlrev_b32 v3, 16, v87
    v_mfma_f32_16x16x32_bf16 v[220:223], a[100:103], v[112:115], v[220:223]
    s_waitcnt lgkmcnt(5)
    ds_read_b64_tr_b16 a[96:97], v12 offset:49152
    ds_read_b64_tr_b16 a[98:99], v12 offset:53248
    v_mfma_f32_16x16x32_bf16 v[112:115], a[128:131], a[4:7], 0
    v_exp_f32 v107, v107
    v_mfma_f32_16x16x32_bf16 v[112:115], a[132:135], a[8:11], v[112:115]
    ds_read_b64_tr_b16 a[92:93], v12 offset:57344
    v_cvt_pk_bf16_f32 v101, v106, v107
    v_mfma_f32_16x16x32_bf16 v[112:115], a[136:139], a[12:15], v[112:115]
    v_exp_f32 v108, v108
    v_mfma_f32_16x16x32_bf16 v[112:115], a[140:143], a[16:19], v[112:115]
    ds_read_b64_tr_b16 a[94:95], v12 offset:61440
    ds_read_b64_tr_b16 a[192:193], v12 offset:57352
    v_mfma_f32_16x16x32_bf16 v[116:119], a[144:147], a[16:19], 0
    v_exp_f32 v109, v109
    v_mfma_f32_16x16x32_bf16 v[116:119], a[148:151], a[12:15], v[116:119]
    ds_read_b64_tr_b16 a[194:195], v12 offset:61448
    v_cvt_pk_bf16_f32 v102, v108, v109
    v_mfma_f32_16x16x32_bf16 v[116:119], a[152:155], a[8:11], v[116:119]
    v_exp_f32 v110, v110
    v_mfma_f32_16x16x32_bf16 v[116:119], a[156:159], a[4:7], v[116:119]
    s_mov_b32 s31, 4096
    ds_read_b64_tr_b16 a[196:197], v12 offset:49160
    buffer_store_dwordx4 v[68:71], v23, s[56:59], s31 offen offset:2048 sc1
    v_mfma_f32_16x16x32_bf16 v[120:123], a[160:163], a[4:7], 0
    v_exp_f32 v111, v111
    v_mfma_f32_16x16x32_bf16 v[120:123], a[164:167], a[8:11], v[120:123]
    ds_read_b64_tr_b16 a[198:199], v12 offset:53256
    v_cvt_pk_bf16_f32 v103, v110, v111
    v_mfma_f32_16x16x32_bf16 v[120:123], a[168:171], a[12:15], v[120:123]
    s_waitcnt lgkmcnt(5)
    v_exp_f32 v112, v112
    v_mfma_f32_16x16x32_bf16 v[120:123], a[172:175], a[16:19], v[120:123]
    ds_read_b64_tr_b16 a[200:201], v13 offset:49152
    v_and_b32 v84, s25, v84
    v_and_b32 v85, s25, v85
    v_and_b32 v86, s25, v86
    v_and_b32 v87, s25, v87
    v_pk_mul_f32 v[0:1], v[0:1], s[34:35]
    v_pk_mul_f32 v[2:3], v[2:3], s[34:35]
    v_pk_mul_f32 v[84:85], v[84:85], s[34:35]
    v_pk_mul_f32 v[86:87], v[86:87], s[34:35]
    v_cvt_pk_bf16_f32 v84, v0, v84
    v_cvt_pk_bf16_f32 v85, v1, v85
    v_cvt_pk_bf16_f32 v86, v2, v86
    v_mfma_f32_16x16x32_bf16 v[124:127], a[176:179], a[16:19], 0
    v_exp_f32 v113, v113
    v_mfma_f32_16x16x32_bf16 v[124:127], a[180:183], a[12:15], v[124:127]
    ds_read_b64_tr_b16 a[202:203], v13 offset:53248
    v_cvt_pk_bf16_f32 v112, v112, v113
    v_mfma_f32_16x16x32_bf16 v[124:127], a[184:187], a[8:11], v[124:127]
    v_exp_f32 v114, v114
    v_mfma_f32_16x16x32_bf16 v[124:127], a[188:191], a[4:7], v[124:127]
    ds_read_b64_tr_b16 a[204:205], v13 offset:57344
    v_cvt_pk_bf16_f32 v87, v3, v87
    v_smfmac_f32_16x16x64_bf16 v[28:31], a[124:127], v[96:103], v22
    v_exp_f32 v115, v115
    v_mfma_f32_16x16x32_bf16 v[224:227], a[212:215], v[96:99], v[224:227]
    ds_read_b64_tr_b16 a[206:207], v13 offset:61440
    v_cvt_pk_bf16_f32 v113, v114, v115
    v_mfma_f32_16x16x32_bf16 v[224:227], a[216:219], v[100:103], v[224:227]
    v_exp_f32 v116, v116
    v_mfma_f32_16x16x32_bf16 v[228:231], a[220:223], v[100:103], v[228:231]
    ds_read_b64_tr_b16 a[208:209], v13 offset:57352
    v_accvgpr_write_b32 a52, v84
    v_mfma_f32_16x16x32_bf16 v[228:231], a[224:227], v[96:99], v[228:231]
    v_exp_f32 v117, v117
    v_mfma_f32_16x16x32_bf16 v[232:235], a[228:231], v[96:99], v[232:235]
    ds_read_b64_tr_b16 a[210:211], v13 offset:61448
    v_cvt_pk_bf16_f32 v114, v116, v117
    v_mfma_f32_16x16x32_bf16 v[232:235], a[232:235], v[100:103], v[232:235]
    v_exp_f32 v118, v118
    v_mfma_f32_16x16x32_bf16 v[236:239], a[236:239], v[100:103], v[236:239]
    ds_read_b64_tr_b16 a[212:213], v13 offset:49160
    v_add_f32 v30, v30, v31
    v_mfma_f32_16x16x32_bf16 v[236:239], a[240:243], v[96:99], v[236:239]
    v_exp_f32 v119, v119
    v_mfma_f32_16x16x32_bf16 v[240:243], a[244:247], v[96:99], v[240:243]
    ds_read_b64_tr_b16 a[214:215], v13 offset:53256
    v_cvt_pk_bf16_f32 v115, v118, v119
    v_mfma_f32_16x16x32_bf16 v[240:243], a[248:251], v[100:103], v[240:243]
    v_exp_f32 v120, v120
    v_mfma_f32_16x16x32_bf16 v[244:247], a[252:255], v[100:103], v[244:247]
    ds_read_b64_tr_b16 a[216:217], v14 offset:49152
    v_accvgpr_write_b32 a53, v85
    v_mfma_f32_16x16x32_bf16 v[244:247], a[116:119], v[96:99], v[244:247]
Lpad11:
    s_cbranch_execz Lret1
    v_exp_f32 v121, v121
    v_mfma_f32_16x16x32_bf16 v[248:251], a[112:115], v[96:99], v[248:251]
    ds_read_b64_tr_b16 a[218:219], v14 offset:53248
    v_cvt_pk_bf16_f32 v116, v120, v121
    v_mfma_f32_16x16x32_bf16 v[248:251], a[108:111], v[100:103], v[248:251]
    v_exp_f32 v122, v122
    v_mfma_f32_16x16x32_bf16 v[252:255], a[104:107], v[100:103], v[252:255]
    ds_read_b64_tr_b16 a[220:221], v14 offset:57344
    v_accvgpr_write_b32 a54, v86
    v_mfma_f32_16x16x32_bf16 v[252:255], a[100:103], v[96:99], v[252:255]
    ds_read_b64_tr_b16 a[222:223], v14 offset:61440
    v_rcp_f32 v20, v30
    v_mfma_f32_16x16x32_bf16 v[96:99], a[128:131], a[20:23], 0
    v_exp_f32 v123, v123
    v_mfma_f32_16x16x32_bf16 v[96:99], a[132:135], a[24:27], v[96:99]
    ds_read_b64_tr_b16 a[224:225], v14 offset:57352
    v_cvt_pk_bf16_f32 v117, v122, v123
    v_mfma_f32_16x16x32_bf16 v[96:99], a[136:139], a[28:31], v[96:99]
    v_exp_f32 v124, v124
    v_mfma_f32_16x16x32_bf16 v[96:99], a[140:143], a[32:35], v[96:99]
    ds_read_b64_tr_b16 a[226:227], v14 offset:61448
    v_accvgpr_write_b32 a55, v87
    v_mfma_f32_16x16x32_bf16 v[100:103], a[144:147], a[32:35], 0
    v_exp_f32 v125, v125
    v_subrev_u32 v30, s28, v30
    v_mov_b32 v21, v20
    v_max_u32 v19, v19, v30
    v_pk_mul_f32 v[224:225], v[224:225], v[20:21]
    v_pk_mul_f32 v[226:227], v[226:227], v[20:21]
    v_pk_mul_f32 v[228:229], v[228:229], v[20:21]
    v_pk_mul_f32 v[230:231], v[230:231], v[20:21]
    v_pk_mul_f32 v[232:233], v[232:233], v[20:21]
    v_pk_mul_f32 v[234:235], v[234:235], v[20:21]
    v_pk_mul_f32 v[236:237], v[236:237], v[20:21]
    v_pk_mul_f32 v[238:239], v[238:239], v[20:21]
    v_pk_mul_f32 v[240:241], v[240:241], v[20:21]
    v_pk_mul_f32 v[242:243], v[242:243], v[20:21]
    v_pk_mul_f32 v[244:245], v[244:245], v[20:21]
    v_pk_mul_f32 v[246:247], v[246:247], v[20:21]
    v_pk_mul_f32 v[248:249], v[248:249], v[20:21]
    v_pk_mul_f32 v[250:251], v[250:251], v[20:21]
    v_pk_mul_f32 v[252:253], v[252:253], v[20:21]
    v_pk_mul_f32 v[254:255], v[254:255], v[20:21]
    v_mov_b32 v30, 0
    v_mov_b32 v31, 0
    v_cvt_pk_bf16_f32 v52, v224, v225
    v_mfma_f32_16x16x32_bf16 v[100:103], a[148:151], a[28:31], v[100:103]
    ds_read_b64_tr_b16 a[228:229], v14 offset:49160
    v_cvt_pk_bf16_f32 v118, v124, v125
    v_mfma_f32_16x16x32_bf16 v[100:103], a[152:155], a[24:27], v[100:103]
    v_exp_f32 v126, v126
    v_mfma_f32_16x16x32_bf16 v[100:103], a[156:159], a[20:23], v[100:103]
    ds_read_b64_tr_b16 a[230:231], v14 offset:53256
    v_lshlrev_b32 v0, 16, v32
    v_mfma_f32_16x16x32_bf16 v[104:107], a[160:163], a[20:23], 0
    v_exp_f32 v127, v127
    v_mfma_f32_16x16x32_bf16 v[104:107], a[164:167], a[24:27], v[104:107]
    ds_read_b64_tr_b16 a[232:233], v15 offset:49152
    v_cvt_pk_bf16_f32 v119, v126, v127
    v_mfma_f32_16x16x32_bf16 v[104:107], a[168:171], a[28:31], v[104:107]
    v_exp_f32 v96, v96
    v_mfma_f32_16x16x32_bf16 v[104:107], a[172:175], a[32:35], v[104:107]
    ds_read_b64_tr_b16 a[234:235], v15 offset:53248
    v_lshlrev_b32 v1, 16, v33
    v_mfma_f32_16x16x32_bf16 v[108:111], a[176:179], a[32:35], 0
    v_exp_f32 v97, v97
    v_mfma_f32_16x16x32_bf16 v[108:111], a[180:183], a[28:31], v[108:111]
    ds_read_b64_tr_b16 a[236:237], v15 offset:57344
    v_cvt_pk_bf16_f32 v96, v96, v97
    v_mfma_f32_16x16x32_bf16 v[108:111], a[184:187], a[24:27], v[108:111]
    v_exp_f32 v98, v98
    v_mfma_f32_16x16x32_bf16 v[108:111], a[188:191], a[20:23], v[108:111]
    ds_read_b64_tr_b16 a[238:239], v15 offset:61440
    v_lshlrev_b32 v2, 16, v34
    v_smfmac_f32_16x16x64_bf16 v[24:27], a[120:123], v[112:119], v22
    v_exp_f32 v99, v99
    v_mfma_f32_16x16x32_bf16 v[128:131], a[96:99], v[112:115], v[128:131]
    s_waitcnt lgkmcnt(4)
    ds_read_b64_tr_b16 a[240:241], v15 offset:57352
    v_cvt_pk_bf16_f32 v97, v98, v99
    v_mfma_f32_16x16x32_bf16 v[128:131], a[92:95], v[116:119], v[128:131]
    v_exp_f32 v100, v100
    v_mfma_f32_16x16x32_bf16 v[132:135], a[192:195], v[116:119], v[132:135]
    ds_read_b64_tr_b16 a[242:243], v15 offset:61448
    v_lshlrev_b32 v3, 16, v35
    v_mfma_f32_16x16x32_bf16 v[132:135], a[196:199], v[112:115], v[132:135]
    v_exp_f32 v101, v101
    v_mfma_f32_16x16x32_bf16 v[136:139], a[200:203], v[112:115], v[136:139]
    ds_read_b64_tr_b16 a[244:245], v15 offset:49160
    v_cvt_pk_bf16_f32 v98, v100, v101
    v_mfma_f32_16x16x32_bf16 v[136:139], a[204:207], v[116:119], v[136:139]
    v_exp_f32 v102, v102
    v_mfma_f32_16x16x32_bf16 v[140:143], a[208:211], v[116:119], v[140:143]
    ds_read_b64_tr_b16 a[246:247], v15 offset:53256
    v_and_b32 v32, s25, v32
    v_and_b32 v33, s25, v33
    v_and_b32 v34, s25, v34
    v_and_b32 v35, s25, v35
    v_pk_mul_f32 v[0:1], v[0:1], s[34:35]
    v_pk_mul_f32 v[2:3], v[2:3], s[34:35]
    v_pk_mul_f32 v[32:33], v[32:33], s[34:35]
    v_pk_mul_f32 v[34:35], v[34:35], s[34:35]
    v_cvt_pk_bf16_f32 v32, v0, v32
    v_cvt_pk_bf16_f32 v33, v1, v33
    v_cvt_pk_bf16_f32 v34, v2, v34
    v_mfma_f32_16x16x32_bf16 v[140:143], a[212:215], v[112:115], v[140:143]
    v_exp_f32 v103, v103
    v_mfma_f32_16x16x32_bf16 v[144:147], a[216:219], v[112:115], v[144:147]
    v_cvt_pk_bf16_f32 v99, v102, v103
    v_cvt_pk_bf16_f32 v35, v3, v35
    v_mfma_f32_16x16x32_bf16 v[144:147], a[220:223], v[116:119], v[144:147]
    v_exp_f32 v104, v104
    v_mfma_f32_16x16x32_bf16 v[148:151], a[224:227], v[116:119], v[148:151]
    v_accvgpr_write_b32 a56, v32
    v_accvgpr_write_b32 a57, v33
    v_mfma_f32_16x16x32_bf16 v[148:151], a[228:231], v[112:115], v[148:151]
    s_waitcnt lgkmcnt(1)
    v_exp_f32 v105, v105
    v_mfma_f32_16x16x32_bf16 v[152:155], a[232:235], v[112:115], v[152:155]
    v_cvt_pk_bf16_f32 v100, v104, v105
    v_accvgpr_write_b32 a58, v34
    v_mfma_f32_16x16x32_bf16 v[152:155], a[236:239], v[116:119], v[152:155]
    v_exp_f32 v106, v106
    v_mfma_f32_16x16x32_bf16 v[156:159], a[240:243], v[116:119], v[156:159]
    s_waitcnt lgkmcnt(0)
    v_accvgpr_write_b32 a59, v35
    v_cndmask_b32_dpp v92, v64, v48, vcc row_ror:8 row_mask:0xf bank_mask:0xf
    v_mfma_f32_16x16x32_bf16 v[156:159], a[244:247], v[112:115], v[156:159]
    s_waitcnt vmcnt(2)
    v_cndmask_b32_dpp v93, v65, v49, vcc row_ror:8 row_mask:0xf bank_mask:0xf
    v_cndmask_b32_dpp v94, v66, v50, vcc row_ror:8 row_mask:0xf bank_mask:0xf
    v_mfma_f32_16x16x32_bf16 v[112:115], a[128:131], a[36:39], 0
    s_barrier
    v_exp_f32 v107, v107
    v_mfma_f32_16x16x32_bf16 v[112:115], a[132:135], a[40:43], v[112:115]
    s_add_u32 s29, s27, 65536
    v_cvt_pk_bf16_f32 v101, v106, v107
    v_cndmask_b32_dpp v95, v67, v51, vcc row_ror:8 row_mask:0xf bank_mask:0xf
    v_mfma_f32_16x16x32_bf16 v[112:115], a[136:139], a[44:47], v[112:115]
    s_add_u32 m0, s27, 147456
    v_exp_f32 v108, v108
    v_mfma_f32_16x16x32_bf16 v[112:115], a[140:143], a[48:51], v[112:115]
    buffer_load_dwordx4 v18, s[52:55], s29 offen lds
    v_mfma_f32_16x16x32_bf16 v[116:119], a[144:147], a[48:51], 0
    v_exp_f32 v109, v109
    v_mfma_f32_16x16x32_bf16 v[116:119], a[148:151], a[44:47], v[116:119]
    v_cvt_pk_bf16_f32 v102, v108, v109
    v_lshlrev_b32 v0, 16, v76
    v_mfma_f32_16x16x32_bf16 v[116:119], a[152:155], a[40:43], v[116:119]
    v_exp_f32 v110, v110
    v_mfma_f32_16x16x32_bf16 v[116:119], a[156:159], a[36:39], v[116:119]
    buffer_load_dwordx4 v18, s[52:55], s29 offen offset:1024 lds
    v_mfma_f32_16x16x32_bf16 v[120:123], a[160:163], a[36:39], 0
    v_exp_f32 v111, v111
    v_mfma_f32_16x16x32_bf16 v[120:123], a[164:167], a[40:43], v[120:123]
    v_cvt_pk_bf16_f32 v103, v110, v111
    v_lshlrev_b32 v1, 16, v77
    v_mfma_f32_16x16x32_bf16 v[120:123], a[168:171], a[44:47], v[120:123]
    v_exp_f32 v112, v112
    v_mfma_f32_16x16x32_bf16 v[120:123], a[172:175], a[48:51], v[120:123]
    buffer_load_dwordx4 v18, s[52:55], s29 offen offset:2048 lds
    v_mfma_f32_16x16x32_bf16 v[124:127], a[176:179], a[48:51], 0
    v_exp_f32 v113, v113
    v_mfma_f32_16x16x32_bf16 v[124:127], a[180:183], a[44:47], v[124:127]
    v_cvt_pk_bf16_f32 v112, v112, v113
    v_lshlrev_b32 v2, 16, v78
    v_mfma_f32_16x16x32_bf16 v[124:127], a[184:187], a[40:43], v[124:127]
    v_exp_f32 v114, v114
    v_mfma_f32_16x16x32_bf16 v[124:127], a[188:191], a[36:39], v[124:127]
    buffer_load_dwordx4 v18, s[52:55], s29 offen offset:3072 lds
    v_smfmac_f32_16x16x64_bf16 v[24:27], a[124:127], v[96:103], v22
    v_exp_f32 v115, v115
    v_mfma_f32_16x16x32_bf16 v[160:163], a[96:99], v[96:99], v[160:163]
    v_cvt_pk_bf16_f32 v113, v114, v115
    v_lshlrev_b32 v3, 16, v79
    v_mfma_f32_16x16x32_bf16 v[160:163], a[92:95], v[100:103], v[160:163]
    v_exp_f32 v116, v116
    v_mfma_f32_16x16x32_bf16 v[164:167], a[192:195], v[100:103], v[164:167]
    v_and_b32 v76, s25, v76
    v_mov_b32_dpp v64, v48 row_ror:8 row_mask:0xf bank_mask:0x3
    v_and_b32 v77, s25, v77
    v_and_b32 v78, s25, v78
    v_and_b32 v79, s25, v79
    v_pk_mul_f32 v[0:1], v[0:1], s[34:35]
    v_pk_mul_f32 v[2:3], v[2:3], s[34:35]
    v_pk_mul_f32 v[76:77], v[76:77], s[34:35]
    v_pk_mul_f32 v[78:79], v[78:79], s[34:35]
    v_cvt_pk_bf16_f32 v76, v0, v76
    v_cvt_pk_bf16_f32 v77, v1, v77
    v_cvt_pk_bf16_f32 v78, v2, v78
    v_mfma_f32_16x16x32_bf16 v[164:167], a[196:199], v[96:99], v[164:167]
    v_exp_f32 v117, v117
    v_mfma_f32_16x16x32_bf16 v[168:171], a[200:203], v[96:99], v[168:171]
    v_cvt_pk_bf16_f32 v114, v116, v117
    v_cvt_pk_bf16_f32 v79, v3, v79
    v_mfma_f32_16x16x32_bf16 v[168:171], a[204:207], v[100:103], v[168:171]
    v_exp_f32 v118, v118
    v_mfma_f32_16x16x32_bf16 v[172:175], a[208:211], v[100:103], v[172:175]
    v_accvgpr_write_b32 a60, v76
    v_accvgpr_write_b32 a61, v77
    v_mfma_f32_16x16x32_bf16 v[172:175], a[212:215], v[96:99], v[172:175]
    v_exp_f32 v119, v119
    v_mfma_f32_16x16x32_bf16 v[176:179], a[216:219], v[96:99], v[176:179]
    v_cvt_pk_bf16_f32 v115, v118, v119
    v_accvgpr_write_b32 a62, v78
    v_mfma_f32_16x16x32_bf16 v[176:179], a[220:223], v[100:103], v[176:179]
    v_exp_f32 v120, v120
    v_mfma_f32_16x16x32_bf16 v[180:183], a[224:227], v[100:103], v[180:183]
    v_accvgpr_write_b32 a63, v79
    v_lshlrev_b32 v0, 16, v40
    v_mfma_f32_16x16x32_bf16 v[180:183], a[228:231], v[96:99], v[180:183]
    v_exp_f32 v121, v121
    v_mfma_f32_16x16x32_bf16 v[184:187], a[232:235], v[96:99], v[184:187]
    v_cvt_pk_bf16_f32 v116, v120, v121
    v_lshlrev_b32 v1, 16, v41
    v_mfma_f32_16x16x32_bf16 v[184:187], a[236:239], v[100:103], v[184:187]
    v_exp_f32 v122, v122
    v_mfma_f32_16x16x32_bf16 v[188:191], a[240:243], v[100:103], v[188:191]
    v_lshlrev_b32 v2, 16, v42
    v_lshlrev_b32 v3, 16, v43
    v_and_b32 v40, s25, v40
    v_and_b32 v41, s25, v41
    v_and_b32 v42, s25, v42
    v_and_b32 v43, s25, v43
    v_pk_mul_f32 v[0:1], v[0:1], s[34:35]
    v_pk_mul_f32 v[2:3], v[2:3], s[34:35]
    v_pk_mul_f32 v[40:41], v[40:41], s[34:35]
    v_pk_mul_f32 v[42:43], v[42:43], s[34:35]
    v_cvt_pk_bf16_f32 v40, v0, v40
    v_cvt_pk_bf16_f32 v41, v1, v41
    v_cvt_pk_bf16_f32 v42, v2, v42
    v_cvt_pk_bf16_f32 v43, v3, v43
    v_accvgpr_write_b32 a64, v40
    v_accvgpr_write_b32 a65, v41
    v_accvgpr_write_b32 a66, v42
    v_accvgpr_write_b32 a67, v43
    v_mfma_f32_16x16x32_bf16 v[188:191], a[244:247], v[96:99], v[188:191]
    v_mov_b32_dpp v65, v49 row_ror:8 row_mask:0xf bank_mask:0x3
    v_mov_b32_dpp v66, v50 row_ror:8 row_mask:0xf bank_mask:0x3
    v_mfma_f32_16x16x32_bf16 v[96:99], a[128:131], a[52:55], 0
    v_exp_f32 v123, v123
    v_mfma_f32_16x16x32_bf16 v[96:99], a[132:135], a[56:59], v[96:99]
    ds_read_b128 a[128:131], v4 offset:49152
    v_cvt_pk_bf16_f32 v117, v122, v123
    v_mfma_f32_16x16x32_bf16 v[96:99], a[136:139], a[60:63], v[96:99]
    v_exp_f32 v124, v124
    v_mfma_f32_16x16x32_bf16 v[96:99], a[140:143], a[64:67], v[96:99]
    ds_read_b128 a[132:135], v5 offset:49152
    v_mov_b32_dpp v67, v51 row_ror:8 row_mask:0xf bank_mask:0x3
    v_mfma_f32_16x16x32_bf16 v[100:103], a[144:147], a[64:67], 0
    v_exp_f32 v125, v125
    v_mfma_f32_16x16x32_bf16 v[100:103], a[148:151], a[60:63], v[100:103]
    ds_read_b128 a[136:139], v6 offset:49152
    v_cvt_pk_bf16_f32 v118, v124, v125
    v_mfma_f32_16x16x32_bf16 v[100:103], a[152:155], a[56:59], v[100:103]
    v_exp_f32 v126, v126
    v_mfma_f32_16x16x32_bf16 v[100:103], a[156:159], a[52:55], v[100:103]
    ds_read_b128 a[140:143], v7 offset:49152
    v_cvt_pk_bf16_f32 v53, v226, v227
    v_mfma_f32_16x16x32_bf16 v[104:107], a[160:163], a[52:55], 0
    v_exp_f32 v127, v127
    v_mfma_f32_16x16x32_bf16 v[104:107], a[164:167], a[56:59], v[104:107]
    ds_read_b128 a[144:147], v7 offset:53248
    v_cvt_pk_bf16_f32 v119, v126, v127
    v_mfma_f32_16x16x32_bf16 v[104:107], a[168:171], a[60:63], v[104:107]
    v_exp_f32 v96, v96
    v_mfma_f32_16x16x32_bf16 v[104:107], a[172:175], a[64:67], v[104:107]
    s_mov_b32 s31, 4096
    ds_read_b128 a[148:151], v6 offset:53248
    buffer_store_dwordx4 v[92:95], v23, s[56:59], s31 offen offset:128 sc1
    v_mfma_f32_16x16x32_bf16 v[108:111], a[176:179], a[64:67], 0
    v_exp_f32 v97, v97
    v_mfma_f32_16x16x32_bf16 v[108:111], a[180:183], a[60:63], v[108:111]
    ds_read_b128 a[152:155], v5 offset:53248
    v_cvt_pk_bf16_f32 v96, v96, v97
    v_mfma_f32_16x16x32_bf16 v[108:111], a[184:187], a[56:59], v[108:111]
    v_exp_f32 v98, v98
    v_mfma_f32_16x16x32_bf16 v[108:111], a[188:191], a[52:55], v[108:111]
    ds_read_b128 a[156:159], v4 offset:53248
    v_cvt_pk_bf16_f32 v54, v228, v229
    v_smfmac_f32_16x16x64_bf16 v[28:31], a[120:123], v[112:119], v22
    v_exp_f32 v99, v99
    v_mfma_f32_16x16x32_bf16 v[192:195], a[96:99], v[112:115], v[192:195]
    ds_read_b128 a[160:163], v4 offset:57344
    v_cvt_pk_bf16_f32 v97, v98, v99
    v_mfma_f32_16x16x32_bf16 v[192:195], a[92:95], v[116:119], v[192:195]
    v_exp_f32 v100, v100
    v_mfma_f32_16x16x32_bf16 v[196:199], a[192:195], v[116:119], v[196:199]
    ds_read_b128 a[164:167], v5 offset:57344
    v_cvt_pk_bf16_f32 v55, v230, v231
    v_mfma_f32_16x16x32_bf16 v[196:199], a[196:199], v[112:115], v[196:199]
    v_exp_f32 v101, v101
    v_mfma_f32_16x16x32_bf16 v[200:203], a[200:203], v[112:115], v[200:203]
    ds_read_b128 a[168:171], v6 offset:57344
    v_cvt_pk_bf16_f32 v98, v100, v101
    v_mfma_f32_16x16x32_bf16 v[200:203], a[204:207], v[116:119], v[200:203]
    v_exp_f32 v102, v102
    v_mfma_f32_16x16x32_bf16 v[204:207], a[208:211], v[116:119], v[204:207]
    ds_read_b128 a[172:175], v7 offset:57344
    v_cvt_pk_bf16_f32 v72, v232, v233
    v_mfma_f32_16x16x32_bf16 v[204:207], a[212:215], v[112:115], v[204:207]
    v_exp_f32 v103, v103
    v_mfma_f32_16x16x32_bf16 v[208:211], a[216:219], v[112:115], v[208:211]
    ds_read_b128 a[176:179], v7 offset:61440
    v_cvt_pk_bf16_f32 v99, v102, v103
    v_mfma_f32_16x16x32_bf16 v[208:211], a[220:223], v[116:119], v[208:211]
    v_exp_f32 v104, v104
    v_mfma_f32_16x16x32_bf16 v[212:215], a[224:227], v[116:119], v[212:215]
    ds_read_b128 a[180:183], v6 offset:61440
    v_cvt_pk_bf16_f32 v73, v234, v235
    v_mfma_f32_16x16x32_bf16 v[212:215], a[228:231], v[112:115], v[212:215]
    v_exp_f32 v105, v105
    v_mfma_f32_16x16x32_bf16 v[216:219], a[232:235], v[112:115], v[216:219]
    ds_read_b128 a[184:187], v5 offset:61440
    v_cvt_pk_bf16_f32 v100, v104, v105
    v_mfma_f32_16x16x32_bf16 v[216:219], a[236:239], v[116:119], v[216:219]
    v_exp_f32 v106, v106
    v_mfma_f32_16x16x32_bf16 v[220:223], a[240:243], v[116:119], v[220:223]
    s_mov_b32 s31, 4096
    ds_read_b128 a[188:191], v4 offset:61440
    buffer_store_dwordx4 v[64:67], v23, s[56:59], s31 offen offset:2176 sc1
    v_mfma_f32_16x16x32_bf16 v[220:223], a[244:247], v[112:115], v[220:223]
    s_waitcnt lgkmcnt(4)
    ds_read_b64_tr_b16 a[248:249], v12 offset:32768
    ds_read_b64_tr_b16 a[250:251], v12 offset:36864
    v_mfma_f32_16x16x32_bf16 v[112:115], a[128:131], a[4:7], 0
    v_exp_f32 v107, v107
    v_mfma_f32_16x16x32_bf16 v[112:115], a[132:135], a[8:11], v[112:115]
    ds_read_b64_tr_b16 a[252:253], v12 offset:40960
    v_cvt_pk_bf16_f32 v101, v106, v107
    v_mfma_f32_16x16x32_bf16 v[112:115], a[136:139], a[12:15], v[112:115]
    v_exp_f32 v108, v108
    v_mfma_f32_16x16x32_bf16 v[112:115], a[140:143], a[16:19], v[112:115]
    ds_read_b64_tr_b16 a[254:255], v12 offset:45056
    ds_read_b64_tr_b16 a[116:117], v12 offset:40968
    v_mfma_f32_16x16x32_bf16 v[116:119], a[144:147], a[16:19], 0
    v_exp_f32 v109, v109
    v_mfma_f32_16x16x32_bf16 v[116:119], a[148:151], a[12:15], v[116:119]
    ds_read_b64_tr_b16 a[118:119], v12 offset:45064
    v_cvt_pk_bf16_f32 v102, v108, v109
    v_mfma_f32_16x16x32_bf16 v[116:119], a[152:155], a[8:11], v[116:119]
    v_exp_f32 v110, v110
    v_mfma_f32_16x16x32_bf16 v[116:119], a[156:159], a[4:7], v[116:119]
    ds_read_b64_tr_b16 a[112:113], v12 offset:32776
    v_cvt_pk_bf16_f32 v74, v236, v237
    v_mfma_f32_16x16x32_bf16 v[120:123], a[160:163], a[4:7], 0
    v_exp_f32 v111, v111
    v_mfma_f32_16x16x32_bf16 v[120:123], a[164:167], a[8:11], v[120:123]
    ds_read_b64_tr_b16 a[114:115], v12 offset:36872
    v_cvt_pk_bf16_f32 v103, v110, v111
    v_mfma_f32_16x16x32_bf16 v[120:123], a[168:171], a[12:15], v[120:123]
    v_exp_f32 v112, v112
    v_mfma_f32_16x16x32_bf16 v[120:123], a[172:175], a[16:19], v[120:123]
    s_waitcnt lgkmcnt(5)
    ds_read_b64_tr_b16 a[108:109], v13 offset:32768
    v_cvt_pk_bf16_f32 v75, v238, v239
    v_mfma_f32_16x16x32_bf16 v[124:127], a[176:179], a[16:19], 0
    v_exp_f32 v113, v113
    v_mfma_f32_16x16x32_bf16 v[124:127], a[180:183], a[12:15], v[124:127]
    ds_read_b64_tr_b16 a[110:111], v13 offset:36864
    v_cvt_pk_bf16_f32 v112, v112, v113
    v_mfma_f32_16x16x32_bf16 v[124:127], a[184:187], a[8:11], v[124:127]
    v_exp_f32 v114, v114
    v_mfma_f32_16x16x32_bf16 v[124:127], a[188:191], a[4:7], v[124:127]
    ds_read_b64_tr_b16 a[104:105], v13 offset:40960
    v_cvt_pk_bf16_f32 v88, v240, v241
    v_smfmac_f32_16x16x64_bf16 v[28:31], a[124:127], v[96:103], v22
    v_exp_f32 v115, v115
    v_mfma_f32_16x16x32_bf16 v[224:227], a[96:99], v[96:99], 0
    ds_read_b64_tr_b16 a[106:107], v13 offset:45056
    v_cvt_pk_bf16_f32 v113, v114, v115
    v_mfma_f32_16x16x32_bf16 v[224:227], a[92:95], v[100:103], v[224:227]
    v_exp_f32 v116, v116
    v_mfma_f32_16x16x32_bf16 v[228:231], a[192:195], v[100:103], 0
    ds_read_b64_tr_b16 a[100:101], v13 offset:40968
    v_cvt_pk_bf16_f32 v89, v242, v243
    v_mfma_f32_16x16x32_bf16 v[228:231], a[196:199], v[96:99], v[228:231]
    v_exp_f32 v117, v117
    v_mfma_f32_16x16x32_bf16 v[232:235], a[200:203], v[96:99], 0
    ds_read_b64_tr_b16 a[102:103], v13 offset:45064
    v_cvt_pk_bf16_f32 v114, v116, v117
    v_mfma_f32_16x16x32_bf16 v[232:235], a[204:207], v[100:103], v[232:235]
    v_exp_f32 v118, v118
    v_mfma_f32_16x16x32_bf16 v[236:239], a[208:211], v[100:103], 0
    ds_read_b64_tr_b16 a[96:97], v13 offset:32776
    v_cvt_pk_bf16_f32 v90, v244, v245
    v_cvt_pk_bf16_f32 v91, v246, v247
    v_mfma_f32_16x16x32_bf16 v[236:239], a[212:215], v[96:99], v[236:239]
    v_exp_f32 v119, v119
    v_mfma_f32_16x16x32_bf16 v[240:243], a[216:219], v[96:99], 0
    ds_read_b64_tr_b16 a[98:99], v13 offset:36872
    v_cvt_pk_bf16_f32 v115, v118, v119
    v_mfma_f32_16x16x32_bf16 v[240:243], a[220:223], v[100:103], v[240:243]
    v_exp_f32 v120, v120
    v_mfma_f32_16x16x32_bf16 v[244:247], a[224:227], v[100:103], 0
    ds_read_b64_tr_b16 a[92:93], v14 offset:32768
    v_cvt_pk_bf16_f32 v56, v248, v249
    v_cvt_pk_bf16_f32 v57, v250, v251
    v_cvt_pk_bf16_f32 v58, v252, v253
    v_cvt_pk_bf16_f32 v59, v254, v255
    v_mfma_f32_16x16x32_bf16 v[244:247], a[228:231], v[96:99], v[244:247]
    v_exp_f32 v121, v121
    v_mfma_f32_16x16x32_bf16 v[248:251], a[232:235], v[96:99], 0
    ds_read_b64_tr_b16 a[94:95], v14 offset:36864
    v_cvt_pk_bf16_f32 v116, v120, v121
    v_mfma_f32_16x16x32_bf16 v[248:251], a[236:239], v[100:103], v[248:251]
    v_exp_f32 v122, v122
    v_mfma_f32_16x16x32_bf16 v[252:255], a[240:243], v[100:103], 0
    ds_read_b64_tr_b16 a[192:193], v14 offset:40960
    v_cndmask_b32_dpp v68, v60, v80, vcc row_ror:8 row_mask:0xf bank_mask:0xf
    v_mfma_f32_16x16x32_bf16 v[252:255], a[244:247], v[96:99], v[252:255]
    ds_read_b64_tr_b16 a[194:195], v14 offset:45056
    v_cndmask_b32_dpp v69, v61, v81, vcc row_ror:8 row_mask:0xf bank_mask:0xf
    v_mfma_f32_16x16x32_bf16 v[96:99], a[128:131], a[20:23], 0
    v_exp_f32 v123, v123
    v_mfma_f32_16x16x32_bf16 v[96:99], a[132:135], a[24:27], v[96:99]
    ds_read_b64_tr_b16 a[196:197], v14 offset:40968
    v_cvt_pk_bf16_f32 v117, v122, v123
    v_mfma_f32_16x16x32_bf16 v[96:99], a[136:139], a[28:31], v[96:99]
    v_exp_f32 v124, v124
    v_mfma_f32_16x16x32_bf16 v[96:99], a[140:143], a[32:35], v[96:99]
    ds_read_b64_tr_b16 a[198:199], v14 offset:45064
    v_cndmask_b32_dpp v70, v62, v82, vcc row_ror:8 row_mask:0xf bank_mask:0xf
    v_mfma_f32_16x16x32_bf16 v[100:103], a[144:147], a[32:35], 0
    v_exp_f32 v125, v125
    v_mfma_f32_16x16x32_bf16 v[100:103], a[148:151], a[28:31], v[100:103]
    ds_read_b64_tr_b16 a[200:201], v14 offset:32776
    v_cvt_pk_bf16_f32 v118, v124, v125
    v_mfma_f32_16x16x32_bf16 v[100:103], a[152:155], a[24:27], v[100:103]
    v_exp_f32 v126, v126
    v_mfma_f32_16x16x32_bf16 v[100:103], a[156:159], a[20:23], v[100:103]
    ds_read_b64_tr_b16 a[202:203], v14 offset:36872
    v_cndmask_b32_dpp v71, v63, v83, vcc row_ror:8 row_mask:0xf bank_mask:0xf
    v_mfma_f32_16x16x32_bf16 v[104:107], a[160:163], a[20:23], 0
    v_exp_f32 v127, v127
    v_mfma_f32_16x16x32_bf16 v[104:107], a[164:167], a[24:27], v[104:107]
    ds_read_b64_tr_b16 a[204:205], v15 offset:32768
    v_cvt_pk_bf16_f32 v119, v126, v127
    v_mfma_f32_16x16x32_bf16 v[104:107], a[168:171], a[28:31], v[104:107]
    v_exp_f32 v96, v96
    v_mfma_f32_16x16x32_bf16 v[104:107], a[172:175], a[32:35], v[104:107]
    ds_read_b64_tr_b16 a[206:207], v15 offset:36864
    v_mov_b32_dpp v60, v80 row_ror:8 row_mask:0xf bank_mask:0x3
    v_mfma_f32_16x16x32_bf16 v[108:111], a[176:179], a[32:35], 0
    v_exp_f32 v97, v97
    v_mfma_f32_16x16x32_bf16 v[108:111], a[180:183], a[28:31], v[108:111]
    ds_read_b64_tr_b16 a[208:209], v15 offset:40960
    v_cvt_pk_bf16_f32 v96, v96, v97
    v_mfma_f32_16x16x32_bf16 v[108:111], a[184:187], a[24:27], v[108:111]
    v_exp_f32 v98, v98
    v_mfma_f32_16x16x32_bf16 v[108:111], a[188:191], a[20:23], v[108:111]
    ds_read_b64_tr_b16 a[210:211], v15 offset:45056
    v_mov_b32_dpp v61, v81 row_ror:8 row_mask:0xf bank_mask:0x3
    v_smfmac_f32_16x16x64_bf16 v[24:27], a[120:123], v[112:119], v22
    v_exp_f32 v99, v99
    v_mfma_f32_16x16x32_bf16 v[128:131], a[248:251], v[112:115], v[128:131]
    s_waitcnt lgkmcnt(4)
    ds_read_b64_tr_b16 a[212:213], v15 offset:40968
    v_cvt_pk_bf16_f32 v97, v98, v99
    v_mfma_f32_16x16x32_bf16 v[128:131], a[252:255], v[116:119], v[128:131]
    v_exp_f32 v100, v100
    v_mfma_f32_16x16x32_bf16 v[132:135], a[116:119], v[116:119], v[132:135]
    ds_read_b64_tr_b16 a[214:215], v15 offset:45064
    v_mov_b32_dpp v62, v82 row_ror:8 row_mask:0xf bank_mask:0x3
    v_mfma_f32_16x16x32_bf16 v[132:135], a[112:115], v[112:115], v[132:135]
    v_exp_f32 v101, v101
    v_mfma_f32_16x16x32_bf16 v[136:139], a[108:111], v[112:115], v[136:139]
    ds_read_b64_tr_b16 a[216:217], v15 offset:32776
    v_cvt_pk_bf16_f32 v98, v100, v101
    v_mfma_f32_16x16x32_bf16 v[136:139], a[104:107], v[116:119], v[136:139]
    v_exp_f32 v102, v102
    v_mfma_f32_16x16x32_bf16 v[140:143], a[100:103], v[116:119], v[140:143]
    ds_read_b64_tr_b16 a[218:219], v15 offset:36872
    v_mov_b32_dpp v63, v83 row_ror:8 row_mask:0xf bank_mask:0x3
    v_mfma_f32_16x16x32_bf16 v[140:143], a[96:99], v[112:115], v[140:143]
    v_exp_f32 v103, v103
    v_mfma_f32_16x16x32_bf16 v[144:147], a[92:95], v[112:115], v[144:147]
    v_cvt_pk_bf16_f32 v99, v102, v103
    v_mfma_f32_16x16x32_bf16 v[144:147], a[192:195], v[116:119], v[144:147]
    v_exp_f32 v104, v104
    v_mfma_f32_16x16x32_bf16 v[148:151], a[196:199], v[116:119], v[148:151]
    v_mfma_f32_16x16x32_bf16 v[148:151], a[200:203], v[112:115], v[148:151]
    s_waitcnt lgkmcnt(3)
    v_exp_f32 v105, v105
    v_mfma_f32_16x16x32_bf16 v[152:155], a[204:207], v[112:115], v[152:155]
    v_cvt_pk_bf16_f32 v100, v104, v105
    v_mfma_f32_16x16x32_bf16 v[152:155], a[208:211], v[116:119], v[152:155]
    s_waitcnt lgkmcnt(2)
    v_exp_f32 v106, v106
    v_mfma_f32_16x16x32_bf16 v[156:159], a[212:215], v[116:119], v[156:159]
    s_waitcnt vmcnt(2) lgkmcnt(0)
    v_mfma_f32_16x16x32_bf16 v[156:159], a[216:219], v[112:115], v[156:159]
    s_barrier
    v_mfma_f32_16x16x32_bf16 v[112:115], a[128:131], a[36:39], 0
    v_exp_f32 v107, v107
    v_mfma_f32_16x16x32_bf16 v[112:115], a[132:135], a[40:43], v[112:115]
    s_add_u32 s29, s27, 81920
    v_cvt_pk_bf16_f32 v101, v106, v107
    v_mfma_f32_16x16x32_bf16 v[112:115], a[136:139], a[44:47], v[112:115]
    s_add_u32 m0, s27, 131072
    v_exp_f32 v108, v108
    v_mfma_f32_16x16x32_bf16 v[112:115], a[140:143], a[48:51], v[112:115]
    buffer_load_dwordx4 v18, s[52:55], s29 offen lds
    v_mfma_f32_16x16x32_bf16 v[116:119], a[144:147], a[48:51], 0
    v_exp_f32 v109, v109
    v_mfma_f32_16x16x32_bf16 v[116:119], a[148:151], a[44:47], v[116:119]
    v_cvt_pk_bf16_f32 v102, v108, v109
    v_mfma_f32_16x16x32_bf16 v[116:119], a[152:155], a[40:43], v[116:119]
    v_exp_f32 v110, v110
    v_mfma_f32_16x16x32_bf16 v[116:119], a[156:159], a[36:39], v[116:119]
    buffer_load_dwordx4 v18, s[52:55], s29 offen offset:1024 lds
    v_mfma_f32_16x16x32_bf16 v[120:123], a[160:163], a[36:39], 0
    v_exp_f32 v111, v111
    v_mfma_f32_16x16x32_bf16 v[120:123], a[164:167], a[40:43], v[120:123]
    v_cvt_pk_bf16_f32 v103, v110, v111
    v_mfma_f32_16x16x32_bf16 v[120:123], a[168:171], a[44:47], v[120:123]
    v_exp_f32 v112, v112
    v_mfma_f32_16x16x32_bf16 v[120:123], a[172:175], a[48:51], v[120:123]
    buffer_load_dwordx4 v18, s[52:55], s29 offen offset:2048 lds
    v_mfma_f32_16x16x32_bf16 v[124:127], a[176:179], a[48:51], 0
    v_exp_f32 v113, v113
    v_mfma_f32_16x16x32_bf16 v[124:127], a[180:183], a[44:47], v[124:127]
    v_cvt_pk_bf16_f32 v112, v112, v113
    v_mfma_f32_16x16x32_bf16 v[124:127], a[184:187], a[40:43], v[124:127]
    v_exp_f32 v114, v114
    v_mfma_f32_16x16x32_bf16 v[124:127], a[188:191], a[36:39], v[124:127]
    buffer_load_dwordx4 v18, s[52:55], s29 offen offset:3072 lds
    v_smfmac_f32_16x16x64_bf16 v[24:27], a[124:127], v[96:103], v22
    v_exp_f32 v115, v115
    v_mfma_f32_16x16x32_bf16 v[160:163], a[248:251], v[96:99], v[160:163]
    v_cvt_pk_bf16_f32 v113, v114, v115
    v_mfma_f32_16x16x32_bf16 v[160:163], a[252:255], v[100:103], v[160:163]
    v_exp_f32 v116, v116
    v_mfma_f32_16x16x32_bf16 v[164:167], a[116:119], v[100:103], v[164:167]
    s_mov_b32 s31, 8192
    buffer_store_dwordx4 v[68:71], v23, s[56:59], s31 offen offset:0 sc1
    v_mfma_f32_16x16x32_bf16 v[164:167], a[112:115], v[96:99], v[164:167]
    v_exp_f32 v117, v117
    v_mfma_f32_16x16x32_bf16 v[168:171], a[108:111], v[96:99], v[168:171]
    v_cvt_pk_bf16_f32 v114, v116, v117
    v_mfma_f32_16x16x32_bf16 v[168:171], a[104:107], v[100:103], v[168:171]
    v_exp_f32 v118, v118
    v_mfma_f32_16x16x32_bf16 v[172:175], a[100:103], v[100:103], v[172:175]
    v_mfma_f32_16x16x32_bf16 v[172:175], a[96:99], v[96:99], v[172:175]
    v_exp_f32 v119, v119
    v_mfma_f32_16x16x32_bf16 v[176:179], a[92:95], v[96:99], v[176:179]
    v_cvt_pk_bf16_f32 v115, v118, v119
    v_mfma_f32_16x16x32_bf16 v[176:179], a[192:195], v[100:103], v[176:179]
    v_exp_f32 v120, v120
    v_mfma_f32_16x16x32_bf16 v[180:183], a[196:199], v[100:103], v[180:183]
    v_mfma_f32_16x16x32_bf16 v[180:183], a[200:203], v[96:99], v[180:183]
    v_exp_f32 v121, v121
    v_mfma_f32_16x16x32_bf16 v[184:187], a[204:207], v[96:99], v[184:187]
    v_cvt_pk_bf16_f32 v116, v120, v121
    v_mfma_f32_16x16x32_bf16 v[184:187], a[208:211], v[100:103], v[184:187]
    v_exp_f32 v122, v122
    v_mfma_f32_16x16x32_bf16 v[188:191], a[212:215], v[100:103], v[188:191]
    s_mov_b32 s31, 8192
    buffer_store_dwordx4 v[60:63], v23, s[56:59], s31 offen offset:2048 sc1
    v_mfma_f32_16x16x32_bf16 v[188:191], a[216:219], v[96:99], v[188:191]
    v_mfma_f32_16x16x32_bf16 v[96:99], a[128:131], a[52:55], 0
    v_exp_f32 v123, v123
    v_mfma_f32_16x16x32_bf16 v[96:99], a[132:135], a[56:59], v[96:99]
    ds_read_b128 a[128:131], v8 offset:0
    v_cvt_pk_bf16_f32 v117, v122, v123
    v_mfma_f32_16x16x32_bf16 v[96:99], a[136:139], a[60:63], v[96:99]
    v_exp_f32 v124, v124
    v_mfma_f32_16x16x32_bf16 v[96:99], a[140:143], a[64:67], v[96:99]
    ds_read_b128 a[132:135], v9 offset:0
    v_mfma_f32_16x16x32_bf16 v[100:103], a[144:147], a[64:67], 0
    v_exp_f32 v125, v125
    v_mfma_f32_16x16x32_bf16 v[100:103], a[148:151], a[60:63], v[100:103]
    ds_read_b128 a[136:139], v10 offset:0
    v_cvt_pk_bf16_f32 v118, v124, v125
    v_mfma_f32_16x16x32_bf16 v[100:103], a[152:155], a[56:59], v[100:103]
    v_exp_f32 v126, v126
    v_mfma_f32_16x16x32_bf16 v[100:103], a[156:159], a[52:55], v[100:103]
    ds_read_b128 a[140:143], v11 offset:0
    v_cndmask_b32_dpp v84, v44, v36, vcc row_ror:8 row_mask:0xf bank_mask:0xf
    v_mfma_f32_16x16x32_bf16 v[104:107], a[160:163], a[52:55], 0
    v_exp_f32 v127, v127
    v_mfma_f32_16x16x32_bf16 v[104:107], a[164:167], a[56:59], v[104:107]
    ds_read_b128 a[144:147], v11 offset:4096
    v_cvt_pk_bf16_f32 v119, v126, v127
    v_mfma_f32_16x16x32_bf16 v[104:107], a[168:171], a[60:63], v[104:107]
Lpad12:
    s_cbranch_execz Lret1
    v_exp_f32 v96, v96
    v_mfma_f32_16x16x32_bf16 v[104:107], a[172:175], a[64:67], v[104:107]
    ds_read_b128 a[148:151], v10 offset:4096
    v_cndmask_b32_dpp v85, v45, v37, vcc row_ror:8 row_mask:0xf bank_mask:0xf
    v_mfma_f32_16x16x32_bf16 v[108:111], a[176:179], a[64:67], 0
    v_exp_f32 v97, v97
    v_mfma_f32_16x16x32_bf16 v[108:111], a[180:183], a[60:63], v[108:111]
    ds_read_b128 a[152:155], v9 offset:4096
    v_cvt_pk_bf16_f32 v96, v96, v97
    v_mfma_f32_16x16x32_bf16 v[108:111], a[184:187], a[56:59], v[108:111]
    v_exp_f32 v98, v98
    v_mfma_f32_16x16x32_bf16 v[108:111], a[188:191], a[52:55], v[108:111]
    ds_read_b128 a[156:159], v8 offset:4096
    v_cndmask_b32_dpp v86, v46, v38, vcc row_ror:8 row_mask:0xf bank_mask:0xf
    v_smfmac_f32_16x16x64_bf16 v[28:31], a[120:123], v[112:119], v22
    v_exp_f32 v99, v99
    v_mfma_f32_16x16x32_bf16 v[192:195], a[248:251], v[112:115], v[192:195]
    ds_read_b128 a[160:163], v8 offset:8192
    v_cvt_pk_bf16_f32 v97, v98, v99
    v_mfma_f32_16x16x32_bf16 v[192:195], a[252:255], v[116:119], v[192:195]
    v_exp_f32 v100, v100
    v_mfma_f32_16x16x32_bf16 v[196:199], a[116:119], v[116:119], v[196:199]
    ds_read_b128 a[164:167], v9 offset:8192
    v_cndmask_b32_dpp v87, v47, v39, vcc row_ror:8 row_mask:0xf bank_mask:0xf
    v_mfma_f32_16x16x32_bf16 v[196:199], a[112:115], v[112:115], v[196:199]
    v_exp_f32 v101, v101
    v_mfma_f32_16x16x32_bf16 v[200:203], a[108:111], v[112:115], v[200:203]
    ds_read_b128 a[168:171], v10 offset:8192
    v_cvt_pk_bf16_f32 v98, v100, v101
    v_mfma_f32_16x16x32_bf16 v[200:203], a[104:107], v[116:119], v[200:203]
    v_exp_f32 v102, v102
    v_mfma_f32_16x16x32_bf16 v[204:207], a[100:103], v[116:119], v[204:207]
    ds_read_b128 a[172:175], v11 offset:8192
    v_mov_b32_dpp v44, v36 row_ror:8 row_mask:0xf bank_mask:0x3
    v_mfma_f32_16x16x32_bf16 v[204:207], a[96:99], v[112:115], v[204:207]
    v_exp_f32 v103, v103
    v_mfma_f32_16x16x32_bf16 v[208:211], a[92:95], v[112:115], v[208:211]
    ds_read_b128 a[176:179], v11 offset:12288
    v_cvt_pk_bf16_f32 v99, v102, v103
    v_mfma_f32_16x16x32_bf16 v[208:211], a[192:195], v[116:119], v[208:211]
    v_exp_f32 v104, v104
    v_mfma_f32_16x16x32_bf16 v[212:215], a[196:199], v[116:119], v[212:215]
    ds_read_b128 a[180:183], v10 offset:12288
    v_mov_b32_dpp v45, v37 row_ror:8 row_mask:0xf bank_mask:0x3
    v_mfma_f32_16x16x32_bf16 v[212:215], a[200:203], v[112:115], v[212:215]
    v_exp_f32 v105, v105
    v_mfma_f32_16x16x32_bf16 v[216:219], a[204:207], v[112:115], v[216:219]
    ds_read_b128 a[184:187], v9 offset:12288
    v_cvt_pk_bf16_f32 v100, v104, v105
    v_mfma_f32_16x16x32_bf16 v[216:219], a[208:211], v[116:119], v[216:219]
    v_exp_f32 v106, v106
    v_mfma_f32_16x16x32_bf16 v[220:223], a[212:215], v[116:119], v[220:223]
    ds_read_b128 a[188:191], v8 offset:12288
    v_mov_b32_dpp v46, v38 row_ror:8 row_mask:0xf bank_mask:0x3
    v_mfma_f32_16x16x32_bf16 v[220:223], a[216:219], v[112:115], v[220:223]
    s_waitcnt lgkmcnt(5)
    ds_read_b64_tr_b16 a[220:221], v12 offset:49152
    ds_read_b64_tr_b16 a[222:223], v12 offset:53248
    v_mfma_f32_16x16x32_bf16 v[112:115], a[128:131], a[4:7], 0
    v_exp_f32 v107, v107
    v_mfma_f32_16x16x32_bf16 v[112:115], a[132:135], a[8:11], v[112:115]
    ds_read_b64_tr_b16 a[224:225], v12 offset:57344
    v_cvt_pk_bf16_f32 v101, v106, v107
    v_mfma_f32_16x16x32_bf16 v[112:115], a[136:139], a[12:15], v[112:115]
    v_exp_f32 v108, v108
    v_mfma_f32_16x16x32_bf16 v[112:115], a[140:143], a[16:19], v[112:115]
    ds_read_b64_tr_b16 a[226:227], v12 offset:61440
    ds_read_b64_tr_b16 a[228:229], v12 offset:57352
    v_mfma_f32_16x16x32_bf16 v[116:119], a[144:147], a[16:19], 0
    v_exp_f32 v109, v109
    v_mfma_f32_16x16x32_bf16 v[116:119], a[148:151], a[12:15], v[116:119]
    ds_read_b64_tr_b16 a[230:231], v12 offset:61448
    v_cvt_pk_bf16_f32 v102, v108, v109
    v_mfma_f32_16x16x32_bf16 v[116:119], a[152:155], a[8:11], v[116:119]
    v_exp_f32 v110, v110
    v_mfma_f32_16x16x32_bf16 v[116:119], a[156:159], a[4:7], v[116:119]
    ds_read_b64_tr_b16 a[232:233], v12 offset:49160
    v_mov_b32_dpp v47, v39 row_ror:8 row_mask:0xf bank_mask:0x3
    v_mfma_f32_16x16x32_bf16 v[120:123], a[160:163], a[4:7], 0
    v_exp_f32 v111, v111
    v_mfma_f32_16x16x32_bf16 v[120:123], a[164:167], a[8:11], v[120:123]
    ds_read_b64_tr_b16 a[234:235], v12 offset:53256
    v_cvt_pk_bf16_f32 v103, v110, v111
    v_mfma_f32_16x16x32_bf16 v[120:123], a[168:171], a[12:15], v[120:123]
    s_waitcnt lgkmcnt(6)
    v_exp_f32 v112, v112
    v_mfma_f32_16x16x32_bf16 v[120:123], a[172:175], a[16:19], v[120:123]
    ds_read_b64_tr_b16 a[236:237], v13 offset:49152
    v_mfma_f32_16x16x32_bf16 v[124:127], a[176:179], a[16:19], 0
    v_exp_f32 v113, v113
    v_mfma_f32_16x16x32_bf16 v[124:127], a[180:183], a[12:15], v[124:127]
    ds_read_b64_tr_b16 a[238:239], v13 offset:53248
    v_cvt_pk_bf16_f32 v112, v112, v113
    v_mfma_f32_16x16x32_bf16 v[124:127], a[184:187], a[8:11], v[124:127]
    v_exp_f32 v114, v114
    v_mfma_f32_16x16x32_bf16 v[124:127], a[188:191], a[4:7], v[124:127]
    ds_read_b64_tr_b16 a[240:241], v13 offset:57344
    v_smfmac_f32_16x16x64_bf16 v[28:31], a[124:127], v[96:103], v22
    v_exp_f32 v115, v115
    v_mfma_f32_16x16x32_bf16 v[224:227], a[248:251], v[96:99], v[224:227]
    ds_read_b64_tr_b16 a[242:243], v13 offset:61440
    v_cvt_pk_bf16_f32 v113, v114, v115
    v_mfma_f32_16x16x32_bf16 v[224:227], a[252:255], v[100:103], v[224:227]
    v_exp_f32 v116, v116
    v_mfma_f32_16x16x32_bf16 v[228:231], a[116:119], v[100:103], v[228:231]
    ds_read_b64_tr_b16 a[244:245], v13 offset:57352
    v_mfma_f32_16x16x32_bf16 v[228:231], a[112:115], v[96:99], v[228:231]
    v_exp_f32 v117, v117
    v_mfma_f32_16x16x32_bf16 v[232:235], a[108:111], v[96:99], v[232:235]
    ds_read_b64_tr_b16 a[246:247], v13 offset:61448
    v_cvt_pk_bf16_f32 v114, v116, v117
    v_mfma_f32_16x16x32_bf16 v[232:235], a[104:107], v[100:103], v[232:235]
    v_exp_f32 v118, v118
    v_mfma_f32_16x16x32_bf16 v[236:239], a[100:103], v[100:103], v[236:239]
    ds_read_b64_tr_b16 a[248:249], v13 offset:49160
    v_mfma_f32_16x16x32_bf16 v[236:239], a[96:99], v[96:99], v[236:239]
    v_exp_f32 v119, v119
    v_mfma_f32_16x16x32_bf16 v[240:243], a[92:95], v[96:99], v[240:243]
    ds_read_b64_tr_b16 a[250:251], v13 offset:53256
    v_cvt_pk_bf16_f32 v115, v118, v119
    v_mfma_f32_16x16x32_bf16 v[240:243], a[192:195], v[100:103], v[240:243]
    v_exp_f32 v120, v120
    v_mfma_f32_16x16x32_bf16 v[244:247], a[196:199], v[100:103], v[244:247]
    ds_read_b64_tr_b16 a[252:253], v14 offset:49152
    v_mfma_f32_16x16x32_bf16 v[244:247], a[200:203], v[96:99], v[244:247]
    v_exp_f32 v121, v121
    v_mfma_f32_16x16x32_bf16 v[248:251], a[204:207], v[96:99], v[248:251]
    ds_read_b64_tr_b16 a[254:255], v14 offset:53248
    v_cvt_pk_bf16_f32 v116, v120, v121
    v_mfma_f32_16x16x32_bf16 v[248:251], a[208:211], v[100:103], v[248:251]
    v_exp_f32 v122, v122
    v_mfma_f32_16x16x32_bf16 v[252:255], a[212:215], v[100:103], v[252:255]
    ds_read_b64_tr_b16 a[116:117], v14 offset:57344
    v_mfma_f32_16x16x32_bf16 v[252:255], a[216:219], v[96:99], v[252:255]
    ds_read_b64_tr_b16 a[118:119], v14 offset:61440
    v_mfma_f32_16x16x32_bf16 v[96:99], a[128:131], a[20:23], 0
    v_exp_f32 v123, v123
    v_mfma_f32_16x16x32_bf16 v[96:99], a[132:135], a[24:27], v[96:99]
    ds_read_b64_tr_b16 a[112:113], v14 offset:57352
    v_cvt_pk_bf16_f32 v117, v122, v123
    v_mfma_f32_16x16x32_bf16 v[96:99], a[136:139], a[28:31], v[96:99]
    v_exp_f32 v124, v124
    v_mfma_f32_16x16x32_bf16 v[96:99], a[140:143], a[32:35], v[96:99]
    ds_read_b64_tr_b16 a[114:115], v14 offset:61448
    v_mfma_f32_16x16x32_bf16 v[100:103], a[144:147], a[32:35], 0
    v_exp_f32 v125, v125
    v_mfma_f32_16x16x32_bf16 v[100:103], a[148:151], a[28:31], v[100:103]
    ds_read_b64_tr_b16 a[108:109], v14 offset:49160
    v_cvt_pk_bf16_f32 v118, v124, v125
    v_mfma_f32_16x16x32_bf16 v[100:103], a[152:155], a[24:27], v[100:103]
    v_exp_f32 v126, v126
    v_mfma_f32_16x16x32_bf16 v[100:103], a[156:159], a[20:23], v[100:103]
    ds_read_b64_tr_b16 a[110:111], v14 offset:53256
    v_mfma_f32_16x16x32_bf16 v[104:107], a[160:163], a[20:23], 0
    v_exp_f32 v127, v127
    v_mfma_f32_16x16x32_bf16 v[104:107], a[164:167], a[24:27], v[104:107]
    ds_read_b64_tr_b16 a[104:105], v15 offset:49152
    v_cvt_pk_bf16_f32 v119, v126, v127
    v_mfma_f32_16x16x32_bf16 v[104:107], a[168:171], a[28:31], v[104:107]
    v_exp_f32 v96, v96
    v_mfma_f32_16x16x32_bf16 v[104:107], a[172:175], a[32:35], v[104:107]
    ds_read_b64_tr_b16 a[106:107], v15 offset:53248
    v_mfma_f32_16x16x32_bf16 v[108:111], a[176:179], a[32:35], 0
    v_exp_f32 v97, v97
    v_mfma_f32_16x16x32_bf16 v[108:111], a[180:183], a[28:31], v[108:111]
    ds_read_b64_tr_b16 a[100:101], v15 offset:57344
    v_cvt_pk_bf16_f32 v96, v96, v97
    v_mfma_f32_16x16x32_bf16 v[108:111], a[184:187], a[24:27], v[108:111]
    v_exp_f32 v98, v98
    v_mfma_f32_16x16x32_bf16 v[108:111], a[188:191], a[20:23], v[108:111]
    ds_read_b64_tr_b16 a[102:103], v15 offset:61440
    v_smfmac_f32_16x16x64_bf16 v[24:27], a[120:123], v[112:119], v22
    v_exp_f32 v99, v99
    v_mfma_f32_16x16x32_bf16 v[128:131], a[220:223], v[112:115], v[128:131]
    s_waitcnt lgkmcnt(5)
    ds_read_b64_tr_b16 a[96:97], v15 offset:57352
    v_cvt_pk_bf16_f32 v97, v98, v99
    v_mfma_f32_16x16x32_bf16 v[128:131], a[224:227], v[116:119], v[128:131]
    v_exp_f32 v100, v100
    v_mfma_f32_16x16x32_bf16 v[132:135], a[228:231], v[116:119], v[132:135]
    ds_read_b64_tr_b16 a[98:99], v15 offset:61448
    v_mfma_f32_16x16x32_bf16 v[132:135], a[232:235], v[112:115], v[132:135]
    v_exp_f32 v101, v101
    v_mfma_f32_16x16x32_bf16 v[136:139], a[236:239], v[112:115], v[136:139]
    ds_read_b64_tr_b16 a[92:93], v15 offset:49160
    v_cvt_pk_bf16_f32 v98, v100, v101
    v_mfma_f32_16x16x32_bf16 v[136:139], a[240:243], v[116:119], v[136:139]
    v_exp_f32 v102, v102
    v_mfma_f32_16x16x32_bf16 v[140:143], a[244:247], v[116:119], v[140:143]
    ds_read_b64_tr_b16 a[94:95], v15 offset:53256
    v_mfma_f32_16x16x32_bf16 v[140:143], a[248:251], v[112:115], v[140:143]
    v_exp_f32 v103, v103
    v_mfma_f32_16x16x32_bf16 v[144:147], a[252:255], v[112:115], v[144:147]
    v_cvt_pk_bf16_f32 v99, v102, v103
    v_mfma_f32_16x16x32_bf16 v[144:147], a[116:119], v[116:119], v[144:147]
    v_exp_f32 v104, v104
    v_mfma_f32_16x16x32_bf16 v[148:151], a[112:115], v[116:119], v[148:151]
    s_waitcnt lgkmcnt(4)
    v_mfma_f32_16x16x32_bf16 v[148:151], a[108:111], v[112:115], v[148:151]
    v_exp_f32 v105, v105
    v_mfma_f32_16x16x32_bf16 v[152:155], a[104:107], v[112:115], v[152:155]
    v_cvt_pk_bf16_f32 v100, v104, v105
    v_mfma_f32_16x16x32_bf16 v[152:155], a[100:103], v[116:119], v[152:155]
    s_waitcnt lgkmcnt(2)
    v_exp_f32 v106, v106
    v_mfma_f32_16x16x32_bf16 v[156:159], a[96:99], v[116:119], v[156:159]
    s_waitcnt vmcnt(2) lgkmcnt(0)
    v_mfma_f32_16x16x32_bf16 v[156:159], a[92:95], v[112:115], v[156:159]
    s_barrier
    v_mfma_f32_16x16x32_bf16 v[112:115], a[128:131], a[36:39], 0
    v_exp_f32 v107, v107
    v_mfma_f32_16x16x32_bf16 v[112:115], a[132:135], a[40:43], v[112:115]
    s_add_u32 s29, s27, 98304
    v_cvt_pk_bf16_f32 v101, v106, v107
    v_mfma_f32_16x16x32_bf16 v[112:115], a[136:139], a[44:47], v[112:115]
    s_add_u32 m0, s27, 147456
    v_exp_f32 v108, v108
    v_mfma_f32_16x16x32_bf16 v[112:115], a[140:143], a[48:51], v[112:115]
    buffer_load_dwordx4 v18, s[52:55], s29 offen lds
    v_mfma_f32_16x16x32_bf16 v[116:119], a[144:147], a[48:51], 0
    v_exp_f32 v109, v109
    v_mfma_f32_16x16x32_bf16 v[116:119], a[148:151], a[44:47], v[116:119]
    v_cvt_pk_bf16_f32 v102, v108, v109
    v_mfma_f32_16x16x32_bf16 v[116:119], a[152:155], a[40:43], v[116:119]
    v_exp_f32 v110, v110
    v_mfma_f32_16x16x32_bf16 v[116:119], a[156:159], a[36:39], v[116:119]
    buffer_load_dwordx4 v18, s[52:55], s29 offen offset:1024 lds
    v_mfma_f32_16x16x32_bf16 v[120:123], a[160:163], a[36:39], 0
    v_exp_f32 v111, v111
    v_mfma_f32_16x16x32_bf16 v[120:123], a[164:167], a[40:43], v[120:123]
    v_cvt_pk_bf16_f32 v103, v110, v111
    v_mfma_f32_16x16x32_bf16 v[120:123], a[168:171], a[44:47], v[120:123]
    v_exp_f32 v112, v112
    v_mfma_f32_16x16x32_bf16 v[120:123], a[172:175], a[48:51], v[120:123]
    buffer_load_dwordx4 v18, s[52:55], s29 offen offset:2048 lds
    v_mfma_f32_16x16x32_bf16 v[124:127], a[176:179], a[48:51], 0
    v_exp_f32 v113, v113
    v_mfma_f32_16x16x32_bf16 v[124:127], a[180:183], a[44:47], v[124:127]
    v_cvt_pk_bf16_f32 v112, v112, v113
    v_mfma_f32_16x16x32_bf16 v[124:127], a[184:187], a[40:43], v[124:127]
    v_exp_f32 v114, v114
    v_mfma_f32_16x16x32_bf16 v[124:127], a[188:191], a[36:39], v[124:127]
    buffer_load_dwordx4 v18, s[52:55], s29 offen offset:3072 lds
    v_smfmac_f32_16x16x64_bf16 v[24:27], a[124:127], v[96:103], v22
    v_exp_f32 v115, v115
    v_mfma_f32_16x16x32_bf16 v[160:163], a[220:223], v[96:99], v[160:163]
    v_cvt_pk_bf16_f32 v113, v114, v115
    v_mfma_f32_16x16x32_bf16 v[160:163], a[224:227], v[100:103], v[160:163]
    v_exp_f32 v116, v116
    v_mfma_f32_16x16x32_bf16 v[164:167], a[228:231], v[100:103], v[164:167]
    s_mov_b32 s31, 8192
    buffer_store_dwordx4 v[84:87], v23, s[56:59], s31 offen offset:128 sc1
    v_mfma_f32_16x16x32_bf16 v[164:167], a[232:235], v[96:99], v[164:167]
    v_exp_f32 v117, v117
    v_mfma_f32_16x16x32_bf16 v[168:171], a[236:239], v[96:99], v[168:171]
    v_cvt_pk_bf16_f32 v114, v116, v117
    v_mfma_f32_16x16x32_bf16 v[168:171], a[240:243], v[100:103], v[168:171]
    v_exp_f32 v118, v118
    v_mfma_f32_16x16x32_bf16 v[172:175], a[244:247], v[100:103], v[172:175]
    v_mfma_f32_16x16x32_bf16 v[172:175], a[248:251], v[96:99], v[172:175]
    v_exp_f32 v119, v119
    v_mfma_f32_16x16x32_bf16 v[176:179], a[252:255], v[96:99], v[176:179]
    v_cvt_pk_bf16_f32 v115, v118, v119
    v_mfma_f32_16x16x32_bf16 v[176:179], a[116:119], v[100:103], v[176:179]
    v_exp_f32 v120, v120
    v_mfma_f32_16x16x32_bf16 v[180:183], a[112:115], v[100:103], v[180:183]
    v_mfma_f32_16x16x32_bf16 v[180:183], a[108:111], v[96:99], v[180:183]
    v_exp_f32 v121, v121
    v_mfma_f32_16x16x32_bf16 v[184:187], a[104:107], v[96:99], v[184:187]
    v_cvt_pk_bf16_f32 v116, v120, v121
    v_mfma_f32_16x16x32_bf16 v[184:187], a[100:103], v[100:103], v[184:187]
    v_exp_f32 v122, v122
    v_mfma_f32_16x16x32_bf16 v[188:191], a[96:99], v[100:103], v[188:191]
    s_mov_b32 s31, 8192
    buffer_store_dwordx4 v[44:47], v23, s[56:59], s31 offen offset:2176 sc1
    v_mfma_f32_16x16x32_bf16 v[188:191], a[92:95], v[96:99], v[188:191]
    v_mfma_f32_16x16x32_bf16 v[96:99], a[128:131], a[52:55], 0
    v_exp_f32 v123, v123
    v_mfma_f32_16x16x32_bf16 v[96:99], a[132:135], a[56:59], v[96:99]
    ds_read_b128 a[128:131], v8 offset:16384
    v_cvt_pk_bf16_f32 v117, v122, v123
    v_mfma_f32_16x16x32_bf16 v[96:99], a[136:139], a[60:63], v[96:99]
    v_exp_f32 v124, v124
    v_mfma_f32_16x16x32_bf16 v[96:99], a[140:143], a[64:67], v[96:99]
    ds_read_b128 a[132:135], v9 offset:16384
    v_mfma_f32_16x16x32_bf16 v[100:103], a[144:147], a[64:67], 0
    v_exp_f32 v125, v125
    v_mfma_f32_16x16x32_bf16 v[100:103], a[148:151], a[60:63], v[100:103]
    ds_read_b128 a[136:139], v10 offset:16384
    v_cvt_pk_bf16_f32 v118, v124, v125
    v_mfma_f32_16x16x32_bf16 v[100:103], a[152:155], a[56:59], v[100:103]
    v_exp_f32 v126, v126
    v_mfma_f32_16x16x32_bf16 v[100:103], a[156:159], a[52:55], v[100:103]
    ds_read_b128 a[140:143], v11 offset:16384
    v_cndmask_b32_dpp v32, v72, v52, vcc row_ror:8 row_mask:0xf bank_mask:0xf
    v_mfma_f32_16x16x32_bf16 v[104:107], a[160:163], a[52:55], 0
    v_exp_f32 v127, v127
    v_mfma_f32_16x16x32_bf16 v[104:107], a[164:167], a[56:59], v[104:107]
    ds_read_b128 a[144:147], v11 offset:20480
    v_cvt_pk_bf16_f32 v119, v126, v127
    v_mfma_f32_16x16x32_bf16 v[104:107], a[168:171], a[60:63], v[104:107]
    v_exp_f32 v96, v96
    v_mfma_f32_16x16x32_bf16 v[104:107], a[172:175], a[64:67], v[104:107]
    ds_read_b128 a[148:151], v10 offset:20480
    v_cndmask_b32_dpp v33, v73, v53, vcc row_ror:8 row_mask:0xf bank_mask:0xf
    v_mfma_f32_16x16x32_bf16 v[108:111], a[176:179], a[64:67], 0
    v_exp_f32 v97, v97
    v_mfma_f32_16x16x32_bf16 v[108:111], a[180:183], a[60:63], v[108:111]
    ds_read_b128 a[152:155], v9 offset:20480
    v_cvt_pk_bf16_f32 v96, v96, v97
    v_mfma_f32_16x16x32_bf16 v[108:111], a[184:187], a[56:59], v[108:111]
    v_exp_f32 v98, v98
    v_mfma_f32_16x16x32_bf16 v[108:111], a[188:191], a[52:55], v[108:111]
    ds_read_b128 a[156:159], v8 offset:20480
    v_cndmask_b32_dpp v34, v74, v54, vcc row_ror:8 row_mask:0xf bank_mask:0xf
    v_smfmac_f32_16x16x64_bf16 v[28:31], a[120:123], v[112:119], v22
    v_exp_f32 v99, v99
    v_mfma_f32_16x16x32_bf16 v[192:195], a[220:223], v[112:115], v[192:195]
    ds_read_b128 a[160:163], v8 offset:24576
    v_cvt_pk_bf16_f32 v97, v98, v99
    v_mfma_f32_16x16x32_bf16 v[192:195], a[224:227], v[116:119], v[192:195]
    v_exp_f32 v100, v100
    v_mfma_f32_16x16x32_bf16 v[196:199], a[228:231], v[116:119], v[196:199]
    ds_read_b128 a[164:167], v9 offset:24576
    v_cndmask_b32_dpp v35, v75, v55, vcc row_ror:8 row_mask:0xf bank_mask:0xf
    v_mfma_f32_16x16x32_bf16 v[196:199], a[232:235], v[112:115], v[196:199]
    v_exp_f32 v101, v101
    v_mfma_f32_16x16x32_bf16 v[200:203], a[236:239], v[112:115], v[200:203]
    ds_read_b128 a[168:171], v10 offset:24576
    v_cvt_pk_bf16_f32 v98, v100, v101
    v_mfma_f32_16x16x32_bf16 v[200:203], a[240:243], v[116:119], v[200:203]
    v_exp_f32 v102, v102
    v_mfma_f32_16x16x32_bf16 v[204:207], a[244:247], v[116:119], v[204:207]
    ds_read_b128 a[172:175], v11 offset:24576
    v_mov_b32_dpp v72, v52 row_ror:8 row_mask:0xf bank_mask:0x3
    v_mfma_f32_16x16x32_bf16 v[204:207], a[248:251], v[112:115], v[204:207]
    v_exp_f32 v103, v103
    v_mfma_f32_16x16x32_bf16 v[208:211], a[252:255], v[112:115], v[208:211]
    ds_read_b128 a[176:179], v11 offset:28672
    v_cvt_pk_bf16_f32 v99, v102, v103
    v_mfma_f32_16x16x32_bf16 v[208:211], a[116:119], v[116:119], v[208:211]
    v_exp_f32 v104, v104
    v_mfma_f32_16x16x32_bf16 v[212:215], a[112:115], v[116:119], v[212:215]
    ds_read_b128 a[180:183], v10 offset:28672
    v_mov_b32_dpp v73, v53 row_ror:8 row_mask:0xf bank_mask:0x3
    v_mfma_f32_16x16x32_bf16 v[212:215], a[108:111], v[112:115], v[212:215]
    v_exp_f32 v105, v105
    v_mfma_f32_16x16x32_bf16 v[216:219], a[104:107], v[112:115], v[216:219]
    ds_read_b128 a[184:187], v9 offset:28672
    v_cvt_pk_bf16_f32 v100, v104, v105
    v_mfma_f32_16x16x32_bf16 v[216:219], a[100:103], v[116:119], v[216:219]
    v_exp_f32 v106, v106
    v_mfma_f32_16x16x32_bf16 v[220:223], a[96:99], v[116:119], v[220:223]
    ds_read_b128 a[188:191], v8 offset:28672
    v_mov_b32_dpp v74, v54 row_ror:8 row_mask:0xf bank_mask:0x3
    v_mfma_f32_16x16x32_bf16 v[220:223], a[92:95], v[112:115], v[220:223]
    s_waitcnt lgkmcnt(5)
    ds_read_b64_tr_b16 a[192:193], v12 offset:32768
    ds_read_b64_tr_b16 a[194:195], v12 offset:36864
    v_mfma_f32_16x16x32_bf16 v[112:115], a[128:131], a[4:7], 0
    v_exp_f32 v107, v107
    v_mfma_f32_16x16x32_bf16 v[112:115], a[132:135], a[8:11], v[112:115]
    ds_read_b64_tr_b16 a[196:197], v12 offset:40960
    v_cvt_pk_bf16_f32 v101, v106, v107
    v_mfma_f32_16x16x32_bf16 v[112:115], a[136:139], a[12:15], v[112:115]
    v_exp_f32 v108, v108
    v_mfma_f32_16x16x32_bf16 v[112:115], a[140:143], a[16:19], v[112:115]
    ds_read_b64_tr_b16 a[198:199], v12 offset:45056
    ds_read_b64_tr_b16 a[200:201], v12 offset:40968
    v_mfma_f32_16x16x32_bf16 v[116:119], a[144:147], a[16:19], 0
    v_exp_f32 v109, v109
    v_mfma_f32_16x16x32_bf16 v[116:119], a[148:151], a[12:15], v[116:119]
    ds_read_b64_tr_b16 a[202:203], v12 offset:45064
    v_cvt_pk_bf16_f32 v102, v108, v109
    v_mfma_f32_16x16x32_bf16 v[116:119], a[152:155], a[8:11], v[116:119]
    s_add_u32 s61, s27, 65536
    v_exp_f32 v110, v110
    v_mfma_f32_16x16x32_bf16 v[116:119], a[156:159], a[4:7], v[116:119]
    s_sub_u32 s62, s61, s7
    ds_read_b64_tr_b16 a[204:205], v12 offset:32776
    v_bfe_u32 v76, v16, 8, 3
    v_mfma_f32_16x16x32_bf16 v[120:123], a[160:163], a[4:7], 0
    v_exp_f32 v111, v111
    v_mfma_f32_16x16x32_bf16 v[120:123], a[164:167], a[8:11], v[120:123]
    ds_read_b64_tr_b16 a[206:207], v12 offset:36872
    v_cvt_pk_bf16_f32 v103, v110, v111
    v_mfma_f32_16x16x32_bf16 v[120:123], a[168:171], a[12:15], v[120:123]
    s_waitcnt lgkmcnt(5)
    v_exp_f32 v112, v112
    v_mfma_f32_16x16x32_bf16 v[120:123], a[172:175], a[16:19], v[120:123]
    ds_read_b64_tr_b16 a[208:209], v13 offset:32768
    v_bfe_u32 v77, v18, 8, 2
    v_mfma_f32_16x16x32_bf16 v[124:127], a[176:179], a[16:19], 0
    v_exp_f32 v113, v113
    v_mfma_f32_16x16x32_bf16 v[124:127], a[180:183], a[12:15], v[124:127]
    ds_read_b64_tr_b16 a[210:211], v13 offset:36864
    v_cvt_pk_bf16_f32 v112, v112, v113
    v_mfma_f32_16x16x32_bf16 v[124:127], a[184:187], a[8:11], v[124:127]
    v_exp_f32 v114, v114
    v_mfma_f32_16x16x32_bf16 v[124:127], a[188:191], a[4:7], v[124:127]
    ds_read_b64_tr_b16 a[212:213], v13 offset:40960
    v_lshlrev_b32 v76, 4, v76
    v_smfmac_f32_16x16x64_bf16 v[28:31], a[124:127], v[96:103], v22
    v_exp_f32 v115, v115
    v_mfma_f32_16x16x32_bf16 v[224:227], a[220:223], v[96:99], v[224:227]
    ds_read_b64_tr_b16 a[214:215], v13 offset:45056
    v_cvt_pk_bf16_f32 v113, v114, v115
    v_mfma_f32_16x16x32_bf16 v[224:227], a[224:227], v[100:103], v[224:227]
    v_exp_f32 v116, v116
    v_mfma_f32_16x16x32_bf16 v[228:231], a[228:231], v[100:103], v[228:231]
    ds_read_b64_tr_b16 a[216:217], v13 offset:40968
    v_lshlrev_b32 v77, 4, v77
    v_mfma_f32_16x16x32_bf16 v[228:231], a[232:235], v[96:99], v[228:231]
    v_exp_f32 v117, v117
    v_mfma_f32_16x16x32_bf16 v[232:235], a[236:239], v[96:99], v[232:235]
    ds_read_b64_tr_b16 a[218:219], v13 offset:45064
    v_cvt_pk_bf16_f32 v114, v116, v117
    v_mfma_f32_16x16x32_bf16 v[232:235], a[240:243], v[100:103], v[232:235]
    v_exp_f32 v118, v118
    v_mfma_f32_16x16x32_bf16 v[236:239], a[244:247], v[100:103], v[236:239]
    ds_read_b64_tr_b16 a[220:221], v13 offset:32776
    v_xor_b32 v76, v76, v16
    v_mfma_f32_16x16x32_bf16 v[236:239], a[248:251], v[96:99], v[236:239]
    v_exp_f32 v119, v119
    v_mfma_f32_16x16x32_bf16 v[240:243], a[252:255], v[96:99], v[240:243]
    ds_read_b64_tr_b16 a[222:223], v13 offset:36872
    v_cvt_pk_bf16_f32 v115, v118, v119
    v_mfma_f32_16x16x32_bf16 v[240:243], a[116:119], v[100:103], v[240:243]
    v_exp_f32 v120, v120
    v_mfma_f32_16x16x32_bf16 v[244:247], a[112:115], v[100:103], v[244:247]
    ds_read_b64_tr_b16 a[224:225], v14 offset:32768
    v_xor_b32 v77, v77, v18
    v_mfma_f32_16x16x32_bf16 v[244:247], a[108:111], v[96:99], v[244:247]
    v_exp_f32 v121, v121
    v_mfma_f32_16x16x32_bf16 v[248:251], a[104:107], v[96:99], v[248:251]
    ds_read_b64_tr_b16 a[226:227], v14 offset:36864
    v_cvt_pk_bf16_f32 v116, v120, v121
    v_mfma_f32_16x16x32_bf16 v[248:251], a[100:103], v[100:103], v[248:251]
    v_exp_f32 v122, v122
    v_mfma_f32_16x16x32_bf16 v[252:255], a[96:99], v[100:103], v[252:255]
    ds_read_b64_tr_b16 a[228:229], v14 offset:40960
    v_add_u32 v76, s62, v76
    v_mfma_f32_16x16x32_bf16 v[252:255], a[92:95], v[96:99], v[252:255]
    ds_read_b64_tr_b16 a[230:231], v14 offset:45056
    v_add_u32 v77, s61, v77
    v_mfma_f32_16x16x32_bf16 v[96:99], a[128:131], a[20:23], 0
    v_exp_f32 v123, v123
    v_mfma_f32_16x16x32_bf16 v[96:99], a[132:135], a[24:27], v[96:99]
    ds_read_b64_tr_b16 a[232:233], v14 offset:40968
    v_cvt_pk_bf16_f32 v117, v122, v123
    v_mfma_f32_16x16x32_bf16 v[96:99], a[136:139], a[28:31], v[96:99]
    v_exp_f32 v124, v124
    v_mfma_f32_16x16x32_bf16 v[96:99], a[140:143], a[32:35], v[96:99]
    ds_read_b64_tr_b16 a[234:235], v14 offset:45064
    v_xor_b32 v78, 64, v76
    v_mfma_f32_16x16x32_bf16 v[100:103], a[144:147], a[32:35], 0
    v_exp_f32 v125, v125
    v_mfma_f32_16x16x32_bf16 v[100:103], a[148:151], a[28:31], v[100:103]
    ds_read_b64_tr_b16 a[236:237], v14 offset:32776
    v_cvt_pk_bf16_f32 v118, v124, v125
    v_mfma_f32_16x16x32_bf16 v[100:103], a[152:155], a[24:27], v[100:103]
    v_exp_f32 v126, v126
    v_mfma_f32_16x16x32_bf16 v[100:103], a[156:159], a[20:23], v[100:103]
    ds_read_b64_tr_b16 a[238:239], v14 offset:36872
    v_xor_b32 v79, 64, v77
    v_mfma_f32_16x16x32_bf16 v[104:107], a[160:163], a[20:23], 0
    v_exp_f32 v127, v127
    v_mfma_f32_16x16x32_bf16 v[104:107], a[164:167], a[24:27], v[104:107]
    ds_read_b64_tr_b16 a[240:241], v15 offset:32768
    v_cvt_pk_bf16_f32 v119, v126, v127
    v_mfma_f32_16x16x32_bf16 v[104:107], a[168:171], a[28:31], v[104:107]
    v_exp_f32 v96, v96
    v_mfma_f32_16x16x32_bf16 v[104:107], a[172:175], a[32:35], v[104:107]
    ds_read_b64_tr_b16 a[242:243], v15 offset:36864
    v_mov_b32_dpp v75, v55 row_ror:8 row_mask:0xf bank_mask:0x3
    v_mfma_f32_16x16x32_bf16 v[108:111], a[176:179], a[32:35], 0
    v_exp_f32 v97, v97
    v_mfma_f32_16x16x32_bf16 v[108:111], a[180:183], a[28:31], v[108:111]
    ds_read_b64_tr_b16 a[244:245], v15 offset:40960
    v_cvt_pk_bf16_f32 v96, v96, v97
    v_mfma_f32_16x16x32_bf16 v[108:111], a[184:187], a[24:27], v[108:111]
    v_exp_f32 v98, v98
    v_mfma_f32_16x16x32_bf16 v[108:111], a[188:191], a[20:23], v[108:111]
    ds_read_b64_tr_b16 a[246:247], v15 offset:45056
    v_smfmac_f32_16x16x64_bf16 v[24:27], a[120:123], v[112:119], v22
    v_exp_f32 v99, v99
    v_mfma_f32_16x16x32_bf16 v[128:131], a[192:195], v[112:115], v[128:131]
    s_waitcnt lgkmcnt(4)
    ds_read_b64_tr_b16 a[248:249], v15 offset:40968
    v_cvt_pk_bf16_f32 v97, v98, v99
    v_mfma_f32_16x16x32_bf16 v[128:131], a[196:199], v[116:119], v[128:131]
    v_exp_f32 v100, v100
    v_mfma_f32_16x16x32_bf16 v[132:135], a[200:203], v[116:119], v[132:135]
    ds_read_b64_tr_b16 a[250:251], v15 offset:45064
    v_mfma_f32_16x16x32_bf16 v[132:135], a[204:207], v[112:115], v[132:135]
    v_exp_f32 v101, v101
    v_mfma_f32_16x16x32_bf16 v[136:139], a[208:211], v[112:115], v[136:139]
    ds_read_b64_tr_b16 a[252:253], v15 offset:32776
    v_cvt_pk_bf16_f32 v98, v100, v101
    v_mfma_f32_16x16x32_bf16 v[136:139], a[212:215], v[116:119], v[136:139]
    v_exp_f32 v102, v102
    v_mfma_f32_16x16x32_bf16 v[140:143], a[216:219], v[116:119], v[140:143]
    ds_read_b64_tr_b16 a[254:255], v15 offset:36872
    v_mfma_f32_16x16x32_bf16 v[140:143], a[220:223], v[112:115], v[140:143]
    v_exp_f32 v103, v103
    v_mfma_f32_16x16x32_bf16 v[144:147], a[224:227], v[112:115], v[144:147]
    v_cvt_pk_bf16_f32 v99, v102, v103
    v_mfma_f32_16x16x32_bf16 v[144:147], a[228:231], v[116:119], v[144:147]
    v_exp_f32 v104, v104
    v_mfma_f32_16x16x32_bf16 v[148:151], a[232:235], v[116:119], v[148:151]
    v_mfma_f32_16x16x32_bf16 v[148:151], a[236:239], v[112:115], v[148:151]
    s_waitcnt lgkmcnt(4)
    v_exp_f32 v105, v105
    v_mfma_f32_16x16x32_bf16 v[152:155], a[240:243], v[112:115], v[152:155]
    v_cvt_pk_bf16_f32 v100, v104, v105
    v_mfma_f32_16x16x32_bf16 v[152:155], a[244:247], v[116:119], v[152:155]
    s_waitcnt lgkmcnt(2)
    v_exp_f32 v106, v106
    v_mfma_f32_16x16x32_bf16 v[156:159], a[248:251], v[116:119], v[156:159]
    s_waitcnt vmcnt(2) lgkmcnt(0)
    v_mfma_f32_16x16x32_bf16 v[156:159], a[252:255], v[112:115], v[156:159]
    s_barrier
    v_mfma_f32_16x16x32_bf16 v[112:115], a[128:131], a[36:39], 0
    v_exp_f32 v107, v107
    v_mfma_f32_16x16x32_bf16 v[112:115], a[132:135], a[40:43], v[112:115]
    s_add_u32 s29, s27, 114688
    v_cvt_pk_bf16_f32 v101, v106, v107
    v_mfma_f32_16x16x32_bf16 v[112:115], a[136:139], a[44:47], v[112:115]
    s_add_u32 m0, s27, 131072
    v_exp_f32 v108, v108
    v_mfma_f32_16x16x32_bf16 v[112:115], a[140:143], a[48:51], v[112:115]
    buffer_load_dwordx4 v18, s[52:55], s29 offen lds
    v_mfma_f32_16x16x32_bf16 v[116:119], a[144:147], a[48:51], 0
    v_exp_f32 v109, v109
    v_mfma_f32_16x16x32_bf16 v[116:119], a[148:151], a[44:47], v[116:119]
    v_cvt_pk_bf16_f32 v102, v108, v109
    v_mfma_f32_16x16x32_bf16 v[116:119], a[152:155], a[40:43], v[116:119]
    v_exp_f32 v110, v110
    v_mfma_f32_16x16x32_bf16 v[116:119], a[156:159], a[36:39], v[116:119]
    buffer_load_dwordx4 v18, s[52:55], s29 offen offset:1024 lds
    v_mfma_f32_16x16x32_bf16 v[120:123], a[160:163], a[36:39], 0
    v_exp_f32 v111, v111
    v_mfma_f32_16x16x32_bf16 v[120:123], a[164:167], a[40:43], v[120:123]
    v_cvt_pk_bf16_f32 v103, v110, v111
    v_mfma_f32_16x16x32_bf16 v[120:123], a[168:171], a[44:47], v[120:123]
    v_exp_f32 v112, v112
    v_mfma_f32_16x16x32_bf16 v[120:123], a[172:175], a[48:51], v[120:123]
    buffer_load_dwordx4 v18, s[52:55], s29 offen offset:2048 lds
    v_mfma_f32_16x16x32_bf16 v[124:127], a[176:179], a[48:51], 0
    v_exp_f32 v113, v113
    v_mfma_f32_16x16x32_bf16 v[124:127], a[180:183], a[44:47], v[124:127]
    v_cvt_pk_bf16_f32 v112, v112, v113
    v_mfma_f32_16x16x32_bf16 v[124:127], a[184:187], a[40:43], v[124:127]
    v_exp_f32 v114, v114
    v_mfma_f32_16x16x32_bf16 v[124:127], a[188:191], a[36:39], v[124:127]
    buffer_load_dwordx4 v18, s[52:55], s29 offen offset:3072 lds
    v_smfmac_f32_16x16x64_bf16 v[24:27], a[124:127], v[96:103], v22
    v_exp_f32 v115, v115
    v_mfma_f32_16x16x32_bf16 v[160:163], a[192:195], v[96:99], v[160:163]
    v_cvt_pk_bf16_f32 v113, v114, v115
    v_mfma_f32_16x16x32_bf16 v[160:163], a[196:199], v[100:103], v[160:163]
    v_exp_f32 v116, v116
    v_mfma_f32_16x16x32_bf16 v[164:167], a[200:203], v[100:103], v[164:167]
    s_mov_b32 s31, 12288
    buffer_store_dwordx4 v[32:35], v23, s[56:59], s31 offen offset:0 sc1
    v_mfma_f32_16x16x32_bf16 v[164:167], a[204:207], v[96:99], v[164:167]
    v_exp_f32 v117, v117
    v_mfma_f32_16x16x32_bf16 v[168:171], a[208:211], v[96:99], v[168:171]
    v_cvt_pk_bf16_f32 v114, v116, v117
    v_mfma_f32_16x16x32_bf16 v[168:171], a[212:215], v[100:103], v[168:171]
    v_exp_f32 v118, v118
    v_mfma_f32_16x16x32_bf16 v[172:175], a[216:219], v[100:103], v[172:175]
    v_mfma_f32_16x16x32_bf16 v[172:175], a[220:223], v[96:99], v[172:175]
    v_exp_f32 v119, v119
    v_mfma_f32_16x16x32_bf16 v[176:179], a[224:227], v[96:99], v[176:179]
    v_cvt_pk_bf16_f32 v115, v118, v119
    v_mfma_f32_16x16x32_bf16 v[176:179], a[228:231], v[100:103], v[176:179]
    v_exp_f32 v120, v120
    v_mfma_f32_16x16x32_bf16 v[180:183], a[232:235], v[100:103], v[180:183]
    v_mfma_f32_16x16x32_bf16 v[180:183], a[236:239], v[96:99], v[180:183]
    v_exp_f32 v121, v121
    v_mfma_f32_16x16x32_bf16 v[184:187], a[240:243], v[96:99], v[184:187]
Lpad13:
    s_cbranch_execz Lret1
    v_cvt_pk_bf16_f32 v116, v120, v121
    v_mfma_f32_16x16x32_bf16 v[184:187], a[244:247], v[100:103], v[184:187]
    v_exp_f32 v122, v122
    v_mfma_f32_16x16x32_bf16 v[188:191], a[248:251], v[100:103], v[188:191]
    s_mov_b32 s31, 12288
    buffer_store_dwordx4 v[72:75], v23, s[56:59], s31 offen offset:2048 sc1
    v_mfma_f32_16x16x32_bf16 v[188:191], a[252:255], v[96:99], v[188:191]
    v_mfma_f32_16x16x32_bf16 v[96:99], a[128:131], a[52:55], 0
    v_exp_f32 v123, v123
    v_mfma_f32_16x16x32_bf16 v[96:99], a[132:135], a[56:59], v[96:99]
    ds_read_b128 a[128:131], v8 offset:32768
    v_cvt_pk_bf16_f32 v117, v122, v123
    v_mfma_f32_16x16x32_bf16 v[96:99], a[136:139], a[60:63], v[96:99]
    v_exp_f32 v124, v124
    v_mfma_f32_16x16x32_bf16 v[96:99], a[140:143], a[64:67], v[96:99]
    ds_read_b128 a[132:135], v9 offset:32768
    v_mfma_f32_16x16x32_bf16 v[100:103], a[144:147], a[64:67], 0
    v_exp_f32 v125, v125
    v_mfma_f32_16x16x32_bf16 v[100:103], a[148:151], a[60:63], v[100:103]
    ds_read_b128 a[136:139], v10 offset:32768
    v_cvt_pk_bf16_f32 v118, v124, v125
    v_mfma_f32_16x16x32_bf16 v[100:103], a[152:155], a[56:59], v[100:103]
    v_exp_f32 v126, v126
    v_mfma_f32_16x16x32_bf16 v[100:103], a[156:159], a[52:55], v[100:103]
    ds_read_b128 a[140:143], v11 offset:32768
    v_cndmask_b32_dpp v40, v56, v88, vcc row_ror:8 row_mask:0xf bank_mask:0xf
    v_mfma_f32_16x16x32_bf16 v[104:107], a[160:163], a[52:55], 0
    v_exp_f32 v127, v127
    v_mfma_f32_16x16x32_bf16 v[104:107], a[164:167], a[56:59], v[104:107]
    ds_read_b128 a[144:147], v11 offset:36864
    v_cvt_pk_bf16_f32 v119, v126, v127
    v_mfma_f32_16x16x32_bf16 v[104:107], a[168:171], a[60:63], v[104:107]
    v_exp_f32 v96, v96
    v_mfma_f32_16x16x32_bf16 v[104:107], a[172:175], a[64:67], v[104:107]
    ds_read_b128 a[148:151], v10 offset:36864
    v_cndmask_b32_dpp v41, v57, v89, vcc row_ror:8 row_mask:0xf bank_mask:0xf
    v_mfma_f32_16x16x32_bf16 v[108:111], a[176:179], a[64:67], 0
    v_exp_f32 v97, v97
    v_mfma_f32_16x16x32_bf16 v[108:111], a[180:183], a[60:63], v[108:111]
    ds_read_b128 a[152:155], v9 offset:36864
    v_cvt_pk_bf16_f32 v96, v96, v97
    v_mfma_f32_16x16x32_bf16 v[108:111], a[184:187], a[56:59], v[108:111]
    v_exp_f32 v98, v98
    v_mfma_f32_16x16x32_bf16 v[108:111], a[188:191], a[52:55], v[108:111]
    ds_read_b128 a[156:159], v8 offset:36864
    v_cndmask_b32_dpp v42, v58, v90, vcc row_ror:8 row_mask:0xf bank_mask:0xf
    v_smfmac_f32_16x16x64_bf16 v[28:31], a[120:123], v[112:119], v22
    v_exp_f32 v99, v99
    v_mfma_f32_16x16x32_bf16 v[192:195], a[192:195], v[112:115], v[192:195]
    ds_read_b128 a[160:163], v8 offset:40960
    v_cvt_pk_bf16_f32 v97, v98, v99
    v_mfma_f32_16x16x32_bf16 v[192:195], a[196:199], v[116:119], v[192:195]
    v_exp_f32 v100, v100
    v_mfma_f32_16x16x32_bf16 v[196:199], a[200:203], v[116:119], v[196:199]
    ds_read_b128 a[164:167], v9 offset:40960
    v_cndmask_b32_dpp v43, v59, v91, vcc row_ror:8 row_mask:0xf bank_mask:0xf
    v_mfma_f32_16x16x32_bf16 v[196:199], a[204:207], v[112:115], v[196:199]
    v_exp_f32 v101, v101
    v_mfma_f32_16x16x32_bf16 v[200:203], a[208:211], v[112:115], v[200:203]
    ds_read_b128 a[168:171], v10 offset:40960
    v_cvt_pk_bf16_f32 v98, v100, v101
    v_mfma_f32_16x16x32_bf16 v[200:203], a[212:215], v[116:119], v[200:203]
    v_exp_f32 v102, v102
    v_mfma_f32_16x16x32_bf16 v[204:207], a[216:219], v[116:119], v[204:207]
    ds_read_b128 a[172:175], v11 offset:40960
    v_mov_b32_dpp v56, v88 row_ror:8 row_mask:0xf bank_mask:0x3
    v_mfma_f32_16x16x32_bf16 v[204:207], a[220:223], v[112:115], v[204:207]
    v_exp_f32 v103, v103
    v_mfma_f32_16x16x32_bf16 v[208:211], a[224:227], v[112:115], v[208:211]
    ds_read_b128 a[176:179], v11 offset:45056
    v_cvt_pk_bf16_f32 v99, v102, v103
    v_mfma_f32_16x16x32_bf16 v[208:211], a[228:231], v[116:119], v[208:211]
    v_exp_f32 v104, v104
    v_mfma_f32_16x16x32_bf16 v[212:215], a[232:235], v[116:119], v[212:215]
    ds_read_b128 a[180:183], v10 offset:45056
    v_mov_b32_dpp v57, v89 row_ror:8 row_mask:0xf bank_mask:0x3
    v_mfma_f32_16x16x32_bf16 v[212:215], a[236:239], v[112:115], v[212:215]
    v_exp_f32 v105, v105
    v_mfma_f32_16x16x32_bf16 v[216:219], a[240:243], v[112:115], v[216:219]
    ds_read_b128 a[184:187], v9 offset:45056
    v_cvt_pk_bf16_f32 v100, v104, v105
    v_mfma_f32_16x16x32_bf16 v[216:219], a[244:247], v[116:119], v[216:219]
    v_exp_f32 v106, v106
    v_mfma_f32_16x16x32_bf16 v[220:223], a[248:251], v[116:119], v[220:223]
    ds_read_b128 a[188:191], v8 offset:45056
    v_mov_b32_dpp v58, v90 row_ror:8 row_mask:0xf bank_mask:0x3
    v_mfma_f32_16x16x32_bf16 v[220:223], a[252:255], v[112:115], v[220:223]
    s_waitcnt lgkmcnt(5)
    ds_read_b64_tr_b16 a[116:117], v12 offset:49152
    ds_read_b64_tr_b16 a[118:119], v12 offset:53248
    v_mfma_f32_16x16x32_bf16 v[112:115], a[128:131], a[4:7], 0
    v_exp_f32 v107, v107
    v_mfma_f32_16x16x32_bf16 v[112:115], a[132:135], a[8:11], v[112:115]
    ds_read_b64_tr_b16 a[112:113], v12 offset:57344
    v_cvt_pk_bf16_f32 v101, v106, v107
    v_mfma_f32_16x16x32_bf16 v[112:115], a[136:139], a[12:15], v[112:115]
    v_exp_f32 v108, v108
    v_mfma_f32_16x16x32_bf16 v[112:115], a[140:143], a[16:19], v[112:115]
    ds_read_b64_tr_b16 a[114:115], v12 offset:61440
    ds_read_b64_tr_b16 a[108:109], v12 offset:57352
    v_mfma_f32_16x16x32_bf16 v[116:119], a[144:147], a[16:19], 0
    v_exp_f32 v109, v109
    v_mfma_f32_16x16x32_bf16 v[116:119], a[148:151], a[12:15], v[116:119]
    ds_read_b64_tr_b16 a[110:111], v12 offset:61448
    v_cvt_pk_bf16_f32 v102, v108, v109
    v_mfma_f32_16x16x32_bf16 v[116:119], a[152:155], a[8:11], v[116:119]
    v_exp_f32 v110, v110
    v_mfma_f32_16x16x32_bf16 v[116:119], a[156:159], a[4:7], v[116:119]
    ds_read_b64_tr_b16 a[104:105], v12 offset:49160
    v_mov_b32_dpp v59, v91 row_ror:8 row_mask:0xf bank_mask:0x3
    v_mfma_f32_16x16x32_bf16 v[120:123], a[160:163], a[4:7], 0
    v_exp_f32 v111, v111
    v_mfma_f32_16x16x32_bf16 v[120:123], a[164:167], a[8:11], v[120:123]
    ds_read_b64_tr_b16 a[106:107], v12 offset:53256
    v_cvt_pk_bf16_f32 v103, v110, v111
    v_mfma_f32_16x16x32_bf16 v[120:123], a[168:171], a[12:15], v[120:123]
    s_waitcnt lgkmcnt(6)
    v_exp_f32 v112, v112
    v_mfma_f32_16x16x32_bf16 v[120:123], a[172:175], a[16:19], v[120:123]
    ds_read_b64_tr_b16 a[100:101], v13 offset:49152
    v_mfma_f32_16x16x32_bf16 v[124:127], a[176:179], a[16:19], 0
    v_exp_f32 v113, v113
    v_mfma_f32_16x16x32_bf16 v[124:127], a[180:183], a[12:15], v[124:127]
    ds_read_b64_tr_b16 a[102:103], v13 offset:53248
    v_cvt_pk_bf16_f32 v112, v112, v113
    v_mfma_f32_16x16x32_bf16 v[124:127], a[184:187], a[8:11], v[124:127]
    v_exp_f32 v114, v114
    v_mfma_f32_16x16x32_bf16 v[124:127], a[188:191], a[4:7], v[124:127]
    ds_read_b64_tr_b16 a[96:97], v13 offset:57344
    v_smfmac_f32_16x16x64_bf16 v[28:31], a[124:127], v[96:103], v22
    v_exp_f32 v115, v115
    v_mfma_f32_16x16x32_bf16 v[224:227], a[192:195], v[96:99], v[224:227]
    ds_read_b64_tr_b16 a[98:99], v13 offset:61440
    v_cvt_pk_bf16_f32 v113, v114, v115
    v_mfma_f32_16x16x32_bf16 v[224:227], a[196:199], v[100:103], v[224:227]
    v_exp_f32 v116, v116
    v_mfma_f32_16x16x32_bf16 v[228:231], a[200:203], v[100:103], v[228:231]
    ds_read_b64_tr_b16 a[92:93], v13 offset:57352
    v_mfma_f32_16x16x32_bf16 v[228:231], a[204:207], v[96:99], v[228:231]
    v_exp_f32 v117, v117
    v_mfma_f32_16x16x32_bf16 v[232:235], a[208:211], v[96:99], v[232:235]
    ds_read_b64_tr_b16 a[94:95], v13 offset:61448
    v_cvt_pk_bf16_f32 v114, v116, v117
    v_mfma_f32_16x16x32_bf16 v[232:235], a[212:215], v[100:103], v[232:235]
    v_exp_f32 v118, v118
    v_mfma_f32_16x16x32_bf16 v[236:239], a[216:219], v[100:103], v[236:239]
    ds_read_b64_tr_b16 a[192:193], v13 offset:49160
    v_mfma_f32_16x16x32_bf16 v[236:239], a[220:223], v[96:99], v[236:239]
    v_exp_f32 v119, v119
    v_mfma_f32_16x16x32_bf16 v[240:243], a[224:227], v[96:99], v[240:243]
    ds_read_b64_tr_b16 a[194:195], v13 offset:53256
    v_cvt_pk_bf16_f32 v115, v118, v119
    v_mfma_f32_16x16x32_bf16 v[240:243], a[228:231], v[100:103], v[240:243]
    v_exp_f32 v120, v120
    v_mfma_f32_16x16x32_bf16 v[244:247], a[232:235], v[100:103], v[244:247]
    ds_read_b64_tr_b16 a[196:197], v14 offset:49152
    v_mfma_f32_16x16x32_bf16 v[244:247], a[236:239], v[96:99], v[244:247]
    v_exp_f32 v121, v121
    v_mfma_f32_16x16x32_bf16 v[248:251], a[240:243], v[96:99], v[248:251]
    ds_read_b64_tr_b16 a[198:199], v14 offset:53248
    v_cvt_pk_bf16_f32 v116, v120, v121
    v_mfma_f32_16x16x32_bf16 v[248:251], a[244:247], v[100:103], v[248:251]
    v_exp_f32 v122, v122
    v_mfma_f32_16x16x32_bf16 v[252:255], a[248:251], v[100:103], v[252:255]
    ds_read_b64_tr_b16 a[200:201], v14 offset:57344
    v_mfma_f32_16x16x32_bf16 v[252:255], a[252:255], v[96:99], v[252:255]
    ds_read_b64_tr_b16 a[202:203], v14 offset:61440
    v_mfma_f32_16x16x32_bf16 v[96:99], a[128:131], a[20:23], 0
    v_exp_f32 v123, v123
    v_mfma_f32_16x16x32_bf16 v[96:99], a[132:135], a[24:27], v[96:99]
    ds_read_b64_tr_b16 a[204:205], v14 offset:57352
    v_cvt_pk_bf16_f32 v117, v122, v123
    v_mfma_f32_16x16x32_bf16 v[96:99], a[136:139], a[28:31], v[96:99]
    v_exp_f32 v124, v124
    v_mfma_f32_16x16x32_bf16 v[96:99], a[140:143], a[32:35], v[96:99]
    ds_read_b64_tr_b16 a[206:207], v14 offset:61448
    v_mfma_f32_16x16x32_bf16 v[100:103], a[144:147], a[32:35], 0
    v_exp_f32 v125, v125
    v_mfma_f32_16x16x32_bf16 v[100:103], a[148:151], a[28:31], v[100:103]
    ds_read_b64_tr_b16 a[208:209], v14 offset:49160
    v_cvt_pk_bf16_f32 v118, v124, v125
    v_mfma_f32_16x16x32_bf16 v[100:103], a[152:155], a[24:27], v[100:103]
    v_exp_f32 v126, v126
    v_mfma_f32_16x16x32_bf16 v[100:103], a[156:159], a[20:23], v[100:103]
    ds_read_b64_tr_b16 a[210:211], v14 offset:53256
    v_mfma_f32_16x16x32_bf16 v[104:107], a[160:163], a[20:23], 0
    v_exp_f32 v127, v127
    v_mfma_f32_16x16x32_bf16 v[104:107], a[164:167], a[24:27], v[104:107]
    ds_read_b64_tr_b16 a[212:213], v15 offset:49152
    v_cvt_pk_bf16_f32 v119, v126, v127
    v_mfma_f32_16x16x32_bf16 v[104:107], a[168:171], a[28:31], v[104:107]
    v_exp_f32 v96, v96
    v_mfma_f32_16x16x32_bf16 v[104:107], a[172:175], a[32:35], v[104:107]
    ds_read_b64_tr_b16 a[214:215], v15 offset:53248
    v_mfma_f32_16x16x32_bf16 v[108:111], a[176:179], a[32:35], 0
    v_exp_f32 v97, v97
    v_mfma_f32_16x16x32_bf16 v[108:111], a[180:183], a[28:31], v[108:111]
    ds_read_b64_tr_b16 a[216:217], v15 offset:57344
    v_cvt_pk_bf16_f32 v96, v96, v97
    v_mfma_f32_16x16x32_bf16 v[108:111], a[184:187], a[24:27], v[108:111]
    v_exp_f32 v98, v98
    v_mfma_f32_16x16x32_bf16 v[108:111], a[188:191], a[20:23], v[108:111]
    ds_read_b64_tr_b16 a[218:219], v15 offset:61440
    v_smfmac_f32_16x16x64_bf16 v[24:27], a[120:123], v[112:119], v22
    v_exp_f32 v99, v99
    v_mfma_f32_16x16x32_bf16 v[128:131], a[116:119], v[112:115], v[128:131]
    s_waitcnt lgkmcnt(5)
    ds_read_b64_tr_b16 a[220:221], v15 offset:57352
    v_cvt_pk_bf16_f32 v97, v98, v99
    v_mfma_f32_16x16x32_bf16 v[128:131], a[112:115], v[116:119], v[128:131]
    v_exp_f32 v100, v100
    v_mfma_f32_16x16x32_bf16 v[132:135], a[108:111], v[116:119], v[132:135]
    ds_read_b64_tr_b16 a[222:223], v15 offset:61448
    v_mfma_f32_16x16x32_bf16 v[132:135], a[104:107], v[112:115], v[132:135]
    v_exp_f32 v101, v101
    v_mfma_f32_16x16x32_bf16 v[136:139], a[100:103], v[112:115], v[136:139]
    ds_read_b64_tr_b16 a[224:225], v15 offset:49160
    v_cvt_pk_bf16_f32 v98, v100, v101
    v_mfma_f32_16x16x32_bf16 v[136:139], a[96:99], v[116:119], v[136:139]
    v_exp_f32 v102, v102
    v_mfma_f32_16x16x32_bf16 v[140:143], a[92:95], v[116:119], v[140:143]
    ds_read_b64_tr_b16 a[226:227], v15 offset:53256
    v_mfma_f32_16x16x32_bf16 v[140:143], a[192:195], v[112:115], v[140:143]
    v_exp_f32 v103, v103
    v_mfma_f32_16x16x32_bf16 v[144:147], a[196:199], v[112:115], v[144:147]
    v_cvt_pk_bf16_f32 v99, v102, v103
    v_mfma_f32_16x16x32_bf16 v[144:147], a[200:203], v[116:119], v[144:147]
    v_exp_f32 v104, v104
    v_mfma_f32_16x16x32_bf16 v[148:151], a[204:207], v[116:119], v[148:151]
    s_waitcnt lgkmcnt(4)
    v_mfma_f32_16x16x32_bf16 v[148:151], a[208:211], v[112:115], v[148:151]
    v_exp_f32 v105, v105
    v_mfma_f32_16x16x32_bf16 v[152:155], a[212:215], v[112:115], v[152:155]
    v_cvt_pk_bf16_f32 v100, v104, v105
    v_mfma_f32_16x16x32_bf16 v[152:155], a[216:219], v[116:119], v[152:155]
    s_waitcnt lgkmcnt(2)
    v_exp_f32 v106, v106
    v_mfma_f32_16x16x32_bf16 v[156:159], a[220:223], v[116:119], v[156:159]
    s_waitcnt vmcnt(2) lgkmcnt(0)
    v_mfma_f32_16x16x32_bf16 v[156:159], a[224:227], v[112:115], v[156:159]
    s_barrier
    v_mfma_f32_16x16x32_bf16 v[112:115], a[128:131], a[36:39], 0
    v_exp_f32 v107, v107
    v_mfma_f32_16x16x32_bf16 v[112:115], a[132:135], a[40:43], v[112:115]
    s_add_u32 s29, s27, 0
    v_cvt_pk_bf16_f32 v101, v106, v107
    v_mfma_f32_16x16x32_bf16 v[112:115], a[136:139], a[44:47], v[112:115]
    s_add_u32 m0, s27, 147456
    v_exp_f32 v108, v108
    v_mfma_f32_16x16x32_bf16 v[112:115], a[140:143], a[48:51], v[112:115]
    buffer_load_dwordx4 v18, s[52:55], s29 offen lds
    v_mfma_f32_16x16x32_bf16 v[116:119], a[144:147], a[48:51], 0
    v_exp_f32 v109, v109
    v_mfma_f32_16x16x32_bf16 v[116:119], a[148:151], a[44:47], v[116:119]
    v_cvt_pk_bf16_f32 v102, v108, v109
    v_mfma_f32_16x16x32_bf16 v[116:119], a[152:155], a[40:43], v[116:119]
    v_exp_f32 v110, v110
    v_mfma_f32_16x16x32_bf16 v[116:119], a[156:159], a[36:39], v[116:119]
    buffer_load_dwordx4 v18, s[52:55], s29 offen offset:1024 lds
    v_mfma_f32_16x16x32_bf16 v[120:123], a[160:163], a[36:39], 0
    v_exp_f32 v111, v111
    v_mfma_f32_16x16x32_bf16 v[120:123], a[164:167], a[40:43], v[120:123]
    v_cvt_pk_bf16_f32 v103, v110, v111
    v_mfma_f32_16x16x32_bf16 v[120:123], a[168:171], a[44:47], v[120:123]
    v_exp_f32 v112, v112
    v_mfma_f32_16x16x32_bf16 v[120:123], a[172:175], a[48:51], v[120:123]
    buffer_load_dwordx4 v18, s[52:55], s29 offen offset:2048 lds
    v_mfma_f32_16x16x32_bf16 v[124:127], a[176:179], a[48:51], 0
    v_exp_f32 v113, v113
    v_mfma_f32_16x16x32_bf16 v[124:127], a[180:183], a[44:47], v[124:127]
    v_cvt_pk_bf16_f32 v112, v112, v113
    v_mfma_f32_16x16x32_bf16 v[124:127], a[184:187], a[40:43], v[124:127]
    v_exp_f32 v114, v114
    v_mfma_f32_16x16x32_bf16 v[124:127], a[188:191], a[36:39], v[124:127]
    buffer_load_dwordx4 v18, s[52:55], s29 offen offset:3072 lds
    v_smfmac_f32_16x16x64_bf16 v[24:27], a[124:127], v[96:103], v22
    v_exp_f32 v115, v115
    v_mfma_f32_16x16x32_bf16 v[160:163], a[116:119], v[96:99], v[160:163]
    v_cvt_pk_bf16_f32 v113, v114, v115
    v_mfma_f32_16x16x32_bf16 v[160:163], a[112:115], v[100:103], v[160:163]
    v_exp_f32 v116, v116
    v_mfma_f32_16x16x32_bf16 v[164:167], a[108:111], v[100:103], v[164:167]
    s_mov_b32 s31, 12288
    buffer_store_dwordx4 v[40:43], v23, s[56:59], s31 offen offset:128 sc1
    v_mfma_f32_16x16x32_bf16 v[164:167], a[104:107], v[96:99], v[164:167]
    v_exp_f32 v117, v117
    v_mfma_f32_16x16x32_bf16 v[168:171], a[100:103], v[96:99], v[168:171]
    v_cvt_pk_bf16_f32 v114, v116, v117
    v_mfma_f32_16x16x32_bf16 v[168:171], a[96:99], v[100:103], v[168:171]
    v_exp_f32 v118, v118
    v_mfma_f32_16x16x32_bf16 v[172:175], a[92:95], v[100:103], v[172:175]
    v_mfma_f32_16x16x32_bf16 v[172:175], a[192:195], v[96:99], v[172:175]
    v_exp_f32 v119, v119
    v_mfma_f32_16x16x32_bf16 v[176:179], a[196:199], v[96:99], v[176:179]
    v_cvt_pk_bf16_f32 v115, v118, v119
    v_mfma_f32_16x16x32_bf16 v[176:179], a[200:203], v[100:103], v[176:179]
    v_exp_f32 v120, v120
    v_mfma_f32_16x16x32_bf16 v[180:183], a[204:207], v[100:103], v[180:183]
    v_mfma_f32_16x16x32_bf16 v[180:183], a[208:211], v[96:99], v[180:183]
    v_exp_f32 v121, v121
    v_mfma_f32_16x16x32_bf16 v[184:187], a[212:215], v[96:99], v[184:187]
    v_cvt_pk_bf16_f32 v116, v120, v121
    v_mfma_f32_16x16x32_bf16 v[184:187], a[216:219], v[100:103], v[184:187]
    v_exp_f32 v122, v122
    v_mfma_f32_16x16x32_bf16 v[188:191], a[220:223], v[100:103], v[188:191]
    s_mov_b32 s31, 12288
    buffer_store_dwordx4 v[56:59], v23, s[56:59], s31 offen offset:2176 sc1
    v_mfma_f32_16x16x32_bf16 v[188:191], a[224:227], v[96:99], v[188:191]
    v_mfma_f32_16x16x32_bf16 v[96:99], a[128:131], a[52:55], 0
    v_exp_f32 v123, v123
    v_mfma_f32_16x16x32_bf16 v[96:99], a[132:135], a[56:59], v[96:99]
    ds_read_b128 a[128:131], v8 offset:49152
    v_cvt_pk_bf16_f32 v117, v122, v123
    v_mfma_f32_16x16x32_bf16 v[96:99], a[136:139], a[60:63], v[96:99]
    v_exp_f32 v124, v124
    v_mfma_f32_16x16x32_bf16 v[96:99], a[140:143], a[64:67], v[96:99]
    ds_read_b128 a[132:135], v9 offset:49152
    v_mfma_f32_16x16x32_bf16 v[100:103], a[144:147], a[64:67], 0
    v_exp_f32 v125, v125
    v_mfma_f32_16x16x32_bf16 v[100:103], a[148:151], a[60:63], v[100:103]
    ds_read_b128 a[136:139], v10 offset:49152
    v_cvt_pk_bf16_f32 v118, v124, v125
    v_mfma_f32_16x16x32_bf16 v[100:103], a[152:155], a[56:59], v[100:103]
    v_exp_f32 v126, v126
    v_mfma_f32_16x16x32_bf16 v[100:103], a[156:159], a[52:55], v[100:103]
    ds_read_b128 a[140:143], v11 offset:49152
    v_mfma_f32_16x16x32_bf16 v[104:107], a[160:163], a[52:55], 0
    v_exp_f32 v127, v127
    v_mfma_f32_16x16x32_bf16 v[104:107], a[164:167], a[56:59], v[104:107]
    ds_read_b128 a[144:147], v11 offset:53248
    v_cvt_pk_bf16_f32 v119, v126, v127
    v_mfma_f32_16x16x32_bf16 v[104:107], a[168:171], a[60:63], v[104:107]
    v_exp_f32 v96, v96
    v_mfma_f32_16x16x32_bf16 v[104:107], a[172:175], a[64:67], v[104:107]
    ds_read_b128 a[148:151], v10 offset:53248
    v_mfma_f32_16x16x32_bf16 v[108:111], a[176:179], a[64:67], 0
    v_exp_f32 v97, v97
    v_mfma_f32_16x16x32_bf16 v[108:111], a[180:183], a[60:63], v[108:111]
    ds_read_b128 a[152:155], v9 offset:53248
    v_cvt_pk_bf16_f32 v96, v96, v97
    v_mfma_f32_16x16x32_bf16 v[108:111], a[184:187], a[56:59], v[108:111]
    v_exp_f32 v98, v98
    v_mfma_f32_16x16x32_bf16 v[108:111], a[188:191], a[52:55], v[108:111]
    ds_read_b128 a[156:159], v8 offset:53248
    v_smfmac_f32_16x16x64_bf16 v[28:31], a[120:123], v[112:119], v22
    v_exp_f32 v99, v99
    v_mfma_f32_16x16x32_bf16 v[192:195], a[116:119], v[112:115], v[192:195]
    ds_read_b128 a[160:163], v8 offset:57344
    v_cvt_pk_bf16_f32 v97, v98, v99
    v_mfma_f32_16x16x32_bf16 v[192:195], a[112:115], v[116:119], v[192:195]
    v_exp_f32 v100, v100
    v_mfma_f32_16x16x32_bf16 v[196:199], a[108:111], v[116:119], v[196:199]
    ds_read_b128 a[164:167], v9 offset:57344
    v_mfma_f32_16x16x32_bf16 v[196:199], a[104:107], v[112:115], v[196:199]
    v_exp_f32 v101, v101
    v_mfma_f32_16x16x32_bf16 v[200:203], a[100:103], v[112:115], v[200:203]
    ds_read_b128 a[168:171], v10 offset:57344
    v_cvt_pk_bf16_f32 v98, v100, v101
    v_mfma_f32_16x16x32_bf16 v[200:203], a[96:99], v[116:119], v[200:203]
    v_exp_f32 v102, v102
    v_mfma_f32_16x16x32_bf16 v[204:207], a[92:95], v[116:119], v[204:207]
    ds_read_b128 a[172:175], v11 offset:57344
    v_mfma_f32_16x16x32_bf16 v[204:207], a[192:195], v[112:115], v[204:207]
    v_exp_f32 v103, v103
    v_mfma_f32_16x16x32_bf16 v[208:211], a[196:199], v[112:115], v[208:211]
    ds_read_b128 a[176:179], v11 offset:61440
    v_cvt_pk_bf16_f32 v99, v102, v103
    v_mfma_f32_16x16x32_bf16 v[208:211], a[200:203], v[116:119], v[208:211]
    v_exp_f32 v104, v104
    v_mfma_f32_16x16x32_bf16 v[212:215], a[204:207], v[116:119], v[212:215]
    ds_read_b128 a[180:183], v10 offset:61440
    v_mfma_f32_16x16x32_bf16 v[212:215], a[208:211], v[112:115], v[212:215]
    v_exp_f32 v105, v105
    v_mfma_f32_16x16x32_bf16 v[216:219], a[212:215], v[112:115], v[216:219]
    ds_read_b128 a[184:187], v9 offset:61440
    v_cvt_pk_bf16_f32 v100, v104, v105
    v_mfma_f32_16x16x32_bf16 v[216:219], a[216:219], v[116:119], v[216:219]
    v_exp_f32 v106, v106
    v_mfma_f32_16x16x32_bf16 v[220:223], a[220:223], v[116:119], v[220:223]
    ds_read_b128 a[188:191], v8 offset:61440
    v_mfma_f32_16x16x32_bf16 v[220:223], a[224:227], v[112:115], v[220:223]
    s_waitcnt lgkmcnt(5)
    ds_read_b64_tr_b16 a[228:229], v12 offset:32768
    ds_read_b64_tr_b16 a[230:231], v12 offset:36864
    v_mfma_f32_16x16x32_bf16 v[112:115], a[128:131], a[4:7], 0
    v_exp_f32 v107, v107
    v_mfma_f32_16x16x32_bf16 v[112:115], a[132:135], a[8:11], v[112:115]
    ds_read_b64_tr_b16 a[232:233], v12 offset:40960
    v_cvt_pk_bf16_f32 v101, v106, v107
    v_mfma_f32_16x16x32_bf16 v[112:115], a[136:139], a[12:15], v[112:115]
    v_exp_f32 v108, v108
    v_mfma_f32_16x16x32_bf16 v[112:115], a[140:143], a[16:19], v[112:115]
    ds_read_b64_tr_b16 a[234:235], v12 offset:45056
    ds_read_b64_tr_b16 a[236:237], v12 offset:40968
    v_mfma_f32_16x16x32_bf16 v[116:119], a[144:147], a[16:19], 0
    v_exp_f32 v109, v109
    v_mfma_f32_16x16x32_bf16 v[116:119], a[148:151], a[12:15], v[116:119]
    ds_read_b64_tr_b16 a[238:239], v12 offset:45064
    v_cvt_pk_bf16_f32 v102, v108, v109
    v_mfma_f32_16x16x32_bf16 v[116:119], a[152:155], a[8:11], v[116:119]
    v_exp_f32 v110, v110
    v_mfma_f32_16x16x32_bf16 v[116:119], a[156:159], a[4:7], v[116:119]
    ds_read_b64_tr_b16 a[240:241], v12 offset:32776
    v_mfma_f32_16x16x32_bf16 v[120:123], a[160:163], a[4:7], 0
    v_exp_f32 v111, v111
    v_mfma_f32_16x16x32_bf16 v[120:123], a[164:167], a[8:11], v[120:123]
    ds_read_b64_tr_b16 a[242:243], v12 offset:36872
    v_cvt_pk_bf16_f32 v103, v110, v111
    v_mfma_f32_16x16x32_bf16 v[120:123], a[168:171], a[12:15], v[120:123]
    s_waitcnt lgkmcnt(6)
    v_exp_f32 v112, v112
    v_mfma_f32_16x16x32_bf16 v[120:123], a[172:175], a[16:19], v[120:123]
    ds_read_b64_tr_b16 a[244:245], v13 offset:32768
    v_mfma_f32_16x16x32_bf16 v[124:127], a[176:179], a[16:19], 0
    v_exp_f32 v113, v113
    v_mfma_f32_16x16x32_bf16 v[124:127], a[180:183], a[12:15], v[124:127]
    ds_read_b64_tr_b16 a[246:247], v13 offset:36864
    v_cvt_pk_bf16_f32 v112, v112, v113
    v_mfma_f32_16x16x32_bf16 v[124:127], a[184:187], a[8:11], v[124:127]
    v_exp_f32 v114, v114
    v_mfma_f32_16x16x32_bf16 v[124:127], a[188:191], a[4:7], v[124:127]
    ds_read_b64_tr_b16 a[248:249], v13 offset:40960
    v_smfmac_f32_16x16x64_bf16 v[28:31], a[124:127], v[96:103], v22
    v_exp_f32 v115, v115
    v_mfma_f32_16x16x32_bf16 v[224:227], a[116:119], v[96:99], v[224:227]
    ds_read_b64_tr_b16 a[250:251], v13 offset:45056
    v_cvt_pk_bf16_f32 v113, v114, v115
    v_mfma_f32_16x16x32_bf16 v[224:227], a[112:115], v[100:103], v[224:227]
    v_exp_f32 v116, v116
    v_mfma_f32_16x16x32_bf16 v[228:231], a[108:111], v[100:103], v[228:231]
    ds_read_b64_tr_b16 a[252:253], v13 offset:40968
    v_mfma_f32_16x16x32_bf16 v[228:231], a[104:107], v[96:99], v[228:231]
    v_exp_f32 v117, v117
    v_mfma_f32_16x16x32_bf16 v[232:235], a[100:103], v[96:99], v[232:235]
    ds_read_b64_tr_b16 a[254:255], v13 offset:45064
    v_cvt_pk_bf16_f32 v114, v116, v117
    v_mfma_f32_16x16x32_bf16 v[232:235], a[96:99], v[100:103], v[232:235]
    v_exp_f32 v118, v118
    v_mfma_f32_16x16x32_bf16 v[236:239], a[92:95], v[100:103], v[236:239]
    ds_read_b64_tr_b16 a[116:117], v13 offset:32776
    v_mfma_f32_16x16x32_bf16 v[236:239], a[192:195], v[96:99], v[236:239]
    v_exp_f32 v119, v119
    v_mfma_f32_16x16x32_bf16 v[240:243], a[196:199], v[96:99], v[240:243]
    ds_read_b64_tr_b16 a[118:119], v13 offset:36872
    v_cvt_pk_bf16_f32 v115, v118, v119
    v_mfma_f32_16x16x32_bf16 v[240:243], a[200:203], v[100:103], v[240:243]
    v_exp_f32 v120, v120
    v_mfma_f32_16x16x32_bf16 v[244:247], a[204:207], v[100:103], v[244:247]
    ds_read_b64_tr_b16 a[112:113], v14 offset:32768
    v_mfma_f32_16x16x32_bf16 v[244:247], a[208:211], v[96:99], v[244:247]
    v_exp_f32 v121, v121
    v_mfma_f32_16x16x32_bf16 v[248:251], a[212:215], v[96:99], v[248:251]
    ds_read_b64_tr_b16 a[114:115], v14 offset:36864
    v_cvt_pk_bf16_f32 v116, v120, v121
    v_mfma_f32_16x16x32_bf16 v[248:251], a[216:219], v[100:103], v[248:251]
    v_exp_f32 v122, v122
    v_mfma_f32_16x16x32_bf16 v[252:255], a[220:223], v[100:103], v[252:255]
    ds_read_b64_tr_b16 a[108:109], v14 offset:40960
    v_mfma_f32_16x16x32_bf16 v[252:255], a[224:227], v[96:99], v[252:255]
    ds_read_b64_tr_b16 a[110:111], v14 offset:45056
    v_mfma_f32_16x16x32_bf16 v[96:99], a[128:131], a[20:23], 0
    v_exp_f32 v123, v123
    v_mfma_f32_16x16x32_bf16 v[96:99], a[132:135], a[24:27], v[96:99]
    ds_read_b64_tr_b16 a[104:105], v14 offset:40968
    v_cvt_pk_bf16_f32 v117, v122, v123
    v_mfma_f32_16x16x32_bf16 v[96:99], a[136:139], a[28:31], v[96:99]
    v_exp_f32 v124, v124
    v_mfma_f32_16x16x32_bf16 v[96:99], a[140:143], a[32:35], v[96:99]
    ds_read_b64_tr_b16 a[106:107], v14 offset:45064
    v_mfma_f32_16x16x32_bf16 v[100:103], a[144:147], a[32:35], 0
    v_exp_f32 v125, v125
    v_mfma_f32_16x16x32_bf16 v[100:103], a[148:151], a[28:31], v[100:103]
    ds_read_b64_tr_b16 a[100:101], v14 offset:32776
    v_cvt_pk_bf16_f32 v118, v124, v125
    v_mfma_f32_16x16x32_bf16 v[100:103], a[152:155], a[24:27], v[100:103]
    v_exp_f32 v126, v126
    v_mfma_f32_16x16x32_bf16 v[100:103], a[156:159], a[20:23], v[100:103]
    ds_read_b64_tr_b16 a[102:103], v14 offset:36872
    v_mfma_f32_16x16x32_bf16 v[104:107], a[160:163], a[20:23], 0
    v_exp_f32 v127, v127
    v_mfma_f32_16x16x32_bf16 v[104:107], a[164:167], a[24:27], v[104:107]
    ds_read_b64_tr_b16 a[96:97], v15 offset:32768
    v_cvt_pk_bf16_f32 v119, v126, v127
    v_mfma_f32_16x16x32_bf16 v[104:107], a[168:171], a[28:31], v[104:107]
    v_exp_f32 v96, v96
    v_mfma_f32_16x16x32_bf16 v[104:107], a[172:175], a[32:35], v[104:107]
    ds_read_b64_tr_b16 a[98:99], v15 offset:36864
    v_mfma_f32_16x16x32_bf16 v[108:111], a[176:179], a[32:35], 0
    v_exp_f32 v97, v97
    v_mfma_f32_16x16x32_bf16 v[108:111], a[180:183], a[28:31], v[108:111]
    ds_read_b64_tr_b16 a[92:93], v15 offset:40960
    v_cvt_pk_bf16_f32 v96, v96, v97
    v_mfma_f32_16x16x32_bf16 v[108:111], a[184:187], a[24:27], v[108:111]
    v_exp_f32 v98, v98
    v_mfma_f32_16x16x32_bf16 v[108:111], a[188:191], a[20:23], v[108:111]
    ds_read_b64_tr_b16 a[94:95], v15 offset:45056
    v_smfmac_f32_16x16x64_bf16 v[24:27], a[120:123], v[112:119], v22
    v_exp_f32 v99, v99
    v_mfma_f32_16x16x32_bf16 v[128:131], a[228:231], v[112:115], v[128:131]
    s_waitcnt lgkmcnt(5)
    ds_read_b64_tr_b16 a[192:193], v15 offset:40968
    v_cvt_pk_bf16_f32 v97, v98, v99
    v_mfma_f32_16x16x32_bf16 v[128:131], a[232:235], v[116:119], v[128:131]
    v_exp_f32 v100, v100
    v_mfma_f32_16x16x32_bf16 v[132:135], a[236:239], v[116:119], v[132:135]
    ds_read_b64_tr_b16 a[194:195], v15 offset:45064
    v_mfma_f32_16x16x32_bf16 v[132:135], a[240:243], v[112:115], v[132:135]
    v_exp_f32 v101, v101
    v_mfma_f32_16x16x32_bf16 v[136:139], a[244:247], v[112:115], v[136:139]
    ds_read_b64_tr_b16 a[196:197], v15 offset:32776
    v_cvt_pk_bf16_f32 v98, v100, v101
    v_mfma_f32_16x16x32_bf16 v[136:139], a[248:251], v[116:119], v[136:139]
    v_exp_f32 v102, v102
    v_mfma_f32_16x16x32_bf16 v[140:143], a[252:255], v[116:119], v[140:143]
    ds_read_b64_tr_b16 a[198:199], v15 offset:36872
    v_add_f32 v24, v24, v25
    v_mfma_f32_16x16x32_bf16 v[140:143], a[116:119], v[112:115], v[140:143]
    v_exp_f32 v103, v103
    v_mfma_f32_16x16x32_bf16 v[144:147], a[112:115], v[112:115], v[144:147]
    v_cvt_pk_bf16_f32 v99, v102, v103
    v_mfma_f32_16x16x32_bf16 v[144:147], a[108:111], v[116:119], v[144:147]
    v_exp_f32 v104, v104
    v_mfma_f32_16x16x32_bf16 v[148:151], a[104:107], v[116:119], v[148:151]
    s_waitcnt lgkmcnt(4)
    v_rcp_f32 v20, v24
    v_mfma_f32_16x16x32_bf16 v[148:151], a[100:103], v[112:115], v[148:151]
    v_exp_f32 v105, v105
    v_mfma_f32_16x16x32_bf16 v[152:155], a[96:99], v[112:115], v[152:155]
    v_cvt_pk_bf16_f32 v100, v104, v105
    v_mfma_f32_16x16x32_bf16 v[152:155], a[92:95], v[116:119], v[152:155]
    s_waitcnt lgkmcnt(2)
    v_exp_f32 v106, v106
    v_mfma_f32_16x16x32_bf16 v[156:159], a[192:195], v[116:119], v[156:159]
    s_waitcnt vmcnt(2) lgkmcnt(0)
    v_mfma_f32_16x16x32_bf16 v[156:159], a[196:199], v[112:115], v[156:159]
    s_barrier
    v_mfma_f32_16x16x32_bf16 v[112:115], a[128:131], a[36:39], 0
    v_exp_f32 v107, v107
    v_mfma_f32_16x16x32_bf16 v[112:115], a[132:135], a[40:43], v[112:115]
    s_add_u32 s29, s27, 16384
    v_cvt_pk_bf16_f32 v101, v106, v107
    v_mfma_f32_16x16x32_bf16 v[112:115], a[136:139], a[44:47], v[112:115]
    s_add_u32 m0, s27, 131072
    v_exp_f32 v108, v108
    v_mfma_f32_16x16x32_bf16 v[112:115], a[140:143], a[48:51], v[112:115]
    buffer_load_dwordx4 v18, s[52:55], s29 offen lds
    v_mfma_f32_16x16x32_bf16 v[116:119], a[144:147], a[48:51], 0
    v_exp_f32 v109, v109
    v_subrev_u32 v24, s28, v24
    v_mov_b32 v21, v20
    v_max_u32 v19, v19, v24
    v_pk_mul_f32 v[128:129], v[128:129], v[20:21]
    v_pk_mul_f32 v[130:131], v[130:131], v[20:21]
    v_pk_mul_f32 v[132:133], v[132:133], v[20:21]
    v_pk_mul_f32 v[134:135], v[134:135], v[20:21]
    v_pk_mul_f32 v[136:137], v[136:137], v[20:21]
    v_pk_mul_f32 v[138:139], v[138:139], v[20:21]
    v_pk_mul_f32 v[140:141], v[140:141], v[20:21]
    v_pk_mul_f32 v[142:143], v[142:143], v[20:21]
    v_pk_mul_f32 v[144:145], v[144:145], v[20:21]
    v_pk_mul_f32 v[146:147], v[146:147], v[20:21]
    v_pk_mul_f32 v[148:149], v[148:149], v[20:21]
    v_pk_mul_f32 v[150:151], v[150:151], v[20:21]
    v_pk_mul_f32 v[152:153], v[152:153], v[20:21]
    v_pk_mul_f32 v[154:155], v[154:155], v[20:21]
    v_pk_mul_f32 v[156:157], v[156:157], v[20:21]
    v_pk_mul_f32 v[158:159], v[158:159], v[20:21]
    v_cvt_pk_bf16_f32 v48, v128, v129
    v_cvt_pk_bf16_f32 v49, v130, v131
    v_cvt_pk_bf16_f32 v50, v132, v133
    v_mfma_f32_16x16x32_bf16 v[116:119], a[148:151], a[44:47], v[116:119]
    v_cvt_pk_bf16_f32 v102, v108, v109
    v_cvt_pk_bf16_f32 v51, v134, v135
    v_mfma_f32_16x16x32_bf16 v[116:119], a[152:155], a[40:43], v[116:119]
    v_exp_f32 v110, v110
    v_mfma_f32_16x16x32_bf16 v[116:119], a[156:159], a[36:39], v[116:119]
    buffer_load_dwordx4 v18, s[52:55], s29 offen offset:1024 lds
    v_mfma_f32_16x16x32_bf16 v[120:123], a[160:163], a[36:39], 0
    v_exp_f32 v111, v111
    v_mfma_f32_16x16x32_bf16 v[120:123], a[164:167], a[40:43], v[120:123]
    v_cvt_pk_bf16_f32 v103, v110, v111
    v_cvt_pk_bf16_f32 v92, v136, v137
    v_mfma_f32_16x16x32_bf16 v[120:123], a[168:171], a[44:47], v[120:123]
Lpad14:
    s_cbranch_execz Lret1
    v_exp_f32 v112, v112
    v_mfma_f32_16x16x32_bf16 v[120:123], a[172:175], a[48:51], v[120:123]
    buffer_load_dwordx4 v18, s[52:55], s29 offen offset:2048 lds
    v_mfma_f32_16x16x32_bf16 v[124:127], a[176:179], a[48:51], 0
    v_exp_f32 v113, v113
    v_mfma_f32_16x16x32_bf16 v[124:127], a[180:183], a[44:47], v[124:127]
    v_cvt_pk_bf16_f32 v112, v112, v113
    v_cvt_pk_bf16_f32 v93, v138, v139
    v_mfma_f32_16x16x32_bf16 v[124:127], a[184:187], a[40:43], v[124:127]
    v_exp_f32 v114, v114
    v_mfma_f32_16x16x32_bf16 v[124:127], a[188:191], a[36:39], v[124:127]
    buffer_load_dwordx4 v18, s[52:55], s29 offen offset:3072 lds
    v_smfmac_f32_16x16x64_bf16 v[24:27], a[124:127], v[96:103], v22
    v_exp_f32 v115, v115
    v_mfma_f32_16x16x32_bf16 v[160:163], a[228:231], v[96:99], v[160:163]
    v_cvt_pk_bf16_f32 v113, v114, v115
    v_cvt_pk_bf16_f32 v94, v140, v141
    v_mfma_f32_16x16x32_bf16 v[160:163], a[232:235], v[100:103], v[160:163]
    v_exp_f32 v116, v116
    v_mfma_f32_16x16x32_bf16 v[164:167], a[236:239], v[100:103], v[164:167]
    s_mov_b32 s31, 65536
    buffer_store_dwordx4 v[48:51], v16, s[56:59], s31 offen sc1
    v_mfma_f32_16x16x32_bf16 v[164:167], a[240:243], v[96:99], v[164:167]
    v_exp_f32 v117, v117
    v_mfma_f32_16x16x32_bf16 v[168:171], a[244:247], v[96:99], v[168:171]
    v_cvt_pk_bf16_f32 v114, v116, v117
    v_cvt_pk_bf16_f32 v95, v142, v143
    v_mfma_f32_16x16x32_bf16 v[168:171], a[248:251], v[100:103], v[168:171]
    v_exp_f32 v118, v118
    v_mfma_f32_16x16x32_bf16 v[172:175], a[252:255], v[100:103], v[172:175]
    s_mov_b32 s31, 65536
    buffer_store_dwordx4 v[92:95], v16, s[56:59], s31 offen offset:64 sc1
    v_mfma_f32_16x16x32_bf16 v[172:175], a[116:119], v[96:99], v[172:175]
    v_exp_f32 v119, v119
    v_mfma_f32_16x16x32_bf16 v[176:179], a[112:115], v[96:99], v[176:179]
    v_cvt_pk_bf16_f32 v115, v118, v119
    v_add_f32 v26, v26, v27
    v_mfma_f32_16x16x32_bf16 v[176:179], a[108:111], v[100:103], v[176:179]
    v_exp_f32 v120, v120
    v_mfma_f32_16x16x32_bf16 v[180:183], a[104:107], v[100:103], v[180:183]
    v_rcp_f32 v20, v26
    v_mfma_f32_16x16x32_bf16 v[180:183], a[100:103], v[96:99], v[180:183]
    v_exp_f32 v121, v121
    v_mfma_f32_16x16x32_bf16 v[184:187], a[96:99], v[96:99], v[184:187]
    v_cvt_pk_bf16_f32 v116, v120, v121
    v_cvt_pk_bf16_f32 v64, v144, v145
    v_mfma_f32_16x16x32_bf16 v[184:187], a[92:95], v[100:103], v[184:187]
    v_exp_f32 v122, v122
    v_mfma_f32_16x16x32_bf16 v[188:191], a[192:195], v[100:103], v[188:191]
    v_cvt_pk_bf16_f32 v65, v146, v147
    v_cvt_pk_bf16_f32 v66, v148, v149
    v_mfma_f32_16x16x32_bf16 v[188:191], a[196:199], v[96:99], v[188:191]
    v_cvt_pk_bf16_f32 v67, v150, v151
    v_cvt_pk_bf16_f32 v80, v152, v153
    v_mfma_f32_16x16x32_bf16 v[96:99], a[128:131], a[52:55], 0
    v_exp_f32 v123, v123
    v_mfma_f32_16x16x32_bf16 v[96:99], a[132:135], a[56:59], v[96:99]
    ds_read_b128 a[128:131], v4 offset:0
    v_cvt_pk_bf16_f32 v117, v122, v123
    v_mfma_f32_16x16x32_bf16 v[96:99], a[136:139], a[60:63], v[96:99]
    v_exp_f32 v124, v124
    v_mfma_f32_16x16x32_bf16 v[96:99], a[140:143], a[64:67], v[96:99]
    ds_read_b128 a[132:135], v5 offset:0
    v_cvt_pk_bf16_f32 v81, v154, v155
    v_mfma_f32_16x16x32_bf16 v[100:103], a[144:147], a[64:67], 0
    v_exp_f32 v125, v125
    v_subrev_u32 v26, s28, v26
    v_mov_b32 v21, v20
    v_max_u32 v19, v19, v26
    v_pk_mul_f32 v[160:161], v[160:161], v[20:21]
    v_pk_mul_f32 v[162:163], v[162:163], v[20:21]
    v_pk_mul_f32 v[164:165], v[164:165], v[20:21]
    v_pk_mul_f32 v[166:167], v[166:167], v[20:21]
    v_pk_mul_f32 v[168:169], v[168:169], v[20:21]
    v_pk_mul_f32 v[170:171], v[170:171], v[20:21]
    v_pk_mul_f32 v[172:173], v[172:173], v[20:21]
    v_pk_mul_f32 v[174:175], v[174:175], v[20:21]
    v_pk_mul_f32 v[176:177], v[176:177], v[20:21]
    v_pk_mul_f32 v[178:179], v[178:179], v[20:21]
    v_pk_mul_f32 v[180:181], v[180:181], v[20:21]
    v_pk_mul_f32 v[182:183], v[182:183], v[20:21]
    v_pk_mul_f32 v[184:185], v[184:185], v[20:21]
    v_pk_mul_f32 v[186:187], v[186:187], v[20:21]
    v_pk_mul_f32 v[188:189], v[188:189], v[20:21]
    v_pk_mul_f32 v[190:191], v[190:191], v[20:21]
    v_cvt_pk_bf16_f32 v68, v160, v161
    v_cvt_pk_bf16_f32 v69, v162, v163
    v_cvt_pk_bf16_f32 v70, v164, v165
    v_mfma_f32_16x16x32_bf16 v[100:103], a[148:151], a[60:63], v[100:103]
    ds_read_b128 a[136:139], v6 offset:0
    v_cvt_pk_bf16_f32 v118, v124, v125
    v_mfma_f32_16x16x32_bf16 v[100:103], a[152:155], a[56:59], v[100:103]
    v_exp_f32 v126, v126
    v_mfma_f32_16x16x32_bf16 v[100:103], a[156:159], a[52:55], v[100:103]
    ds_read_b128 a[140:143], v7 offset:0
    v_cvt_pk_bf16_f32 v82, v156, v157
    v_mfma_f32_16x16x32_bf16 v[104:107], a[160:163], a[52:55], 0
    v_exp_f32 v127, v127
    v_mfma_f32_16x16x32_bf16 v[104:107], a[164:167], a[56:59], v[104:107]
    ds_read_b128 a[144:147], v7 offset:4096
    v_cvt_pk_bf16_f32 v119, v126, v127
    v_mfma_f32_16x16x32_bf16 v[104:107], a[168:171], a[60:63], v[104:107]
    v_exp_f32 v96, v96
    v_mfma_f32_16x16x32_bf16 v[104:107], a[172:175], a[64:67], v[104:107]
    ds_read_b128 a[148:151], v6 offset:4096
    v_cvt_pk_bf16_f32 v83, v158, v159
    v_mfma_f32_16x16x32_bf16 v[108:111], a[176:179], a[64:67], 0
    v_exp_f32 v97, v97
    v_mfma_f32_16x16x32_bf16 v[108:111], a[180:183], a[60:63], v[108:111]
    ds_read_b128 a[152:155], v5 offset:4096
    v_cvt_pk_bf16_f32 v96, v96, v97
    v_mfma_f32_16x16x32_bf16 v[108:111], a[184:187], a[56:59], v[108:111]
    v_exp_f32 v98, v98
    v_mfma_f32_16x16x32_bf16 v[108:111], a[188:191], a[52:55], v[108:111]
    ds_read_b128 a[156:159], v4 offset:4096
    v_cvt_pk_bf16_f32 v71, v166, v167
    v_smfmac_f32_16x16x64_bf16 v[28:31], a[120:123], v[112:119], v22
    v_exp_f32 v99, v99
    v_mfma_f32_16x16x32_bf16 v[192:195], a[228:231], v[112:115], v[192:195]
    ds_read_b128 a[160:163], v4 offset:8192
    v_cvt_pk_bf16_f32 v97, v98, v99
    v_mfma_f32_16x16x32_bf16 v[192:195], a[232:235], v[116:119], v[192:195]
    v_exp_f32 v100, v100
    v_mfma_f32_16x16x32_bf16 v[196:199], a[236:239], v[116:119], v[196:199]
    s_mov_b32 s31, 65536
    ds_read_b128 a[164:167], v5 offset:8192
    buffer_store_dwordx4 v[64:67], v16, s[56:59], s31 offen offset:128 sc1
    v_mfma_f32_16x16x32_bf16 v[196:199], a[240:243], v[112:115], v[196:199]
    v_exp_f32 v101, v101
    v_mfma_f32_16x16x32_bf16 v[200:203], a[244:247], v[112:115], v[200:203]
    ds_read_b128 a[168:171], v6 offset:8192
    v_cvt_pk_bf16_f32 v98, v100, v101
    v_mfma_f32_16x16x32_bf16 v[200:203], a[248:251], v[116:119], v[200:203]
    v_exp_f32 v102, v102
    v_mfma_f32_16x16x32_bf16 v[204:207], a[252:255], v[116:119], v[204:207]
    s_mov_b32 s31, 65536
    ds_read_b128 a[172:175], v7 offset:8192
    buffer_store_dwordx4 v[80:83], v16, s[56:59], s31 offen offset:192 sc1
    v_mfma_f32_16x16x32_bf16 v[204:207], a[116:119], v[112:115], v[204:207]
    v_exp_f32 v103, v103
    v_mfma_f32_16x16x32_bf16 v[208:211], a[112:115], v[112:115], v[208:211]
    ds_read_b128 a[176:179], v7 offset:12288
    v_cvt_pk_bf16_f32 v99, v102, v103
    v_mfma_f32_16x16x32_bf16 v[208:211], a[108:111], v[116:119], v[208:211]
    v_exp_f32 v104, v104
    v_mfma_f32_16x16x32_bf16 v[212:215], a[104:107], v[116:119], v[212:215]
    ds_read_b128 a[180:183], v6 offset:12288
    v_cvt_pk_bf16_f32 v60, v168, v169
    v_mfma_f32_16x16x32_bf16 v[212:215], a[100:103], v[112:115], v[212:215]
    v_exp_f32 v105, v105
    v_mfma_f32_16x16x32_bf16 v[216:219], a[96:99], v[112:115], v[216:219]
    ds_read_b128 a[184:187], v5 offset:12288
    v_cvt_pk_bf16_f32 v100, v104, v105
    v_mfma_f32_16x16x32_bf16 v[216:219], a[92:95], v[116:119], v[216:219]
    v_exp_f32 v106, v106
    v_mfma_f32_16x16x32_bf16 v[220:223], a[192:195], v[116:119], v[220:223]
    ds_read_b128 a[188:191], v4 offset:12288
    v_cvt_pk_bf16_f32 v61, v170, v171
    v_mfma_f32_16x16x32_bf16 v[220:223], a[196:199], v[112:115], v[220:223]
    s_waitcnt lgkmcnt(5)
    ds_read_b64_tr_b16 a[200:201], v12 offset:49152
    ds_read_b64_tr_b16 a[202:203], v12 offset:53248
    v_mfma_f32_16x16x32_bf16 v[112:115], a[128:131], a[36:39], 0
    v_exp_f32 v107, v107
    v_mfma_f32_16x16x32_bf16 v[112:115], a[132:135], a[40:43], v[112:115]
    ds_read_b64_tr_b16 a[204:205], v12 offset:57344
    v_cvt_pk_bf16_f32 v101, v106, v107
    v_mfma_f32_16x16x32_bf16 v[112:115], a[136:139], a[44:47], v[112:115]
    v_exp_f32 v108, v108
    v_mfma_f32_16x16x32_bf16 v[112:115], a[140:143], a[48:51], v[112:115]
    ds_read_b64_tr_b16 a[206:207], v12 offset:61440
    ds_read_b64_tr_b16 a[208:209], v12 offset:57352
    v_mfma_f32_16x16x32_bf16 v[116:119], a[144:147], a[48:51], 0
    v_exp_f32 v109, v109
    v_mfma_f32_16x16x32_bf16 v[116:119], a[148:151], a[44:47], v[116:119]
    ds_read_b64_tr_b16 a[210:211], v12 offset:61448
    v_cvt_pk_bf16_f32 v102, v108, v109
    v_mfma_f32_16x16x32_bf16 v[116:119], a[152:155], a[40:43], v[116:119]
    v_exp_f32 v110, v110
    v_mfma_f32_16x16x32_bf16 v[116:119], a[156:159], a[36:39], v[116:119]
    ds_read_b64_tr_b16 a[212:213], v12 offset:49160
    v_cvt_pk_bf16_f32 v62, v172, v173
    v_mfma_f32_16x16x32_bf16 v[120:123], a[160:163], a[36:39], 0
    v_exp_f32 v111, v111
    v_mfma_f32_16x16x32_bf16 v[120:123], a[164:167], a[40:43], v[120:123]
    ds_read_b64_tr_b16 a[214:215], v12 offset:53256
    v_cvt_pk_bf16_f32 v103, v110, v111
    v_mfma_f32_16x16x32_bf16 v[120:123], a[168:171], a[44:47], v[120:123]
    s_waitcnt lgkmcnt(6)
    v_exp_f32 v112, v112
    v_mfma_f32_16x16x32_bf16 v[120:123], a[172:175], a[48:51], v[120:123]
    ds_read_b64_tr_b16 a[216:217], v13 offset:49152
    v_cvt_pk_bf16_f32 v63, v174, v175
    v_mfma_f32_16x16x32_bf16 v[124:127], a[176:179], a[48:51], 0
    v_exp_f32 v113, v113
    v_mfma_f32_16x16x32_bf16 v[124:127], a[180:183], a[44:47], v[124:127]
    ds_read_b64_tr_b16 a[218:219], v13 offset:53248
    v_cvt_pk_bf16_f32 v112, v112, v113
    v_mfma_f32_16x16x32_bf16 v[124:127], a[184:187], a[40:43], v[124:127]
    v_exp_f32 v114, v114
    v_mfma_f32_16x16x32_bf16 v[124:127], a[188:191], a[36:39], v[124:127]
    s_mov_b32 s31, 69632
    ds_read_b64_tr_b16 a[220:221], v13 offset:57344
    buffer_store_dwordx4 v[68:71], v16, s[56:59], s31 offen sc1
    v_smfmac_f32_16x16x64_bf16 v[28:31], a[124:127], v[96:103], v22
    v_exp_f32 v115, v115
    v_mfma_f32_16x16x32_bf16 v[224:227], a[228:231], v[96:99], v[224:227]
    ds_read_b64_tr_b16 a[222:223], v13 offset:61440
    v_cvt_pk_bf16_f32 v113, v114, v115
    v_mfma_f32_16x16x32_bf16 v[224:227], a[232:235], v[100:103], v[224:227]
    v_exp_f32 v116, v116
    v_mfma_f32_16x16x32_bf16 v[228:231], a[236:239], v[100:103], v[228:231]
    s_mov_b32 s31, 69632
    ds_read_b64_tr_b16 a[224:225], v13 offset:57352
    buffer_store_dwordx4 v[60:63], v16, s[56:59], s31 offen offset:64 sc1
    v_mfma_f32_16x16x32_bf16 v[228:231], a[240:243], v[96:99], v[228:231]
    v_exp_f32 v117, v117
    v_mfma_f32_16x16x32_bf16 v[232:235], a[244:247], v[96:99], v[232:235]
    ds_read_b64_tr_b16 a[226:227], v13 offset:61448
    v_cvt_pk_bf16_f32 v114, v116, v117
    v_mfma_f32_16x16x32_bf16 v[232:235], a[248:251], v[100:103], v[232:235]
    v_exp_f32 v118, v118
    v_mfma_f32_16x16x32_bf16 v[236:239], a[252:255], v[100:103], v[236:239]
    ds_read_b64_tr_b16 a[228:229], v13 offset:49160
    v_cvt_pk_bf16_f32 v36, v176, v177
    v_mfma_f32_16x16x32_bf16 v[236:239], a[116:119], v[96:99], v[236:239]
    v_exp_f32 v119, v119
    v_mfma_f32_16x16x32_bf16 v[240:243], a[112:115], v[96:99], v[240:243]
    ds_read_b64_tr_b16 a[230:231], v13 offset:53256
    v_cvt_pk_bf16_f32 v115, v118, v119
    v_mfma_f32_16x16x32_bf16 v[240:243], a[108:111], v[100:103], v[240:243]
    v_exp_f32 v120, v120
    v_mfma_f32_16x16x32_bf16 v[244:247], a[104:107], v[100:103], v[244:247]
    ds_read_b64_tr_b16 a[232:233], v14 offset:49152
    v_cvt_pk_bf16_f32 v37, v178, v179
    v_mfma_f32_16x16x32_bf16 v[244:247], a[100:103], v[96:99], v[244:247]
    v_exp_f32 v121, v121
    v_mfma_f32_16x16x32_bf16 v[248:251], a[96:99], v[96:99], v[248:251]
    ds_read_b64_tr_b16 a[234:235], v14 offset:53248
    v_cvt_pk_bf16_f32 v116, v120, v121
    v_mfma_f32_16x16x32_bf16 v[248:251], a[92:95], v[100:103], v[248:251]
    v_exp_f32 v122, v122
    v_mfma_f32_16x16x32_bf16 v[252:255], a[192:195], v[100:103], v[252:255]
    ds_read_b64_tr_b16 a[236:237], v14 offset:57344
    v_cvt_pk_bf16_f32 v38, v180, v181
    v_mfma_f32_16x16x32_bf16 v[252:255], a[196:199], v[96:99], v[252:255]
    ds_read_b64_tr_b16 a[238:239], v14 offset:61440
    v_cvt_pk_bf16_f32 v39, v182, v183
    v_mfma_f32_16x16x32_bf16 v[96:99], a[128:131], a[52:55], 0
    v_exp_f32 v123, v123
    v_mfma_f32_16x16x32_bf16 v[96:99], a[132:135], a[56:59], v[96:99]
    ds_read_b64_tr_b16 a[240:241], v14 offset:57352
    v_cvt_pk_bf16_f32 v117, v122, v123
    v_mfma_f32_16x16x32_bf16 v[96:99], a[136:139], a[60:63], v[96:99]
    v_exp_f32 v124, v124
    v_mfma_f32_16x16x32_bf16 v[96:99], a[140:143], a[64:67], v[96:99]
    ds_read_b64_tr_b16 a[242:243], v14 offset:61448
    ds_read_b128 a[128:131], v4 offset:16384
    v_mfma_f32_16x16x32_bf16 v[100:103], a[144:147], a[64:67], 0
    v_exp_f32 v125, v125
    v_mfma_f32_16x16x32_bf16 v[100:103], a[148:151], a[60:63], v[100:103]
    ds_read_b64_tr_b16 a[244:245], v14 offset:49160
    v_cvt_pk_bf16_f32 v118, v124, v125
    v_mfma_f32_16x16x32_bf16 v[100:103], a[152:155], a[56:59], v[100:103]
    v_exp_f32 v126, v126
    v_mfma_f32_16x16x32_bf16 v[100:103], a[156:159], a[52:55], v[100:103]
    ds_read_b64_tr_b16 a[246:247], v14 offset:53256
    ds_read_b128 a[132:135], v5 offset:16384
    v_mfma_f32_16x16x32_bf16 v[104:107], a[160:163], a[52:55], 0
    v_exp_f32 v127, v127
    v_mfma_f32_16x16x32_bf16 v[104:107], a[164:167], a[56:59], v[104:107]
    ds_read_b64_tr_b16 a[248:249], v15 offset:49152
    v_cvt_pk_bf16_f32 v119, v126, v127
    v_cvt_pk_bf16_f32 v84, v184, v185
    v_cvt_pk_bf16_f32 v85, v186, v187
    v_cvt_pk_bf16_f32 v86, v188, v189
    v_cvt_pk_bf16_f32 v87, v190, v191
    v_mfma_f32_16x16x32_bf16 v[104:107], a[168:171], a[60:63], v[104:107]
    v_exp_f32 v96, v96
    v_mfma_f32_16x16x32_bf16 v[104:107], a[172:175], a[64:67], v[104:107]
    ds_read_b64_tr_b16 a[250:251], v15 offset:53248
    ds_read_b128 a[136:139], v6 offset:16384
    v_mfma_f32_16x16x32_bf16 v[108:111], a[176:179], a[64:67], 0
    s_mov_b32 s31, 69632
    buffer_store_dwordx4 v[36:39], v16, s[56:59], s31 offen offset:128 sc1
    v_exp_f32 v97, v97
    v_mfma_f32_16x16x32_bf16 v[108:111], a[180:183], a[60:63], v[108:111]
    ds_read_b64_tr_b16 a[252:253], v15 offset:57344
    v_cvt_pk_bf16_f32 v96, v96, v97
    v_mfma_f32_16x16x32_bf16 v[108:111], a[184:187], a[56:59], v[108:111]
    v_exp_f32 v98, v98
    v_mfma_f32_16x16x32_bf16 v[108:111], a[188:191], a[52:55], v[108:111]
    s_mov_b32 s31, 69632
    ds_read_b64_tr_b16 a[254:255], v15 offset:61440
    ds_read_b128 a[140:143], v7 offset:16384
    buffer_store_dwordx4 v[84:87], v16, s[56:59], s31 offen offset:192 sc1
    v_smfmac_f32_16x16x64_bf16 v[28:31], a[120:123], v[112:119], v22
    v_exp_f32 v99, v99
    v_mfma_f32_16x16x32_bf16 v[192:195], a[200:203], v[112:115], v[192:195]
    s_waitcnt lgkmcnt(5)
    ds_read_b64_tr_b16 a[116:117], v15 offset:57352
    v_cvt_pk_bf16_f32 v97, v98, v99
    v_mfma_f32_16x16x32_bf16 v[192:195], a[204:207], v[116:119], v[192:195]
    v_exp_f32 v100, v100
    v_mfma_f32_16x16x32_bf16 v[196:199], a[208:211], v[116:119], v[196:199]
    ds_read_b64_tr_b16 a[118:119], v15 offset:61448
    ds_read_b128 a[144:147], v7 offset:20480
    v_mfma_f32_16x16x32_bf16 v[196:199], a[212:215], v[112:115], v[196:199]
    v_exp_f32 v101, v101
    v_mfma_f32_16x16x32_bf16 v[200:203], a[216:219], v[112:115], v[200:203]
    ds_read_b64_tr_b16 a[112:113], v15 offset:49160
    v_cvt_pk_bf16_f32 v98, v100, v101
    v_mfma_f32_16x16x32_bf16 v[200:203], a[220:223], v[116:119], v[200:203]
    v_exp_f32 v102, v102
    v_mfma_f32_16x16x32_bf16 v[204:207], a[224:227], v[116:119], v[204:207]
    ds_read_b64_tr_b16 a[114:115], v15 offset:53256
    ds_read_b128 a[148:151], v6 offset:20480
    v_mfma_f32_16x16x32_bf16 v[204:207], a[228:231], v[112:115], v[204:207]
    v_exp_f32 v103, v103
    v_mfma_f32_16x16x32_bf16 v[208:211], a[232:235], v[112:115], v[208:211]
    ds_read_b128 a[152:155], v5 offset:20480
    v_cvt_pk_bf16_f32 v99, v102, v103
    v_mfma_f32_16x16x32_bf16 v[208:211], a[236:239], v[116:119], v[208:211]
    v_exp_f32 v104, v104
    v_mfma_f32_16x16x32_bf16 v[212:215], a[240:243], v[116:119], v[212:215]
    ds_read_b128 a[156:159], v4 offset:20480
    ds_read_b128 a[160:163], v4 offset:24576
    v_mfma_f32_16x16x32_bf16 v[212:215], a[244:247], v[112:115], v[212:215]
    s_waitcnt lgkmcnt(8)
    v_exp_f32 v105, v105
    v_mfma_f32_16x16x32_bf16 v[216:219], a[248:251], v[112:115], v[216:219]
    ds_read_b128 a[164:167], v5 offset:24576
    v_cvt_pk_bf16_f32 v100, v104, v105
    v_mfma_f32_16x16x32_bf16 v[216:219], a[252:255], v[116:119], v[216:219]
    s_waitcnt lgkmcnt(6)
    v_exp_f32 v106, v106
    v_add_f32 v28, v28, v29
    v_mfma_f32_16x16x32_bf16 v[220:223], a[116:119], v[116:119], v[220:223]
    s_waitcnt lgkmcnt(5)
    ds_read_b128 a[168:171], v6 offset:24576
    ds_read_b128 a[172:175], v7 offset:24576
    v_mfma_f32_16x16x32_bf16 v[220:223], a[112:115], v[112:115], v[220:223]
    s_waitcnt vmcnt(8)
    ds_read_b128 a[176:179], v7 offset:28672
    ds_read_b128 a[180:183], v6 offset:28672
    v_rcp_f32 v20, v28
    v_mfma_f32_16x16x32_bf16 v[112:115], a[128:131], a[52:55], 0
    s_barrier
    v_exp_f32 v107, v107
    v_mfma_f32_16x16x32_bf16 v[112:115], a[132:135], a[56:59], v[112:115]
    ds_read_b128 a[184:187], v5 offset:28672
    v_cvt_pk_bf16_f32 v101, v106, v107
    v_mfma_f32_16x16x32_bf16 v[112:115], a[136:139], a[60:63], v[112:115]
    v_exp_f32 v108, v108
    v_mfma_f32_16x16x32_bf16 v[112:115], a[140:143], a[64:67], v[112:115]
    ds_read_b128 a[188:191], v4 offset:28672
    ds_read_b64_tr_b16 a[108:109], v12 offset:32768
    v_mfma_f32_16x16x32_bf16 v[116:119], a[144:147], a[64:67], 0
    v_exp_f32 v109, v109
    v_subrev_u32 v28, s28, v28
    v_mov_b32 v21, v20
    v_max_u32 v19, v19, v28
    v_pk_mul_f32 v[192:193], v[192:193], v[20:21]
    v_pk_mul_f32 v[194:195], v[194:195], v[20:21]
    v_pk_mul_f32 v[196:197], v[196:197], v[20:21]
    v_pk_mul_f32 v[198:199], v[198:199], v[20:21]
    v_pk_mul_f32 v[200:201], v[200:201], v[20:21]
    v_pk_mul_f32 v[202:203], v[202:203], v[20:21]
    v_pk_mul_f32 v[204:205], v[204:205], v[20:21]
    v_pk_mul_f32 v[206:207], v[206:207], v[20:21]
    v_pk_mul_f32 v[208:209], v[208:209], v[20:21]
    v_pk_mul_f32 v[210:211], v[210:211], v[20:21]
    v_pk_mul_f32 v[212:213], v[212:213], v[20:21]
    v_pk_mul_f32 v[214:215], v[214:215], v[20:21]
    v_pk_mul_f32 v[216:217], v[216:217], v[20:21]
    v_pk_mul_f32 v[218:219], v[218:219], v[20:21]
    v_pk_mul_f32 v[220:221], v[220:221], v[20:21]
    v_pk_mul_f32 v[222:223], v[222:223], v[20:21]
    v_cvt_pk_bf16_f32 v44, v192, v193
    v_cvt_pk_bf16_f32 v45, v194, v195
    v_cvt_pk_bf16_f32 v46, v196, v197
    s_waitcnt lgkmcnt(0)
    v_mfma_f32_16x16x32_bf16 v[116:119], a[148:151], a[60:63], v[116:119]
    ds_read_b64_tr_b16 a[110:111], v12 offset:36864
    v_cvt_pk_bf16_f32 v102, v108, v109
    v_mfma_f32_16x16x32_bf16 v[116:119], a[152:155], a[56:59], v[116:119]
    v_exp_f32 v110, v110
    v_mfma_f32_16x16x32_bf16 v[116:119], a[156:159], a[52:55], v[116:119]
    ds_read_b64_tr_b16 a[104:105], v12 offset:40960
    ds_read_b64_tr_b16 a[106:107], v12 offset:45056
    v_mfma_f32_16x16x32_bf16 v[120:123], a[160:163], a[52:55], 0
    v_exp_f32 v111, v111
    v_cvt_pk_bf16_f32 v47, v198, v199
    v_mfma_f32_16x16x32_bf16 v[120:123], a[164:167], a[56:59], v[120:123]
    ds_read_b64_tr_b16 a[100:101], v12 offset:40968
    v_cvt_pk_bf16_f32 v103, v110, v111
    v_mfma_f32_16x16x32_bf16 v[120:123], a[168:171], a[60:63], v[120:123]
    v_exp_f32 v112, v112
    v_mfma_f32_16x16x32_bf16 v[120:123], a[172:175], a[64:67], v[120:123]
    ds_read_b64_tr_b16 a[102:103], v12 offset:45064
    ds_read_b64_tr_b16 a[96:97], v12 offset:32776
    v_mfma_f32_16x16x32_bf16 v[124:127], a[176:179], a[64:67], 0
    v_exp_f32 v113, v113
    v_cvt_pk_bf16_f32 v52, v200, v201
    v_cvt_pk_bf16_f32 v53, v202, v203
    v_cvt_pk_bf16_f32 v54, v204, v205
    v_cvt_pk_bf16_f32 v55, v206, v207
    v_mfma_f32_16x16x32_bf16 v[124:127], a[180:183], a[60:63], v[124:127]
    ds_read_b64_tr_b16 a[98:99], v12 offset:36872
    v_cvt_pk_bf16_f32 v112, v112, v113
    v_mfma_f32_16x16x32_bf16 v[124:127], a[184:187], a[56:59], v[124:127]
    s_mov_b32 s31, 73728
    buffer_store_dwordx4 v[44:47], v16, s[56:59], s31 offen sc1
    v_exp_f32 v114, v114
    v_mfma_f32_16x16x32_bf16 v[124:127], a[188:191], a[52:55], v[124:127]
    ds_read_b64_tr_b16 a[92:93], v13 offset:32768
    ds_read_b64_tr_b16 a[94:95], v13 offset:36864
    v_smfmac_f32_16x16x64_bf16 v[28:31], a[124:127], v[96:103], v22
    v_exp_f32 v115, v115
    v_mfma_f32_16x16x32_bf16 v[224:227], a[200:203], v[96:99], v[224:227]
    ds_read_b64_tr_b16 a[192:193], v13 offset:40960
    v_cvt_pk_bf16_f32 v113, v114, v115
    v_mfma_f32_16x16x32_bf16 v[224:227], a[204:207], v[100:103], v[224:227]
    s_mov_b32 s31, 73728
    buffer_store_dwordx4 v[52:55], v16, s[56:59], s31 offen offset:64 sc1
    v_exp_f32 v116, v116
    v_mfma_f32_16x16x32_bf16 v[228:231], a[208:211], v[100:103], v[228:231]
    ds_read_b64_tr_b16 a[194:195], v13 offset:45056
    ds_read_b64_tr_b16 a[196:197], v13 offset:40968
    v_mfma_f32_16x16x32_bf16 v[228:231], a[212:215], v[96:99], v[228:231]
    v_exp_f32 v117, v117
    v_mfma_f32_16x16x32_bf16 v[232:235], a[216:219], v[96:99], v[232:235]
    ds_read_b64_tr_b16 a[198:199], v13 offset:45064
    v_cvt_pk_bf16_f32 v114, v116, v117
    v_mfma_f32_16x16x32_bf16 v[232:235], a[220:223], v[100:103], v[232:235]
    v_exp_f32 v118, v118
    v_mfma_f32_16x16x32_bf16 v[236:239], a[224:227], v[100:103], v[236:239]
    ds_read_b64_tr_b16 a[200:201], v13 offset:32776
    ds_read_b64_tr_b16 a[202:203], v13 offset:36872
    v_mfma_f32_16x16x32_bf16 v[236:239], a[228:231], v[96:99], v[236:239]
    v_exp_f32 v119, v119
    v_mfma_f32_16x16x32_bf16 v[240:243], a[232:235], v[96:99], v[240:243]
    ds_read_b64_tr_b16 a[204:205], v14 offset:32768
    v_cvt_pk_bf16_f32 v115, v118, v119
    v_mfma_f32_16x16x32_bf16 v[240:243], a[236:239], v[100:103], v[240:243]
    v_exp_f32 v120, v120
    v_mfma_f32_16x16x32_bf16 v[244:247], a[240:243], v[100:103], v[244:247]
    ds_read_b64_tr_b16 a[206:207], v14 offset:36864
    ds_read_b64_tr_b16 a[208:209], v14 offset:40960
    v_mfma_f32_16x16x32_bf16 v[244:247], a[244:247], v[96:99], v[244:247]
    v_exp_f32 v121, v121
    v_mfma_f32_16x16x32_bf16 v[248:251], a[248:251], v[96:99], v[248:251]
    ds_read_b64_tr_b16 a[210:211], v14 offset:45056
    v_cvt_pk_bf16_f32 v116, v120, v121
    v_cvt_pk_bf16_f32 v32, v208, v209
    v_cvt_pk_bf16_f32 v33, v210, v211
    v_cvt_pk_bf16_f32 v34, v212, v213
    v_cvt_pk_bf16_f32 v35, v214, v215
    v_mfma_f32_16x16x32_bf16 v[248:251], a[252:255], v[100:103], v[248:251]
    v_exp_f32 v122, v122
    v_mfma_f32_16x16x32_bf16 v[252:255], a[116:119], v[100:103], v[252:255]
    s_mov_b32 s31, 73728
    ds_read_b64_tr_b16 a[212:213], v14 offset:40968
    ds_read_b64_tr_b16 a[214:215], v14 offset:45064
    v_mfma_f32_16x16x32_bf16 v[252:255], a[112:115], v[96:99], v[252:255]
    ds_read_b64_tr_b16 a[216:217], v14 offset:32776
    ds_read_b64_tr_b16 a[218:219], v14 offset:36872
    v_cvt_pk_bf16_f32 v72, v216, v217
    v_cvt_pk_bf16_f32 v73, v218, v219
    v_cvt_pk_bf16_f32 v74, v220, v221
    v_cvt_pk_bf16_f32 v75, v222, v223
    v_exp_f32 v123, v123
    ds_read_b64_tr_b16 a[220:221], v15 offset:32768
    v_cvt_pk_bf16_f32 v117, v122, v123
    buffer_store_dwordx4 v[32:35], v16, s[56:59], s31 offen offset:128 sc1
    v_exp_f32 v124, v124
    ds_read_b64_tr_b16 a[222:223], v15 offset:36864
    ds_read_b64_tr_b16 a[224:225], v15 offset:40960
    v_exp_f32 v125, v125
    s_mov_b32 s31, 73728
    ds_read_b64_tr_b16 a[226:227], v15 offset:45056
    buffer_store_dwordx4 v[72:75], v16, s[56:59], s31 offen offset:192 sc1
    v_cvt_pk_bf16_f32 v118, v124, v125
    v_exp_f32 v126, v126
    ds_read_b64_tr_b16 a[228:229], v15 offset:40968
    ds_read_b64_tr_b16 a[230:231], v15 offset:45064
    v_exp_f32 v127, v127
    ds_read_b64_tr_b16 a[232:233], v15 offset:32776
    v_cvt_pk_bf16_f32 v119, v126, v127
    ds_read_b64_tr_b16 a[234:235], v15 offset:36872
    s_nop 0
    v_smfmac_f32_16x16x64_bf16 v[28:31], a[124:127], v[112:119], v22
    s_waitcnt lgkmcnt(8)
    v_mfma_f32_16x16x32_bf16 v[224:227], a[108:111], v[112:115], v[224:227]
    v_mfma_f32_16x16x32_bf16 v[224:227], a[104:107], v[116:119], v[224:227]
    v_mfma_f32_16x16x32_bf16 v[228:231], a[100:103], v[116:119], v[228:231]
    v_mfma_f32_16x16x32_bf16 v[228:231], a[96:99], v[112:115], v[228:231]
    s_nop 2
    v_add_f32 v30, v30, v31
    v_mfma_f32_16x16x32_bf16 v[232:235], a[92:95], v[112:115], v[232:235]
    v_rcp_f32 v20, v30
    v_mfma_f32_16x16x32_bf16 v[232:235], a[192:195], v[116:119], v[232:235]
    v_subrev_u32 v30, s28, v30
    v_mov_b32 v21, v20
    v_mfma_f32_16x16x32_bf16 v[236:239], a[196:199], v[116:119], v[236:239]
    v_max_u32 v19, v19, v30
    v_cmp_le_u32_e64 s[100:101], s32, v19
    v_mfma_f32_16x16x32_bf16 v[236:239], a[200:203], v[112:115], v[236:239]
    v_mul_f32 v224, v20, v224
    v_mul_f32 v225, v20, v225
    v_mfma_f32_16x16x32_bf16 v[240:243], a[204:207], v[112:115], v[240:243]
    v_mul_f32 v226, v20, v226
    v_mul_f32 v227, v20, v227
    v_mfma_f32_16x16x32_bf16 v[240:243], a[208:211], v[116:119], v[240:243]
    v_mul_f32 v228, v20, v228
    v_mul_f32 v229, v20, v229
    v_mfma_f32_16x16x32_bf16 v[244:247], a[212:215], v[116:119], v[244:247]
    v_mul_f32 v230, v20, v230
    v_mul_f32 v231, v20, v231
    v_mfma_f32_16x16x32_bf16 v[244:247], a[216:219], v[112:115], v[244:247]
    s_waitcnt lgkmcnt(0)
    v_cvt_pk_bf16_f32 v88, v224, v225
    v_cvt_pk_bf16_f32 v89, v226, v227
    v_mfma_f32_16x16x32_bf16 v[248:251], a[220:223], v[112:115], v[248:251]
    v_cvt_pk_bf16_f32 v90, v228, v229
    v_cvt_pk_bf16_f32 v91, v230, v231
    v_mfma_f32_16x16x32_bf16 v[248:251], a[224:227], v[116:119], v[248:251]
    ds_write_b128 v76, v[88:91] offset:0
    v_mfma_f32_16x16x32_bf16 v[252:255], a[228:231], v[116:119], v[252:255]
    s_add_u32 s31, s7, 77824
    v_mfma_f32_16x16x32_bf16 v[252:255], a[232:235], v[112:115], v[252:255]
    v_pk_mul_f32 v[232:233], v[232:233], v[20:21]
    v_pk_mul_f32 v[234:235], v[234:235], v[20:21]
    v_pk_mul_f32 v[236:237], v[236:237], v[20:21]
    v_pk_mul_f32 v[238:239], v[238:239], v[20:21]
    v_cvt_pk_bf16_f32 v40, v232, v233
    v_cvt_pk_bf16_f32 v41, v234, v235
    v_cvt_pk_bf16_f32 v42, v236, v237
    v_cvt_pk_bf16_f32 v43, v238, v239
    ds_write_b128 v78, v[40:43] offset:0
    v_pk_mul_f32 v[240:241], v[240:241], v[20:21]
    v_pk_mul_f32 v[242:243], v[242:243], v[20:21]
    v_pk_mul_f32 v[244:245], v[244:245], v[20:21]
    v_pk_mul_f32 v[246:247], v[246:247], v[20:21]
    v_cvt_pk_bf16_f32 v56, v240, v241
    v_cvt_pk_bf16_f32 v57, v242, v243
    v_cvt_pk_bf16_f32 v58, v244, v245
    v_cvt_pk_bf16_f32 v59, v246, v247
    ds_write_b128 v76, v[56:59] offset:128
    v_pk_mul_f32 v[248:249], v[248:249], v[20:21]
    v_pk_mul_f32 v[250:251], v[250:251], v[20:21]
    v_pk_mul_f32 v[252:253], v[252:253], v[20:21]
    v_pk_mul_f32 v[254:255], v[254:255], v[20:21]
    v_cvt_pk_bf16_f32 v48, v248, v249
    v_cvt_pk_bf16_f32 v49, v250, v251
    v_cvt_pk_bf16_f32 v50, v252, v253
    v_cvt_pk_bf16_f32 v51, v254, v255
    ds_write_b128 v78, v[48:51] offset:128
    ds_read_b128 v[88:91], v77 offset:0
    ds_read_b128 v[40:43], v79 offset:1024
    ds_read_b128 v[56:59], v77 offset:2048
    ds_read_b128 v[48:51], v79 offset:3072
    s_waitcnt lgkmcnt(3)
    buffer_store_dwordx4 v[88:91], v18, s[56:59], s31 offen offset:0 sc1
    s_waitcnt lgkmcnt(2)
    buffer_store_dwordx4 v[40:43], v18, s[56:59], s31 offen offset:1024 sc1
    s_waitcnt lgkmcnt(1)
    buffer_store_dwordx4 v[56:59], v18, s[56:59], s31 offen offset:2048 sc1
    s_waitcnt lgkmcnt(0)
    buffer_store_dwordx4 v[48:51], v18, s[56:59], s31 offen offset:3072 sc1
    s_cmp_lg_u64 s[100:101], 0
    s_cbranch_scc1 Lfb
Ldone:
    s_endpgm
Lfb:
    s_waitcnt vmcnt(0) lgkmcnt(0)
    s_barrier
    v_subrev_u32 v3, s7, v16
    s_lshl_b32 s36, s33, 13
    v_add_u32 v124, s36, v12
    v_add_u32 v125, s36, v13
    v_add_u32 v126, s36, v14
    v_add_u32 v127, s36, v15
    s_add_u32 s36, s36, 98304
    s_add_u32 s37, s36, 4096
    s_mov_b32 s38, 0
Lfb_blk0:
    buffer_load_dwordx4 v[32:35], v16, s[8:11], s38 offen offset:0
    buffer_load_dwordx4 v[36:39], v16, s[8:11], s38 offen offset:64
    buffer_load_dwordx4 v[40:43], v16, s[8:11], s38 offen offset:128
    buffer_load_dwordx4 v[44:47], v16, s[8:11], s38 offen offset:192
    v_mov_b32 v0, 0xff800000
    s_mov_b32 s39, 0
Lfb_max0:
    s_add_u32 s40, s39, 4096
    buffer_load_dwordx4 v[48:51], v3, s[12:15], s39 offen offset:0
    buffer_load_dwordx4 v[52:55], v3, s[12:15], s39 offen offset:64
    buffer_load_dwordx4 v[56:59], v3, s[12:15], s39 offen offset:128
    buffer_load_dwordx4 v[60:63], v3, s[12:15], s39 offen offset:192
    buffer_load_dwordx4 v[64:67], v3, s[12:15], s40 offen offset:0
    buffer_load_dwordx4 v[68:71], v3, s[12:15], s40 offen offset:64
    buffer_load_dwordx4 v[72:75], v3, s[12:15], s40 offen offset:128
    buffer_load_dwordx4 v[76:79], v3, s[12:15], s40 offen offset:192
    s_waitcnt vmcnt(0)
    v_mfma_f32_16x16x32_bf16 v[80:83], v[48:51], v[32:35], 0
    v_mfma_f32_16x16x32_bf16 v[80:83], v[52:55], v[36:39], v[80:83]
    v_mfma_f32_16x16x32_bf16 v[80:83], v[56:59], v[40:43], v[80:83]
    v_mfma_f32_16x16x32_bf16 v[80:83], v[60:63], v[44:47], v[80:83]
    v_mfma_f32_16x16x32_bf16 v[84:87], v[64:67], v[32:35], 0
    v_mfma_f32_16x16x32_bf16 v[84:87], v[68:71], v[36:39], v[84:87]
    v_mfma_f32_16x16x32_bf16 v[84:87], v[72:75], v[40:43], v[84:87]
    v_mfma_f32_16x16x32_bf16 v[84:87], v[76:79], v[44:47], v[84:87]
    s_nop 9
    v_max3_f32 v0, v0, v80, v81
    v_max3_f32 v0, v0, v82, v83
    v_max3_f32 v0, v0, v84, v85
    v_max3_f32 v0, v0, v86, v87
    s_add_u32 s39, s39, 8192
    s_cmp_lt_u32 s39, 131072
    s_cbranch_scc1 Lfb_max0
    v_mov_b32 v2, v0
    s_nop 2
    v_permlane16_swap_b32 v0, v2
    s_nop 2
    v_max_f32 v0, v0, v2
    v_mov_b32 v2, v0
    s_nop 2
    v_permlane32_swap_b32 v0, v2
    s_nop 2
    v_max_f32 v0, v0, v2
    v_mul_f32 v0, s24, v0
    v_mov_b32 v1, 0
    v_mov_b32 v128, 0
    v_mov_b32 v129, 0
    v_mov_b32 v130, 0
    v_mov_b32 v131, 0
    v_mov_b32 v132, 0
    v_mov_b32 v133, 0
    v_mov_b32 v134, 0
    v_mov_b32 v135, 0
    v_mov_b32 v136, 0
    v_mov_b32 v137, 0
    v_mov_b32 v138, 0
    v_mov_b32 v139, 0
    v_mov_b32 v140, 0
    v_mov_b32 v141, 0
    v_mov_b32 v142, 0
    v_mov_b32 v143, 0
    v_mov_b32 v144, 0
    v_mov_b32 v145, 0
    v_mov_b32 v146, 0
    v_mov_b32 v147, 0
    v_mov_b32 v148, 0
    v_mov_b32 v149, 0
    v_mov_b32 v150, 0
    v_mov_b32 v151, 0
    v_mov_b32 v152, 0
    v_mov_b32 v153, 0
    v_mov_b32 v154, 0
    v_mov_b32 v155, 0
    v_mov_b32 v156, 0
    v_mov_b32 v157, 0
    v_mov_b32 v158, 0
    v_mov_b32 v159, 0
    s_mov_b32 s39, 0
Lfb_pv0:
    s_add_u32 s40, s39, 4096
    buffer_load_dwordx4 v[48:51], v3, s[12:15], s39 offen offset:0
    buffer_load_dwordx4 v[52:55], v3, s[12:15], s39 offen offset:64
    buffer_load_dwordx4 v[56:59], v3, s[12:15], s39 offen offset:128
    buffer_load_dwordx4 v[60:63], v3, s[12:15], s39 offen offset:192
    buffer_load_dwordx4 v[64:67], v3, s[12:15], s40 offen offset:0
    buffer_load_dwordx4 v[68:71], v3, s[12:15], s40 offen offset:64
    buffer_load_dwordx4 v[72:75], v3, s[12:15], s40 offen offset:128
    buffer_load_dwordx4 v[76:79], v3, s[12:15], s40 offen offset:192
    s_mov_b32 m0, s36
    s_nop 0
    buffer_load_dwordx4 v18, s[16:19], s39 offen offset:0 lds
    buffer_load_dwordx4 v18, s[16:19], s39 offen offset:1024 lds
    buffer_load_dwordx4 v18, s[16:19], s39 offen offset:2048 lds
    buffer_load_dwordx4 v18, s[16:19], s39 offen offset:3072 lds
    s_mov_b32 m0, s37
    s_nop 0
    buffer_load_dwordx4 v18, s[16:19], s40 offen offset:0 lds
    buffer_load_dwordx4 v18, s[16:19], s40 offen offset:1024 lds
    buffer_load_dwordx4 v18, s[16:19], s40 offen offset:2048 lds
    buffer_load_dwordx4 v18, s[16:19], s40 offen offset:3072 lds
    s_waitcnt vmcnt(0)
    v_mfma_f32_16x16x32_bf16 v[80:83], v[48:51], v[32:35], 0
    v_mfma_f32_16x16x32_bf16 v[80:83], v[52:55], v[36:39], v[80:83]
    v_mfma_f32_16x16x32_bf16 v[80:83], v[56:59], v[40:43], v[80:83]
    v_mfma_f32_16x16x32_bf16 v[80:83], v[60:63], v[44:47], v[80:83]
    v_mfma_f32_16x16x32_bf16 v[84:87], v[64:67], v[32:35], 0
    v_mfma_f32_16x16x32_bf16 v[84:87], v[68:71], v[36:39], v[84:87]
    v_mfma_f32_16x16x32_bf16 v[84:87], v[72:75], v[40:43], v[84:87]
    v_mfma_f32_16x16x32_bf16 v[84:87], v[76:79], v[44:47], v[84:87]
    s_nop 9
    v_fma_f32 v80, v80, s24, -v0
    v_fma_f32 v81, v81, s24, -v0
    v_fma_f32 v82, v82, s24, -v0
    v_fma_f32 v83, v83, s24, -v0
    v_fma_f32 v84, v84, s24, -v0
    v_fma_f32 v85, v85, s24, -v0
    v_fma_f32 v86, v86, s24, -v0
    v_fma_f32 v87, v87, s24, -v0
    v_exp_f32 v80, v80
    v_exp_f32 v81, v81
    v_exp_f32 v82, v82
    v_exp_f32 v83, v83
    v_exp_f32 v84, v84
    v_exp_f32 v85, v85
    v_exp_f32 v86, v86
    v_exp_f32 v87, v87
    s_nop 1
    v_add_f32 v1, v1, v80
    v_add_f32 v1, v1, v81
    v_add_f32 v1, v1, v82
    v_add_f32 v1, v1, v83
    v_add_f32 v1, v1, v84
    v_add_f32 v1, v1, v85
    v_add_f32 v1, v1, v86
    v_add_f32 v1, v1, v87
    v_cvt_pk_bf16_f32 v88, v80, v81
    v_cvt_pk_bf16_f32 v89, v82, v83
    v_cvt_pk_bf16_f32 v90, v84, v85
    v_cvt_pk_bf16_f32 v91, v86, v87
    ds_read_b64_tr_b16 v[92:93], v124 offset:0
    ds_read_b64_tr_b16 v[94:95], v124 offset:4096
    ds_read_b64_tr_b16 v[96:97], v124 offset:8
    ds_read_b64_tr_b16 v[98:99], v124 offset:4104
    ds_read_b64_tr_b16 v[100:101], v125 offset:0
    ds_read_b64_tr_b16 v[102:103], v125 offset:4096
    ds_read_b64_tr_b16 v[104:105], v125 offset:8
    ds_read_b64_tr_b16 v[106:107], v125 offset:4104
    ds_read_b64_tr_b16 v[108:109], v126 offset:0
    ds_read_b64_tr_b16 v[110:111], v126 offset:4096
    ds_read_b64_tr_b16 v[112:113], v126 offset:8
    ds_read_b64_tr_b16 v[114:115], v126 offset:4104
    ds_read_b64_tr_b16 v[116:117], v127 offset:0
    ds_read_b64_tr_b16 v[118:119], v127 offset:4096
    ds_read_b64_tr_b16 v[120:121], v127 offset:8
    ds_read_b64_tr_b16 v[122:123], v127 offset:4104
    s_waitcnt lgkmcnt(0)
    v_mfma_f32_16x16x32_bf16 v[128:131], v[92:95], v[88:91], v[128:131]
    v_mfma_f32_16x16x32_bf16 v[132:135], v[96:99], v[88:91], v[132:135]
    v_mfma_f32_16x16x32_bf16 v[136:139], v[100:103], v[88:91], v[136:139]
    v_mfma_f32_16x16x32_bf16 v[140:143], v[104:107], v[88:91], v[140:143]
    v_mfma_f32_16x16x32_bf16 v[144:147], v[108:111], v[88:91], v[144:147]
    v_mfma_f32_16x16x32_bf16 v[148:151], v[112:115], v[88:91], v[148:151]
    v_mfma_f32_16x16x32_bf16 v[152:155], v[116:119], v[88:91], v[152:155]
    v_mfma_f32_16x16x32_bf16 v[156:159], v[120:123], v[88:91], v[156:159]
    s_add_u32 s39, s39, 8192
    s_cmp_lt_u32 s39, 131072
    s_cbranch_scc1 Lfb_pv0
    s_nop 9
    v_mov_b32 v2, v1
    s_nop 2
    v_permlane16_swap_b32 v1, v2
    s_nop 2
    v_add_f32 v1, v1, v2
    v_mov_b32 v2, v1
    s_nop 2
    v_permlane32_swap_b32 v1, v2
    s_nop 2
    v_add_f32 v1, v1, v2
    v_rcp_f32 v1, v1
    s_nop 1
    v_mul_f32 v128, v1, v128
    v_mul_f32 v129, v1, v129
    v_mul_f32 v130, v1, v130
    v_mul_f32 v131, v1, v131
    v_mul_f32 v132, v1, v132
    v_mul_f32 v133, v1, v133
    v_mul_f32 v134, v1, v134
    v_mul_f32 v135, v1, v135
    v_mul_f32 v136, v1, v136
    v_mul_f32 v137, v1, v137
    v_mul_f32 v138, v1, v138
    v_mul_f32 v139, v1, v139
    v_mul_f32 v140, v1, v140
    v_mul_f32 v141, v1, v141
    v_mul_f32 v142, v1, v142
    v_mul_f32 v143, v1, v143
    v_mul_f32 v144, v1, v144
    v_mul_f32 v145, v1, v145
    v_mul_f32 v146, v1, v146
    v_mul_f32 v147, v1, v147
    v_mul_f32 v148, v1, v148
    v_mul_f32 v149, v1, v149
    v_mul_f32 v150, v1, v150
    v_mul_f32 v151, v1, v151
    v_mul_f32 v152, v1, v152
    v_mul_f32 v153, v1, v153
    v_mul_f32 v154, v1, v154
    v_mul_f32 v155, v1, v155
    v_mul_f32 v156, v1, v156
    v_mul_f32 v157, v1, v157
    v_mul_f32 v158, v1, v158
    v_mul_f32 v159, v1, v159
    v_cvt_pk_bf16_f32 v128, v128, v129
    v_cvt_pk_bf16_f32 v129, v130, v131
    v_cvt_pk_bf16_f32 v130, v132, v133
    v_cvt_pk_bf16_f32 v131, v134, v135
    buffer_store_dwordx4 v[128:131], v16, s[20:23], s38 offen offset:0
    v_cvt_pk_bf16_f32 v136, v136, v137
    v_cvt_pk_bf16_f32 v137, v138, v139
    v_cvt_pk_bf16_f32 v138, v140, v141
    v_cvt_pk_bf16_f32 v139, v142, v143
    buffer_store_dwordx4 v[136:139], v16, s[20:23], s38 offen offset:64
    v_cvt_pk_bf16_f32 v144, v144, v145
    v_cvt_pk_bf16_f32 v145, v146, v147
    v_cvt_pk_bf16_f32 v146, v148, v149
    v_cvt_pk_bf16_f32 v147, v150, v151
    buffer_store_dwordx4 v[144:147], v16, s[20:23], s38 offen offset:128
    v_cvt_pk_bf16_f32 v152, v152, v153
    v_cvt_pk_bf16_f32 v153, v154, v155
    v_cvt_pk_bf16_f32 v154, v156, v157
    v_cvt_pk_bf16_f32 v155, v158, v159
    buffer_store_dwordx4 v[152:155], v16, s[20:23], s38 offen offset:192
    s_waitcnt vmcnt(0)
    s_add_u32 s38, s38, 4096
    s_and_b32 s39, s38, 16384
    s_mul_i32 s39, s39, 3
    s_add_u32 s38, s38, s39
    s_cmp_lt_u32 s38, 65536
    s_cbranch_scc1 Lfb_blk0
    s_mov_b32 s38, 0
Lfb_blk1:
    buffer_load_dwordx4 v[32:35], v16, s[44:47], s38 offen offset:0
    buffer_load_dwordx4 v[36:39], v16, s[44:47], s38 offen offset:64
    buffer_load_dwordx4 v[40:43], v16, s[44:47], s38 offen offset:128
    buffer_load_dwordx4 v[44:47], v16, s[44:47], s38 offen offset:192
    v_mov_b32 v0, 0xff800000
    s_mov_b32 s39, 0
Lfb_max1:
    s_add_u32 s40, s39, 4096
    buffer_load_dwordx4 v[48:51], v3, s[48:51], s39 offen offset:0
    buffer_load_dwordx4 v[52:55], v3, s[48:51], s39 offen offset:64
    buffer_load_dwordx4 v[56:59], v3, s[48:51], s39 offen offset:128
    buffer_load_dwordx4 v[60:63], v3, s[48:51], s39 offen offset:192
    buffer_load_dwordx4 v[64:67], v3, s[48:51], s40 offen offset:0
    buffer_load_dwordx4 v[68:71], v3, s[48:51], s40 offen offset:64
    buffer_load_dwordx4 v[72:75], v3, s[48:51], s40 offen offset:128
    buffer_load_dwordx4 v[76:79], v3, s[48:51], s40 offen offset:192
    s_waitcnt vmcnt(0)
    v_mfma_f32_16x16x32_bf16 v[80:83], v[48:51], v[32:35], 0
    v_mfma_f32_16x16x32_bf16 v[80:83], v[52:55], v[36:39], v[80:83]
    v_mfma_f32_16x16x32_bf16 v[80:83], v[56:59], v[40:43], v[80:83]
    v_mfma_f32_16x16x32_bf16 v[80:83], v[60:63], v[44:47], v[80:83]
    v_mfma_f32_16x16x32_bf16 v[84:87], v[64:67], v[32:35], 0
    v_mfma_f32_16x16x32_bf16 v[84:87], v[68:71], v[36:39], v[84:87]
    v_mfma_f32_16x16x32_bf16 v[84:87], v[72:75], v[40:43], v[84:87]
    v_mfma_f32_16x16x32_bf16 v[84:87], v[76:79], v[44:47], v[84:87]
    s_nop 9
    v_max3_f32 v0, v0, v80, v81
    v_max3_f32 v0, v0, v82, v83
    v_max3_f32 v0, v0, v84, v85
    v_max3_f32 v0, v0, v86, v87
    s_add_u32 s39, s39, 8192
    s_cmp_lt_u32 s39, 131072
    s_cbranch_scc1 Lfb_max1
    v_mov_b32 v2, v0
    s_nop 2
    v_permlane16_swap_b32 v0, v2
    s_nop 2
    v_max_f32 v0, v0, v2
    v_mov_b32 v2, v0
    s_nop 2
    v_permlane32_swap_b32 v0, v2
    s_nop 2
    v_max_f32 v0, v0, v2
    v_mul_f32 v0, s24, v0
    v_mov_b32 v1, 0
    v_mov_b32 v128, 0
    v_mov_b32 v129, 0
    v_mov_b32 v130, 0
    v_mov_b32 v131, 0
    v_mov_b32 v132, 0
    v_mov_b32 v133, 0
    v_mov_b32 v134, 0
    v_mov_b32 v135, 0
    v_mov_b32 v136, 0
    v_mov_b32 v137, 0
    v_mov_b32 v138, 0
    v_mov_b32 v139, 0
    v_mov_b32 v140, 0
    v_mov_b32 v141, 0
    v_mov_b32 v142, 0
    v_mov_b32 v143, 0
    v_mov_b32 v144, 0
    v_mov_b32 v145, 0
    v_mov_b32 v146, 0
    v_mov_b32 v147, 0
    v_mov_b32 v148, 0
    v_mov_b32 v149, 0
    v_mov_b32 v150, 0
    v_mov_b32 v151, 0
    v_mov_b32 v152, 0
    v_mov_b32 v153, 0
    v_mov_b32 v154, 0
    v_mov_b32 v155, 0
    v_mov_b32 v156, 0
    v_mov_b32 v157, 0
    v_mov_b32 v158, 0
    v_mov_b32 v159, 0
    s_mov_b32 s39, 0
Lfb_pv1:
    s_add_u32 s40, s39, 4096
    buffer_load_dwordx4 v[48:51], v3, s[48:51], s39 offen offset:0
    buffer_load_dwordx4 v[52:55], v3, s[48:51], s39 offen offset:64
    buffer_load_dwordx4 v[56:59], v3, s[48:51], s39 offen offset:128
    buffer_load_dwordx4 v[60:63], v3, s[48:51], s39 offen offset:192
    buffer_load_dwordx4 v[64:67], v3, s[48:51], s40 offen offset:0
    buffer_load_dwordx4 v[68:71], v3, s[48:51], s40 offen offset:64
    buffer_load_dwordx4 v[72:75], v3, s[48:51], s40 offen offset:128
    buffer_load_dwordx4 v[76:79], v3, s[48:51], s40 offen offset:192
    s_mov_b32 m0, s36
    s_nop 0
    buffer_load_dwordx4 v18, s[52:55], s39 offen offset:0 lds
    buffer_load_dwordx4 v18, s[52:55], s39 offen offset:1024 lds
    buffer_load_dwordx4 v18, s[52:55], s39 offen offset:2048 lds
    buffer_load_dwordx4 v18, s[52:55], s39 offen offset:3072 lds
    s_mov_b32 m0, s37
    s_nop 0
    buffer_load_dwordx4 v18, s[52:55], s40 offen offset:0 lds
    buffer_load_dwordx4 v18, s[52:55], s40 offen offset:1024 lds
    buffer_load_dwordx4 v18, s[52:55], s40 offen offset:2048 lds
    buffer_load_dwordx4 v18, s[52:55], s40 offen offset:3072 lds
    s_waitcnt vmcnt(0)
    v_mfma_f32_16x16x32_bf16 v[80:83], v[48:51], v[32:35], 0
    v_mfma_f32_16x16x32_bf16 v[80:83], v[52:55], v[36:39], v[80:83]
    v_mfma_f32_16x16x32_bf16 v[80:83], v[56:59], v[40:43], v[80:83]
    v_mfma_f32_16x16x32_bf16 v[80:83], v[60:63], v[44:47], v[80:83]
    v_mfma_f32_16x16x32_bf16 v[84:87], v[64:67], v[32:35], 0
    v_mfma_f32_16x16x32_bf16 v[84:87], v[68:71], v[36:39], v[84:87]
    v_mfma_f32_16x16x32_bf16 v[84:87], v[72:75], v[40:43], v[84:87]
    v_mfma_f32_16x16x32_bf16 v[84:87], v[76:79], v[44:47], v[84:87]
    s_nop 9
    v_fma_f32 v80, v80, s24, -v0
    v_fma_f32 v81, v81, s24, -v0
    v_fma_f32 v82, v82, s24, -v0
    v_fma_f32 v83, v83, s24, -v0
    v_fma_f32 v84, v84, s24, -v0
    v_fma_f32 v85, v85, s24, -v0
    v_fma_f32 v86, v86, s24, -v0
    v_fma_f32 v87, v87, s24, -v0
    v_exp_f32 v80, v80
    v_exp_f32 v81, v81
    v_exp_f32 v82, v82
    v_exp_f32 v83, v83
    v_exp_f32 v84, v84
    v_exp_f32 v85, v85
    v_exp_f32 v86, v86
    v_exp_f32 v87, v87
    s_nop 1
    v_add_f32 v1, v1, v80
    v_add_f32 v1, v1, v81
    v_add_f32 v1, v1, v82
    v_add_f32 v1, v1, v83
    v_add_f32 v1, v1, v84
    v_add_f32 v1, v1, v85
    v_add_f32 v1, v1, v86
    v_add_f32 v1, v1, v87
    v_cvt_pk_bf16_f32 v88, v80, v81
    v_cvt_pk_bf16_f32 v89, v82, v83
    v_cvt_pk_bf16_f32 v90, v84, v85
    v_cvt_pk_bf16_f32 v91, v86, v87
    ds_read_b64_tr_b16 v[92:93], v124 offset:0
    ds_read_b64_tr_b16 v[94:95], v124 offset:4096
    ds_read_b64_tr_b16 v[96:97], v124 offset:8
    ds_read_b64_tr_b16 v[98:99], v124 offset:4104
    ds_read_b64_tr_b16 v[100:101], v125 offset:0
    ds_read_b64_tr_b16 v[102:103], v125 offset:4096
    ds_read_b64_tr_b16 v[104:105], v125 offset:8
    ds_read_b64_tr_b16 v[106:107], v125 offset:4104
    ds_read_b64_tr_b16 v[108:109], v126 offset:0
    ds_read_b64_tr_b16 v[110:111], v126 offset:4096
    ds_read_b64_tr_b16 v[112:113], v126 offset:8
    ds_read_b64_tr_b16 v[114:115], v126 offset:4104
    ds_read_b64_tr_b16 v[116:117], v127 offset:0
    ds_read_b64_tr_b16 v[118:119], v127 offset:4096
    ds_read_b64_tr_b16 v[120:121], v127 offset:8
    ds_read_b64_tr_b16 v[122:123], v127 offset:4104
    s_waitcnt lgkmcnt(0)
    v_mfma_f32_16x16x32_bf16 v[128:131], v[92:95], v[88:91], v[128:131]
    v_mfma_f32_16x16x32_bf16 v[132:135], v[96:99], v[88:91], v[132:135]
    v_mfma_f32_16x16x32_bf16 v[136:139], v[100:103], v[88:91], v[136:139]
    v_mfma_f32_16x16x32_bf16 v[140:143], v[104:107], v[88:91], v[140:143]
    v_mfma_f32_16x16x32_bf16 v[144:147], v[108:111], v[88:91], v[144:147]
    v_mfma_f32_16x16x32_bf16 v[148:151], v[112:115], v[88:91], v[148:151]
    v_mfma_f32_16x16x32_bf16 v[152:155], v[116:119], v[88:91], v[152:155]
    v_mfma_f32_16x16x32_bf16 v[156:159], v[120:123], v[88:91], v[156:159]
    s_add_u32 s39, s39, 8192
    s_cmp_lt_u32 s39, 131072
    s_cbranch_scc1 Lfb_pv1
    s_nop 9
    v_mov_b32 v2, v1
    s_nop 2
    v_permlane16_swap_b32 v1, v2
    s_nop 2
    v_add_f32 v1, v1, v2
    v_mov_b32 v2, v1
    s_nop 2
    v_permlane32_swap_b32 v1, v2
    s_nop 2
    v_add_f32 v1, v1, v2
    v_rcp_f32 v1, v1
    s_nop 1
    v_mul_f32 v128, v1, v128
    v_mul_f32 v129, v1, v129
    v_mul_f32 v130, v1, v130
    v_mul_f32 v131, v1, v131
    v_mul_f32 v132, v1, v132
    v_mul_f32 v133, v1, v133
    v_mul_f32 v134, v1, v134
    v_mul_f32 v135, v1, v135
    v_mul_f32 v136, v1, v136
    v_mul_f32 v137, v1, v137
    v_mul_f32 v138, v1, v138
    v_mul_f32 v139, v1, v139
    v_mul_f32 v140, v1, v140
    v_mul_f32 v141, v1, v141
    v_mul_f32 v142, v1, v142
    v_mul_f32 v143, v1, v143
    v_mul_f32 v144, v1, v144
    v_mul_f32 v145, v1, v145
    v_mul_f32 v146, v1, v146
    v_mul_f32 v147, v1, v147
    v_mul_f32 v148, v1, v148
    v_mul_f32 v149, v1, v149
    v_mul_f32 v150, v1, v150
    v_mul_f32 v151, v1, v151
    v_mul_f32 v152, v1, v152
    v_mul_f32 v153, v1, v153
    v_mul_f32 v154, v1, v154
    v_mul_f32 v155, v1, v155
    v_mul_f32 v156, v1, v156
    v_mul_f32 v157, v1, v157
    v_mul_f32 v158, v1, v158
    v_mul_f32 v159, v1, v159
    v_cvt_pk_bf16_f32 v128, v128, v129
    v_cvt_pk_bf16_f32 v129, v130, v131
    v_cvt_pk_bf16_f32 v130, v132, v133
    v_cvt_pk_bf16_f32 v131, v134, v135
    buffer_store_dwordx4 v[128:131], v16, s[56:59], s38 offen offset:0
    v_cvt_pk_bf16_f32 v136, v136, v137
    v_cvt_pk_bf16_f32 v137, v138, v139
    v_cvt_pk_bf16_f32 v138, v140, v141
    v_cvt_pk_bf16_f32 v139, v142, v143
    buffer_store_dwordx4 v[136:139], v16, s[56:59], s38 offen offset:64
    v_cvt_pk_bf16_f32 v144, v144, v145
    v_cvt_pk_bf16_f32 v145, v146, v147
    v_cvt_pk_bf16_f32 v146, v148, v149
    v_cvt_pk_bf16_f32 v147, v150, v151
    buffer_store_dwordx4 v[144:147], v16, s[56:59], s38 offen offset:128
    v_cvt_pk_bf16_f32 v152, v152, v153
    v_cvt_pk_bf16_f32 v153, v154, v155
    v_cvt_pk_bf16_f32 v154, v156, v157
    v_cvt_pk_bf16_f32 v155, v158, v159
    buffer_store_dwordx4 v[152:155], v16, s[56:59], s38 offen offset:192
    s_waitcnt vmcnt(0)
    s_add_u32 s38, s38, 4096
    s_and_b32 s39, s38, 16384
    s_mul_i32 s39, s39, 3
    s_add_u32 s38, s38, s39
    s_cmp_lt_u32 s38, 131072
    s_cbranch_scc1 Lfb_blk1
Lend:
    s_endpgm
.section .rodata,"a"
.p2align 6
.amdhsa_kernel standalone__gqa_softmax__near_ridge_kernel
  .amdhsa_next_free_vgpr 512
  .amdhsa_next_free_sgpr 102
  .amdhsa_accum_offset 256
  .amdhsa_group_segment_fixed_size 0
  .amdhsa_kernarg_size 48
  .amdhsa_user_sgpr_count 2
  .amdhsa_user_sgpr_kernarg_segment_ptr 1
  .amdhsa_system_sgpr_workgroup_id_x 1
.end_amdhsa_kernel
```
